```python
import torch

def _softmax(x, axis=-1):
    return torch.softmax(x, dim=axis)
def _gelu(x):
    return torch.nn.functional.gelu(x, approximate="tanh")
def _silu(x):
    return torch.nn.functional.silu(x)
def _sigmoid(x):
    return torch.sigmoid(x)
def _layernorm(x, axis=-1, eps=1e-5):
    m = x.mean(dim=axis, keepdim=True)
    v = x.var(dim=axis, keepdim=True, unbiased=False)
    return (x - m) / torch.sqrt(v + eps)
def _scatter_add(tgt, idx, src, axis=0):
    return tgt.clone().index_add_(axis, idx, src)
def _segment_sum(src, seg, n):
    out = torch.zeros((n,) + src.shape[1:], dtype=src.dtype)
    return out.index_add_(0, seg, src)
def _pad(x, pw):
    flat = tuple(v for pair in reversed(pw) for v in pair)
    return torch.nn.functional.pad(x, flat)

kernel_name = 'gated_mix__compressed_kv_cla__dense_activation_mish__prompt'

def setup_inputs():

    _w = (lambda a: (lambda t: t.to(torch.bfloat16) if t.is_floating_point() else t)(torch.as_tensor(a)))
    def _A_setup():
        B, H, Sq, Sk, D, M = 1, 32, 2048, 2048, 128, 640
        Dc = 4 * D
        return {
            "x": _w((lambda *s: torch.randn(*s, dtype=torch.bfloat16) * 0.05)(B, Sq, M)),
            "c_kv": _w((lambda *s: torch.randn(*s, dtype=torch.bfloat16) * 0.4)(B, Sk, Dc)),
            "w_q": _w((lambda *s: torch.randn(*s, dtype=torch.bfloat16) * 6.4)(M, H, D) * (M ** -0.5)),
            "w_uk": _w((lambda *s: torch.randn(*s, dtype=torch.bfloat16) * 6.4)(Dc, H, D) * (Dc ** -0.5)),
            "w_uv": _w((lambda *s: torch.randn(*s, dtype=torch.bfloat16) * 0.4)(Dc, H, D) * (Dc ** -0.5)),
            "w_o": _w((lambda *s: torch.randn(*s, dtype=torch.bfloat16) * 0.4)(H, D, M) * ((H * D) ** -0.5)),
        }
    _A_in = _A_setup()

    def _B_setup():
        B, S, D, F = 1, 2048, 640, 1728
        return {
            "x": _w((lambda *s: torch.randn(*s, dtype=torch.bfloat16) * 0.05)(B, S, D)),
            "w1": _w((lambda *s: torch.randn(*s, dtype=torch.bfloat16) * 12.8)(D, F) * (D ** -0.5)),
            "b1": _w((lambda *s: torch.randn(*s, dtype=torch.bfloat16) * 0.2)(F)),
            "w2": _w((lambda *s: torch.randn(*s, dtype=torch.bfloat16) * 0.05)(F, D) * (F ** -0.5)),
        }
    _B_in = _B_setup()

    return {
        "A_x": _A_in["x"],
        "A_c_kv": _A_in["c_kv"],
        "A_w_q": _A_in["w_q"],
        "A_w_uk": _A_in["w_uk"],
        "A_w_uv": _A_in["w_uv"],
        "A_w_o": _A_in["w_o"],
        "B_x": _B_in["x"],
        "B_w1": _B_in["w1"],
        "B_b1": _B_in["b1"],
        "B_w2": _B_in["w2"],
        "gate_w": _w((lambda *s: torch.randn(*s, dtype=torch.bfloat16) * 0.05)(640) * 16.0),
    }

def reference(A_x, A_c_kv, A_w_q, A_w_uk, A_w_uv, A_w_o, B_x, B_w1, B_b1, B_w2, gate_w):
    def _A_ref(x, c_kv, w_q, w_uk, w_uv, w_o):
        B, Sq, M = x.shape[0], x.shape[1], x.shape[2]
        Sk = c_kv.shape[1]
        H, D = w_q.shape[1], w_q.shape[2]
        q = torch.einsum("bqm,mhd->bhqd", x, w_q)
        k = torch.einsum("bkc,chd->bhkd", c_kv, w_uk)
        v = torch.einsum("bkc,chd->bhkd", c_kv, w_uv)
        scores = torch.einsum("bhqd,bhkd->bhqk", q, k) * (D ** -0.5)
        off = Sk - Sq
        qi = torch.arange(Sq)[:, None]
        kj = torch.arange(Sk)[None, :]
        cmask = kj <= (qi + off)
        scores = torch.where(cmask[None, None], scores, -1e9)
        p = _softmax(scores, axis=-1)
        ctx = torch.einsum("bhqk,bhkd->bhqd", p, v)
        return torch.einsum("bhqd,hdm->bqm", ctx, w_o)

    def _B_ref(x, w1, b1, w2):
        h = torch.einsum("bsd,df->bsf", x, w1) + b1
        sp = torch.log1p(torch.exp(-torch.abs(h))) + torch.where(h > 0, h, torch.zeros_like(h))
        act = h * torch.tanh(sp)
        return torch.einsum("bsf,fd->bsd", act, w2)

    x = A_x
    g = _sigmoid((x * gate_w).sum(-1, keepdims=True))
    a = _A_ref(x, A_c_kv, A_w_q, A_w_uk, A_w_uv, A_w_o)
    b = _B_ref(x, B_w1, B_b1, B_w2)
    return g * a + (1 - g) * b
```

```asm
; @launch grid=(256,1,1) block=(256,1,1) lds=163840
.amdgcn_target "amdgcn-amd-amdhsa--gfx950"
.text
.globl gated_mix__compressed_kv_cla__dense_activation_mish__prompt_kernel
.p2align 8
.type gated_mix__compressed_kv_cla__dense_activation_mish__prompt_kernel,@function
gated_mix__compressed_kv_cla__dense_activation_mish__prompt_kernel:
  s_load_dwordx16 s[64:79], s[0:1], 0
  s_cmp_ge_u32 s2, 256
  s_cbranch_scc1 L_exit
  s_load_dwordx8 s[80:87], s[0:1], 64
  s_load_dwordx4 s[88:91], s[0:1], 96
  v_lshrrev_b32 v29, 6, v0
  v_and_b32 v1, 63, v0
  v_readfirstlane_b32 s38, v29
  v_lshrrev_b32 v40, 3, v1
  v_and_b32 v41, 7, v1
  v_lshrrev_b32 v42, 4, v1
  v_and_b32 v43, 15, v1
  v_lshl_add_u32 v44, v29, 5, v40
  v_xor_b32 v45, v41, v42
  v_lshlrev_b32 v2, 10, v44
  v_lshl_add_u32 v2, v45, 4, v2
  v_xor_b32 v3, 64, v2
  v_add_u32 v3, 7168, v3
  v_add_u32 v4, 14336, v2
  v_add_u32 v5, 14336, v3
  s_lshr_b32 s37, s2, 5
  s_add_u32 s3, s2, s37
  s_and_b32 s3, s3, 7
  s_lshl_b32 s43, s3, 19
  s_lshl_b32 s3, s3, 7
  s_lshl_b32 s46, s37, 18
  s_add_u32 s46, s46, s3
  s_mov_b32 s11, 0x20000
  s_add_u32 s47, s46, s11
  s_mov_b32 s10, 2097152
  s_lshl_b32 s41, s38, 12
  s_and_b32 s3, s2, 7
  s_lshl_b32 s3, s3, 2
  s_lshr_b32 s3, 0x76543210, s3
  s_and_b32 s3, s3, 7
  s_lshl_b32 s3, s3, 2
  s_bfe_u32 s4, s2, 0x20003
  s_add_u32 s36, s3, s4
  v_lshlrev_b32 v6, 1, v42
  v_xor_b32 v6, v6, v43
  v_lshl_add_u32 v29, v29, 4, v42
  v_lshl_add_u32 v6, s36, 4, v6
  v_lshlrev_b32 v29, 13, v29
  v_lshl_add_u32 v6, v6, 4, v29
  v_xor_b32 v8, 128, v6
  v_add_u32 v7, 31744, v6
  v_add_u32 v9, 95232, v8
  v_add_u32 v8, 63488, v8
  s_mov_b32 s14, 4194304
  s_mov_b32 s15, s11
  s_getpc_b64 s[100:101]
L_base:
  s_lshr_b32 s63, s2, 3
  s_lshl_b32 s63, s63, 2
  s_add_u32 s63, s63, s38
  s_lshl_b32 s63, s63, 10
  s_add_u32 s63, s63, L_base-L_base
  v_and_b32 v29, 7, v1
  v_lshl_add_u32 v29, v29, 7, s63
  v_min_u32 v29, L_slowj-L_base-4, v29
  global_load_dword v63, v29, s[100:101]
  s_add_u32 m0, s41, 65536
  s_waitcnt lgkmcnt(0)
  s_mov_b32 s8, s66
  s_and_b32 s9, s67, 0xffff
  buffer_load_dwordx4 v2, s[8:11], s46 offen offset:0 lds
  buffer_load_dwordx4 v3, s[8:11], s46 offen offset:1024 lds
  buffer_load_dwordx4 v4, s[8:11], s46 offen offset:2048 lds
  buffer_load_dwordx4 v5, s[8:11], s46 offen offset:3072 lds
  s_add_u32 m0, m0, 16384
  s_mov_b32 s12, s70
  buffer_load_dwordx4 v2, s[8:11], s47 offen offset:0 lds
  buffer_load_dwordx4 v3, s[8:11], s47 offen offset:1024 lds
  buffer_load_dwordx4 v4, s[8:11], s47 offen offset:2048 lds
  buffer_load_dwordx4 v5, s[8:11], s47 offen offset:3072 lds
  s_mov_b32 m0, s41
  s_and_b32 s13, s71, 0xffff
  buffer_load_dwordx4 v6, s[12:15], s43 offen offset:0 lds
  buffer_load_dwordx4 v7, s[12:15], s43 offen offset:1024 lds
  buffer_load_dwordx4 v8, s[12:15], s43 offen offset:2048 lds
  buffer_load_dwordx4 v9, s[12:15], s43 offen offset:3072 lds
  s_add_u32 m0, m0, 16384
  s_mov_b32 s32, s68
  s_and_b32 s33, s69, 0xffff
  s_mov_b32 s68, s72
  s_and_b32 s69, s73, 0xffff
  s_mov_b32 s70, 4194304
  s_mov_b32 s71, 0x20000
  buffer_load_dwordx4 v6, s[68:71], s43 offen offset:0 lds
  buffer_load_dwordx4 v7, s[68:71], s43 offen offset:1024 lds
  buffer_load_dwordx4 v8, s[68:71], s43 offen offset:2048 lds
  buffer_load_dwordx4 v9, s[68:71], s43 offen offset:3072 lds
  s_add_u32 s46, s46, 128
  s_bitset0_b32 s46, 10
  s_add_u32 s47, s47, 128
  s_bitset0_b32 s47, 10
  s_add_u32 s43, s43, 524288
  s_bitset0_b32 s43, 22
  s_mov_b64 s[0:1], s[100:101]
  v_lshlrev_b32 v0, 4, v1
  s_and_b32 s39, s38, 1
  s_lshr_b32 s40, s38, 1
  s_mov_b32 s16, s90
  s_and_b32 s17, s91, 0xffff
  s_mov_b32 s18, 150994944
  s_mov_b32 s19, 0x20000
  s_lshl_b32 s3, s37, 14
  s_add_u32 s3, s3, s41
  s_add_u32 s3, s3, 68222976
  s_lshl_b32 s4, s37, 10
  s_add_u32 s4, s4, 68354048
  s_cmp_eq_u32 s36, 31
  s_cselect_b32 s3, s3, 2146435072
  s_cselect_b32 s4, s4, 2146435072
  v_mov_b32 v32, 0
  v_mov_b32 v33, 0
  v_mov_b32 v34, 0
  v_mov_b32 v35, 0
  buffer_store_dwordx4 v[32:35], v0, s[16:19], s3 offen offset:0 sc1
  buffer_store_dwordx4 v[32:35], v0, s[16:19], s3 offen offset:1024 sc1
  buffer_store_dwordx4 v[32:35], v0, s[16:19], s3 offen offset:2048 sc1
  buffer_store_dwordx4 v[32:35], v0, s[16:19], s3 offen offset:3072 sc1
  buffer_store_dwordx4 v[32:35], v0, s[16:19], s4 offen sc1
  s_lshl_b32 s3, s36, 10
  s_lshl_b32 s4, s37, 7
  s_add_u32 s3, s3, s4
  s_lshl_b32 s4, s38, 2
  s_add_u32 s3, s3, s4
  s_add_u32 s55, s3, 68222976
  s_mov_b32 s20, s88
  s_and_b32 s21, s89, 0xffff
  s_mov_b32 s22, 256
  s_mov_b32 s23, 0x20000
  s_mov_b32 s28, s64
  s_and_b32 s29, s65, 0xffff
  s_mov_b32 s30, 2621440
  s_mov_b32 s31, 0x20000
  s_mov_b32 s24, s80
  s_and_b32 s25, s81, 0xffff
  s_mov_b32 s26, 3456
  s_mov_b32 s27, 0x20000
  s_lshl_b32 s3, s36, 7
  s_lshl_b32 s4, s40, 6
  s_add_u32 s3, s3, s4
  v_lshlrev_b32 v29, 3, v42
  buffer_load_dwordx2 v[32:33], v29, s[24:27], s3 offen
  buffer_load_dwordx2 v[36:37], v29, s[24:27], s3 offen offset:32
  v_lshrrev_b32 v29, 1, v43
  v_xor_b32 v29, v29, v42
  v_lshlrev_b32 v29, 4, v29
  v_lshl_add_u32 v29, v43, 7, v29
  s_lshl_b32 s3, s39, 14
  s_lshl_b32 s4, s39, 11
  v_add_u32 v10, s3, v29
  v_xor_b32 v11, 64, v10
  v_add_u32 v27, s4, v29
  v_xor_b32 v28, 64, v27
  v_lshrrev_b32 v46, 2, v43
  v_lshl_add_u32 v47, v42, 3, v46
  v_and_b32 v29, 1, v42
  v_lshl_add_u32 v48, v29, 2, v46
  v_and_b32 v49, 3, v43
  v_lshlrev_b32 v49, 3, v49
  s_lshl_b32 s3, s40, 2
  s_add_u32 s4, s3, 0
  v_xor_b32 v29, s4, v48
  v_lshl_add_u32 v29, v29, 5, v49
  v_lshl_add_u32 v13, v47, 8, v29
  s_add_u32 s4, s3, 1
  v_xor_b32 v29, s4, v48
  v_lshl_add_u32 v29, v29, 5, v49
  v_lshl_add_u32 v14, v47, 8, v29
  s_add_u32 s4, s3, 2
  v_xor_b32 v29, s4, v48
  v_lshl_add_u32 v29, v29, 5, v49
  v_lshl_add_u32 v15, v47, 8, v29
  s_add_u32 s4, s3, 3
  v_xor_b32 v29, s4, v48
  v_lshl_add_u32 v29, v29, 5, v49
  v_lshl_add_u32 v16, v47, 8, v29
  v_and_b32 v29, 1, v42
  v_lshrrev_b32 v48, 3, v43
  v_lshl_add_u32 v48, v29, 1, v48
  s_lshl_b32 s3, s40, 1
  s_add_u32 s4, s3, 0
  v_xor_b32 v29, s4, v48
  v_lshl_add_u32 v29, v29, 5, v49
  v_lshl_add_u32 v17, v47, 7, v29
  s_add_u32 s4, s3, 1
  v_xor_b32 v29, s4, v48
  v_lshl_add_u32 v29, v29, 5, v49
  v_lshl_add_u32 v18, v47, 7, v29
  v_mul_u32_u24 v19, 1280, v44
  v_xor_b32 v29, 0, v45
  v_lshl_add_u32 v19, v29, 4, v19
  v_mul_u32_u24 v20, 1280, v44
  v_xor_b32 v29, 4, v45
  v_lshl_add_u32 v20, v29, 4, v20
  v_add_u32 v20, 9216, v20
  v_mul_u32_u24 v21, 1280, v44
  v_xor_b32 v29, 0, v45
  v_lshl_add_u32 v21, v29, 4, v21
  v_add_u32 v21, 18432, v21
  v_mul_u32_u24 v22, 1280, v44
  v_xor_b32 v29, 4, v45
  v_lshl_add_u32 v22, v29, 4, v22
  v_add_u32 v22, 27648, v22
  s_sub_u32 s3, 15, s37
  s_mul_i32 s49, s3, 163840
  s_mul_i32 s50, s37, 163840
  s_mov_b32 s51, 0
  v_lshrrev_b32 v30, 1, v1
  v_and_b32 v29, 1, v1
  v_lshlrev_b32 v29, 7, v29
  v_mov_b32 v31, 2146435072
  v_mul_u32_u24 v61, 1280, v30
  v_cmp_gt_u32 vcc, 4, v1
  v_add_u32 v61, v61, v29
  v_lshl_add_u32 v62, v30, 13, v29
  v_cndmask_b32 v60, v31, v61, vcc
  v_cmp_gt_u32 vcc, 16, v1
  s_lshl_b32 s3, s2, 2
  s_add_u32 s3, s3, s38
  v_cndmask_b32 v62, v31, v62, vcc
  v_cndmask_b32 v61, v31, v61, vcc
  s_mul_i32 s60, s3, 2560
  s_lshl_b32 s3, s37, 1
  s_add_u32 s3, s3, s39
  s_lshl_b32 s3, s3, 16
  s_lshl_b32 s4, s36, 8
  s_add_u32 s61, s3, s4
  s_mov_b32 s34, 5242880
  s_mov_b32 s35, 0x20000
  s_mov_b32 s62, 0
  s_mov_b32 s88, s78
  s_and_b32 s89, s79, 0xffff
  s_mov_b32 s90, 2211840
  s_mov_b32 s91, 0x20000
  s_mov_b32 s52, 221184
  v_and_b32 v46, 1, v42
  v_lshlrev_b32 v46, 1, v46
  v_xor_b32 v46, v46, v41
  s_mul_i32 s3, s38, 55296
  s_lshl_b32 s4, s36, 7
  s_add_u32 s3, s3, s4
  v_mul_u32_u24 v23, 3456, v40
  v_xor_b32 v29, 0, v46
  v_lshl_add_u32 v23, v29, 4, v23
  s_add_u32 s4, s3, 0
  v_add_u32 v23, s4, v23
  v_mul_u32_u24 v24, 3456, v40
  v_xor_b32 v29, 4, v46
  v_lshl_add_u32 v24, v29, 4, v24
  s_add_u32 s4, s3, 26624
  v_add_u32 v24, s4, v24
  s_mov_b32 s64, s32
  s_mov_b32 s65, s33
  s_mov_b32 s66, s34
  s_mov_b32 s67, 0x20000
  s_mov_b32 s6, 1048576
  s_cmp_lt_u32 s38, 2
  s_cbranch_scc1 L_pfdone_3
  s_mov_b32 s64, s88
  s_mov_b32 s65, s89
  s_mov_b32 s6, 442368
  s_lshl_b32 s3, s36, 7
  s_mul_i32 s61, s37, 55296
  s_add_u32 s61, s61, s3
  v_mul_u32_u24 v62, 3456, v1
  v_cndmask_b32 v62, v31, v62, vcc
  s_cmp_eq_u32 s38, 2
  s_cselect_b32 s66, s90, 0
L_pfdone_3:
  s_cmp_lt_u32 s36, 27
  s_cbranch_scc1 L_wmdone_1
  s_mov_b32 s90, 0
  s_cmp_gt_u32 s36, 27
  s_cbranch_scc1 L_wmdone_1
  s_sub_u32 s88, s84, 4096
  s_subb_u32 s89, s85, 0
  s_and_b32 s89, s89, 0xffff
  s_mov_b32 s90, 5376
  s_mov_b32 s52, 128
  v_and_b32 v47, 1, v40
  v_and_b32 v48, 6, v40
  v_lshlrev_b32 v48, 1, v48
  s_lshl_b32 s3, s38, 5
  v_add_u32 v48, s3, v48
  v_mov_b32 v49, 2146435072
  v_xor_b32 v29, 0, v46
  v_cmp_eq_u32 vcc, v29, v47
  v_add_u32 v29, 4096, v48
  s_nop 0
  v_cndmask_b32 v23, v49, v29, vcc
  v_xor_b32 v29, 4, v46
  v_cmp_eq_u32 vcc, v29, v47
  v_add_u32 v29, 3088, v48
  s_nop 0
  v_cndmask_b32 v24, v49, v29, vcc
L_wmdone_1:
  s_mov_b32 s76, 1699160323
  s_mov_b32 s77, 152
  s_mov_b32 s3, s36
  s_and_b32 s3, s3, 3
  s_cmp_eq_u32 s3, 1
  s_cselect_b32 s76, 1703092544, s76
  s_cselect_b32 s77, 151, s77
  s_cmp_eq_u32 s3, 2
  s_cselect_b32 s76, 1766008080, s76
  s_cselect_b32 s77, 135, s77
  s_cmp_eq_u32 s3, 3
  s_cselect_b32 s76, 1967350288, s76
  s_cselect_b32 s77, 152, s77
  s_mul_i32 s3, s36, 532480
  s_lshl_b32 s4, s37, 16
  s_add_u32 s3, s3, s4
  s_lshl_b32 s4, s39, 15
  s_add_u32 s3, s3, s4
  s_lshl_b32 s4, s40, 11
  s_add_u32 s53, s3, s4
  s_add_u32 s53, s53, 65536
  s_lshl_b32 s4, s40, 12
  s_add_u32 s54, s3, s4
  s_add_u32 s54, s54, 17825792
  s_mov_b32 s96, 0x3e0293ee
  s_lshl_b32 s97, s37, 5
  s_add_u32 s97, s97, s39
  s_lshl_b32 s97, s97, 2
  s_add_u32 s97, s97, 68255744
  s_mov_b32 s5, 4096
  s_lshl_b32 s3, s2, 2
  s_add_u32 s3, s3, s38
  s_mul_hi_u32 s4, s3, 858993460
  s_mul_i32 s95, s4, 5
  s_sub_u32 s3, s3, s95
  s_mul_i32 s95, s4, 40960
  s_lshl_b32 s94, s3, 13
  s_add_u32 s95, s95, s94
  s_add_u32 s95, s95, 59768832
  s_cmp_lt_u32 s4, 182
  s_cselect_b32 s95, s95, 2146435072
  s_cmp_lt_u32 s4, 54
  s_cselect_b32 s24, s82, s74
  s_cselect_b32 s25, s83, s75
  s_mov_b32 s26, 5242880
  s_cselect_b32 s26, 2211840, s26
  s_cselect_b32 s94, 0, 54
  s_and_b32 s25, s25, 0xffff
  s_sub_u32 s4, s4, s94
  s_mul_i32 s94, s4, 40960
  s_lshl_b32 s3, s3, 8
  s_add_u32 s94, s94, s3
  v_lshrrev_b32 v58, 4, v1
  v_and_b32 v56, 15, v1
  v_lshlrev_b32 v57, 1, v58
  v_xor_b32 v56, v56, v57
  v_lshlrev_b32 v56, 4, v56
  v_xor_b32 v57, 128, v56
  v_mul_u32_u24 v58, 1280, v58
  v_add_u32 v56, v56, v58
  v_add3_u32 v57, v57, v58, s5
  v_lshrrev_b32 v29, 2, v1
  v_lshlrev_b32 v58, 8, v29
  v_and_b32 v29, 7, v29
  v_lshl_add_u32 v58, v29, 5, v58
  v_and_b32 v29, 3, v1
  v_lshl_add_u32 v58, v29, 3, v58
  s_lshl_b32 s3, s38, 13
  s_add_u32 s3, s3, 65536
  v_add_u32 v58, s3, v58
  s_mul_i32 s3, s36, 532480
  s_lshl_b32 s4, s39, 13
  s_add_u32 s3, s3, s4
  s_mul_i32 s57, s40, 17760256
  s_add_u32 s3, s3, s57
  s_add_u32 s58, s3, 65536
  s_mov_b32 s56, s58
  s_lshl_b32 s3, s37, 15
  s_sub_u32 s57, s58, s3
  s_add_u32 s57, s57, 524288
  s_lshl_b32 s59, s40, 16
  s_add_u32 s59, s59, s4
  s_mov_b32 s63, s94
  s_lshr_b32 s7, s2, 3
  s_lshl_b32 s7, s7, 2
  s_add_u32 s7, s7, s38
  s_lshl_b32 s7, s7, 7
  s_mov_b32 s44, 98304
  s_add_u32 s42, s41, 32768
  s_mov_b32 s48, 4
  v_add_u32 v12, 65536, v10
  v_add_u32 v25, 65536, v11
  s_waitcnt vmcnt(11)
  s_barrier
  ds_read_b128 a[144:147], v12 offset:0
  ds_read_b128 a[148:151], v25 offset:0
  ds_read_b64_tr_b16 v[176:177], v13 offset:0
  ds_read_b64_tr_b16 v[178:179], v13 offset:1024
  ds_read_b64_tr_b16 v[180:181], v13 offset:8192
  ds_read_b64_tr_b16 v[182:183], v13 offset:9216
  ds_read_b64_tr_b16 v[184:185], v14 offset:0
  ds_read_b64_tr_b16 v[186:187], v14 offset:1024
  ds_read_b64_tr_b16 v[188:189], v14 offset:8192
  ds_read_b64_tr_b16 v[190:191], v14 offset:9216
  ds_read_b64_tr_b16 v[192:193], v15 offset:0
  ds_read_b64_tr_b16 v[194:195], v15 offset:1024
  ds_read_b64_tr_b16 v[196:197], v15 offset:8192
  ds_read_b64_tr_b16 v[198:199], v15 offset:9216
  ds_read_b64_tr_b16 v[200:201], v16 offset:0
  ds_read_b64_tr_b16 v[202:203], v16 offset:1024
  ds_read_b64_tr_b16 v[204:205], v16 offset:8192
  ds_read_b64_tr_b16 v[206:207], v16 offset:9216
  ds_read_b128 a[152:155], v12 offset:2048
  ds_read_b128 a[156:159], v25 offset:2048
  ds_read_b128 a[160:163], v12 offset:4096
  ds_read_b128 a[164:167], v25 offset:4096
  ds_read_b128 a[168:171], v12 offset:6144
  ds_read_b128 a[172:175], v25 offset:6144
  ds_read_b128 a[176:179], v12 offset:8192
  ds_read_b128 a[180:183], v25 offset:8192
  ds_read_b128 a[184:187], v12 offset:10240
  ds_read_b128 a[188:191], v25 offset:10240
  ds_read_b128 a[192:195], v12 offset:12288
  ds_read_b128 a[196:199], v25 offset:12288
  ds_read_b128 a[200:203], v12 offset:14336
  ds_read_b128 a[204:207], v25 offset:14336
  s_waitcnt lgkmcnt(15)
  v_mfma_f32_16x16x32_bf16 v[64:67], v[176:179], a[144:147], 0
  s_add_u32 m0, s41, 98304
  v_mfma_f32_16x16x32_bf16 v[64:67], v[180:183], a[148:151], v[64:67]
  buffer_load_dwordx4 v2, s[8:11], s46 offen offset:0  lds
  v_mfma_f32_16x16x32_bf16 v[68:71], v[188:191], a[148:151], 0
  v_mfma_f32_16x16x32_bf16 v[68:71], v[184:187], a[144:147], v[68:71]
  v_mfma_f32_16x16x32_bf16 v[72:75], v[192:195], a[144:147], 0
  buffer_load_dwordx4 v3, s[8:11], s46 offen offset:1024  lds
  v_mfma_f32_16x16x32_bf16 v[72:75], v[196:199], a[148:151], v[72:75]
  s_waitcnt vmcnt(9) lgkmcnt(0)
  s_barrier
  v_mfma_f32_16x16x32_bf16 v[76:79], v[204:207], a[148:151], 0
  ds_read_b64_tr_b16 v[208:209], v13 offset:16384
  v_mfma_f32_16x16x32_bf16 v[76:79], v[200:203], a[144:147], v[76:79]
  buffer_load_dwordx4 v4, s[8:11], s46 offen offset:2048  lds
  v_mfma_f32_16x16x32_bf16 v[92:95], v[200:203], a[152:155], 0
  v_mfma_f32_16x16x32_bf16 v[92:95], v[204:207], a[156:159], v[92:95]
  ds_read_b64_tr_b16 v[210:211], v13 offset:17408
  v_mfma_f32_16x16x32_bf16 v[88:91], v[196:199], a[156:159], 0
  buffer_load_dwordx4 v5, s[8:11], s46 offen offset:3072  lds
  v_mfma_f32_16x16x32_bf16 v[88:91], v[192:195], a[152:155], v[88:91]
  v_mfma_f32_16x16x32_bf16 v[84:87], v[184:187], a[152:155], 0
  ds_read_b64_tr_b16 v[212:213], v13 offset:24576
  v_mfma_f32_16x16x32_bf16 v[84:87], v[188:191], a[156:159], v[84:87]
  s_add_u32 s46, s46, 128
  v_mfma_f32_16x16x32_bf16 v[80:83], v[180:183], a[156:159], 0
  s_bitset0_b32 s46, 10
  v_mfma_f32_16x16x32_bf16 v[80:83], v[176:179], a[152:155], v[80:83]
  s_add_u32 m0, s41, 114688
  ds_read_b64_tr_b16 v[214:215], v13 offset:25600
  v_mfma_f32_16x16x32_bf16 v[96:99], v[176:179], a[160:163], 0
  v_mfma_f32_16x16x32_bf16 v[96:99], v[180:183], a[164:167], v[96:99]
  buffer_load_dwordx4 v2, s[8:11], s47 offen offset:0  lds
  v_mfma_f32_16x16x32_bf16 v[100:103], v[188:191], a[164:167], 0
  ds_read_b64_tr_b16 v[216:217], v14 offset:16384
  v_mfma_f32_16x16x32_bf16 v[100:103], v[184:187], a[160:163], v[100:103]
  v_mfma_f32_16x16x32_bf16 v[104:107], v[192:195], a[160:163], 0
  buffer_load_dwordx4 v3, s[8:11], s47 offen offset:1024  lds
  v_mfma_f32_16x16x32_bf16 v[104:107], v[196:199], a[164:167], v[104:107]
  ds_read_b64_tr_b16 v[218:219], v14 offset:17408
  v_mfma_f32_16x16x32_bf16 v[108:111], v[204:207], a[164:167], 0
  v_mfma_f32_16x16x32_bf16 v[108:111], v[200:203], a[160:163], v[108:111]
  buffer_load_dwordx4 v4, s[8:11], s47 offen offset:2048  lds
  v_mfma_f32_16x16x32_bf16 v[124:127], v[200:203], a[168:171], 0
  ds_read_b64_tr_b16 v[220:221], v14 offset:24576
  v_mfma_f32_16x16x32_bf16 v[124:127], v[204:207], a[172:175], v[124:127]
  v_mfma_f32_16x16x32_bf16 v[120:123], v[196:199], a[172:175], 0
  buffer_load_dwordx4 v5, s[8:11], s47 offen offset:3072  lds
  v_mfma_f32_16x16x32_bf16 v[120:123], v[192:195], a[168:171], v[120:123]
  ds_read_b64_tr_b16 v[222:223], v14 offset:25600
  v_mfma_f32_16x16x32_bf16 v[116:119], v[184:187], a[168:171], 0
  v_mfma_f32_16x16x32_bf16 v[116:119], v[188:191], a[172:175], v[116:119]
  s_add_u32 s47, s47, 128
  v_mfma_f32_16x16x32_bf16 v[112:115], v[180:183], a[172:175], 0
  s_bitset0_b32 s47, 10
  ds_read_b64_tr_b16 v[224:225], v15 offset:16384
  v_mfma_f32_16x16x32_bf16 v[112:115], v[176:179], a[168:171], v[112:115]
  s_add_u32 m0, s41, 32768
  v_mfma_f32_16x16x32_bf16 v[128:131], v[176:179], a[176:179], 0
  v_mfma_f32_16x16x32_bf16 v[128:131], v[180:183], a[180:183], v[128:131]
  buffer_load_dwordx4 v6, s[12:15], s43 offen offset:0 lds
  v_mfma_f32_16x16x32_bf16 v[132:135], v[188:191], a[180:183], 0
  ds_read_b64_tr_b16 v[226:227], v15 offset:17408
  v_mfma_f32_16x16x32_bf16 v[132:135], v[184:187], a[176:179], v[132:135]
  v_mfma_f32_16x16x32_bf16 v[136:139], v[192:195], a[176:179], 0
  buffer_load_dwordx4 v7, s[12:15], s43 offen offset:1024 lds
  v_mfma_f32_16x16x32_bf16 v[136:139], v[196:199], a[180:183], v[136:139]
  ds_read_b64_tr_b16 v[228:229], v15 offset:24576
  v_mfma_f32_16x16x32_bf16 v[140:143], v[204:207], a[180:183], 0
  v_mfma_f32_16x16x32_bf16 v[140:143], v[200:203], a[176:179], v[140:143]
  buffer_load_dwordx4 v8, s[12:15], s43 offen offset:2048 lds
  v_mfma_f32_16x16x32_bf16 v[156:159], v[200:203], a[184:187], 0
  ds_read_b64_tr_b16 v[230:231], v15 offset:25600
  v_mfma_f32_16x16x32_bf16 v[156:159], v[204:207], a[188:191], v[156:159]
  v_mfma_f32_16x16x32_bf16 v[152:155], v[196:199], a[188:191], 0
  buffer_load_dwordx4 v9, s[12:15], s43 offen offset:3072 lds
  v_mfma_f32_16x16x32_bf16 v[152:155], v[192:195], a[184:187], v[152:155]
  ds_read_b64_tr_b16 v[232:233], v16 offset:16384
  v_mfma_f32_16x16x32_bf16 v[148:151], v[184:187], a[184:187], 0
  v_mfma_f32_16x16x32_bf16 v[148:151], v[188:191], a[188:191], v[148:151]
  s_add_u32 m0, s41, 49152
  ds_read_b64_tr_b16 v[234:235], v16 offset:17408
  v_mfma_f32_16x16x32_bf16 v[144:147], v[180:183], a[188:191], 0
  buffer_load_dwordx4 v6, s[68:71], s43 offen offset:0 lds
  v_mfma_f32_16x16x32_bf16 v[144:147], v[176:179], a[184:187], v[144:147]
  v_mfma_f32_16x16x32_bf16 v[160:163], v[176:179], a[192:195], 0
  ds_read_b64_tr_b16 v[236:237], v16 offset:24576
  v_mfma_f32_16x16x32_bf16 v[160:163], v[180:183], a[196:199], v[160:163]
  buffer_load_dwordx4 v7, s[68:71], s43 offen offset:1024 lds
  v_mfma_f32_16x16x32_bf16 v[164:167], v[188:191], a[196:199], 0
  v_mfma_f32_16x16x32_bf16 v[164:167], v[184:187], a[192:195], v[164:167]
  ds_read_b64_tr_b16 v[238:239], v16 offset:25600
  v_mfma_f32_16x16x32_bf16 v[168:171], v[192:195], a[192:195], 0
  buffer_load_dwordx4 v8, s[68:71], s43 offen offset:2048 lds
  v_mfma_f32_16x16x32_bf16 v[168:171], v[196:199], a[196:199], v[168:171]
  v_mfma_f32_16x16x32_bf16 v[172:175], v[204:207], a[196:199], 0
  v_mfma_f32_16x16x32_bf16 v[172:175], v[200:203], a[192:195], v[172:175]
  buffer_load_dwordx4 v9, s[68:71], s43 offen offset:3072 lds
  v_mfma_f32_16x16x32_bf16 a[12:15], v[200:203], a[200:203], 0
  v_mfma_f32_16x16x32_bf16 a[12:15], v[204:207], a[204:207], a[12:15]
  v_mfma_f32_16x16x32_bf16 a[8:11], v[196:199], a[204:207], 0
  s_add_u32 s43, s43, 524288
  v_mfma_f32_16x16x32_bf16 a[8:11], v[192:195], a[200:203], a[8:11]
  s_bitset0_b32 s43, 22
  v_mfma_f32_16x16x32_bf16 a[4:7], v[184:187], a[200:203], 0
  v_mfma_f32_16x16x32_bf16 a[4:7], v[188:191], a[204:207], a[4:7]
  v_mfma_f32_16x16x32_bf16 a[0:3], v[180:183], a[204:207], 0
  v_mfma_f32_16x16x32_bf16 a[0:3], v[176:179], a[200:203], a[0:3]
  s_waitcnt lgkmcnt(4)
  v_mfma_f32_16x16x32_bf16 a[16:19], a[144:147], v[208:211], 0
  v_add_u32 v12, 98304, v10
  v_add_u32 v25, 98304, v11
  v_mfma_f32_16x16x32_bf16 a[16:19], a[148:151], v[212:215], a[16:19]
  v_mfma_f32_16x16x32_bf16 a[24:27], a[148:151], v[220:223], 0
  v_mfma_f32_16x16x32_bf16 a[24:27], a[144:147], v[216:219], a[24:27]
  v_mfma_f32_16x16x32_bf16 a[32:35], a[144:147], v[224:227], 0
  v_mfma_f32_16x16x32_bf16 a[32:35], a[148:151], v[228:231], a[32:35]
  s_waitcnt vmcnt(4) lgkmcnt(0)
  s_barrier
  v_mfma_f32_16x16x32_bf16 a[40:43], a[148:151], v[236:239], 0
  ds_read_b128 a[148:151], v25 offset:0
  s_add_u32 m0, s41, 131072
  v_mfma_f32_16x16x32_bf16 a[40:43], a[144:147], v[232:235], a[40:43]
  ds_read_b128 a[144:147], v12 offset:0
  ds_read_b64_tr_b16 v[176:177], v13 offset:32768
  v_mfma_f32_16x16x32_bf16 a[44:47], a[152:155], v[232:235], 0
  buffer_load_dwordx4 v2, s[8:11], s46 offen offset:0  lds
  v_mfma_f32_16x16x32_bf16 a[44:47], a[156:159], v[236:239], a[44:47]
  buffer_load_dwordx4 v3, s[8:11], s46 offen offset:1024  lds
  v_mfma_f32_16x16x32_bf16 a[36:39], a[156:159], v[228:231], 0
  ds_read_b64_tr_b16 v[178:179], v13 offset:33792
  v_mfma_f32_16x16x32_bf16 a[36:39], a[152:155], v[224:227], a[36:39]
  v_mfma_f32_16x16x32_bf16 a[28:31], a[152:155], v[216:219], 0
  buffer_load_dwordx4 v4, s[8:11], s46 offen offset:2048  lds
  v_mfma_f32_16x16x32_bf16 a[28:31], a[156:159], v[220:223], a[28:31]
  ds_read_b64_tr_b16 v[180:181], v13 offset:40960
  v_mfma_f32_16x16x32_bf16 a[20:23], a[156:159], v[212:215], 0
  ds_read_b128 a[156:159], v25 offset:2048
  v_mfma_f32_16x16x32_bf16 a[20:23], a[152:155], v[208:211], a[20:23]
  ds_read_b128 a[152:155], v12 offset:2048
  ds_read_b64_tr_b16 v[182:183], v13 offset:41984
  v_mfma_f32_16x16x32_bf16 a[48:51], a[160:163], v[208:211], 0
  buffer_load_dwordx4 v5, s[8:11], s46 offen offset:3072  lds
  v_mfma_f32_16x16x32_bf16 a[48:51], a[164:167], v[212:215], a[48:51]
  s_add_u32 s46, s46, 128
  v_mfma_f32_16x16x32_bf16 a[56:59], a[164:167], v[220:223], 0
  ds_read_b64_tr_b16 v[184:185], v14 offset:32768
  v_mfma_f32_16x16x32_bf16 a[56:59], a[160:163], v[216:219], a[56:59]
  s_bitset0_b32 s46, 10
  v_mfma_f32_16x16x32_bf16 a[64:67], a[160:163], v[224:227], 0
  s_add_u32 m0, s41, 147456
  v_mfma_f32_16x16x32_bf16 a[64:67], a[164:167], v[228:231], a[64:67]
  buffer_load_dwordx4 v2, s[8:11], s47 offen offset:0  lds
  v_mfma_f32_16x16x32_bf16 a[72:75], a[164:167], v[236:239], 0
  ds_read_b128 a[164:167], v25 offset:4096
  ds_read_b64_tr_b16 v[186:187], v14 offset:33792
  v_mfma_f32_16x16x32_bf16 a[72:75], a[160:163], v[232:235], a[72:75]
  ds_read_b128 a[160:163], v12 offset:4096
  v_mfma_f32_16x16x32_bf16 a[76:79], a[168:171], v[232:235], 0
  buffer_load_dwordx4 v3, s[8:11], s47 offen offset:1024  lds
  v_mfma_f32_16x16x32_bf16 a[76:79], a[172:175], v[236:239], a[76:79]
  ds_read_b64_tr_b16 v[188:189], v14 offset:40960
  v_mfma_f32_16x16x32_bf16 a[68:71], a[172:175], v[228:231], 0
  buffer_load_dwordx4 v4, s[8:11], s47 offen offset:2048  lds
  v_mfma_f32_16x16x32_bf16 a[68:71], a[168:171], v[224:227], a[68:71]
  ds_read_b64_tr_b16 v[190:191], v14 offset:41984
  v_mfma_f32_16x16x32_bf16 a[60:63], a[168:171], v[216:219], 0
  v_mfma_f32_16x16x32_bf16 a[60:63], a[172:175], v[220:223], a[60:63]
  buffer_load_dwordx4 v5, s[8:11], s47 offen offset:3072  lds
  v_mfma_f32_16x16x32_bf16 a[52:55], a[172:175], v[212:215], 0
  ds_read_b128 a[172:175], v25 offset:6144
  ds_read_b64_tr_b16 v[192:193], v15 offset:32768
  v_mfma_f32_16x16x32_bf16 a[52:55], a[168:171], v[208:211], a[52:55]
  ds_read_b128 a[168:171], v12 offset:6144
  v_mfma_f32_16x16x32_bf16 a[80:83], a[176:179], v[208:211], 0
  s_add_u32 s47, s47, 128
  v_mfma_f32_16x16x32_bf16 a[80:83], a[180:183], v[212:215], a[80:83]
  s_bitset0_b32 s47, 10
  ds_read_b64_tr_b16 v[194:195], v15 offset:33792
  v_mfma_f32_16x16x32_bf16 a[88:91], a[180:183], v[220:223], 0
  s_add_u32 m0, s41, 0
  v_mfma_f32_16x16x32_bf16 a[88:91], a[176:179], v[216:219], a[88:91]
  v_mfma_f32_16x16x32_bf16 a[96:99], a[176:179], v[224:227], 0
  buffer_load_dwordx4 v6, s[12:15], s43 offen offset:0 lds
  v_mfma_f32_16x16x32_bf16 a[96:99], a[180:183], v[228:231], a[96:99]
  ds_read_b64_tr_b16 v[196:197], v15 offset:40960
  v_mfma_f32_16x16x32_bf16 a[104:107], a[180:183], v[236:239], 0
  ds_read_b128 a[180:183], v25 offset:8192
  v_mfma_f32_16x16x32_bf16 a[104:107], a[176:179], v[232:235], a[104:107]
  ds_read_b128 a[176:179], v12 offset:8192
  ds_read_b64_tr_b16 v[198:199], v15 offset:41984
  v_mfma_f32_16x16x32_bf16 a[108:111], a[184:187], v[232:235], 0
  buffer_load_dwordx4 v7, s[12:15], s43 offen offset:1024 lds
  v_mfma_f32_16x16x32_bf16 a[108:111], a[188:191], v[236:239], a[108:111]
  buffer_load_dwordx4 v8, s[12:15], s43 offen offset:2048 lds
  v_mfma_f32_16x16x32_bf16 a[100:103], a[188:191], v[228:231], 0
  ds_read_b64_tr_b16 v[200:201], v16 offset:32768
  v_mfma_f32_16x16x32_bf16 a[100:103], a[184:187], v[224:227], a[100:103]
  buffer_load_dwordx4 v9, s[12:15], s43 offen offset:3072 lds
  v_mfma_f32_16x16x32_bf16 a[92:95], a[184:187], v[216:219], 0
  v_mfma_f32_16x16x32_bf16 a[92:95], a[188:191], v[220:223], a[92:95]
  ds_read_b64_tr_b16 v[202:203], v16 offset:33792
  v_mfma_f32_16x16x32_bf16 a[84:87], a[188:191], v[212:215], 0
  ds_read_b128 a[188:191], v25 offset:10240
  s_add_u32 m0, s41, 16384
  v_mfma_f32_16x16x32_bf16 a[84:87], a[184:187], v[208:211], a[84:87]
  ds_read_b128 a[184:187], v12 offset:10240
  v_mfma_f32_16x16x32_bf16 a[112:115], a[192:195], v[208:211], 0
  buffer_load_dwordx4 v6, s[68:71], s43 offen offset:0 lds
  v_mfma_f32_16x16x32_bf16 a[112:115], a[196:199], v[212:215], a[112:115]
  ds_read_b64_tr_b16 v[204:205], v16 offset:40960
  v_mfma_f32_16x16x32_bf16 a[120:123], a[196:199], v[220:223], 0
  buffer_load_dwordx4 v7, s[68:71], s43 offen offset:1024 lds
  v_mfma_f32_16x16x32_bf16 a[120:123], a[192:195], v[216:219], a[120:123]
  ds_read_b64_tr_b16 v[206:207], v16 offset:41984
  v_mfma_f32_16x16x32_bf16 a[128:131], a[192:195], v[224:227], 0
  v_mfma_f32_16x16x32_bf16 a[128:131], a[196:199], v[228:231], a[128:131]
  buffer_load_dwordx4 v8, s[68:71], s43 offen offset:2048 lds
  v_mfma_f32_16x16x32_bf16 a[136:139], a[196:199], v[236:239], 0
  ds_read_b128 a[196:199], v25 offset:12288
  v_mfma_f32_16x16x32_bf16 a[136:139], a[192:195], v[232:235], a[136:139]
  ds_read_b128 a[192:195], v12 offset:12288
  v_mfma_f32_16x16x32_bf16 a[140:143], a[200:203], v[232:235], 0
  buffer_load_dwordx4 v9, s[68:71], s43 offen offset:3072 lds
  v_mfma_f32_16x16x32_bf16 a[140:143], a[204:207], v[236:239], a[140:143]
  v_mfma_f32_16x16x32_bf16 a[132:135], a[204:207], v[228:231], 0
  s_add_u32 s43, s43, 524288
  v_mfma_f32_16x16x32_bf16 a[132:135], a[200:203], v[224:227], a[132:135]
  s_bitset0_b32 s43, 22
  v_mfma_f32_16x16x32_bf16 a[124:127], a[200:203], v[216:219], 0
  v_mfma_f32_16x16x32_bf16 a[124:127], a[204:207], v[220:223], a[124:127]
  v_mfma_f32_16x16x32_bf16 a[116:119], a[204:207], v[212:215], 0
  ds_read_b128 a[204:207], v25 offset:14336
  v_mfma_f32_16x16x32_bf16 a[116:119], a[200:203], v[208:211], a[116:119]
  ds_read_b128 a[200:203], v12 offset:14336
  s_waitcnt lgkmcnt(10)
  v_mfma_f32_16x16x32_bf16 v[64:67], v[176:179], a[144:147], v[64:67]
  v_mfma_f32_16x16x32_bf16 v[64:67], v[180:183], a[148:151], v[64:67]
  v_mfma_f32_16x16x32_bf16 v[68:71], v[188:191], a[148:151], v[68:71]
  v_mfma_f32_16x16x32_bf16 v[68:71], v[184:187], a[144:147], v[68:71]
  v_mfma_f32_16x16x32_bf16 v[72:75], v[192:195], a[144:147], v[72:75]
  v_mfma_f32_16x16x32_bf16 v[72:75], v[196:199], a[148:151], v[72:75]
  s_waitcnt vmcnt(16) lgkmcnt(0)
  s_barrier
  v_mfma_f32_16x16x32_bf16 v[76:79], v[204:207], a[148:151], v[76:79]
  s_add_u32 m0, s41, 65536
  ds_read_b64_tr_b16 v[208:209], v13 offset:49152
  v_mfma_f32_16x16x32_bf16 v[76:79], v[200:203], a[144:147], v[76:79]
  buffer_load_dwordx4 v2, s[8:11], s46 offen offset:0  lds
  v_mfma_f32_16x16x32_bf16 v[92:95], v[200:203], a[152:155], v[92:95]
  v_mfma_f32_16x16x32_bf16 v[92:95], v[204:207], a[156:159], v[92:95]
  ds_read_b64_tr_b16 v[210:211], v13 offset:50176
  v_mfma_f32_16x16x32_bf16 v[88:91], v[196:199], a[156:159], v[88:91]
  v_mfma_f32_16x16x32_bf16 v[88:91], v[192:195], a[152:155], v[88:91]
  buffer_load_dwordx4 v3, s[8:11], s46 offen offset:1024  lds
  v_mfma_f32_16x16x32_bf16 v[84:87], v[184:187], a[152:155], v[84:87]
  ds_read_b64_tr_b16 v[212:213], v13 offset:57344
  v_mfma_f32_16x16x32_bf16 v[84:87], v[188:191], a[156:159], v[84:87]
  v_mfma_f32_16x16x32_bf16 v[80:83], v[180:183], a[156:159], v[80:83]
  buffer_load_dwordx4 v4, s[8:11], s46 offen offset:2048  lds
  v_mfma_f32_16x16x32_bf16 v[80:83], v[176:179], a[152:155], v[80:83]
  ds_read_b64_tr_b16 v[214:215], v13 offset:58368
  v_mfma_f32_16x16x32_bf16 v[96:99], v[176:179], a[160:163], v[96:99]
  v_mfma_f32_16x16x32_bf16 v[96:99], v[180:183], a[164:167], v[96:99]
  v_mfma_f32_16x16x32_bf16 v[100:103], v[188:191], a[164:167], v[100:103]
  buffer_load_dwordx4 v5, s[8:11], s46 offen offset:3072  lds
  v_mfma_f32_16x16x32_bf16 v[100:103], v[184:187], a[160:163], v[100:103]
  ds_read_b64_tr_b16 v[216:217], v14 offset:49152
  v_mfma_f32_16x16x32_bf16 v[104:107], v[192:195], a[160:163], v[104:107]
  v_mfma_f32_16x16x32_bf16 v[104:107], v[196:199], a[164:167], v[104:107]
  s_add_u32 s46, s46, 128
  ds_read_b64_tr_b16 v[218:219], v14 offset:50176
  v_mfma_f32_16x16x32_bf16 v[108:111], v[204:207], a[164:167], v[108:111]
  v_mfma_f32_16x16x32_bf16 v[108:111], v[200:203], a[160:163], v[108:111]
  s_bitset0_b32 s46, 10
  v_mfma_f32_16x16x32_bf16 v[124:127], v[200:203], a[168:171], v[124:127]
  ds_read_b64_tr_b16 v[220:221], v14 offset:57344
  v_mfma_f32_16x16x32_bf16 v[124:127], v[204:207], a[172:175], v[124:127]
  s_add_u32 m0, s41, 81920
  v_mfma_f32_16x16x32_bf16 v[120:123], v[196:199], a[172:175], v[120:123]
  v_mfma_f32_16x16x32_bf16 v[120:123], v[192:195], a[168:171], v[120:123]
  buffer_load_dwordx4 v2, s[8:11], s47 offen offset:0  lds
  v_mfma_f32_16x16x32_bf16 v[116:119], v[184:187], a[168:171], v[116:119]
  ds_read_b64_tr_b16 v[222:223], v14 offset:58368
  v_mfma_f32_16x16x32_bf16 v[116:119], v[188:191], a[172:175], v[116:119]
  v_mfma_f32_16x16x32_bf16 v[112:115], v[180:183], a[172:175], v[112:115]
  buffer_load_dwordx4 v3, s[8:11], s47 offen offset:1024  lds
  v_mfma_f32_16x16x32_bf16 v[112:115], v[176:179], a[168:171], v[112:115]
  ds_read_b64_tr_b16 v[224:225], v15 offset:49152
  v_mfma_f32_16x16x32_bf16 v[128:131], v[176:179], a[176:179], v[128:131]
  v_mfma_f32_16x16x32_bf16 v[128:131], v[180:183], a[180:183], v[128:131]
  ds_read_b64_tr_b16 v[226:227], v15 offset:50176
  v_mfma_f32_16x16x32_bf16 v[132:135], v[188:191], a[180:183], v[132:135]
  buffer_load_dwordx4 v4, s[8:11], s47 offen offset:2048  lds
  v_mfma_f32_16x16x32_bf16 v[132:135], v[184:187], a[176:179], v[132:135]
  v_mfma_f32_16x16x32_bf16 v[136:139], v[192:195], a[176:179], v[136:139]
  ds_read_b64_tr_b16 v[228:229], v15 offset:57344
  v_mfma_f32_16x16x32_bf16 v[136:139], v[196:199], a[180:183], v[136:139]
  buffer_load_dwordx4 v5, s[8:11], s47 offen offset:3072  lds
  v_mfma_f32_16x16x32_bf16 v[140:143], v[204:207], a[180:183], v[140:143]
  v_mfma_f32_16x16x32_bf16 v[140:143], v[200:203], a[176:179], v[140:143]
  ds_read_b64_tr_b16 v[230:231], v15 offset:58368
  v_mfma_f32_16x16x32_bf16 v[156:159], v[200:203], a[184:187], v[156:159]
  v_mfma_f32_16x16x32_bf16 v[156:159], v[204:207], a[188:191], v[156:159]
  s_add_u32 s47, s47, 128
  v_mfma_f32_16x16x32_bf16 v[152:155], v[196:199], a[188:191], v[152:155]
  ds_read_b64_tr_b16 v[232:233], v16 offset:49152
  v_mfma_f32_16x16x32_bf16 v[152:155], v[192:195], a[184:187], v[152:155]
  s_bitset0_b32 s47, 10
  v_mfma_f32_16x16x32_bf16 v[148:151], v[184:187], a[184:187], v[148:151]
  v_mfma_f32_16x16x32_bf16 v[148:151], v[188:191], a[188:191], v[148:151]
  s_add_u32 m0, s41, 32768
  ds_read_b64_tr_b16 v[234:235], v16 offset:50176
  v_mfma_f32_16x16x32_bf16 v[144:147], v[180:183], a[188:191], v[144:147]
  buffer_load_dwordx4 v6, s[12:15], s43 offen offset:0 lds
  v_mfma_f32_16x16x32_bf16 v[144:147], v[176:179], a[184:187], v[144:147]
  v_mfma_f32_16x16x32_bf16 v[160:163], v[176:179], a[192:195], v[160:163]
  ds_read_b64_tr_b16 v[236:237], v16 offset:57344
  v_mfma_f32_16x16x32_bf16 v[160:163], v[180:183], a[196:199], v[160:163]
  v_mfma_f32_16x16x32_bf16 v[164:167], v[188:191], a[196:199], v[164:167]
  buffer_load_dwordx4 v7, s[12:15], s43 offen offset:1024 lds
  v_mfma_f32_16x16x32_bf16 v[164:167], v[184:187], a[192:195], v[164:167]
  ds_read_b64_tr_b16 v[238:239], v16 offset:58368
  v_mfma_f32_16x16x32_bf16 v[168:171], v[192:195], a[192:195], v[168:171]
  v_mfma_f32_16x16x32_bf16 v[168:171], v[196:199], a[196:199], v[168:171]
  buffer_load_dwordx4 v8, s[12:15], s43 offen offset:2048 lds
  v_mfma_f32_16x16x32_bf16 v[172:175], v[204:207], a[196:199], v[172:175]
  v_mfma_f32_16x16x32_bf16 v[172:175], v[200:203], a[192:195], v[172:175]
  v_mfma_f32_16x16x32_bf16 a[12:15], v[200:203], a[200:203], a[12:15]
  v_mfma_f32_16x16x32_bf16 a[12:15], v[204:207], a[204:207], a[12:15]
  buffer_load_dwordx4 v9, s[12:15], s43 offen offset:3072 lds
  v_mfma_f32_16x16x32_bf16 a[8:11], v[196:199], a[204:207], a[8:11]
  v_xor_b32 v13, 32768, v13
  v_xor_b32 v14, 32768, v14
  v_mfma_f32_16x16x32_bf16 a[8:11], v[192:195], a[200:203], a[8:11]
  v_xor_b32 v15, 32768, v15
  v_xor_b32 v16, 32768, v16
  v_mfma_f32_16x16x32_bf16 a[4:7], v[184:187], a[200:203], a[4:7]
  v_mfma_f32_16x16x32_bf16 a[4:7], v[188:191], a[204:207], a[4:7]
  v_mfma_f32_16x16x32_bf16 a[0:3], v[180:183], a[204:207], a[0:3]
  v_mfma_f32_16x16x32_bf16 a[0:3], v[176:179], a[200:203], a[0:3]
.p2align 5
L_p1loop:
  s_waitcnt lgkmcnt(4)
  v_mfma_f32_16x16x32_bf16 a[16:19], a[144:147], v[208:211], a[16:19]
  s_add_u32 s45, s44, s41
  s_add_u32 s44, s44, 32768
  v_mfma_f32_16x16x32_bf16 a[16:19], a[148:151], v[212:215], a[16:19]
  s_cmp_eq_u32 s44, 163840
  s_cselect_b32 s44, 65536, s44
  v_mfma_f32_16x16x32_bf16 a[24:27], a[148:151], v[220:223], a[24:27]
  v_add_u32 v12, s44, v10
  v_add_u32 v25, s44, v11
  v_mfma_f32_16x16x32_bf16 a[24:27], a[144:147], v[216:219], a[24:27]
  v_xor_b32 v13, 32768, v13
  v_xor_b32 v14, 32768, v14
  v_mfma_f32_16x16x32_bf16 a[32:35], a[144:147], v[224:227], a[32:35]
  v_xor_b32 v15, 32768, v15
  v_xor_b32 v16, 32768, v16
  v_mfma_f32_16x16x32_bf16 a[32:35], a[148:151], v[228:231], a[32:35]
  s_waitcnt vmcnt(16) lgkmcnt(0)
  s_barrier
  v_mfma_f32_16x16x32_bf16 a[40:43], a[148:151], v[236:239], a[40:43]
  ds_read_b128 a[148:151], v25 offset:0
  ds_read_b64_tr_b16 v[176:177], v13 offset:0
  v_mfma_f32_16x16x32_bf16 a[40:43], a[144:147], v[232:235], a[40:43]
  ds_read_b128 a[144:147], v12 offset:0
  v_mfma_f32_16x16x32_bf16 a[44:47], a[152:155], v[232:235], a[44:47]
  v_mfma_f32_16x16x32_bf16 a[44:47], a[156:159], v[236:239], a[44:47]
  ds_read_b64_tr_b16 v[178:179], v13 offset:1024
  v_mfma_f32_16x16x32_bf16 a[36:39], a[156:159], v[228:231], a[36:39]
  v_mfma_f32_16x16x32_bf16 a[36:39], a[152:155], v[224:227], a[36:39]
  v_mfma_f32_16x16x32_bf16 a[28:31], a[152:155], v[216:219], a[28:31]
  ds_read_b64_tr_b16 v[180:181], v13 offset:8192
  v_mfma_f32_16x16x32_bf16 a[28:31], a[156:159], v[220:223], a[28:31]
  v_mfma_f32_16x16x32_bf16 a[20:23], a[156:159], v[212:215], a[20:23]
  ds_read_b128 a[156:159], v25 offset:2048
  v_mfma_f32_16x16x32_bf16 a[20:23], a[152:155], v[208:211], a[20:23]
  ds_read_b128 a[152:155], v12 offset:2048
  ds_read_b64_tr_b16 v[182:183], v13 offset:9216
  v_mfma_f32_16x16x32_bf16 a[48:51], a[160:163], v[208:211], a[48:51]
  v_mfma_f32_16x16x32_bf16 a[48:51], a[164:167], v[212:215], a[48:51]
  v_mfma_f32_16x16x32_bf16 a[56:59], a[164:167], v[220:223], a[56:59]
  ds_read_b64_tr_b16 v[184:185], v14 offset:0
  v_mfma_f32_16x16x32_bf16 a[56:59], a[160:163], v[216:219], a[56:59]
  v_mfma_f32_16x16x32_bf16 a[64:67], a[160:163], v[224:227], a[64:67]
  v_mfma_f32_16x16x32_bf16 a[64:67], a[164:167], v[228:231], a[64:67]
  ds_read_b64_tr_b16 v[186:187], v14 offset:1024
  v_mfma_f32_16x16x32_bf16 a[72:75], a[164:167], v[236:239], a[72:75]
  ds_read_b128 a[164:167], v25 offset:4096
  v_mfma_f32_16x16x32_bf16 a[72:75], a[160:163], v[232:235], a[72:75]
  ds_read_b128 a[160:163], v12 offset:4096
  v_mfma_f32_16x16x32_bf16 a[76:79], a[168:171], v[232:235], a[76:79]
  ds_read_b64_tr_b16 v[188:189], v14 offset:8192
  v_mfma_f32_16x16x32_bf16 a[76:79], a[172:175], v[236:239], a[76:79]
  v_mfma_f32_16x16x32_bf16 a[68:71], a[172:175], v[228:231], a[68:71]
  s_add_u32 m0, s45, 0
  v_mfma_f32_16x16x32_bf16 a[68:71], a[168:171], v[224:227], a[68:71]
  buffer_load_dwordx4 v2, s[8:11], s46 offen offset:0  lds
  v_mfma_f32_16x16x32_bf16 a[60:63], a[168:171], v[216:219], a[60:63]
  ds_read_b64_tr_b16 v[190:191], v14 offset:9216
  v_mfma_f32_16x16x32_bf16 a[60:63], a[172:175], v[220:223], a[60:63]
  v_mfma_f32_16x16x32_bf16 a[52:55], a[172:175], v[212:215], a[52:55]
  ds_read_b128 a[172:175], v25 offset:6144
  ds_read_b64_tr_b16 v[192:193], v15 offset:0
  v_mfma_f32_16x16x32_bf16 a[52:55], a[168:171], v[208:211], a[52:55]
  ds_read_b128 a[168:171], v12 offset:6144
  v_mfma_f32_16x16x32_bf16 a[80:83], a[176:179], v[208:211], a[80:83]
  buffer_load_dwordx4 v3, s[8:11], s46 offen offset:1024  lds
  v_mfma_f32_16x16x32_bf16 a[80:83], a[180:183], v[212:215], a[80:83]
  ds_read_b64_tr_b16 v[194:195], v15 offset:1024
  v_mfma_f32_16x16x32_bf16 a[88:91], a[180:183], v[220:223], a[88:91]
  buffer_load_dwordx4 v4, s[8:11], s46 offen offset:2048  lds
  v_mfma_f32_16x16x32_bf16 a[88:91], a[176:179], v[216:219], a[88:91]
  v_mfma_f32_16x16x32_bf16 a[96:99], a[176:179], v[224:227], a[96:99]
  ds_read_b64_tr_b16 v[196:197], v15 offset:8192
  v_mfma_f32_16x16x32_bf16 a[96:99], a[180:183], v[228:231], a[96:99]
  buffer_load_dwordx4 v5, s[8:11], s46 offen offset:3072  lds
  v_mfma_f32_16x16x32_bf16 a[104:107], a[180:183], v[236:239], a[104:107]
  ds_read_b128 a[180:183], v25 offset:8192
  v_mfma_f32_16x16x32_bf16 a[104:107], a[176:179], v[232:235], a[104:107]
  ds_read_b128 a[176:179], v12 offset:8192
  ds_read_b64_tr_b16 v[198:199], v15 offset:9216
  v_mfma_f32_16x16x32_bf16 a[108:111], a[184:187], v[232:235], a[108:111]
  s_add_u32 s46, s46, 128
  v_mfma_f32_16x16x32_bf16 a[108:111], a[188:191], v[236:239], a[108:111]
  v_mfma_f32_16x16x32_bf16 a[100:103], a[188:191], v[228:231], a[100:103]
  s_bitset0_b32 s46, 10
  ds_read_b64_tr_b16 v[200:201], v16 offset:0
  v_mfma_f32_16x16x32_bf16 a[100:103], a[184:187], v[224:227], a[100:103]
  s_add_u32 m0, s42, 16384
  v_mfma_f32_16x16x32_bf16 a[92:95], a[184:187], v[216:219], a[92:95]
  v_mfma_f32_16x16x32_bf16 a[92:95], a[188:191], v[220:223], a[92:95]
  buffer_load_dwordx4 v6, s[68:71], s43 offen offset:0 lds
  v_mfma_f32_16x16x32_bf16 a[84:87], a[188:191], v[212:215], a[84:87]
  ds_read_b128 a[188:191], v25 offset:10240
  ds_read_b64_tr_b16 v[202:203], v16 offset:1024
  v_mfma_f32_16x16x32_bf16 a[84:87], a[184:187], v[208:211], a[84:87]
  ds_read_b128 a[184:187], v12 offset:10240
  v_mfma_f32_16x16x32_bf16 a[112:115], a[192:195], v[208:211], a[112:115]
  buffer_load_dwordx4 v7, s[68:71], s43 offen offset:1024 lds
  v_mfma_f32_16x16x32_bf16 a[112:115], a[196:199], v[212:215], a[112:115]
  ds_read_b64_tr_b16 v[204:205], v16 offset:8192
  v_mfma_f32_16x16x32_bf16 a[120:123], a[196:199], v[220:223], a[120:123]
  v_mfma_f32_16x16x32_bf16 a[120:123], a[192:195], v[216:219], a[120:123]
  buffer_load_dwordx4 v8, s[68:71], s43 offen offset:2048 lds
  v_mfma_f32_16x16x32_bf16 a[128:131], a[192:195], v[224:227], a[128:131]
  ds_read_b64_tr_b16 v[206:207], v16 offset:9216
  v_mfma_f32_16x16x32_bf16 a[128:131], a[196:199], v[228:231], a[128:131]
  v_mfma_f32_16x16x32_bf16 a[136:139], a[196:199], v[236:239], a[136:139]
  ds_read_b128 a[196:199], v25 offset:12288
  v_mfma_f32_16x16x32_bf16 a[136:139], a[192:195], v[232:235], a[136:139]
  ds_read_b128 a[192:195], v12 offset:12288
  v_mfma_f32_16x16x32_bf16 a[140:143], a[200:203], v[232:235], a[140:143]
  buffer_load_dwordx4 v9, s[68:71], s43 offen offset:3072 lds
  v_mfma_f32_16x16x32_bf16 a[140:143], a[204:207], v[236:239], a[140:143]
  v_mfma_f32_16x16x32_bf16 a[132:135], a[204:207], v[228:231], a[132:135]
  s_add_u32 s43, s43, 524288
  v_mfma_f32_16x16x32_bf16 a[132:135], a[200:203], v[224:227], a[132:135]
  s_bitset0_b32 s43, 22
  v_mfma_f32_16x16x32_bf16 a[124:127], a[200:203], v[216:219], a[124:127]
  s_sub_u32 s48, s48, 1
  v_mfma_f32_16x16x32_bf16 a[124:127], a[204:207], v[220:223], a[124:127]
  s_xor_b32 s42, s42, 32768
  v_mfma_f32_16x16x32_bf16 a[116:119], a[204:207], v[212:215], a[116:119]
  ds_read_b128 a[204:207], v25 offset:14336
  v_mfma_f32_16x16x32_bf16 a[116:119], a[200:203], v[208:211], a[116:119]
  ds_read_b128 a[200:203], v12 offset:14336
  s_waitcnt lgkmcnt(10)
  v_mfma_f32_16x16x32_bf16 v[64:67], v[176:179], a[144:147], v[64:67]
  v_mfma_f32_16x16x32_bf16 v[64:67], v[180:183], a[148:151], v[64:67]
  v_mfma_f32_16x16x32_bf16 v[68:71], v[188:191], a[148:151], v[68:71]
  v_mfma_f32_16x16x32_bf16 v[68:71], v[184:187], a[144:147], v[68:71]
  v_mfma_f32_16x16x32_bf16 v[72:75], v[192:195], a[144:147], v[72:75]
  v_mfma_f32_16x16x32_bf16 v[72:75], v[196:199], a[148:151], v[72:75]
  s_waitcnt vmcnt(19) lgkmcnt(0)
  s_barrier
  v_mfma_f32_16x16x32_bf16 v[76:79], v[204:207], a[148:151], v[76:79]
  s_add_u32 m0, s45, 16384
  ds_read_b64_tr_b16 v[208:209], v13 offset:16384
  v_mfma_f32_16x16x32_bf16 v[76:79], v[200:203], a[144:147], v[76:79]
  buffer_load_dwordx4 v2, s[8:11], s47 offen offset:0  lds
  v_mfma_f32_16x16x32_bf16 v[92:95], v[200:203], a[152:155], v[92:95]
  v_mfma_f32_16x16x32_bf16 v[92:95], v[204:207], a[156:159], v[92:95]
  ds_read_b64_tr_b16 v[210:211], v13 offset:17408
  v_mfma_f32_16x16x32_bf16 v[88:91], v[196:199], a[156:159], v[88:91]
  buffer_load_dwordx4 v3, s[8:11], s47 offen offset:1024  lds
  v_mfma_f32_16x16x32_bf16 v[88:91], v[192:195], a[152:155], v[88:91]
  v_mfma_f32_16x16x32_bf16 v[84:87], v[184:187], a[152:155], v[84:87]
  ds_read_b64_tr_b16 v[212:213], v13 offset:24576
  v_mfma_f32_16x16x32_bf16 v[84:87], v[188:191], a[156:159], v[84:87]
  buffer_load_dwordx4 v4, s[8:11], s47 offen offset:2048  lds
  v_mfma_f32_16x16x32_bf16 v[80:83], v[180:183], a[156:159], v[80:83]
  v_mfma_f32_16x16x32_bf16 v[80:83], v[176:179], a[152:155], v[80:83]
  ds_read_b64_tr_b16 v[214:215], v13 offset:25600
  v_mfma_f32_16x16x32_bf16 v[96:99], v[176:179], a[160:163], v[96:99]
  buffer_load_dwordx4 v5, s[8:11], s47 offen offset:3072  lds
  v_mfma_f32_16x16x32_bf16 v[96:99], v[180:183], a[164:167], v[96:99]
  v_mfma_f32_16x16x32_bf16 v[100:103], v[188:191], a[164:167], v[100:103]
  ds_read_b64_tr_b16 v[216:217], v14 offset:16384
  v_mfma_f32_16x16x32_bf16 v[100:103], v[184:187], a[160:163], v[100:103]
  s_add_u32 s47, s47, 128
  v_mfma_f32_16x16x32_bf16 v[104:107], v[192:195], a[160:163], v[104:107]
  v_mfma_f32_16x16x32_bf16 v[104:107], v[196:199], a[164:167], v[104:107]
  s_bitset0_b32 s47, 10
  ds_read_b64_tr_b16 v[218:219], v14 offset:17408
  v_mfma_f32_16x16x32_bf16 v[108:111], v[204:207], a[164:167], v[108:111]
  v_mfma_f32_16x16x32_bf16 v[108:111], v[200:203], a[160:163], v[108:111]
  s_add_u32 m0, s42, 0
  v_mfma_f32_16x16x32_bf16 v[124:127], v[200:203], a[168:171], v[124:127]
  buffer_load_dwordx4 v6, s[12:15], s43 offen offset:0 lds
  v_mfma_f32_16x16x32_bf16 v[124:127], v[204:207], a[172:175], v[124:127]
  ds_read_b64_tr_b16 v[220:221], v14 offset:24576
  v_mfma_f32_16x16x32_bf16 v[120:123], v[196:199], a[172:175], v[120:123]
  v_mfma_f32_16x16x32_bf16 v[120:123], v[192:195], a[168:171], v[120:123]
  buffer_load_dwordx4 v7, s[12:15], s43 offen offset:1024 lds
  v_mfma_f32_16x16x32_bf16 v[116:119], v[184:187], a[168:171], v[116:119]
  ds_read_b64_tr_b16 v[222:223], v14 offset:25600
  v_mfma_f32_16x16x32_bf16 v[116:119], v[188:191], a[172:175], v[116:119]
  v_mfma_f32_16x16x32_bf16 v[112:115], v[180:183], a[172:175], v[112:115]
  buffer_load_dwordx4 v8, s[12:15], s43 offen offset:2048 lds
  v_mfma_f32_16x16x32_bf16 v[112:115], v[176:179], a[168:171], v[112:115]
  ds_read_b64_tr_b16 v[224:225], v15 offset:16384
  v_mfma_f32_16x16x32_bf16 v[128:131], v[176:179], a[176:179], v[128:131]
  v_mfma_f32_16x16x32_bf16 v[128:131], v[180:183], a[180:183], v[128:131]
  buffer_load_dwordx4 v9, s[12:15], s43 offen offset:3072 lds
  v_mfma_f32_16x16x32_bf16 v[132:135], v[188:191], a[180:183], v[132:135]
  ds_read_b64_tr_b16 v[226:227], v15 offset:17408
  v_mfma_f32_16x16x32_bf16 v[132:135], v[184:187], a[176:179], v[132:135]
  v_mfma_f32_16x16x32_bf16 v[136:139], v[192:195], a[176:179], v[136:139]
  ds_read_b64_tr_b16 v[228:229], v15 offset:24576
  v_mfma_f32_16x16x32_bf16 v[136:139], v[196:199], a[180:183], v[136:139]
  buffer_load_dword v63, v62, s[64:67], s61 offen
  v_mfma_f32_16x16x32_bf16 v[140:143], v[204:207], a[180:183], v[140:143]
  v_mfma_f32_16x16x32_bf16 v[140:143], v[200:203], a[176:179], v[140:143]
  ds_read_b64_tr_b16 v[230:231], v15 offset:25600
  v_mfma_f32_16x16x32_bf16 v[156:159], v[200:203], a[184:187], v[156:159]
  buffer_load_dword v63, v60, s[28:31], s60 offen
  v_mfma_f32_16x16x32_bf16 v[156:159], v[204:207], a[188:191], v[156:159]
  v_mfma_f32_16x16x32_bf16 v[152:155], v[196:199], a[188:191], v[152:155]
  ds_read_b64_tr_b16 v[232:233], v16 offset:16384
  v_mfma_f32_16x16x32_bf16 v[152:155], v[192:195], a[184:187], v[152:155]
  buffer_load_dword v63, v61, s[24:27], s63 offen
  v_mfma_f32_16x16x32_bf16 v[148:151], v[184:187], a[184:187], v[148:151]
  v_mfma_f32_16x16x32_bf16 v[148:151], v[188:191], a[188:191], v[148:151]
  ds_read_b64_tr_b16 v[234:235], v16 offset:17408
  v_mfma_f32_16x16x32_bf16 v[144:147], v[180:183], a[188:191], v[144:147]
  s_add_u32 s61, s61, s6
  v_mfma_f32_16x16x32_bf16 v[144:147], v[176:179], a[184:187], v[144:147]
  s_add_u32 s60, s60, 256
  v_mfma_f32_16x16x32_bf16 v[160:163], v[176:179], a[192:195], v[160:163]
  ds_read_b64_tr_b16 v[236:237], v16 offset:24576
  v_mfma_f32_16x16x32_bf16 v[160:163], v[180:183], a[196:199], v[160:163]
  s_add_u32 s63, s63, 10240
  v_mfma_f32_16x16x32_bf16 v[164:167], v[188:191], a[196:199], v[164:167]
  v_mfma_f32_16x16x32_bf16 v[164:167], v[184:187], a[192:195], v[164:167]
  ds_read_b64_tr_b16 v[238:239], v16 offset:25600
  v_mfma_f32_16x16x32_bf16 v[168:171], v[192:195], a[192:195], v[168:171]
  v_mfma_f32_16x16x32_bf16 v[168:171], v[196:199], a[196:199], v[168:171]
  v_mfma_f32_16x16x32_bf16 v[172:175], v[204:207], a[196:199], v[172:175]
  v_mfma_f32_16x16x32_bf16 v[172:175], v[200:203], a[192:195], v[172:175]
  v_mfma_f32_16x16x32_bf16 a[12:15], v[200:203], a[200:203], a[12:15]
  v_mfma_f32_16x16x32_bf16 a[12:15], v[204:207], a[204:207], a[12:15]
  v_mfma_f32_16x16x32_bf16 a[8:11], v[196:199], a[204:207], a[8:11]
  v_mfma_f32_16x16x32_bf16 a[8:11], v[192:195], a[200:203], a[8:11]
  v_mfma_f32_16x16x32_bf16 a[4:7], v[184:187], a[200:203], a[4:7]
  v_mfma_f32_16x16x32_bf16 a[4:7], v[188:191], a[204:207], a[4:7]
  v_mfma_f32_16x16x32_bf16 a[0:3], v[180:183], a[204:207], a[0:3]
  s_cmp_lg_u32 s48, 0
  v_mfma_f32_16x16x32_bf16 a[0:3], v[176:179], a[200:203], a[0:3]
  s_cbranch_scc1 L_p1loop
  s_waitcnt lgkmcnt(4)
  v_mfma_f32_16x16x32_bf16 a[16:19], a[144:147], v[208:211], a[16:19]
  v_and_b32 v13, 0x7fff, v13
  v_and_b32 v14, 0x7fff, v14
  v_mfma_f32_16x16x32_bf16 a[16:19], a[148:151], v[212:215], a[16:19]
  v_and_b32 v15, 0x7fff, v15
  v_and_b32 v16, 0x7fff, v16
  v_mfma_f32_16x16x32_bf16 a[24:27], a[148:151], v[220:223], a[24:27]
  v_add_u32 v12, 65536, v10
  v_add_u32 v25, 65536, v11
  v_mfma_f32_16x16x32_bf16 a[24:27], a[144:147], v[216:219], a[24:27]
  v_mfma_f32_16x16x32_bf16 a[32:35], a[144:147], v[224:227], a[32:35]
  v_mfma_f32_16x16x32_bf16 a[32:35], a[148:151], v[228:231], a[32:35]
  s_waitcnt vmcnt(22) lgkmcnt(0)
  s_barrier
  v_mfma_f32_16x16x32_bf16 a[40:43], a[148:151], v[236:239], a[40:43]
  ds_read_b128 a[148:151], v25 offset:0
  ds_read_b64_tr_b16 v[176:177], v13 offset:0
  v_mfma_f32_16x16x32_bf16 a[40:43], a[144:147], v[232:235], a[40:43]
  ds_read_b128 a[144:147], v12 offset:0
  v_mfma_f32_16x16x32_bf16 a[44:47], a[152:155], v[232:235], a[44:47]
  buffer_load_dword v63, v62, s[64:67], s61 offen
  v_mfma_f32_16x16x32_bf16 a[44:47], a[156:159], v[236:239], a[44:47]
  ds_read_b64_tr_b16 v[178:179], v13 offset:1024
  s_sub_u32 s3, 31, s36
  v_mfma_f32_16x16x32_bf16 a[36:39], a[156:159], v[228:231], a[36:39]
  buffer_load_dword v63, v60, s[28:31], s60 offen
  v_mfma_f32_16x16x32_bf16 a[36:39], a[152:155], v[224:227], a[36:39]
  s_lshl_b32 s3, s3, 6
  s_add_u32 s3, s3, s37
  v_mfma_f32_16x16x32_bf16 a[28:31], a[152:155], v[216:219], a[28:31]
  ds_read_b64_tr_b16 v[180:181], v13 offset:8192
  s_lshl_b32 s3, s3, 2
  v_mfma_f32_16x16x32_bf16 a[28:31], a[156:159], v[220:223], a[28:31]
  v_and_b32 v61, 7, v1
  v_lshlrev_b32 v61, 2, v61
  v_mfma_f32_16x16x32_bf16 a[20:23], a[156:159], v[212:215], a[20:23]
  ds_read_b128 a[156:159], v25 offset:2048
  s_add_u32 m0, s41, 131072
  v_mfma_f32_16x16x32_bf16 a[20:23], a[152:155], v[208:211], a[20:23]
  ds_read_b128 a[152:155], v12 offset:2048
  ds_read_b64_tr_b16 v[182:183], v13 offset:9216
  v_mfma_f32_16x16x32_bf16 a[48:51], a[160:163], v[208:211], a[48:51]
  s_bfe_u32 s6, s76, 0x40000
  v_mov_b32 v29, 1
  v_mfma_f32_16x16x32_bf16 a[48:51], a[164:167], v[212:215], a[48:51]
  buffer_store_dword v29, off, s[20:23], s3 sc1
  v_mfma_f32_16x16x32_bf16 a[56:59], a[164:167], v[220:223], a[56:59]
  s_mul_i32 s6, s6, 128
  ds_read_b64_tr_b16 v[184:185], v14 offset:0
  v_mfma_f32_16x16x32_bf16 a[56:59], a[160:163], v[216:219], a[56:59]
  v_mfma_f32_16x16x32_bf16 a[64:67], a[160:163], v[224:227], a[64:67]
  s_add_u32 s6, s6, s49
  v_mfma_f32_16x16x32_bf16 a[64:67], a[164:167], v[228:231], a[64:67]
  ds_read_b64_tr_b16 v[186:187], v14 offset:1024
  v_mfma_f32_16x16x32_bf16 a[72:75], a[164:167], v[236:239], a[72:75]
  ds_read_b128 a[164:167], v25 offset:4096
  v_mfma_f32_16x16x32_bf16 a[72:75], a[160:163], v[232:235], a[72:75]
  ds_read_b128 a[160:163], v12 offset:4096
  v_mfma_f32_16x16x32_bf16 a[76:79], a[168:171], v[232:235], a[76:79]
  buffer_load_dwordx4 v19, s[28:31], s6 offen offset:0 lds
  v_mfma_f32_16x16x32_bf16 a[76:79], a[172:175], v[236:239], a[76:79]
  ds_read_b64_tr_b16 v[188:189], v14 offset:8192
  v_mfma_f32_16x16x32_bf16 a[68:71], a[172:175], v[228:231], a[68:71]
  buffer_load_dwordx4 v20, s[28:31], s6 offen offset:1024 lds
  v_mfma_f32_16x16x32_bf16 a[68:71], a[168:171], v[224:227], a[68:71]
  ds_read_b64_tr_b16 v[190:191], v14 offset:9216
  v_mfma_f32_16x16x32_bf16 a[60:63], a[168:171], v[216:219], a[60:63]
  v_mfma_f32_16x16x32_bf16 a[60:63], a[172:175], v[220:223], a[60:63]
  v_mfma_f32_16x16x32_bf16 a[52:55], a[172:175], v[212:215], a[52:55]
  ds_read_b128 a[172:175], v25 offset:6144
  ds_read_b64_tr_b16 v[192:193], v15 offset:0
  v_mfma_f32_16x16x32_bf16 a[52:55], a[168:171], v[208:211], a[52:55]
  ds_read_b128 a[168:171], v12 offset:6144
  v_mfma_f32_16x16x32_bf16 a[80:83], a[176:179], v[208:211], a[80:83]
  buffer_load_dwordx4 v21, s[28:31], s6 offen offset:2048 lds
  v_mfma_f32_16x16x32_bf16 a[80:83], a[180:183], v[212:215], a[80:83]
  ds_read_b64_tr_b16 v[194:195], v15 offset:1024
  v_mfma_f32_16x16x32_bf16 a[88:91], a[180:183], v[220:223], a[88:91]
  buffer_load_dwordx4 v22, s[28:31], s6 offen offset:3072 lds
  v_mfma_f32_16x16x32_bf16 a[88:91], a[176:179], v[216:219], a[88:91]
  v_mfma_f32_16x16x32_bf16 a[96:99], a[176:179], v[224:227], a[96:99]
  ds_read_b64_tr_b16 v[196:197], v15 offset:8192
  v_mfma_f32_16x16x32_bf16 a[96:99], a[180:183], v[228:231], a[96:99]
  v_mfma_f32_16x16x32_bf16 a[104:107], a[180:183], v[236:239], a[104:107]
  ds_read_b128 a[180:183], v25 offset:8192
  s_add_u32 m0, s41, 49152
  v_mfma_f32_16x16x32_bf16 a[104:107], a[176:179], v[232:235], a[104:107]
  ds_read_b128 a[176:179], v12 offset:8192
  ds_read_b64_tr_b16 v[198:199], v15 offset:9216
  v_mfma_f32_16x16x32_bf16 a[108:111], a[184:187], v[232:235], a[108:111]
  buffer_load_dwordx4 v6, s[68:71], s43 offen offset:0 lds
  v_mfma_f32_16x16x32_bf16 a[108:111], a[188:191], v[236:239], a[108:111]
  v_mfma_f32_16x16x32_bf16 a[100:103], a[188:191], v[228:231], a[100:103]
  ds_read_b64_tr_b16 v[200:201], v16 offset:0
  v_mfma_f32_16x16x32_bf16 a[100:103], a[184:187], v[224:227], a[100:103]
  v_mfma_f32_16x16x32_bf16 a[92:95], a[184:187], v[216:219], a[92:95]
  buffer_load_dwordx4 v7, s[68:71], s43 offen offset:1024 lds
  v_mfma_f32_16x16x32_bf16 a[92:95], a[188:191], v[220:223], a[92:95]
  ds_read_b64_tr_b16 v[202:203], v16 offset:1024
  v_mfma_f32_16x16x32_bf16 a[84:87], a[188:191], v[212:215], a[84:87]
  ds_read_b128 a[188:191], v25 offset:10240
  v_mfma_f32_16x16x32_bf16 a[84:87], a[184:187], v[208:211], a[84:87]
  ds_read_b128 a[184:187], v12 offset:10240
  v_mfma_f32_16x16x32_bf16 a[112:115], a[192:195], v[208:211], a[112:115]
  buffer_load_dwordx4 v8, s[68:71], s43 offen offset:2048 lds
  v_mfma_f32_16x16x32_bf16 a[112:115], a[196:199], v[212:215], a[112:115]
  ds_read_b64_tr_b16 v[204:205], v16 offset:8192
  v_mfma_f32_16x16x32_bf16 a[120:123], a[196:199], v[220:223], a[120:123]
  v_mfma_f32_16x16x32_bf16 a[120:123], a[192:195], v[216:219], a[120:123]
  ds_read_b64_tr_b16 v[206:207], v16 offset:9216
  v_mfma_f32_16x16x32_bf16 a[128:131], a[192:195], v[224:227], a[128:131]
  buffer_load_dwordx4 v9, s[68:71], s43 offen offset:3072 lds
  v_mfma_f32_16x16x32_bf16 a[128:131], a[196:199], v[228:231], a[128:131]
  v_mfma_f32_16x16x32_bf16 a[136:139], a[196:199], v[236:239], a[136:139]
  ds_read_b128 a[196:199], v25 offset:12288
  v_mfma_f32_16x16x32_bf16 a[136:139], a[192:195], v[232:235], a[136:139]
  ds_read_b128 a[192:195], v12 offset:12288
  v_mfma_f32_16x16x32_bf16 a[140:143], a[200:203], v[232:235], a[140:143]
  s_add_u32 s43, s43, 524288
  v_mfma_f32_16x16x32_bf16 a[140:143], a[204:207], v[236:239], a[140:143]
  v_mfma_f32_16x16x32_bf16 a[132:135], a[204:207], v[228:231], a[132:135]
  s_bitset0_b32 s43, 22
  v_mfma_f32_16x16x32_bf16 a[132:135], a[200:203], v[224:227], a[132:135]
  v_mfma_f32_16x16x32_bf16 a[124:127], a[200:203], v[216:219], a[124:127]
  v_mfma_f32_16x16x32_bf16 a[124:127], a[204:207], v[220:223], a[124:127]
  v_mfma_f32_16x16x32_bf16 a[116:119], a[204:207], v[212:215], a[116:119]
  ds_read_b128 a[204:207], v25 offset:14336
  v_mfma_f32_16x16x32_bf16 a[116:119], a[200:203], v[208:211], a[116:119]
  ds_read_b128 a[200:203], v12 offset:14336
  s_waitcnt lgkmcnt(10)
  v_mfma_f32_16x16x32_bf16 v[64:67], v[176:179], a[144:147], v[64:67]
  s_and_b32 s83, s2, 7
  s_lshr_b32 s83, s83, 1
  v_mfma_f32_16x16x32_bf16 v[64:67], v[180:183], a[148:151], v[64:67]
  s_xor_b32 s3, s2, 0
  s_and_b32 s3, s3, 1
  v_mfma_f32_16x16x32_bf16 v[68:71], v[188:191], a[148:151], v[68:71]
  s_lshl_b32 s3, s3, 3
  s_add_u32 s73, s3, s37
  v_mfma_f32_16x16x32_bf16 v[68:71], v[184:187], a[144:147], v[68:71]
  s_and_b32 s74, s36, 3
  s_lshl_b32 s3, s73, 1
  v_mfma_f32_16x16x32_bf16 v[72:75], v[192:195], a[144:147], v[72:75]
  s_add_u32 s3, s3, s39
  s_mul_i32 s3, s3, 745472
  v_mfma_f32_16x16x32_bf16 v[72:75], v[196:199], a[148:151], v[72:75]
  s_waitcnt vmcnt(22) lgkmcnt(0)
  s_barrier
  v_mfma_f32_16x16x32_bf16 v[76:79], v[204:207], a[148:151], v[76:79]
  s_add_u32 m0, s41, 147456
  ds_read_b64_tr_b16 v[208:209], v13 offset:16384
  v_mfma_f32_16x16x32_bf16 v[76:79], v[200:203], a[144:147], v[76:79]
  s_add_u32 s3, s3, 35651584
  s_mul_i32 s4, s39, 40960
  v_mfma_f32_16x16x32_bf16 v[92:95], v[200:203], a[152:155], v[92:95]
  s_bfe_u32 s6, s76, 0x40000
  s_add_u32 s63, s7, L_p2-L_base
  v_mfma_f32_16x16x32_bf16 v[92:95], v[204:207], a[156:159], v[92:95]
  ds_read_b64_tr_b16 v[210:211], v13 offset:17408
  s_min_u32 s63, s63, L_block-L_base-4
  v_mfma_f32_16x16x32_bf16 v[88:91], v[196:199], a[156:159], v[88:91]
  v_mov_b32 v29, s63
  s_mul_i32 s45, s74, 10240
  v_mfma_f32_16x16x32_bf16 v[88:91], v[192:195], a[152:155], v[88:91]
  s_mul_i32 s6, s6, 128
  s_add_u32 s4, s4, s45
  v_mfma_f32_16x16x32_bf16 v[84:87], v[184:187], a[152:155], v[84:87]
  ds_read_b64_tr_b16 v[212:213], v13 offset:24576
  s_add_u32 s4, s4, 59768832
  v_mfma_f32_16x16x32_bf16 v[84:87], v[188:191], a[156:159], v[84:87]
  global_load_dword v63, v29, s[0:1]
  v_mfma_f32_16x16x32_bf16 v[80:83], v[180:183], a[156:159], v[80:83]
  s_add_u32 s6, s6, s50
  s_sub_u32 s44, s4, s3
  v_mfma_f32_16x16x32_bf16 v[80:83], v[176:179], a[152:155], v[80:83]
  ds_read_b64_tr_b16 v[214:215], v13 offset:25600
  s_mul_i32 s44, s44, s40
  v_mfma_f32_16x16x32_bf16 v[96:99], v[176:179], a[160:163], v[96:99]
  s_add_u32 s44, s44, s3
  s_lshl_b32 s3, s40, 10
  v_mfma_f32_16x16x32_bf16 v[96:99], v[180:183], a[164:167], v[96:99]
  buffer_load_dwordx4 v19, s[28:31], s6 offen offset:0 lds
  v_mfma_f32_16x16x32_bf16 v[100:103], v[188:191], a[164:167], v[100:103]
  ds_read_b64_tr_b16 v[216:217], v14 offset:16384
  s_sub_u32 s45, s4, s3
  v_mfma_f32_16x16x32_bf16 v[100:103], v[184:187], a[160:163], v[100:103]
  s_add_u32 s45, s45, 9216
  s_mul_i32 s46, s40, 36864
  v_mfma_f32_16x16x32_bf16 v[104:107], v[192:195], a[160:163], v[104:107]
  s_add_u32 s46, s46, 4096
  s_max_u32 s3, s83, 1
  v_mfma_f32_16x16x32_bf16 v[104:107], v[196:199], a[164:167], v[104:107]
  ds_read_b64_tr_b16 v[218:219], v14 offset:17408
  s_mul_i32 s4, s83, 14
  v_mfma_f32_16x16x32_bf16 v[108:111], v[204:207], a[164:167], v[108:111]
  s_sub_u32 s3, s4, s3
  s_add_u32 s3, s3, 1
  v_mfma_f32_16x16x32_bf16 v[108:111], v[200:203], a[160:163], v[108:111]
  buffer_load_dwordx4 v20, s[28:31], s6 offen offset:1024 lds
  v_mfma_f32_16x16x32_bf16 v[124:127], v[200:203], a[168:171], v[124:127]
  ds_read_b64_tr_b16 v[220:221], v14 offset:24576
  s_mul_i32 s4, s3, s46
  v_mfma_f32_16x16x32_bf16 v[124:127], v[204:207], a[172:175], v[124:127]
  s_add_u32 s42, s44, s4
  s_mul_i32 s4, s3, 40960
  v_mfma_f32_16x16x32_bf16 v[120:123], v[196:199], a[172:175], v[120:123]
  s_add_u32 s43, s45, s4
  s_lshl_b32 s3, s83, 3
  v_mfma_f32_16x16x32_bf16 v[120:123], v[192:195], a[168:171], v[120:123]
  ds_read_b64_tr_b16 v[222:223], v14 offset:25600
  s_and_b32 s4, s83, 0
  v_mfma_f32_16x16x32_bf16 v[116:119], v[184:187], a[168:171], v[116:119]
  s_add_u32 s3, s3, s4
  s_lshl_b32 s3, s3, 2
  v_mfma_f32_16x16x32_bf16 v[116:119], v[188:191], a[172:175], v[116:119]
  buffer_load_dwordx4 v21, s[28:31], s6 offen offset:2048 lds
  v_mfma_f32_16x16x32_bf16 v[112:115], v[180:183], a[172:175], v[112:115]
  ds_read_b64_tr_b16 v[224:225], v15 offset:16384
  s_add_u32 s3, s3, 54
  v_mfma_f32_16x16x32_bf16 v[112:115], v[176:179], a[168:171], v[112:115]
  s_mul_i32 s4, s3, s46
  s_add_u32 s44, s44, s4
  v_mfma_f32_16x16x32_bf16 v[128:131], v[176:179], a[176:179], v[128:131]
  s_mul_i32 s4, s3, 40960
  s_add_u32 s45, s45, s4
  v_mfma_f32_16x16x32_bf16 v[128:131], v[180:183], a[180:183], v[128:131]
  ds_read_b64_tr_b16 v[226:227], v15 offset:17408
  s_lshl_b32 s46, s46, 1
  v_mfma_f32_16x16x32_bf16 v[132:135], v[188:191], a[180:183], v[132:135]
  buffer_load_dwordx4 v22, s[28:31], s6 offen offset:3072 lds
  v_mfma_f32_16x16x32_bf16 v[132:135], v[184:187], a[176:179], v[132:135]
  s_lshr_b32 s3, s83, 1
  s_xor_b32 s4, s39, 1
  v_mfma_f32_16x16x32_bf16 v[136:139], v[192:195], a[176:179], v[136:139]
  ds_read_b64_tr_b16 v[228:229], v15 offset:24576
  s_and_b32 s3, s3, s4
  v_mfma_f32_16x16x32_bf16 v[136:139], v[196:199], a[180:183], v[136:139]
  s_mul_i32 s84, s3, 2146435072
  s_mul_i32 s85, s84, s40
  v_mfma_f32_16x16x32_bf16 v[140:143], v[204:207], a[180:183], v[140:143]
  s_add_u32 s84, s84, s43
  s_add_u32 s85, s85, s42
  v_mfma_f32_16x16x32_bf16 v[140:143], v[200:203], a[176:179], v[140:143]
  ds_read_b64_tr_b16 v[230:231], v15 offset:25600
  s_mul_i32 s47, s38, 9216
  v_mfma_f32_16x16x32_bf16 v[156:159], v[200:203], a[184:187], v[156:159]
  s_lshl_b32 m0, s38, 11
  s_lshl_b32 s3, s73, 2
  v_mfma_f32_16x16x32_bf16 v[156:159], v[204:207], a[188:191], v[156:159]
  s_add_u32 s3, s3, s74
  s_mul_i32 s93, s3, 163840
  v_mfma_f32_16x16x32_bf16 v[152:155], v[196:199], a[188:191], v[152:155]
  ds_read_b64_tr_b16 v[232:233], v16 offset:16384
  s_add_u32 s93, s93, 77594624
  v_mfma_f32_16x16x32_bf16 v[152:155], v[192:195], a[184:187], v[152:155]
  s_bfe_u32 s51, s76, 0x40000
  s_lshl_b32 s3, s38, 2
  v_mfma_f32_16x16x32_bf16 v[148:151], v[184:187], a[184:187], v[148:151]
  s_add_u32 s3, s3, s83
  s_mul_i32 s3, s3, 10240
  v_mfma_f32_16x16x32_bf16 v[148:151], v[188:191], a[188:191], v[148:151]
  ds_read_b64_tr_b16 v[234:235], v16 offset:17408
  s_add_u32 s92, s93, s3
  v_mfma_f32_16x16x32_bf16 v[144:147], v[180:183], a[188:191], v[144:147]
  s_mul_i32 s51, s51, s52
  s_xor_b32 s3, s38, s83
  v_mfma_f32_16x16x32_bf16 v[144:147], v[176:179], a[184:187], v[144:147]
  s_min_u32 s3, s3, 1
  s_xor_b32 s3, s3, 1
  v_mfma_f32_16x16x32_bf16 v[160:163], v[176:179], a[192:195], v[160:163]
  ds_read_b64_tr_b16 v[236:237], v16 offset:24576
  s_mul_i32 s3, s3, 2146435072
  v_mfma_f32_16x16x32_bf16 v[160:163], v[180:183], a[196:199], v[160:163]
  buffer_load_dwordx4 v23, s[88:91], s51 offen offset:0 lds
  v_mfma_f32_16x16x32_bf16 v[164:167], v[188:191], a[196:199], v[164:167]
  s_add_u32 s92, s92, s3
  s_mul_i32 s3, s83, 40960
  v_mfma_f32_16x16x32_bf16 v[164:167], v[184:187], a[192:195], v[164:167]
  ds_read_b64_tr_b16 v[238:239], v16 offset:25600
  s_add_u32 s93, s93, s3
  v_mfma_f32_16x16x32_bf16 v[168:171], v[192:195], a[192:195], v[168:171]
  v_and_b32 v35, 0xffff0000, v33
  v_mfma_f32_16x16x32_bf16 v[168:171], v[196:199], a[196:199], v[168:171]
  v_lshlrev_b32 v34, 16, v33
  v_and_b32 v33, 0xffff0000, v32
  v_mfma_f32_16x16x32_bf16 v[172:175], v[204:207], a[196:199], v[172:175]
  v_lshlrev_b32 v32, 16, v32
  v_and_b32 v39, 0xffff0000, v37
  v_mfma_f32_16x16x32_bf16 v[172:175], v[200:203], a[192:195], v[172:175]
  buffer_load_dwordx4 v24, s[88:91], s51 offen offset:1024 lds
  v_mfma_f32_16x16x32_bf16 a[12:15], v[200:203], a[200:203], a[12:15]
  v_lshlrev_b32 v38, 16, v37
  v_and_b32 v37, 0xffff0000, v36
  v_mfma_f32_16x16x32_bf16 a[12:15], v[204:207], a[204:207], a[12:15]
  v_lshlrev_b32 v36, 16, v36
  v_mfma_f32_16x16x32_bf16 a[8:11], v[196:199], a[204:207], a[8:11]
  v_mfma_f32_16x16x32_bf16 a[8:11], v[192:195], a[200:203], a[8:11]
  v_mfma_f32_16x16x32_bf16 a[4:7], v[184:187], a[200:203], a[4:7]
  v_mfma_f32_16x16x32_bf16 a[4:7], v[188:191], a[204:207], a[4:7]
  v_mfma_f32_16x16x32_bf16 a[0:3], v[180:183], a[204:207], a[0:3]
  v_mfma_f32_16x16x32_bf16 a[0:3], v[176:179], a[200:203], a[0:3]
  s_waitcnt lgkmcnt(4)
  v_mfma_f32_16x16x32_bf16 a[16:19], a[144:147], v[208:211], a[16:19]
  v_add_u32 v12, 98304, v10
  v_add_u32 v25, 98304, v11
  v_mfma_f32_16x16x32_bf16 a[16:19], a[148:151], v[212:215], a[16:19]
  s_lshl_b32 s3, s39, 6
  s_add_u32 s3, s3, 68157440
  v_mfma_f32_16x16x32_bf16 a[24:27], a[148:151], v[220:223], a[24:27]
  s_lshl_b32 s4, s37, 9
  s_add_u32 s65, s3, s4
  v_mfma_f32_16x16x32_bf16 a[24:27], a[144:147], v[216:219], a[24:27]
  s_sub_u32 s64, s3, s4
  s_lshl_b32 s3, s40, 8
  v_mfma_f32_16x16x32_bf16 a[32:35], a[144:147], v[224:227], a[32:35]
  s_add_u32 s64, s64, s3
  s_add_u32 s64, s64, 7680
  v_mfma_f32_16x16x32_bf16 a[32:35], a[148:151], v[228:231], a[32:35]
  s_waitcnt vmcnt(21) lgkmcnt(0)
  s_barrier
  v_mfma_f32_16x16x32_bf16 a[40:43], a[148:151], v[236:239], a[40:43]
  ds_read_b128 a[148:151], v25 offset:0
  s_add_u32 m0, s41, 65536
  v_mfma_f32_16x16x32_bf16 a[40:43], a[144:147], v[232:235], a[40:43]
  ds_read_b128 a[144:147], v12 offset:0
  ds_read_b64_tr_b16 v[176:177], v13 offset:32768
  v_mfma_f32_16x16x32_bf16 a[44:47], a[152:155], v[232:235], a[44:47]
  s_bfe_u32 s6, s76, 0x40004
  s_lshl_b32 s3, s36, 7
  v_mfma_f32_16x16x32_bf16 a[44:47], a[156:159], v[236:239], a[44:47]
  ds_read_b64_tr_b16 v[178:179], v13 offset:33792
  s_lshl_b32 s4, s39, 3
  v_mfma_f32_16x16x32_bf16 a[36:39], a[156:159], v[228:231], a[36:39]
  s_mul_i32 s6, s6, 128
  s_add_u32 s3, s3, s4
  v_mfma_f32_16x16x32_bf16 a[36:39], a[152:155], v[224:227], a[36:39]
  s_add_u32 s3, s3, 68288512
  s_lshl_b32 s4, s37, 12
  v_mfma_f32_16x16x32_bf16 a[28:31], a[152:155], v[216:219], a[28:31]
  ds_read_b64_tr_b16 v[180:181], v13 offset:40960
  s_add_u32 s60, s3, s4
  v_mfma_f32_16x16x32_bf16 a[28:31], a[156:159], v[220:223], a[28:31]
  s_add_u32 s6, s6, s49
  s_sub_u32 s82, s3, s4
  v_mfma_f32_16x16x32_bf16 a[20:23], a[156:159], v[212:215], a[20:23]
  ds_read_b128 a[156:159], v25 offset:2048
  s_lshl_b32 s4, s40, 2
  v_mfma_f32_16x16x32_bf16 a[20:23], a[152:155], v[208:211], a[20:23]
  ds_read_b128 a[152:155], v12 offset:2048
  ds_read_b64_tr_b16 v[182:183], v13 offset:41984
  v_mfma_f32_16x16x32_bf16 a[48:51], a[160:163], v[208:211], a[48:51]
  buffer_load_dwordx4 v19, s[28:31], s6 offen offset:0 lds
  v_mfma_f32_16x16x32_bf16 a[48:51], a[164:167], v[212:215], a[48:51]
  s_add_u32 s82, s82, s4
  s_add_u32 s82, s82, 61440
  v_mfma_f32_16x16x32_bf16 a[56:59], a[164:167], v[220:223], a[56:59]
  ds_read_b64_tr_b16 v[184:185], v14 offset:32768
  s_mul_i32 s3, s39, 745472
  v_mfma_f32_16x16x32_bf16 a[56:59], a[160:163], v[216:219], a[56:59]
  s_add_u32 s3, s3, 35651584
  s_mul_i32 s4, s37, 1490944
  v_mfma_f32_16x16x32_bf16 a[64:67], a[160:163], v[224:227], a[64:67]
  buffer_load_dwordx4 v20, s[28:31], s6 offen offset:1024 lds
  v_mfma_f32_16x16x32_bf16 a[64:67], a[164:167], v[228:231], a[64:67]
  ds_read_b64_tr_b16 v[186:187], v14 offset:33792
  s_add_u32 s69, s3, s4
  v_mfma_f32_16x16x32_bf16 a[72:75], a[164:167], v[236:239], a[72:75]
  ds_read_b128 a[164:167], v25 offset:4096
  s_sub_u32 s68, s3, s4
  v_mfma_f32_16x16x32_bf16 a[72:75], a[160:163], v[232:235], a[72:75]
  ds_read_b128 a[160:163], v12 offset:4096
  s_add_u32 s68, s68, 22364160
  v_mfma_f32_16x16x32_bf16 a[76:79], a[168:171], v[232:235], a[76:79]
  ds_read_b64_tr_b16 v[188:189], v14 offset:40960
  s_lshl_b32 s3, s36, 14
  v_mfma_f32_16x16x32_bf16 a[76:79], a[172:175], v[236:239], a[76:79]
  buffer_load_dwordx4 v21, s[28:31], s6 offen offset:2048 lds
  v_mfma_f32_16x16x32_bf16 a[68:71], a[172:175], v[228:231], a[68:71]
  s_add_u32 s3, s3, 221184
  s_add_u32 s67, s69, s3
  v_mfma_f32_16x16x32_bf16 a[68:71], a[168:171], v[224:227], a[68:71]
  ds_read_b64_tr_b16 v[190:191], v14 offset:41984
  s_lshl_b32 s4, s40, 11
  v_mfma_f32_16x16x32_bf16 a[60:63], a[168:171], v[216:219], a[60:63]
  s_add_u32 s3, s3, s4
  s_add_u32 s66, s68, s3
  v_mfma_f32_16x16x32_bf16 a[60:63], a[172:175], v[220:223], a[60:63]
  buffer_load_dwordx4 v22, s[28:31], s6 offen offset:3072 lds
  v_mfma_f32_16x16x32_bf16 a[52:55], a[172:175], v[212:215], a[52:55]
  ds_read_b128 a[172:175], v25 offset:6144
  ds_read_b64_tr_b16 v[192:193], v15 offset:32768
  v_mfma_f32_16x16x32_bf16 a[52:55], a[168:171], v[208:211], a[52:55]
  ds_read_b128 a[168:171], v12 offset:6144
  s_lshl_b32 s3, s36, 13
  v_mfma_f32_16x16x32_bf16 a[80:83], a[176:179], v[208:211], a[80:83]
  s_lshl_b32 s4, s40, 12
  s_add_u32 s3, s3, s4
  v_mfma_f32_16x16x32_bf16 a[80:83], a[180:183], v[212:215], a[80:83]
  ds_read_b64_tr_b16 v[194:195], v15 offset:33792
  s_add_u32 s68, s68, s3
  v_mfma_f32_16x16x32_bf16 a[88:91], a[180:183], v[220:223], a[88:91]
  s_add_u32 m0, s41, 16384
  s_add_u32 s69, s69, s3
  v_mfma_f32_16x16x32_bf16 a[88:91], a[176:179], v[216:219], a[88:91]
  s_lshl_b32 s3, s37, 1
  s_add_u32 s79, s3, 2
  v_mfma_f32_16x16x32_bf16 a[96:99], a[176:179], v[224:227], a[96:99]
  ds_read_b64_tr_b16 v[196:197], v15 offset:40960
  s_lshl_b32 s78, -1, s79
  v_mfma_f32_16x16x32_bf16 a[96:99], a[180:183], v[228:231], a[96:99]
  s_bfe_u32 s62, s76, 0x40000
  s_or_b32 s78, s78, 3
  v_mfma_f32_16x16x32_bf16 a[104:107], a[180:183], v[236:239], a[104:107]
  ds_read_b128 a[180:183], v25 offset:8192
  s_lshl_b32 s80, s40, s3
  v_mfma_f32_16x16x32_bf16 a[104:107], a[176:179], v[232:235], a[104:107]
  ds_read_b128 a[176:179], v12 offset:8192
  s_mul_i32 s62, s62, 524288
  v_mfma_f32_16x16x32_bf16 a[108:111], a[184:187], v[232:235], a[108:111]
  ds_read_b64_tr_b16 v[198:199], v15 offset:41984
  s_lshl_b32 s3, s40, 16
  v_mfma_f32_16x16x32_bf16 a[108:111], a[188:191], v[236:239], a[108:111]
  buffer_load_dwordx4 v6, s[32:35], s62 offen offset:0 lds
  v_mfma_f32_16x16x32_bf16 a[100:103], a[188:191], v[228:231], a[100:103]
  ds_read_b64_tr_b16 v[200:201], v16 offset:32768
  s_or_b32 s80, s80, s3
  v_mfma_f32_16x16x32_bf16 a[100:103], a[184:187], v[224:227], a[100:103]
  s_or_b32 s80, s80, 65536
  s_min_u32 s3, s38, 1
  v_mfma_f32_16x16x32_bf16 a[92:95], a[184:187], v[216:219], a[92:95]
  s_xor_b32 s3, s3, 1
  s_lshl_b32 s3, s3, 13
  v_mfma_f32_16x16x32_bf16 a[92:95], a[188:191], v[220:223], a[92:95]
  ds_read_b64_tr_b16 v[202:203], v16 offset:33792
  s_or_b32 s80, s80, s3
  v_mfma_f32_16x16x32_bf16 a[84:87], a[188:191], v[212:215], a[84:87]
  ds_read_b128 a[188:191], v25 offset:10240
  s_mov_b32 s48, 0
  v_mfma_f32_16x16x32_bf16 a[84:87], a[184:187], v[208:211], a[84:87]
  ds_read_b128 a[184:187], v12 offset:10240
  s_mov_b32 s70, 0
  v_mfma_f32_16x16x32_bf16 a[112:115], a[192:195], v[208:211], a[112:115]
  buffer_load_dwordx4 v7, s[32:35], s62 offen offset:1024 lds
  v_mfma_f32_16x16x32_bf16 a[112:115], a[196:199], v[212:215], a[112:115]
  ds_read_b64_tr_b16 v[204:205], v16 offset:40960
  s_mov_b32 s61, 16384
  v_mfma_f32_16x16x32_bf16 a[120:123], a[196:199], v[220:223], a[120:123]
  s_mov_b32 s81, 68354048
  s_mov_b32 s98, 0x3fb8aa3b
  v_mfma_f32_16x16x32_bf16 a[120:123], a[192:195], v[216:219], a[120:123]
  buffer_load_dwordx4 v8, s[32:35], s62 offen offset:2048 lds
  v_mfma_f32_16x16x32_bf16 a[128:131], a[192:195], v[224:227], a[128:131]
  ds_read_b64_tr_b16 v[206:207], v16 offset:41984
  s_mov_b32 s99, 0x3f3504f3
  v_mfma_f32_16x16x32_bf16 a[128:131], a[196:199], v[228:231], a[128:131]
  s_mov_b32 s8, s16
  s_mov_b32 s9, s17
  v_mfma_f32_16x16x32_bf16 a[136:139], a[196:199], v[236:239], a[136:139]
  ds_read_b128 a[196:199], v25 offset:12288
  s_mov_b32 s10, s57
  v_mfma_f32_16x16x32_bf16 a[136:139], a[192:195], v[232:235], a[136:139]
  ds_read_b128 a[192:195], v12 offset:12288
  s_add_u32 s57, s56, 16384
  v_mfma_f32_16x16x32_bf16 a[140:143], a[200:203], v[232:235], a[140:143]
  buffer_load_dwordx4 v9, s[32:35], s62 offen offset:3072 lds
  v_mfma_f32_16x16x32_bf16 a[140:143], a[204:207], v[236:239], a[140:143]
  s_add_u32 s72, s59, 16384
  v_mfma_f32_16x16x32_bf16 a[132:135], a[204:207], v[228:231], a[132:135]
  v_mfma_f32_16x16x32_bf16 a[132:135], a[200:203], v[224:227], a[132:135]
  v_mfma_f32_16x16x32_bf16 a[124:127], a[200:203], v[216:219], a[124:127]
  v_mfma_f32_16x16x32_bf16 a[124:127], a[204:207], v[220:223], a[124:127]
  v_mfma_f32_16x16x32_bf16 a[116:119], a[204:207], v[212:215], a[116:119]
  ds_read_b128 a[204:207], v25 offset:14336
  v_mfma_f32_16x16x32_bf16 a[116:119], a[200:203], v[208:211], a[116:119]
  ds_read_b128 a[200:203], v12 offset:14336
  s_waitcnt lgkmcnt(10)
  v_mfma_f32_16x16x32_bf16 v[64:67], v[176:179], a[144:147], v[64:67]
  v_mfma_f32_16x16x32_bf16 v[64:67], v[180:183], a[148:151], v[64:67]
  v_mfma_f32_16x16x32_bf16 v[68:71], v[188:191], a[148:151], v[68:71]
  v_mfma_f32_16x16x32_bf16 v[68:71], v[184:187], a[144:147], v[68:71]
  v_mfma_f32_16x16x32_bf16 v[72:75], v[192:195], a[144:147], v[72:75]
  v_mfma_f32_16x16x32_bf16 v[72:75], v[196:199], a[148:151], v[72:75]
  s_waitcnt vmcnt(15) lgkmcnt(0)
  s_barrier
  v_mfma_f32_16x16x32_bf16 v[76:79], v[204:207], a[148:151], v[76:79]
  s_add_u32 m0, s41, 81920
  ds_read_b64_tr_b16 v[208:209], v13 offset:49152
  v_mfma_f32_16x16x32_bf16 v[76:79], v[200:203], a[144:147], v[76:79]
  v_mfma_f32_16x16x32_bf16 v[92:95], v[200:203], a[152:155], v[92:95]
  s_bfe_u32 s6, s76, 0x40004
  v_mfma_f32_16x16x32_bf16 v[92:95], v[204:207], a[156:159], v[92:95]
  ds_read_b64_tr_b16 v[210:211], v13 offset:50176
  v_mfma_f32_16x16x32_bf16 v[88:91], v[196:199], a[156:159], v[88:91]
  v_mfma_f32_16x16x32_bf16 v[88:91], v[192:195], a[152:155], v[88:91]
  s_mul_i32 s6, s6, 128
  v_mfma_f32_16x16x32_bf16 v[84:87], v[184:187], a[152:155], v[84:87]
  ds_read_b64_tr_b16 v[212:213], v13 offset:57344
  v_mul_f32 v64, s96, v64
  v_mfma_f32_16x16x32_bf16 v[84:87], v[188:191], a[156:159], v[84:87]
  v_mul_f32 v65, s96, v65
  v_mul_f32 v66, s96, v66
  v_mfma_f32_16x16x32_bf16 v[80:83], v[180:183], a[156:159], v[80:83]
  s_add_u32 s6, s6, s50
  v_mul_f32 v67, s96, v67
  v_mfma_f32_16x16x32_bf16 v[80:83], v[176:179], a[152:155], v[80:83]
  ds_read_b64_tr_b16 v[214:215], v13 offset:58368
  v_mul_f32 v68, s96, v68
  v_mfma_f32_16x16x32_bf16 v[96:99], v[176:179], a[160:163], v[96:99]
  v_mul_f32 v69, s96, v69
  v_mul_f32 v70, s96, v70
  v_mfma_f32_16x16x32_bf16 v[96:99], v[180:183], a[164:167], v[96:99]
  buffer_load_dwordx4 v19, s[28:31], s6 offen offset:0 lds
  v_mfma_f32_16x16x32_bf16 v[100:103], v[188:191], a[164:167], v[100:103]
  ds_read_b64_tr_b16 v[216:217], v14 offset:49152
  v_mul_f32 v71, s96, v71
  v_mfma_f32_16x16x32_bf16 v[100:103], v[184:187], a[160:163], v[100:103]
  v_cvt_pk_bf16_f32 v64, v64, v65
  v_cvt_pk_bf16_f32 v65, v66, v67
  v_mfma_f32_16x16x32_bf16 v[104:107], v[192:195], a[160:163], v[104:107]
  v_cvt_pk_bf16_f32 v66, v68, v69
  v_cvt_pk_bf16_f32 v67, v70, v71
  v_mfma_f32_16x16x32_bf16 v[104:107], v[196:199], a[164:167], v[104:107]
  ds_read_b64_tr_b16 v[218:219], v14 offset:50176
  s_add_u32 s5, s53, 0
  v_mfma_f32_16x16x32_bf16 v[108:111], v[204:207], a[164:167], v[108:111]
  buffer_load_dwordx4 v20, s[28:31], s6 offen offset:1024 lds
  v_mfma_f32_16x16x32_bf16 v[108:111], v[200:203], a[160:163], v[108:111]
  buffer_store_dwordx4 v[64:67], v0, s[16:19], s5 offen offset:0 sc1
  v_mfma_f32_16x16x32_bf16 v[124:127], v[200:203], a[168:171], v[124:127]
  ds_read_b64_tr_b16 v[220:221], v14 offset:57344
  v_mul_f32 v72, s96, v72
  v_mfma_f32_16x16x32_bf16 v[124:127], v[204:207], a[172:175], v[124:127]
  v_mul_f32 v73, s96, v73
  v_mul_f32 v74, s96, v74
  v_mfma_f32_16x16x32_bf16 v[120:123], v[196:199], a[172:175], v[120:123]
  v_mul_f32 v75, s96, v75
  v_mul_f32 v76, s96, v76
  v_mfma_f32_16x16x32_bf16 v[120:123], v[192:195], a[168:171], v[120:123]
  ds_read_b64_tr_b16 v[222:223], v14 offset:58368
  v_mul_f32 v77, s96, v77
  v_mfma_f32_16x16x32_bf16 v[116:119], v[184:187], a[168:171], v[116:119]
  buffer_load_dwordx4 v21, s[28:31], s6 offen offset:2048 lds
  v_mfma_f32_16x16x32_bf16 v[116:119], v[188:191], a[172:175], v[116:119]
  v_mul_f32 v78, s96, v78
  v_mul_f32 v79, s96, v79
  v_mfma_f32_16x16x32_bf16 v[112:115], v[180:183], a[172:175], v[112:115]
  ds_read_b64_tr_b16 v[224:225], v15 offset:49152
  v_cvt_pk_bf16_f32 v72, v72, v73
  v_mfma_f32_16x16x32_bf16 v[112:115], v[176:179], a[168:171], v[112:115]
  v_cvt_pk_bf16_f32 v73, v74, v75
  v_cvt_pk_bf16_f32 v74, v76, v77
  v_mfma_f32_16x16x32_bf16 v[128:131], v[176:179], a[176:179], v[128:131]
  v_cvt_pk_bf16_f32 v75, v78, v79
  v_mfma_f32_16x16x32_bf16 v[128:131], v[180:183], a[180:183], v[128:131]
  buffer_load_dwordx4 v22, s[28:31], s6 offen offset:3072 lds
  v_mfma_f32_16x16x32_bf16 v[132:135], v[188:191], a[180:183], v[132:135]
  ds_read_b64_tr_b16 v[226:227], v15 offset:50176
  s_add_u32 s5, s53, 0
  v_mfma_f32_16x16x32_bf16 v[132:135], v[184:187], a[176:179], v[132:135]
  buffer_store_dwordx4 v[72:75], v0, s[16:19], s5 offen offset:1024 sc1
  v_mfma_f32_16x16x32_bf16 v[136:139], v[192:195], a[176:179], v[136:139]
  ds_read_b64_tr_b16 v[228:229], v15 offset:57344
  v_mul_f32 v80, s96, v80
  v_mfma_f32_16x16x32_bf16 v[136:139], v[196:199], a[180:183], v[136:139]
  v_mul_f32 v81, s96, v81
  v_mul_f32 v82, s96, v82
  v_mfma_f32_16x16x32_bf16 v[140:143], v[204:207], a[180:183], v[140:143]
  v_mul_f32 v83, s96, v83
  v_mul_f32 v84, s96, v84
  v_mfma_f32_16x16x32_bf16 v[140:143], v[200:203], a[176:179], v[140:143]
  s_lshl_b32 m0, s38, 11
  ds_read_b64_tr_b16 v[230:231], v15 offset:58368
  v_mfma_f32_16x16x32_bf16 v[156:159], v[200:203], a[184:187], v[156:159]
  v_mul_f32 v85, s96, v85
  v_mul_f32 v86, s96, v86
  v_mfma_f32_16x16x32_bf16 v[156:159], v[204:207], a[188:191], v[156:159]
  s_add_u32 m0, m0, 32768
  v_mul_f32 v87, s96, v87
  v_mfma_f32_16x16x32_bf16 v[152:155], v[196:199], a[188:191], v[152:155]
  ds_read_b64_tr_b16 v[232:233], v16 offset:49152
  v_cvt_pk_bf16_f32 v80, v80, v81
  v_mfma_f32_16x16x32_bf16 v[152:155], v[192:195], a[184:187], v[152:155]
  v_cvt_pk_bf16_f32 v81, v82, v83
  v_cvt_pk_bf16_f32 v82, v84, v85
  v_mfma_f32_16x16x32_bf16 v[148:151], v[184:187], a[184:187], v[148:151]
  s_bfe_u32 s51, s76, 0x40004
  v_cvt_pk_bf16_f32 v83, v86, v87
  v_mfma_f32_16x16x32_bf16 v[148:151], v[188:191], a[188:191], v[148:151]
  ds_read_b64_tr_b16 v[234:235], v16 offset:50176
  v_mul_f32 v88, s96, v88
  v_mfma_f32_16x16x32_bf16 v[144:147], v[180:183], a[188:191], v[144:147]
  v_mul_f32 v89, s96, v89
  v_mul_f32 v90, s96, v90
  v_mfma_f32_16x16x32_bf16 v[144:147], v[176:179], a[184:187], v[144:147]
  s_mul_i32 s51, s51, s52
  v_mul_f32 v91, s96, v91
  v_mfma_f32_16x16x32_bf16 v[160:163], v[176:179], a[192:195], v[160:163]
  ds_read_b64_tr_b16 v[236:237], v16 offset:57344
  v_mul_f32 v92, s96, v92
  v_mfma_f32_16x16x32_bf16 v[160:163], v[180:183], a[196:199], v[160:163]
  v_mul_f32 v93, s96, v93
  v_mul_f32 v94, s96, v94
  v_mfma_f32_16x16x32_bf16 v[164:167], v[188:191], a[196:199], v[164:167]
  buffer_load_dwordx4 v23, s[88:91], s51 offen offset:0 lds
  v_mfma_f32_16x16x32_bf16 v[164:167], v[184:187], a[192:195], v[164:167]
  ds_read_b64_tr_b16 v[238:239], v16 offset:58368
  v_mul_f32 v95, s96, v95
  v_mfma_f32_16x16x32_bf16 v[168:171], v[192:195], a[192:195], v[168:171]
  v_cvt_pk_bf16_f32 v88, v88, v89
  v_cvt_pk_bf16_f32 v89, v90, v91
  v_mfma_f32_16x16x32_bf16 v[168:171], v[196:199], a[196:199], v[168:171]
  v_cvt_pk_bf16_f32 v90, v92, v93
  v_cvt_pk_bf16_f32 v91, v94, v95
  v_mfma_f32_16x16x32_bf16 v[172:175], v[204:207], a[196:199], v[172:175]
  v_mul_f32 v96, s96, v96
  v_mfma_f32_16x16x32_bf16 v[172:175], v[200:203], a[192:195], v[172:175]
  buffer_load_dwordx4 v24, s[88:91], s51 offen offset:1024 lds
  v_mfma_f32_16x16x32_bf16 a[12:15], v[200:203], a[200:203], a[12:15]
  v_mul_f32 v97, s96, v97
  v_mul_f32 v98, s96, v98
  v_mfma_f32_16x16x32_bf16 a[12:15], v[204:207], a[204:207], a[12:15]
  v_mul_f32 v99, s96, v99
  v_mul_f32 v100, s96, v100
  v_mfma_f32_16x16x32_bf16 a[8:11], v[196:199], a[204:207], a[8:11]
  v_mul_f32 v101, s96, v101
  v_mfma_f32_16x16x32_bf16 a[8:11], v[192:195], a[200:203], a[8:11]
  v_mul_f32 v102, s96, v102
  v_mfma_f32_16x16x32_bf16 a[4:7], v[184:187], a[200:203], a[4:7]
  v_mul_f32 v103, s96, v103
  v_cvt_pk_bf16_f32 v96, v96, v97
  v_mfma_f32_16x16x32_bf16 a[4:7], v[188:191], a[204:207], a[4:7]
  v_cvt_pk_bf16_f32 v97, v98, v99
  v_mfma_f32_16x16x32_bf16 a[0:3], v[180:183], a[204:207], a[0:3]
  v_cvt_pk_bf16_f32 v98, v100, v101
  v_mfma_f32_16x16x32_bf16 a[0:3], v[176:179], a[200:203], a[0:3]
  v_cvt_pk_bf16_f32 v99, v102, v103
  s_waitcnt lgkmcnt(4)
  v_mfma_f32_16x16x32_bf16 a[16:19], a[144:147], v[208:211], a[16:19]
  v_add_u32 v12, 131072, v27
  v_add_u32 v25, 131072, v28
  v_mfma_f32_16x16x32_bf16 a[16:19], a[148:151], v[212:215], a[16:19]
  s_add_u32 s5, s53, 4096
  v_mul_f32 v104, s96, v104
  v_mfma_f32_16x16x32_bf16 a[24:27], a[148:151], v[220:223], a[24:27]
  v_mul_f32 v105, s96, v105
  v_mul_f32 v106, s96, v106
  v_mfma_f32_16x16x32_bf16 a[24:27], a[144:147], v[216:219], a[24:27]
  v_mul_f32 v107, s96, v107
  v_mfma_f32_16x16x32_bf16 a[32:35], a[144:147], v[224:227], a[32:35]
  v_mul_f32 v108, s96, v108
  v_mfma_f32_16x16x32_bf16 a[32:35], a[148:151], v[228:231], a[32:35]
  s_waitcnt vmcnt(16) lgkmcnt(0)
  s_barrier
  v_mfma_f32_16x16x32_bf16 a[40:43], a[148:151], v[236:239], a[40:43]
  ds_read_b128 a[148:151], v25 offset:0
  s_add_u32 m0, s41, 98304
  v_mfma_f32_16x16x32_bf16 a[40:43], a[144:147], v[232:235], a[40:43]
  ds_read_b128 a[144:147], v12 offset:0
  ds_read_b64_tr_b16 a[208:209], v17 offset:0
  v_mfma_f32_16x16x32_bf16 a[44:47], a[152:155], v[232:235], a[44:47]
  s_bfe_u32 s6, s76, 0x40008
  v_mul_f32 v109, s96, v109
  v_mfma_f32_16x16x32_bf16 a[44:47], a[156:159], v[236:239], a[44:47]
  buffer_store_dwordx4 v[80:83], v0, s[16:19], s5 offen offset:0 sc1
  v_mfma_f32_16x16x32_bf16 a[36:39], a[156:159], v[228:231], a[36:39]
  s_mul_i32 s6, s6, 128
  v_mul_f32 v110, s96, v110
  v_mfma_f32_16x16x32_bf16 a[36:39], a[152:155], v[224:227], a[36:39]
  v_mul_f32 v111, s96, v111
  v_cvt_pk_bf16_f32 v104, v104, v105
  v_mfma_f32_16x16x32_bf16 a[28:31], a[152:155], v[216:219], a[28:31]
  ds_read_b64_tr_b16 a[210:211], v17 offset:512
  v_cvt_pk_bf16_f32 v105, v106, v107
  v_mfma_f32_16x16x32_bf16 a[28:31], a[156:159], v[220:223], a[28:31]
  s_add_u32 s6, s6, s49
  v_cvt_pk_bf16_f32 v106, v108, v109
  v_mfma_f32_16x16x32_bf16 a[20:23], a[156:159], v[212:215], a[20:23]
  ds_read_b128 a[156:159], v25 offset:4096
  v_cvt_pk_bf16_f32 v107, v110, v111
  v_mfma_f32_16x16x32_bf16 a[20:23], a[152:155], v[208:211], a[20:23]
  ds_read_b128 a[152:155], v12 offset:4096
  v_mul_f32 v112, s96, v112
  v_mfma_f32_16x16x32_bf16 a[48:51], a[160:163], v[208:211], a[48:51]
  buffer_load_dwordx4 v19, s[28:31], s6 offen offset:0 lds
  v_mfma_f32_16x16x32_bf16 a[48:51], a[164:167], v[212:215], a[48:51]
  v_mul_f32 v113, s96, v113
  v_mul_f32 v114, s96, v114
  v_mfma_f32_16x16x32_bf16 a[56:59], a[164:167], v[220:223], a[56:59]
  ds_read_b64_tr_b16 a[212:213], v17 offset:4096
  v_mul_f32 v115, s96, v115
  v_mfma_f32_16x16x32_bf16 a[56:59], a[160:163], v[216:219], a[56:59]
  v_mul_f32 v116, s96, v116
  v_mul_f32 v117, s96, v117
  v_mfma_f32_16x16x32_bf16 a[64:67], a[160:163], v[224:227], a[64:67]
  buffer_load_dwordx4 v20, s[28:31], s6 offen offset:1024 lds
  v_mfma_f32_16x16x32_bf16 a[64:67], a[164:167], v[228:231], a[64:67]
  s_add_u32 s5, s53, 4096
  v_mul_f32 v118, s96, v118
  v_mfma_f32_16x16x32_bf16 a[72:75], a[164:167], v[236:239], a[72:75]
  ds_read_b128 a[164:167], v25 offset:8192
  v_mul_f32 v119, s96, v119
  v_mfma_f32_16x16x32_bf16 a[72:75], a[160:163], v[232:235], a[72:75]
  ds_read_b128 a[160:163], v12 offset:8192
  v_cvt_pk_bf16_f32 v112, v112, v113
  v_mfma_f32_16x16x32_bf16 a[76:79], a[168:171], v[232:235], a[76:79]
  ds_read_b64_tr_b16 a[214:215], v17 offset:4608
  v_cvt_pk_bf16_f32 v113, v114, v115
  v_mfma_f32_16x16x32_bf16 a[76:79], a[172:175], v[236:239], a[76:79]
  buffer_load_dwordx4 v21, s[28:31], s6 offen offset:2048 lds
  v_mfma_f32_16x16x32_bf16 a[68:71], a[172:175], v[228:231], a[68:71]
  v_cvt_pk_bf16_f32 v114, v116, v117
  v_cvt_pk_bf16_f32 v115, v118, v119
  v_mfma_f32_16x16x32_bf16 a[68:71], a[168:171], v[224:227], a[68:71]
  v_mul_f32 v120, s96, v120
  v_mul_f32 v121, s96, v121
  v_mfma_f32_16x16x32_bf16 a[60:63], a[168:171], v[216:219], a[60:63]
  buffer_store_dwordx4 v[88:91], v0, s[16:19], s5 offen offset:1024 sc1
  v_mfma_f32_16x16x32_bf16 a[60:63], a[172:175], v[220:223], a[60:63]
  buffer_load_dwordx4 v22, s[28:31], s6 offen offset:3072 lds
  v_mfma_f32_16x16x32_bf16 a[52:55], a[172:175], v[212:215], a[52:55]
  ds_read_b128 a[172:175], v25 offset:12288
  ds_read_b64_tr_b16 a[216:217], v18 offset:0
  v_mfma_f32_16x16x32_bf16 a[52:55], a[168:171], v[208:211], a[52:55]
  ds_read_b128 a[168:171], v12 offset:12288
  v_mul_f32 v122, s96, v122
  v_mfma_f32_16x16x32_bf16 a[80:83], a[176:179], v[208:211], a[80:83]
  v_mul_f32 v123, s96, v123
  v_mul_f32 v124, s96, v124
  v_mfma_f32_16x16x32_bf16 a[80:83], a[180:183], v[212:215], a[80:83]
  v_mul_f32 v125, s96, v125
  v_mul_f32 v126, s96, v126
  v_mfma_f32_16x16x32_bf16 a[88:91], a[180:183], v[220:223], a[88:91]
  s_add_u32 m0, s41, 49152
  v_mul_f32 v127, s96, v127
  v_mfma_f32_16x16x32_bf16 a[88:91], a[176:179], v[216:219], a[88:91]
  v_cvt_pk_bf16_f32 v40, v120, v121
  v_cvt_pk_bf16_f32 v41, v122, v123
  v_mfma_f32_16x16x32_bf16 a[96:99], a[176:179], v[224:227], a[96:99]
  ds_read_b64_tr_b16 a[218:219], v18 offset:512
  v_cvt_pk_bf16_f32 v42, v124, v125
  v_mfma_f32_16x16x32_bf16 a[96:99], a[180:183], v[228:231], a[96:99]
  s_bfe_u32 s62, s76, 0x40004
  v_cvt_pk_bf16_f32 v43, v126, v127
  v_mfma_f32_16x16x32_bf16 a[104:107], a[180:183], v[236:239], a[104:107]
  ds_read_b128 a[180:183], v25 offset:16384
  v_mul_f32 v128, s96, v128
  v_mfma_f32_16x16x32_bf16 a[104:107], a[176:179], v[232:235], a[104:107]
  ds_read_b128 a[176:179], v12 offset:16384
  s_mul_i32 s62, s62, 524288
  v_mfma_f32_16x16x32_bf16 a[108:111], a[184:187], v[232:235], a[108:111]
  v_mul_f32 v129, s96, v129
  v_mul_f32 v130, s96, v130
  v_mfma_f32_16x16x32_bf16 a[108:111], a[188:191], v[236:239], a[108:111]
  buffer_load_dwordx4 v6, s[32:35], s62 offen offset:0 lds
  v_mfma_f32_16x16x32_bf16 a[100:103], a[188:191], v[228:231], a[100:103]
  ds_read_b64_tr_b16 a[220:221], v18 offset:4096
  s_add_u32 s5, s53, 8192
  v_mfma_f32_16x16x32_bf16 a[100:103], a[184:187], v[224:227], a[100:103]
  v_mul_f32 v131, s96, v131
  v_mul_f32 v132, s96, v132
  v_mfma_f32_16x16x32_bf16 a[92:95], a[184:187], v[216:219], a[92:95]
  v_mul_f32 v133, s96, v133
  v_mul_f32 v134, s96, v134
  v_mfma_f32_16x16x32_bf16 a[92:95], a[188:191], v[220:223], a[92:95]
  v_mul_f32 v135, s96, v135
  v_mfma_f32_16x16x32_bf16 a[84:87], a[188:191], v[212:215], a[84:87]
  ds_read_b128 a[188:191], v25 offset:20480
  v_cvt_pk_bf16_f32 v44, v128, v129
  v_mfma_f32_16x16x32_bf16 a[84:87], a[184:187], v[208:211], a[84:87]
  ds_read_b128 a[184:187], v12 offset:20480
  v_mfma_f32_16x16x32_bf16 a[112:115], a[192:195], v[208:211], a[112:115]
  buffer_load_dwordx4 v7, s[32:35], s62 offen offset:1024 lds
  v_mfma_f32_16x16x32_bf16 a[112:115], a[196:199], v[212:215], a[112:115]
  ds_read_b64_tr_b16 a[222:223], v18 offset:4608
  v_cvt_pk_bf16_f32 v45, v130, v131
  v_mfma_f32_16x16x32_bf16 a[120:123], a[196:199], v[220:223], a[120:123]
  buffer_store_dwordx4 v[96:99], v0, s[16:19], s5 offen offset:0 sc1
  v_mfma_f32_16x16x32_bf16 a[120:123], a[192:195], v[216:219], a[120:123]
  buffer_load_dwordx4 v8, s[32:35], s62 offen offset:2048 lds
  v_mfma_f32_16x16x32_bf16 a[128:131], a[192:195], v[224:227], a[128:131]
  v_cvt_pk_bf16_f32 v46, v132, v133
  v_cvt_pk_bf16_f32 v47, v134, v135
  v_mfma_f32_16x16x32_bf16 a[128:131], a[196:199], v[228:231], a[128:131]
  v_mul_f32 v136, s96, v136
  v_mul_f32 v137, s96, v137
  v_mfma_f32_16x16x32_bf16 a[136:139], a[196:199], v[236:239], a[136:139]
  ds_read_b128 a[196:199], v25 offset:24576
  v_mul_f32 v138, s96, v138
  v_mfma_f32_16x16x32_bf16 a[136:139], a[192:195], v[232:235], a[136:139]
  ds_read_b128 a[192:195], v12 offset:24576
  v_mul_f32 v139, s96, v139
  v_mfma_f32_16x16x32_bf16 a[140:143], a[200:203], v[232:235], a[140:143]
  buffer_load_dwordx4 v9, s[32:35], s62 offen offset:3072 lds
  v_mfma_f32_16x16x32_bf16 a[140:143], a[204:207], v[236:239], a[140:143]
  v_mul_f32 v140, s96, v140
  v_mul_f32 v141, s96, v141
  v_mfma_f32_16x16x32_bf16 a[132:135], a[204:207], v[228:231], a[132:135]
  v_mul_f32 v142, s96, v142
  v_mul_f32 v143, s96, v143
  v_mfma_f32_16x16x32_bf16 a[132:135], a[200:203], v[224:227], a[132:135]
  v_cvt_pk_bf16_f32 v48, v136, v137
  v_mfma_f32_16x16x32_bf16 a[124:127], a[200:203], v[216:219], a[124:127]
  v_cvt_pk_bf16_f32 v49, v138, v139
  v_mfma_f32_16x16x32_bf16 a[124:127], a[204:207], v[220:223], a[124:127]
  v_cvt_pk_bf16_f32 v50, v140, v141
  v_mfma_f32_16x16x32_bf16 a[116:119], a[204:207], v[212:215], a[116:119]
  ds_read_b128 a[204:207], v25 offset:28672
  v_cvt_pk_bf16_f32 v51, v142, v143
  v_mfma_f32_16x16x32_bf16 a[116:119], a[200:203], v[208:211], a[116:119]
  ds_read_b128 a[200:203], v12 offset:28672
L_p2:
  s_waitcnt lgkmcnt(4)
  v_mfma_f32_16x16x32_bf16 v[176:179], a[208:211], a[144:147], v[32:35]
  s_add_u32 s5, s53, 8192
  v_mul_f32 v144, s96, v144
  v_mfma_f32_16x16x32_bf16 v[176:179], a[212:215], a[148:151], v[176:179]
  v_mfma_f32_16x16x32_bf16 v[180:183], a[220:223], a[148:151], v[36:39]
  v_mul_f32 v145, s96, v145
  v_mfma_f32_16x16x32_bf16 v[180:183], a[216:219], a[144:147], v[180:183]
  v_mfma_f32_16x16x32_bf16 v[188:191], a[216:219], a[152:155], v[36:39]
  v_mfma_f32_16x16x32_bf16 v[188:191], a[220:223], a[156:159], v[188:191]
  s_waitcnt vmcnt(19) lgkmcnt(0)
  s_barrier
  v_mfma_f32_16x16x32_bf16 v[184:187], a[212:215], a[156:159], v[32:35]
  s_add_u32 m0, s41, 114688
  ds_read_b64_tr_b16 a[224:225], v13 offset:16384
  v_mfma_f32_16x16x32_bf16 v[184:187], a[208:211], a[152:155], v[184:187]
  s_bfe_u32 s6, s76, 0x40008
  ds_read_b64_tr_b16 a[226:227], v13 offset:17408
  v_mfma_f32_16x16x32_bf16 v[192:195], a[208:211], a[160:163], v[32:35]
  s_mul_i32 s6, s6, 128
  ds_read_b64_tr_b16 a[228:229], v13 offset:24576
  v_mfma_f32_16x16x32_bf16 v[192:195], a[212:215], a[164:167], v[192:195]
  s_add_u32 s6, s6, s50
  v_mul_f32 v146, s96, v146
  v_mfma_f32_16x16x32_bf16 v[196:199], a[220:223], a[164:167], v[36:39]
  ds_read_b64_tr_b16 a[230:231], v13 offset:25600
  v_mul_f32 v147, s96, v147
  v_mfma_f32_16x16x32_bf16 v[196:199], a[216:219], a[160:163], v[196:199]
  buffer_load_dwordx4 v19, s[28:31], s6 offen offset:0 lds
  v_mfma_f32_16x16x32_bf16 v[204:207], a[216:219], a[168:171], v[36:39]
  ds_read_b64_tr_b16 a[232:233], v14 offset:16384
  v_mul_f32 v148, s96, v148
  v_mfma_f32_16x16x32_bf16 v[204:207], a[220:223], a[172:175], v[204:207]
  buffer_load_dwordx4 v20, s[28:31], s6 offen offset:1024 lds
  v_mfma_f32_16x16x32_bf16 v[200:203], a[212:215], a[172:175], v[32:35]
  ds_read_b64_tr_b16 a[234:235], v14 offset:17408
  ds_read_b64_tr_b16 a[236:237], v14 offset:24576
  v_mfma_f32_16x16x32_bf16 v[200:203], a[208:211], a[168:171], v[200:203]
  buffer_store_dwordx4 v[104:107], v0, s[16:19], s5 offen offset:1024 sc1
  v_mfma_f32_16x16x32_bf16 v[208:211], a[208:211], a[176:179], v[32:35]
  buffer_load_dwordx4 v21, s[28:31], s6 offen offset:2048 lds
  v_mfma_f32_16x16x32_bf16 v[208:211], a[212:215], a[180:183], v[208:211]
  ds_read_b64_tr_b16 a[238:239], v14 offset:25600
  ds_read_b64_tr_b16 a[240:241], v15 offset:16384
  v_mfma_f32_16x16x32_bf16 v[212:215], a[220:223], a[180:183], v[36:39]
  ds_read_b64_tr_b16 a[242:243], v15 offset:17408
  v_mul_f32 v149, s96, v149
  v_mfma_f32_16x16x32_bf16 v[212:215], a[216:219], a[176:179], v[212:215]
  buffer_load_dwordx4 v22, s[28:31], s6 offen offset:3072 lds
  v_mfma_f32_16x16x32_bf16 v[220:223], a[216:219], a[184:187], v[36:39]
  ds_read_b64_tr_b16 a[244:245], v15 offset:24576
  v_mul_f32 v150, s96, v150
  v_mfma_f32_16x16x32_bf16 v[220:223], a[220:223], a[188:191], v[220:223]
  s_lshl_b32 m0, s38, 11
  ds_read_b64_tr_b16 a[246:247], v15 offset:25600
  v_mfma_f32_16x16x32_bf16 v[216:219], a[212:215], a[188:191], v[32:35]
  v_mul_f32 v151, s96, v151
  v_cvt_pk_bf16_f32 v52, v144, v145
  v_mfma_f32_16x16x32_bf16 v[216:219], a[208:211], a[184:187], v[216:219]
  s_bfe_u32 s51, s76, 0x40008
  ds_read_b64_tr_b16 a[248:249], v16 offset:16384
  v_mfma_f32_16x16x32_bf16 v[224:227], a[208:211], a[192:195], v[32:35]
  s_mul_i32 s51, s51, s52
  ds_read_b64_tr_b16 a[250:251], v16 offset:17408
  v_mfma_f32_16x16x32_bf16 v[224:227], a[212:215], a[196:199], v[224:227]
  buffer_load_dwordx4 v23, s[88:91], s51 offen offset:0 lds
  v_mfma_f32_16x16x32_bf16 v[228:231], a[220:223], a[196:199], v[36:39]
  ds_read_b64_tr_b16 a[252:253], v16 offset:24576
  v_cvt_pk_bf16_f32 v53, v146, v147
  v_mfma_f32_16x16x32_bf16 v[228:231], a[216:219], a[192:195], v[228:231]
  ds_read_b64_tr_b16 a[254:255], v16 offset:25600
  v_cvt_pk_bf16_f32 v54, v148, v149
  v_mfma_f32_16x16x32_bf16 v[236:239], a[216:219], a[200:203], v[36:39]
  buffer_load_dwordx4 v24, s[88:91], s51 offen offset:1024 lds
  v_mfma_f32_16x16x32_bf16 v[236:239], a[220:223], a[204:207], v[236:239]
  v_cvt_pk_bf16_f32 v55, v150, v151
  v_mfma_f32_16x16x32_bf16 v[232:235], a[212:215], a[204:207], v[32:35]
  v_mfma_f32_16x16x32_bf16 v[232:235], a[208:211], a[200:203], v[232:235]
  s_waitcnt lgkmcnt(4)
  v_mfma_f32_16x16x32_bf16 v[240:243], a[224:227], a[144:147], 0
  v_add_u32 v12, 65536, v27
  v_add_u32 v25, 65536, v28
  v_mfma_f32_16x16x32_bf16 v[240:243], a[228:231], a[148:151], v[240:243]
  s_add_u32 s5, s53, 12288
  v_mfma_f32_16x16x32_bf16 v[244:247], a[236:239], a[148:151], 0
  buffer_store_dwordx4 v[112:115], v0, s[16:19], s5 offen offset:0 sc1
  v_mfma_f32_16x16x32_bf16 v[244:247], a[232:235], a[144:147], v[244:247]
  v_mfma_f32_16x16x32_bf16 v[248:251], a[240:243], a[144:147], 0
  v_mul_f32 v152, s96, v152
  v_mfma_f32_16x16x32_bf16 v[248:251], a[244:247], a[148:151], v[248:251]
  s_waitcnt vmcnt(19) lgkmcnt(0)
  s_barrier
  v_mfma_f32_16x16x32_bf16 v[252:255], a[252:255], a[148:151], 0
  ds_read_b128 a[148:151], v25 offset:0
  s_add_u32 m0, s41, 131072
  v_mfma_f32_16x16x32_bf16 v[252:255], a[248:251], a[144:147], v[252:255]
  ds_read_b128 a[144:147], v12 offset:0
  ds_read_b64_tr_b16 a[208:209], v17 offset:32768
  v_mfma_f32_16x16x32_bf16 v[76:79], a[248:251], a[152:155], 0
  s_bfe_u32 s6, s76, 0x4000c
  v_mul_f32 v153, s96, v153
  v_mfma_f32_16x16x32_bf16 v[76:79], a[252:255], a[156:159], v[76:79]
  v_mul_f32 v154, s96, v154
  v_mul_f32 v155, s96, v155
  v_mfma_f32_16x16x32_bf16 v[72:75], a[244:247], a[156:159], 0
  s_mul_i32 s6, s6, 128
  v_mul_f32 v156, s96, v156
  v_mfma_f32_16x16x32_bf16 v[72:75], a[240:243], a[152:155], v[72:75]
  v_mul_f32 v157, s96, v157
  v_mfma_f32_16x16x32_bf16 v[68:71], a[232:235], a[152:155], 0
  ds_read_b64_tr_b16 a[210:211], v17 offset:33280
  v_mul_f32 v158, s96, v158
  v_mfma_f32_16x16x32_bf16 v[68:71], a[236:239], a[156:159], v[68:71]
  s_add_u32 s6, s6, s49
  v_mul_f32 v159, s96, v159
  v_mfma_f32_16x16x32_bf16 v[64:67], a[228:231], a[156:159], 0
  ds_read_b128 a[156:159], v25 offset:4096
  v_cvt_pk_bf16_f32 v2, v152, v153
  v_mfma_f32_16x16x32_bf16 v[64:67], a[224:227], a[152:155], v[64:67]
  ds_read_b128 a[152:155], v12 offset:4096
  v_mfma_f32_16x16x32_bf16 v[80:83], a[224:227], a[160:163], 0
  buffer_load_dwordx4 v19, s[28:31], s6 offen offset:0 lds
  v_mfma_f32_16x16x32_bf16 v[80:83], a[228:231], a[164:167], v[80:83]
  v_cvt_pk_bf16_f32 v3, v154, v155
  v_cvt_pk_bf16_f32 v4, v156, v157
  v_mfma_f32_16x16x32_bf16 v[84:87], a[236:239], a[164:167], 0
  ds_read_b64_tr_b16 a[212:213], v17 offset:36864
  v_cvt_pk_bf16_f32 v5, v158, v159
  v_mfma_f32_16x16x32_bf16 v[84:87], a[232:235], a[160:163], v[84:87]
  v_mfma_f32_16x16x32_bf16 v[88:91], a[240:243], a[160:163], 0
  buffer_load_dwordx4 v20, s[28:31], s6 offen offset:1024 lds
  v_mfma_f32_16x16x32_bf16 v[88:91], a[244:247], a[164:167], v[88:91]
  v_mul_f32 v160, s96, v160
  v_mul_f32 v161, s96, v161
  v_mfma_f32_16x16x32_bf16 v[92:95], a[252:255], a[164:167], 0
  ds_read_b128 a[164:167], v25 offset:8192
  v_mfma_f32_16x16x32_bf16 v[92:95], a[248:251], a[160:163], v[92:95]
  ds_read_b128 a[160:163], v12 offset:8192
  v_mul_f32 v162, s96, v162
  v_mfma_f32_16x16x32_bf16 v[108:111], a[248:251], a[168:171], 0
  ds_read_b64_tr_b16 a[214:215], v17 offset:37376
  v_mul_f32 v163, s96, v163
  v_mfma_f32_16x16x32_bf16 v[108:111], a[252:255], a[172:175], v[108:111]
  buffer_load_dwordx4 v21, s[28:31], s6 offen offset:2048 lds
  v_mfma_f32_16x16x32_bf16 v[104:107], a[244:247], a[172:175], 0
  v_mul_f32 v164, s96, v164
  v_mfma_f32_16x16x32_bf16 v[104:107], a[240:243], a[168:171], v[104:107]
  v_mul_f32 v165, s96, v165
  v_mfma_f32_16x16x32_bf16 v[100:103], a[232:235], a[168:171], 0
  v_mul_f32 v166, s96, v166
  v_mfma_f32_16x16x32_bf16 v[100:103], a[236:239], a[172:175], v[100:103]
  buffer_load_dwordx4 v22, s[28:31], s6 offen offset:3072 lds
  v_mfma_f32_16x16x32_bf16 v[96:99], a[228:231], a[172:175], 0
  ds_read_b128 a[172:175], v25 offset:12288
  ds_read_b64_tr_b16 a[216:217], v18 offset:32768
  v_mfma_f32_16x16x32_bf16 v[96:99], a[224:227], a[168:171], v[96:99]
  ds_read_b128 a[168:171], v12 offset:12288
  s_add_u32 s5, s53, 12288
  v_mfma_f32_16x16x32_bf16 v[112:115], a[224:227], a[176:179], 0
  v_mul_f32 v167, s96, v167
  v_cvt_pk_bf16_f32 v32, v160, v161
  v_mfma_f32_16x16x32_bf16 v[112:115], a[228:231], a[180:183], v[112:115]
  v_cvt_pk_bf16_f32 v33, v162, v163
  v_cvt_pk_bf16_f32 v34, v164, v165
  v_mfma_f32_16x16x32_bf16 v[116:119], a[236:239], a[180:183], 0
  s_add_u32 m0, s41, 16384
  v_mfma_f32_16x16x32_bf16 v[116:119], a[232:235], a[176:179], v[116:119]
  buffer_store_dwordx4 v[40:43], v0, s[16:19], s5 offen offset:1024 sc1
  v_mfma_f32_16x16x32_bf16 v[120:123], a[240:243], a[176:179], 0
  ds_read_b64_tr_b16 a[218:219], v18 offset:33280
  v_cvt_pk_bf16_f32 v35, v166, v167
  v_mfma_f32_16x16x32_bf16 v[120:123], a[244:247], a[180:183], v[120:123]
  s_bfe_u32 s62, s76, 0x40008
  v_mul_f32 v168, s96, v168
  v_mfma_f32_16x16x32_bf16 v[124:127], a[252:255], a[180:183], 0
  ds_read_b128 a[180:183], v25 offset:16384
  v_mul_f32 v169, s96, v169
  v_mfma_f32_16x16x32_bf16 v[124:127], a[248:251], a[176:179], v[124:127]
  ds_read_b128 a[176:179], v12 offset:16384
  s_mul_i32 s62, s62, 524288
  v_mfma_f32_16x16x32_bf16 v[140:143], a[248:251], a[184:187], 0
  v_mul_f32 v170, s96, v170
  v_mul_f32 v171, s96, v171
  v_mfma_f32_16x16x32_bf16 v[140:143], a[252:255], a[188:191], v[140:143]
  buffer_load_dwordx4 v6, s[32:35], s62 offen offset:0 lds
  v_mfma_f32_16x16x32_bf16 v[136:139], a[244:247], a[188:191], 0
  ds_read_b64_tr_b16 a[220:221], v18 offset:36864
  v_mul_f32 v172, s96, v172
  v_mfma_f32_16x16x32_bf16 v[136:139], a[240:243], a[184:187], v[136:139]
  v_mul_f32 v173, s96, v173
  v_mfma_f32_16x16x32_bf16 v[132:135], a[232:235], a[184:187], 0
  v_mul_f32 v174, s96, v174
  v_mfma_f32_16x16x32_bf16 v[132:135], a[236:239], a[188:191], v[132:135]
  v_mfma_f32_16x16x32_bf16 v[128:131], a[228:231], a[188:191], 0
  ds_read_b128 a[188:191], v25 offset:20480
  v_mul_f32 v175, s96, v175
  v_mfma_f32_16x16x32_bf16 v[128:131], a[224:227], a[184:187], v[128:131]
  ds_read_b128 a[184:187], v12 offset:20480
  s_add_u32 s5, s53, 16384
  v_cvt_pk_bf16_f32 v36, v168, v169
  v_mfma_f32_16x16x32_bf16 v[144:147], a[224:227], a[192:195], 0
  buffer_load_dwordx4 v7, s[32:35], s62 offen offset:1024 lds
  v_mfma_f32_16x16x32_bf16 v[144:147], a[228:231], a[196:199], v[144:147]
  ds_read_b64_tr_b16 a[222:223], v18 offset:37376
  v_cvt_pk_bf16_f32 v37, v170, v171
  v_mfma_f32_16x16x32_bf16 v[148:151], a[236:239], a[196:199], 0
  v_cvt_pk_bf16_f32 v38, v172, v173
  v_mfma_f32_16x16x32_bf16 v[148:151], a[232:235], a[192:195], v[148:151]
  buffer_load_dwordx4 v8, s[32:35], s62 offen offset:2048 lds
  v_cvt_pk_bf16_f32 v39, v174, v175
  v_mfma_f32_16x16x32_bf16 v[152:155], a[240:243], a[192:195], 0
  buffer_store_dwordx4 v[44:47], v0, s[16:19], s5 offen offset:0 sc1
  v_mfma_f32_16x16x32_bf16 v[152:155], a[244:247], a[196:199], v[152:155]
  v_mfma_f32_16x16x32_bf16 v[156:159], a[252:255], a[196:199], 0
  ds_read_b128 a[196:199], v25 offset:24576
  v_mfma_f32_16x16x32_bf16 v[156:159], a[248:251], a[192:195], v[156:159]
  ds_read_b128 a[192:195], v12 offset:24576
  v_mfma_f32_16x16x32_bf16 v[172:175], a[248:251], a[200:203], 0
  buffer_load_dwordx4 v9, s[32:35], s62 offen offset:3072 lds
  v_mfma_f32_16x16x32_bf16 v[172:175], a[252:255], a[204:207], v[172:175]
  v_mfma_f32_16x16x32_bf16 v[168:171], a[244:247], a[204:207], 0
  v_mfma_f32_16x16x32_bf16 v[168:171], a[240:243], a[200:203], v[168:171]
  v_mfma_f32_16x16x32_bf16 v[164:167], a[232:235], a[200:203], 0
  v_mfma_f32_16x16x32_bf16 v[164:167], a[236:239], a[204:207], v[164:167]
  v_mfma_f32_16x16x32_bf16 v[160:163], a[228:231], a[204:207], 0
  ds_read_b128 a[204:207], v25 offset:28672
  v_mfma_f32_16x16x32_bf16 v[160:163], a[224:227], a[200:203], v[160:163]
  ds_read_b128 a[200:203], v12 offset:28672
  s_waitcnt lgkmcnt(4)
  v_mfma_f32_16x16x32_bf16 v[176:179], a[208:211], a[144:147], v[176:179]
  s_add_u32 s5, s53, 16384
  v_mfma_f32_16x16x32_bf16 v[176:179], a[212:215], a[148:151], v[176:179]
  v_mfma_f32_16x16x32_bf16 v[180:183], a[220:223], a[148:151], v[180:183]
  v_mfma_f32_16x16x32_bf16 v[180:183], a[216:219], a[144:147], v[180:183]
  v_mfma_f32_16x16x32_bf16 v[188:191], a[216:219], a[152:155], v[188:191]
  v_mfma_f32_16x16x32_bf16 v[188:191], a[220:223], a[156:159], v[188:191]
  s_waitcnt vmcnt(18) lgkmcnt(0)
  s_barrier
  v_mfma_f32_16x16x32_bf16 v[184:187], a[212:215], a[156:159], v[184:187]
  s_add_u32 m0, s41, 147456
  ds_read_b64_tr_b16 a[224:225], v13 offset:49152
  v_mfma_f32_16x16x32_bf16 v[184:187], a[208:211], a[152:155], v[184:187]
  s_bfe_u32 s6, s76, 0x4000c
  ds_read_b64_tr_b16 a[226:227], v13 offset:50176
  v_mfma_f32_16x16x32_bf16 v[192:195], a[208:211], a[160:163], v[192:195]
  s_mul_i32 s6, s6, 128
  ds_read_b64_tr_b16 a[228:229], v13 offset:57344
  v_mfma_f32_16x16x32_bf16 v[192:195], a[212:215], a[164:167], v[192:195]
  s_add_u32 s6, s6, s50
  v_mfma_f32_16x16x32_bf16 v[196:199], a[220:223], a[164:167], v[196:199]
  ds_read_b64_tr_b16 a[230:231], v13 offset:58368
  v_mfma_f32_16x16x32_bf16 v[196:199], a[216:219], a[160:163], v[196:199]
  buffer_load_dwordx4 v19, s[28:31], s6 offen offset:0 lds
  v_mfma_f32_16x16x32_bf16 v[204:207], a[216:219], a[168:171], v[204:207]
  ds_read_b64_tr_b16 a[232:233], v14 offset:49152
  v_mfma_f32_16x16x32_bf16 v[204:207], a[220:223], a[172:175], v[204:207]
  buffer_load_dwordx4 v20, s[28:31], s6 offen offset:1024 lds
  v_mfma_f32_16x16x32_bf16 v[200:203], a[212:215], a[172:175], v[200:203]
  ds_read_b64_tr_b16 a[234:235], v14 offset:50176
  ds_read_b64_tr_b16 a[236:237], v14 offset:57344
  v_mfma_f32_16x16x32_bf16 v[200:203], a[208:211], a[168:171], v[200:203]
  buffer_store_dwordx4 v[48:51], v0, s[16:19], s5 offen offset:1024 sc1
  v_mfma_f32_16x16x32_bf16 v[208:211], a[208:211], a[176:179], v[208:211]
  buffer_load_dwordx4 v21, s[28:31], s6 offen offset:2048 lds
  v_mfma_f32_16x16x32_bf16 v[208:211], a[212:215], a[180:183], v[208:211]
  ds_read_b64_tr_b16 a[238:239], v14 offset:58368
  ds_read_b64_tr_b16 a[240:241], v15 offset:49152
  v_mfma_f32_16x16x32_bf16 v[212:215], a[220:223], a[180:183], v[212:215]
  buffer_load_dwordx4 v22, s[28:31], s6 offen offset:3072 lds
  v_mfma_f32_16x16x32_bf16 v[212:215], a[216:219], a[176:179], v[212:215]
  ds_read_b64_tr_b16 a[242:243], v15 offset:50176
  v_mfma_f32_16x16x32_bf16 v[220:223], a[216:219], a[184:187], v[220:223]
  ds_read_b64_tr_b16 a[244:245], v15 offset:57344
  v_mfma_f32_16x16x32_bf16 v[220:223], a[220:223], a[188:191], v[220:223]
  s_lshl_b32 m0, s38, 11
  ds_read_b64_tr_b16 a[246:247], v15 offset:58368
  v_mfma_f32_16x16x32_bf16 v[216:219], a[212:215], a[188:191], v[216:219]
  s_add_u32 m0, m0, 32768
  v_mfma_f32_16x16x32_bf16 v[216:219], a[208:211], a[184:187], v[216:219]
  s_bfe_u32 s51, s76, 0x4000c
  ds_read_b64_tr_b16 a[248:249], v16 offset:49152
  v_mfma_f32_16x16x32_bf16 v[224:227], a[208:211], a[192:195], v[224:227]
  s_mul_i32 s51, s51, s52
  ds_read_b64_tr_b16 a[250:251], v16 offset:50176
  v_mfma_f32_16x16x32_bf16 v[224:227], a[212:215], a[196:199], v[224:227]
  v_mfma_f32_16x16x32_bf16 v[228:231], a[220:223], a[196:199], v[228:231]
  buffer_load_dwordx4 v23, s[88:91], s51 offen offset:0 lds
  v_mfma_f32_16x16x32_bf16 v[228:231], a[216:219], a[192:195], v[228:231]
  ds_read_b64_tr_b16 a[252:253], v16 offset:57344
  ds_read_b64_tr_b16 a[254:255], v16 offset:58368
  v_mfma_f32_16x16x32_bf16 v[236:239], a[216:219], a[200:203], v[236:239]
  buffer_load_dwordx4 v24, s[88:91], s51 offen offset:1024 lds
  v_mfma_f32_16x16x32_bf16 v[236:239], a[220:223], a[204:207], v[236:239]
  v_mfma_f32_16x16x32_bf16 v[232:235], a[212:215], a[204:207], v[232:235]
  v_mfma_f32_16x16x32_bf16 v[232:235], a[208:211], a[200:203], v[232:235]
  s_waitcnt lgkmcnt(4)
  v_mfma_f32_16x16x32_bf16 v[240:243], a[224:227], a[144:147], v[240:243]
  v_add_u32 v12, 98304, v27
  v_add_u32 v25, 98304, v28
  v_mfma_f32_16x16x32_bf16 v[240:243], a[228:231], a[148:151], v[240:243]
  s_add_u32 s5, s53, 20480
  v_mfma_f32_16x16x32_bf16 v[244:247], a[236:239], a[148:151], v[244:247]
  v_mfma_f32_16x16x32_bf16 v[244:247], a[232:235], a[144:147], v[244:247]
  v_mfma_f32_16x16x32_bf16 v[248:251], a[240:243], a[144:147], v[248:251]
  v_mfma_f32_16x16x32_bf16 v[248:251], a[244:247], a[148:151], v[248:251]
  s_waitcnt vmcnt(18) lgkmcnt(0)
  s_barrier
  v_mfma_f32_16x16x32_bf16 v[252:255], a[252:255], a[148:151], v[252:255]
  ds_read_b128 a[148:151], v25 offset:0
  s_add_u32 m0, s41, 65536
  v_mfma_f32_16x16x32_bf16 v[252:255], a[248:251], a[144:147], v[252:255]
  ds_read_b128 a[144:147], v12 offset:0
  ds_read_b64_tr_b16 a[208:209], v17 offset:0
  v_mfma_f32_16x16x32_bf16 v[76:79], a[248:251], a[152:155], v[76:79]
  s_bfe_u32 s6, s76, 0x40010
  v_mfma_f32_16x16x32_bf16 v[76:79], a[252:255], a[156:159], v[76:79]
  buffer_store_dwordx4 v[52:55], v0, s[16:19], s5 offen offset:0 sc1
  v_mfma_f32_16x16x32_bf16 v[72:75], a[244:247], a[156:159], v[72:75]
  s_mul_i32 s6, s6, 128
  v_mfma_f32_16x16x32_bf16 v[72:75], a[240:243], a[152:155], v[72:75]
  v_mfma_f32_16x16x32_bf16 v[68:71], a[232:235], a[152:155], v[68:71]
  ds_read_b64_tr_b16 a[210:211], v17 offset:512
  v_mfma_f32_16x16x32_bf16 v[68:71], a[236:239], a[156:159], v[68:71]
  s_add_u32 s6, s6, s49
  v_mfma_f32_16x16x32_bf16 v[64:67], a[228:231], a[156:159], v[64:67]
  ds_read_b128 a[156:159], v25 offset:4096
  v_mfma_f32_16x16x32_bf16 v[64:67], a[224:227], a[152:155], v[64:67]
  ds_read_b128 a[152:155], v12 offset:4096
  v_mfma_f32_16x16x32_bf16 v[80:83], a[224:227], a[160:163], v[80:83]
  buffer_load_dwordx4 v19, s[28:31], s6 offen offset:0 lds
  v_mfma_f32_16x16x32_bf16 v[80:83], a[228:231], a[164:167], v[80:83]
  v_mfma_f32_16x16x32_bf16 v[84:87], a[236:239], a[164:167], v[84:87]
  ds_read_b64_tr_b16 a[212:213], v17 offset:4096
  v_mfma_f32_16x16x32_bf16 v[84:87], a[232:235], a[160:163], v[84:87]
  v_mfma_f32_16x16x32_bf16 v[88:91], a[240:243], a[160:163], v[88:91]
  buffer_load_dwordx4 v20, s[28:31], s6 offen offset:1024 lds
  v_mfma_f32_16x16x32_bf16 v[88:91], a[244:247], a[164:167], v[88:91]
  s_add_u32 s5, s53, 20480
  v_mfma_f32_16x16x32_bf16 v[92:95], a[252:255], a[164:167], v[92:95]
  ds_read_b128 a[164:167], v25 offset:8192
  v_mfma_f32_16x16x32_bf16 v[92:95], a[248:251], a[160:163], v[92:95]
  ds_read_b128 a[160:163], v12 offset:8192
  v_mfma_f32_16x16x32_bf16 v[108:111], a[248:251], a[168:171], v[108:111]
  ds_read_b64_tr_b16 a[214:215], v17 offset:4608
  v_mfma_f32_16x16x32_bf16 v[108:111], a[252:255], a[172:175], v[108:111]
  buffer_load_dwordx4 v21, s[28:31], s6 offen offset:2048 lds
  v_mfma_f32_16x16x32_bf16 v[104:107], a[244:247], a[172:175], v[104:107]
  v_mfma_f32_16x16x32_bf16 v[104:107], a[240:243], a[168:171], v[104:107]
  v_mfma_f32_16x16x32_bf16 v[100:103], a[232:235], a[168:171], v[100:103]
  buffer_store_dwordx4 v[2:5], v0, s[16:19], s5 offen offset:1024 sc1
  v_mfma_f32_16x16x32_bf16 v[100:103], a[236:239], a[172:175], v[100:103]
  buffer_load_dwordx4 v22, s[28:31], s6 offen offset:3072 lds
  v_mfma_f32_16x16x32_bf16 v[96:99], a[228:231], a[172:175], v[96:99]
  ds_read_b128 a[172:175], v25 offset:12288
  ds_read_b64_tr_b16 a[216:217], v18 offset:0
  v_mfma_f32_16x16x32_bf16 v[96:99], a[224:227], a[168:171], v[96:99]
  ds_read_b128 a[168:171], v12 offset:12288
  v_mfma_f32_16x16x32_bf16 v[112:115], a[224:227], a[176:179], v[112:115]
  v_mfma_f32_16x16x32_bf16 v[112:115], a[228:231], a[180:183], v[112:115]
  v_mfma_f32_16x16x32_bf16 v[116:119], a[236:239], a[180:183], v[116:119]
  s_add_u32 m0, s41, 49152
  v_mfma_f32_16x16x32_bf16 v[116:119], a[232:235], a[176:179], v[116:119]
  v_mfma_f32_16x16x32_bf16 v[120:123], a[240:243], a[176:179], v[120:123]
  ds_read_b64_tr_b16 a[218:219], v18 offset:512
  v_mfma_f32_16x16x32_bf16 v[120:123], a[244:247], a[180:183], v[120:123]
  s_bfe_u32 s62, s76, 0x4000c
  v_mfma_f32_16x16x32_bf16 v[124:127], a[252:255], a[180:183], v[124:127]
  ds_read_b128 a[180:183], v25 offset:16384
  v_mfma_f32_16x16x32_bf16 v[124:127], a[248:251], a[176:179], v[124:127]
  ds_read_b128 a[176:179], v12 offset:16384
  s_mul_i32 s62, s62, 524288
  v_mfma_f32_16x16x32_bf16 v[140:143], a[248:251], a[184:187], v[140:143]
  v_mfma_f32_16x16x32_bf16 v[140:143], a[252:255], a[188:191], v[140:143]
  buffer_load_dwordx4 v6, s[32:35], s62 offen offset:0 lds
  v_mfma_f32_16x16x32_bf16 v[136:139], a[244:247], a[188:191], v[136:139]
  ds_read_b64_tr_b16 a[220:221], v18 offset:4096
  s_add_u32 s5, s53, 24576
  v_mfma_f32_16x16x32_bf16 v[136:139], a[240:243], a[184:187], v[136:139]
  v_mfma_f32_16x16x32_bf16 v[132:135], a[232:235], a[184:187], v[132:135]
  v_mfma_f32_16x16x32_bf16 v[132:135], a[236:239], a[188:191], v[132:135]
  v_mfma_f32_16x16x32_bf16 v[128:131], a[228:231], a[188:191], v[128:131]
  ds_read_b128 a[188:191], v25 offset:20480
  v_mfma_f32_16x16x32_bf16 v[128:131], a[224:227], a[184:187], v[128:131]
  ds_read_b128 a[184:187], v12 offset:20480
  v_mfma_f32_16x16x32_bf16 v[144:147], a[224:227], a[192:195], v[144:147]
  buffer_load_dwordx4 v7, s[32:35], s62 offen offset:1024 lds
  v_mfma_f32_16x16x32_bf16 v[144:147], a[228:231], a[196:199], v[144:147]
  ds_read_b64_tr_b16 a[222:223], v18 offset:4608
  v_mfma_f32_16x16x32_bf16 v[148:151], a[236:239], a[196:199], v[148:151]
  buffer_store_dwordx4 v[32:35], v0, s[16:19], s5 offen offset:0 sc1
  v_mfma_f32_16x16x32_bf16 v[148:151], a[232:235], a[192:195], v[148:151]
  buffer_load_dwordx4 v8, s[32:35], s62 offen offset:2048 lds
  v_mfma_f32_16x16x32_bf16 v[152:155], a[240:243], a[192:195], v[152:155]
  v_mfma_f32_16x16x32_bf16 v[152:155], a[244:247], a[196:199], v[152:155]
  v_mfma_f32_16x16x32_bf16 v[156:159], a[252:255], a[196:199], v[156:159]
  ds_read_b128 a[196:199], v25 offset:24576
  v_mfma_f32_16x16x32_bf16 v[156:159], a[248:251], a[192:195], v[156:159]
  ds_read_b128 a[192:195], v12 offset:24576
  v_mfma_f32_16x16x32_bf16 v[172:175], a[248:251], a[200:203], v[172:175]
  buffer_load_dwordx4 v9, s[32:35], s62 offen offset:3072 lds
  v_mfma_f32_16x16x32_bf16 v[172:175], a[252:255], a[204:207], v[172:175]
  v_mfma_f32_16x16x32_bf16 v[168:171], a[244:247], a[204:207], v[168:171]
  v_mfma_f32_16x16x32_bf16 v[168:171], a[240:243], a[200:203], v[168:171]
  v_mfma_f32_16x16x32_bf16 v[164:167], a[232:235], a[200:203], v[164:167]
  v_mfma_f32_16x16x32_bf16 v[164:167], a[236:239], a[204:207], v[164:167]
  v_mfma_f32_16x16x32_bf16 v[160:163], a[228:231], a[204:207], v[160:163]
  ds_read_b128 a[204:207], v25 offset:28672
  v_mfma_f32_16x16x32_bf16 v[160:163], a[224:227], a[200:203], v[160:163]
  ds_read_b128 a[200:203], v12 offset:28672
  s_waitcnt lgkmcnt(4)
  v_mfma_f32_16x16x32_bf16 v[176:179], a[208:211], a[144:147], v[176:179]
  s_add_u32 s5, s53, 24576
  v_mfma_f32_16x16x32_bf16 v[176:179], a[212:215], a[148:151], v[176:179]
  v_mfma_f32_16x16x32_bf16 v[180:183], a[220:223], a[148:151], v[180:183]
  v_mfma_f32_16x16x32_bf16 v[180:183], a[216:219], a[144:147], v[180:183]
  v_mfma_f32_16x16x32_bf16 v[188:191], a[216:219], a[152:155], v[188:191]
  v_mfma_f32_16x16x32_bf16 v[188:191], a[220:223], a[156:159], v[188:191]
  s_waitcnt vmcnt(18) lgkmcnt(0)
  s_barrier
  v_mfma_f32_16x16x32_bf16 v[184:187], a[212:215], a[156:159], v[184:187]
  s_add_u32 m0, s41, 81920
  ds_read_b64_tr_b16 a[224:225], v13 offset:16384
  v_mfma_f32_16x16x32_bf16 v[184:187], a[208:211], a[152:155], v[184:187]
  s_bfe_u32 s6, s76, 0x40010
  ds_read_b64_tr_b16 a[226:227], v13 offset:17408
  v_mfma_f32_16x16x32_bf16 v[192:195], a[208:211], a[160:163], v[192:195]
  s_mul_i32 s6, s6, 128
  ds_read_b64_tr_b16 a[228:229], v13 offset:24576
  v_mfma_f32_16x16x32_bf16 v[192:195], a[212:215], a[164:167], v[192:195]
  s_add_u32 s6, s6, s50
  v_mfma_f32_16x16x32_bf16 v[196:199], a[220:223], a[164:167], v[196:199]
  ds_read_b64_tr_b16 a[230:231], v13 offset:25600
  v_mfma_f32_16x16x32_bf16 v[196:199], a[216:219], a[160:163], v[196:199]
  buffer_load_dwordx4 v19, s[28:31], s6 offen offset:0 lds
  v_mfma_f32_16x16x32_bf16 v[204:207], a[216:219], a[168:171], v[204:207]
  ds_read_b64_tr_b16 a[232:233], v14 offset:16384
  v_mfma_f32_16x16x32_bf16 v[204:207], a[220:223], a[172:175], v[204:207]
  buffer_load_dwordx4 v20, s[28:31], s6 offen offset:1024 lds
  v_mfma_f32_16x16x32_bf16 v[200:203], a[212:215], a[172:175], v[200:203]
  ds_read_b64_tr_b16 a[234:235], v14 offset:17408
  ds_read_b64_tr_b16 a[236:237], v14 offset:24576
  v_mfma_f32_16x16x32_bf16 v[200:203], a[208:211], a[168:171], v[200:203]
  buffer_store_dwordx4 v[36:39], v0, s[16:19], s5 offen offset:1024 sc1
  v_mfma_f32_16x16x32_bf16 v[208:211], a[208:211], a[176:179], v[208:211]
  buffer_load_dwordx4 v21, s[28:31], s6 offen offset:2048 lds
  v_mfma_f32_16x16x32_bf16 v[208:211], a[212:215], a[180:183], v[208:211]
  ds_read_b64_tr_b16 a[238:239], v14 offset:25600
  ds_read_b64_tr_b16 a[240:241], v15 offset:16384
  v_mfma_f32_16x16x32_bf16 v[212:215], a[220:223], a[180:183], v[212:215]
  ds_read_b64_tr_b16 a[242:243], v15 offset:17408
  v_mfma_f32_16x16x32_bf16 v[212:215], a[216:219], a[176:179], v[212:215]
  buffer_load_dwordx4 v22, s[28:31], s6 offen offset:3072 lds
  v_mfma_f32_16x16x32_bf16 v[220:223], a[216:219], a[184:187], v[220:223]
  ds_read_b64_tr_b16 a[244:245], v15 offset:24576
  v_mfma_f32_16x16x32_bf16 v[220:223], a[220:223], a[188:191], v[220:223]
  s_lshl_b32 m0, s38, 11
  ds_read_b64_tr_b16 a[246:247], v15 offset:25600
  v_mfma_f32_16x16x32_bf16 v[216:219], a[212:215], a[188:191], v[216:219]
  v_mfma_f32_16x16x32_bf16 v[216:219], a[208:211], a[184:187], v[216:219]
  s_bfe_u32 s51, s76, 0x40010
  ds_read_b64_tr_b16 a[248:249], v16 offset:16384
  v_mfma_f32_16x16x32_bf16 v[224:227], a[208:211], a[192:195], v[224:227]
  s_mul_i32 s51, s51, s52
  ds_read_b64_tr_b16 a[250:251], v16 offset:17408
  v_mfma_f32_16x16x32_bf16 v[224:227], a[212:215], a[196:199], v[224:227]
  buffer_load_dwordx4 v23, s[88:91], s51 offen offset:0 lds
  v_mfma_f32_16x16x32_bf16 v[228:231], a[220:223], a[196:199], v[228:231]
  ds_read_b64_tr_b16 a[252:253], v16 offset:24576
  v_mfma_f32_16x16x32_bf16 v[228:231], a[216:219], a[192:195], v[228:231]
  ds_read_b64_tr_b16 a[254:255], v16 offset:25600
  v_mfma_f32_16x16x32_bf16 v[236:239], a[216:219], a[200:203], v[236:239]
  buffer_load_dwordx4 v24, s[88:91], s51 offen offset:1024 lds
  v_mfma_f32_16x16x32_bf16 v[236:239], a[220:223], a[204:207], v[236:239]
  v_mfma_f32_16x16x32_bf16 v[232:235], a[212:215], a[204:207], v[232:235]
  v_mfma_f32_16x16x32_bf16 v[232:235], a[208:211], a[200:203], v[232:235]
  s_waitcnt lgkmcnt(4)
  v_mfma_f32_16x16x32_bf16 v[240:243], a[224:227], a[144:147], v[240:243]
  v_add_u32 v12, 131072, v27
  v_add_u32 v25, 131072, v28
  v_mfma_f32_16x16x32_bf16 v[240:243], a[228:231], a[148:151], v[240:243]
  v_accvgpr_read_b32 v40, a0
  v_accvgpr_read_b32 v41, a1
  v_mfma_f32_16x16x32_bf16 v[244:247], a[236:239], a[148:151], v[244:247]
  v_accvgpr_read_b32 v42, a2
  v_mfma_f32_16x16x32_bf16 v[244:247], a[232:235], a[144:147], v[244:247]
  v_accvgpr_read_b32 v43, a3
  v_mfma_f32_16x16x32_bf16 v[248:251], a[240:243], a[144:147], v[248:251]
  v_accvgpr_read_b32 v44, a4
  v_mfma_f32_16x16x32_bf16 v[248:251], a[244:247], a[148:151], v[248:251]
  s_waitcnt vmcnt(18) lgkmcnt(0)
  s_barrier
  v_mfma_f32_16x16x32_bf16 v[252:255], a[252:255], a[148:151], v[252:255]
  ds_read_b128 a[148:151], v25 offset:0
  s_add_u32 m0, s41, 98304
  v_mfma_f32_16x16x32_bf16 v[252:255], a[248:251], a[144:147], v[252:255]
  ds_read_b128 a[144:147], v12 offset:0
  ds_read_b64_tr_b16 a[208:209], v17 offset:32768
  v_mfma_f32_16x16x32_bf16 v[76:79], a[248:251], a[152:155], v[76:79]
  s_bfe_u32 s6, s76, 0x40014
  v_accvgpr_read_b32 v45, a5
  v_mfma_f32_16x16x32_bf16 v[76:79], a[252:255], a[156:159], v[76:79]
  v_accvgpr_read_b32 v46, a6
  v_accvgpr_read_b32 v47, a7
  v_mfma_f32_16x16x32_bf16 v[72:75], a[244:247], a[156:159], v[72:75]
  s_mul_i32 s6, s6, 128
  v_mul_f32 v40, s96, v40
  v_mfma_f32_16x16x32_bf16 v[72:75], a[240:243], a[152:155], v[72:75]
  v_mul_f32 v41, s96, v41
  v_mul_f32 v42, s96, v42
  v_mfma_f32_16x16x32_bf16 v[68:71], a[232:235], a[152:155], v[68:71]
  ds_read_b64_tr_b16 a[210:211], v17 offset:33280
  v_mul_f32 v43, s96, v43
  v_mfma_f32_16x16x32_bf16 v[68:71], a[236:239], a[156:159], v[68:71]
  s_add_u32 s6, s6, s49
  v_mul_f32 v44, s96, v44
  v_mfma_f32_16x16x32_bf16 v[64:67], a[228:231], a[156:159], v[64:67]
  ds_read_b128 a[156:159], v25 offset:4096
  v_mul_f32 v45, s96, v45
  v_mfma_f32_16x16x32_bf16 v[64:67], a[224:227], a[152:155], v[64:67]
  ds_read_b128 a[152:155], v12 offset:4096
  v_mul_f32 v46, s96, v46
  v_mfma_f32_16x16x32_bf16 v[80:83], a[224:227], a[160:163], v[80:83]
  buffer_load_dwordx4 v19, s[28:31], s6 offen offset:0 lds
  v_mfma_f32_16x16x32_bf16 v[80:83], a[228:231], a[164:167], v[80:83]
  v_mul_f32 v47, s96, v47
  v_cvt_pk_bf16_f32 v40, v40, v41
  v_mfma_f32_16x16x32_bf16 v[84:87], a[236:239], a[164:167], v[84:87]
  ds_read_b64_tr_b16 a[212:213], v17 offset:36864
  v_cvt_pk_bf16_f32 v41, v42, v43
  v_mfma_f32_16x16x32_bf16 v[84:87], a[232:235], a[160:163], v[84:87]
  v_cvt_pk_bf16_f32 v42, v44, v45
  v_cvt_pk_bf16_f32 v43, v46, v47
  v_mfma_f32_16x16x32_bf16 v[88:91], a[240:243], a[160:163], v[88:91]
  buffer_load_dwordx4 v20, s[28:31], s6 offen offset:1024 lds
  v_mfma_f32_16x16x32_bf16 v[88:91], a[244:247], a[164:167], v[88:91]
  s_add_u32 s5, s53, 28672
  v_mfma_f32_16x16x32_bf16 v[92:95], a[252:255], a[164:167], v[92:95]
  ds_read_b128 a[164:167], v25 offset:8192
  v_mfma_f32_16x16x32_bf16 v[92:95], a[248:251], a[160:163], v[92:95]
  ds_read_b128 a[160:163], v12 offset:8192
  v_mfma_f32_16x16x32_bf16 v[108:111], a[248:251], a[168:171], v[108:111]
  ds_read_b64_tr_b16 a[214:215], v17 offset:37376
  v_mfma_f32_16x16x32_bf16 v[108:111], a[252:255], a[172:175], v[108:111]
  buffer_load_dwordx4 v21, s[28:31], s6 offen offset:2048 lds
  v_mfma_f32_16x16x32_bf16 v[104:107], a[244:247], a[172:175], v[104:107]
  buffer_store_dwordx4 v[40:43], v0, s[16:19], s5 offen offset:0 sc1
  v_mfma_f32_16x16x32_bf16 v[104:107], a[240:243], a[168:171], v[104:107]
  v_accvgpr_read_b32 v48, a8
  v_accvgpr_read_b32 v49, a9
  v_mfma_f32_16x16x32_bf16 v[100:103], a[232:235], a[168:171], v[100:103]
  v_accvgpr_read_b32 v50, a10
  v_accvgpr_read_b32 v51, a11
  v_mfma_f32_16x16x32_bf16 v[100:103], a[236:239], a[172:175], v[100:103]
  buffer_load_dwordx4 v22, s[28:31], s6 offen offset:3072 lds
  v_mfma_f32_16x16x32_bf16 v[96:99], a[228:231], a[172:175], v[96:99]
  ds_read_b128 a[172:175], v25 offset:12288
  ds_read_b64_tr_b16 a[216:217], v18 offset:32768
  v_mfma_f32_16x16x32_bf16 v[96:99], a[224:227], a[168:171], v[96:99]
  ds_read_b128 a[168:171], v12 offset:12288
  v_accvgpr_read_b32 v52, a12
  v_mfma_f32_16x16x32_bf16 v[112:115], a[224:227], a[176:179], v[112:115]
  v_accvgpr_read_b32 v53, a13
  v_accvgpr_read_b32 v54, a14
  v_mfma_f32_16x16x32_bf16 v[112:115], a[228:231], a[180:183], v[112:115]
  v_accvgpr_read_b32 v55, a15
  v_mul_f32 v48, s96, v48
  v_mfma_f32_16x16x32_bf16 v[116:119], a[236:239], a[180:183], v[116:119]
  s_add_u32 m0, s41, 16384
  v_mul_f32 v49, s96, v49
  v_mfma_f32_16x16x32_bf16 v[116:119], a[232:235], a[176:179], v[116:119]
  v_mul_f32 v50, s96, v50
  v_mul_f32 v51, s96, v51
  v_mfma_f32_16x16x32_bf16 v[120:123], a[240:243], a[176:179], v[120:123]
  ds_read_b64_tr_b16 a[218:219], v18 offset:33280
  v_mul_f32 v52, s96, v52
  v_mfma_f32_16x16x32_bf16 v[120:123], a[244:247], a[180:183], v[120:123]
  s_bfe_u32 s62, s76, 0x40010
  v_mul_f32 v53, s96, v53
  v_mfma_f32_16x16x32_bf16 v[124:127], a[252:255], a[180:183], v[124:127]
  ds_read_b128 a[180:183], v25 offset:16384
  v_mul_f32 v54, s96, v54
  v_mfma_f32_16x16x32_bf16 v[124:127], a[248:251], a[176:179], v[124:127]
  ds_read_b128 a[176:179], v12 offset:16384
  s_mul_i32 s62, s62, 524288
  v_mfma_f32_16x16x32_bf16 v[140:143], a[248:251], a[184:187], v[140:143]
  v_mul_f32 v55, s96, v55
  v_cvt_pk_bf16_f32 v48, v48, v49
  v_mfma_f32_16x16x32_bf16 v[140:143], a[252:255], a[188:191], v[140:143]
  buffer_load_dwordx4 v6, s[32:35], s62 offen offset:0 lds
  v_mfma_f32_16x16x32_bf16 v[136:139], a[244:247], a[188:191], v[136:139]
  ds_read_b64_tr_b16 a[220:221], v18 offset:36864
  v_cvt_pk_bf16_f32 v49, v50, v51
  v_mfma_f32_16x16x32_bf16 v[136:139], a[240:243], a[184:187], v[136:139]
  v_cvt_pk_bf16_f32 v50, v52, v53
  v_mfma_f32_16x16x32_bf16 v[132:135], a[232:235], a[184:187], v[132:135]
  v_cvt_pk_bf16_f32 v51, v54, v55
  v_mfma_f32_16x16x32_bf16 v[132:135], a[236:239], a[188:191], v[132:135]
  s_add_u32 s5, s53, 28672
  v_mfma_f32_16x16x32_bf16 v[128:131], a[228:231], a[188:191], v[128:131]
  ds_read_b128 a[188:191], v25 offset:20480
  v_mfma_f32_16x16x32_bf16 v[128:131], a[224:227], a[184:187], v[128:131]
  ds_read_b128 a[184:187], v12 offset:20480
  v_mfma_f32_16x16x32_bf16 v[144:147], a[224:227], a[192:195], v[144:147]
  buffer_load_dwordx4 v7, s[32:35], s62 offen offset:1024 lds
  v_mfma_f32_16x16x32_bf16 v[144:147], a[228:231], a[196:199], v[144:147]
  ds_read_b64_tr_b16 a[222:223], v18 offset:37376
  v_mfma_f32_16x16x32_bf16 v[148:151], a[236:239], a[196:199], v[148:151]
  buffer_store_dwordx4 v[48:51], v0, s[16:19], s5 offen offset:1024 sc1
  v_mfma_f32_16x16x32_bf16 v[148:151], a[232:235], a[192:195], v[148:151]
  buffer_load_dwordx4 v8, s[32:35], s62 offen offset:2048 lds
  v_mfma_f32_16x16x32_bf16 v[152:155], a[240:243], a[192:195], v[152:155]
  v_accvgpr_read_b32 v40, a16
  v_accvgpr_read_b32 v41, a17
  v_mfma_f32_16x16x32_bf16 v[152:155], a[244:247], a[196:199], v[152:155]
  v_accvgpr_read_b32 v42, a18
  v_accvgpr_read_b32 v43, a19
  v_mfma_f32_16x16x32_bf16 v[156:159], a[252:255], a[196:199], v[156:159]
  ds_read_b128 a[196:199], v25 offset:24576
  v_accvgpr_read_b32 v44, a20
  v_mfma_f32_16x16x32_bf16 v[156:159], a[248:251], a[192:195], v[156:159]
  ds_read_b128 a[192:195], v12 offset:24576
  v_accvgpr_read_b32 v45, a21
  v_mfma_f32_16x16x32_bf16 v[172:175], a[248:251], a[200:203], v[172:175]
  buffer_load_dwordx4 v9, s[32:35], s62 offen offset:3072 lds
  v_mfma_f32_16x16x32_bf16 v[172:175], a[252:255], a[204:207], v[172:175]
  v_accvgpr_read_b32 v46, a22
  v_accvgpr_read_b32 v47, a23
  v_mfma_f32_16x16x32_bf16 v[168:171], a[244:247], a[204:207], v[168:171]
  v_cvt_pk_bf16_f32 v40, v40, v41
  v_cvt_pk_bf16_f32 v41, v42, v43
  v_mfma_f32_16x16x32_bf16 v[168:171], a[240:243], a[200:203], v[168:171]
  v_cvt_pk_bf16_f32 v42, v44, v45
  v_cvt_pk_bf16_f32 v43, v46, v47
  v_mfma_f32_16x16x32_bf16 v[164:167], a[232:235], a[200:203], v[164:167]
  s_add_u32 s5, s54, 0
  v_mfma_f32_16x16x32_bf16 v[164:167], a[236:239], a[204:207], v[164:167]
  buffer_store_dwordx4 v[40:43], v0, s[16:19], s5 offen offset:0 sc1
  v_mfma_f32_16x16x32_bf16 v[160:163], a[228:231], a[204:207], v[160:163]
  ds_read_b128 a[204:207], v25 offset:28672
  v_mfma_f32_16x16x32_bf16 v[160:163], a[224:227], a[200:203], v[160:163]
  ds_read_b128 a[200:203], v12 offset:28672
  s_waitcnt lgkmcnt(4)
  v_mfma_f32_16x16x32_bf16 v[176:179], a[208:211], a[144:147], v[176:179]
  v_accvgpr_read_b32 v48, a24
  v_mfma_f32_16x16x32_bf16 v[176:179], a[212:215], a[148:151], v[176:179]
  v_mfma_f32_16x16x32_bf16 v[180:183], a[220:223], a[148:151], v[180:183]
  v_accvgpr_read_b32 v49, a25
  v_mfma_f32_16x16x32_bf16 v[180:183], a[216:219], a[144:147], v[180:183]
  v_mfma_f32_16x16x32_bf16 v[188:191], a[216:219], a[152:155], v[188:191]
  v_accvgpr_read_b32 v50, a26
  v_mfma_f32_16x16x32_bf16 v[188:191], a[220:223], a[156:159], v[188:191]
  s_waitcnt vmcnt(18) lgkmcnt(0)
  s_barrier
  v_mfma_f32_16x16x32_bf16 v[184:187], a[212:215], a[156:159], v[184:187]
  s_add_u32 m0, s41, 114688
  ds_read_b64_tr_b16 a[224:225], v13 offset:49152
  v_mfma_f32_16x16x32_bf16 v[184:187], a[208:211], a[152:155], v[184:187]
  s_bfe_u32 s6, s76, 0x40014
  ds_read_b64_tr_b16 a[226:227], v13 offset:50176
  v_mfma_f32_16x16x32_bf16 v[192:195], a[208:211], a[160:163], v[192:195]
  s_mul_i32 s6, s6, 128
  ds_read_b64_tr_b16 a[228:229], v13 offset:57344
  v_mfma_f32_16x16x32_bf16 v[192:195], a[212:215], a[164:167], v[192:195]
  s_add_u32 s6, s6, s50
  v_accvgpr_read_b32 v51, a27
  v_mfma_f32_16x16x32_bf16 v[196:199], a[220:223], a[164:167], v[196:199]
  ds_read_b64_tr_b16 a[230:231], v13 offset:58368
  v_accvgpr_read_b32 v52, a28
  v_mfma_f32_16x16x32_bf16 v[196:199], a[216:219], a[160:163], v[196:199]
  buffer_load_dwordx4 v19, s[28:31], s6 offen offset:0 lds
  v_mfma_f32_16x16x32_bf16 v[204:207], a[216:219], a[168:171], v[204:207]
  ds_read_b64_tr_b16 a[232:233], v14 offset:49152
  v_accvgpr_read_b32 v53, a29
  v_mfma_f32_16x16x32_bf16 v[204:207], a[220:223], a[172:175], v[204:207]
  buffer_load_dwordx4 v20, s[28:31], s6 offen offset:1024 lds
  v_mfma_f32_16x16x32_bf16 v[200:203], a[212:215], a[172:175], v[200:203]
  ds_read_b64_tr_b16 a[234:235], v14 offset:50176
  ds_read_b64_tr_b16 a[236:237], v14 offset:57344
  v_mfma_f32_16x16x32_bf16 v[200:203], a[208:211], a[168:171], v[200:203]
  v_accvgpr_read_b32 v54, a30
  v_accvgpr_read_b32 v55, a31
  v_mfma_f32_16x16x32_bf16 v[208:211], a[208:211], a[176:179], v[208:211]
  buffer_load_dwordx4 v21, s[28:31], s6 offen offset:2048 lds
  v_mfma_f32_16x16x32_bf16 v[208:211], a[212:215], a[180:183], v[208:211]
  ds_read_b64_tr_b16 a[238:239], v14 offset:58368
  ds_read_b64_tr_b16 a[240:241], v15 offset:49152
  v_mfma_f32_16x16x32_bf16 v[212:215], a[220:223], a[180:183], v[212:215]
  buffer_load_dwordx4 v22, s[28:31], s6 offen offset:3072 lds
  v_mfma_f32_16x16x32_bf16 v[212:215], a[216:219], a[176:179], v[212:215]
  ds_read_b64_tr_b16 a[242:243], v15 offset:50176
  v_cvt_pk_bf16_f32 v48, v48, v49
  v_mfma_f32_16x16x32_bf16 v[220:223], a[216:219], a[184:187], v[220:223]
  ds_read_b64_tr_b16 a[244:245], v15 offset:57344
  v_cvt_pk_bf16_f32 v49, v50, v51
  v_mfma_f32_16x16x32_bf16 v[220:223], a[220:223], a[188:191], v[220:223]
  s_lshl_b32 m0, s38, 11
  ds_read_b64_tr_b16 a[246:247], v15 offset:58368
  v_mfma_f32_16x16x32_bf16 v[216:219], a[212:215], a[188:191], v[216:219]
  s_add_u32 m0, m0, 32768
  v_cvt_pk_bf16_f32 v50, v52, v53
  v_mfma_f32_16x16x32_bf16 v[216:219], a[208:211], a[184:187], v[216:219]
  s_bfe_u32 s51, s76, 0x40014
  ds_read_b64_tr_b16 a[248:249], v16 offset:49152
  v_mfma_f32_16x16x32_bf16 v[224:227], a[208:211], a[192:195], v[224:227]
  s_mul_i32 s51, s51, s52
  ds_read_b64_tr_b16 a[250:251], v16 offset:50176
  v_mfma_f32_16x16x32_bf16 v[224:227], a[212:215], a[196:199], v[224:227]
  v_cvt_pk_bf16_f32 v51, v54, v55
  s_add_u32 s5, s54, 0
  v_mfma_f32_16x16x32_bf16 v[228:231], a[220:223], a[196:199], v[228:231]
  buffer_load_dwordx4 v23, s[88:91], s51 offen offset:0 lds
  v_mfma_f32_16x16x32_bf16 v[228:231], a[216:219], a[192:195], v[228:231]
  ds_read_b64_tr_b16 a[252:253], v16 offset:57344
  ds_read_b64_tr_b16 a[254:255], v16 offset:58368
  v_mfma_f32_16x16x32_bf16 v[236:239], a[216:219], a[200:203], v[236:239]
  buffer_load_dwordx4 v24, s[88:91], s51 offen offset:1024 lds
  v_mfma_f32_16x16x32_bf16 v[236:239], a[220:223], a[204:207], v[236:239]
  buffer_store_dwordx4 v[48:51], v0, s[16:19], s5 offen offset:1024 sc1
  v_mfma_f32_16x16x32_bf16 v[232:235], a[212:215], a[204:207], v[232:235]
  v_mfma_f32_16x16x32_bf16 v[232:235], a[208:211], a[200:203], v[232:235]
  s_waitcnt lgkmcnt(4)
  v_mfma_f32_16x16x32_bf16 v[240:243], a[224:227], a[144:147], v[240:243]
  v_add_u32 v12, 65536, v27
  v_add_u32 v25, 65536, v28
  v_mfma_f32_16x16x32_bf16 v[240:243], a[228:231], a[148:151], v[240:243]
  v_accvgpr_read_b32 v40, a32
  v_accvgpr_read_b32 v41, a33
  v_mfma_f32_16x16x32_bf16 v[244:247], a[236:239], a[148:151], v[244:247]
  v_accvgpr_read_b32 v42, a34
  v_mfma_f32_16x16x32_bf16 v[244:247], a[232:235], a[144:147], v[244:247]
  v_mfma_f32_16x16x32_bf16 v[248:251], a[240:243], a[144:147], v[248:251]
  v_accvgpr_read_b32 v43, a35
  v_mfma_f32_16x16x32_bf16 v[248:251], a[244:247], a[148:151], v[248:251]
  s_waitcnt vmcnt(18) lgkmcnt(0)
  s_barrier
  v_mfma_f32_16x16x32_bf16 v[252:255], a[252:255], a[148:151], v[252:255]
  ds_read_b128 a[148:151], v25 offset:0
  s_add_u32 m0, s41, 131072
  v_mfma_f32_16x16x32_bf16 v[252:255], a[248:251], a[144:147], v[252:255]
  ds_read_b128 a[144:147], v12 offset:0
  ds_read_b64_tr_b16 a[208:209], v17 offset:0
  v_mfma_f32_16x16x32_bf16 v[76:79], a[248:251], a[152:155], v[76:79]
  s_bfe_u32 s6, s76, 0x40018
  v_accvgpr_read_b32 v44, a36
  v_mfma_f32_16x16x32_bf16 v[76:79], a[252:255], a[156:159], v[76:79]
  v_accvgpr_read_b32 v45, a37
  v_accvgpr_read_b32 v46, a38
  v_mfma_f32_16x16x32_bf16 v[72:75], a[244:247], a[156:159], v[72:75]
  s_mul_i32 s6, s6, 128
  v_accvgpr_read_b32 v47, a39
  v_mfma_f32_16x16x32_bf16 v[72:75], a[240:243], a[152:155], v[72:75]
  v_cvt_pk_bf16_f32 v40, v40, v41
  v_mfma_f32_16x16x32_bf16 v[68:71], a[232:235], a[152:155], v[68:71]
  ds_read_b64_tr_b16 a[210:211], v17 offset:512
  v_cvt_pk_bf16_f32 v41, v42, v43
  v_mfma_f32_16x16x32_bf16 v[68:71], a[236:239], a[156:159], v[68:71]
  s_add_u32 s6, s6, s49
  v_mfma_f32_16x16x32_bf16 v[64:67], a[228:231], a[156:159], v[64:67]
  ds_read_b128 a[156:159], v25 offset:4096
  v_cvt_pk_bf16_f32 v42, v44, v45
  v_mfma_f32_16x16x32_bf16 v[64:67], a[224:227], a[152:155], v[64:67]
  ds_read_b128 a[152:155], v12 offset:4096
  v_cvt_pk_bf16_f32 v43, v46, v47
  v_mfma_f32_16x16x32_bf16 v[80:83], a[224:227], a[160:163], v[80:83]
  buffer_load_dwordx4 v19, s[28:31], s6 offen offset:0 lds
  v_mfma_f32_16x16x32_bf16 v[80:83], a[228:231], a[164:167], v[80:83]
  s_add_u32 s5, s54, 0
  v_mfma_f32_16x16x32_bf16 v[84:87], a[236:239], a[164:167], v[84:87]
  ds_read_b64_tr_b16 a[212:213], v17 offset:4096
  v_mfma_f32_16x16x32_bf16 v[84:87], a[232:235], a[160:163], v[84:87]
  buffer_store_dwordx4 v[40:43], v0, s[16:19], s5 offen offset:2048 sc1
  v_mfma_f32_16x16x32_bf16 v[88:91], a[240:243], a[160:163], v[88:91]
  buffer_load_dwordx4 v20, s[28:31], s6 offen offset:1024 lds
  v_mfma_f32_16x16x32_bf16 v[88:91], a[244:247], a[164:167], v[88:91]
  v_accvgpr_read_b32 v48, a40
  v_mfma_f32_16x16x32_bf16 v[92:95], a[252:255], a[164:167], v[92:95]
  ds_read_b128 a[164:167], v25 offset:8192
  v_accvgpr_read_b32 v49, a41
  v_mfma_f32_16x16x32_bf16 v[92:95], a[248:251], a[160:163], v[92:95]
  ds_read_b128 a[160:163], v12 offset:8192
  v_mfma_f32_16x16x32_bf16 v[108:111], a[248:251], a[168:171], v[108:111]
  ds_read_b64_tr_b16 a[214:215], v17 offset:4608
  v_accvgpr_read_b32 v50, a42
  v_mfma_f32_16x16x32_bf16 v[108:111], a[252:255], a[172:175], v[108:111]
  buffer_load_dwordx4 v21, s[28:31], s6 offen offset:2048 lds
  v_mfma_f32_16x16x32_bf16 v[104:107], a[244:247], a[172:175], v[104:107]
  v_accvgpr_read_b32 v51, a43
  v_mfma_f32_16x16x32_bf16 v[104:107], a[240:243], a[168:171], v[104:107]
  v_accvgpr_read_b32 v52, a44
  v_mfma_f32_16x16x32_bf16 v[100:103], a[232:235], a[168:171], v[100:103]
  v_accvgpr_read_b32 v53, a45
  v_mfma_f32_16x16x32_bf16 v[100:103], a[236:239], a[172:175], v[100:103]
  buffer_load_dwordx4 v22, s[28:31], s6 offen offset:3072 lds
  v_mfma_f32_16x16x32_bf16 v[96:99], a[228:231], a[172:175], v[96:99]
  ds_read_b128 a[172:175], v25 offset:12288
  ds_read_b64_tr_b16 a[216:217], v18 offset:0
  v_mfma_f32_16x16x32_bf16 v[96:99], a[224:227], a[168:171], v[96:99]
  ds_read_b128 a[168:171], v12 offset:12288
  v_accvgpr_read_b32 v54, a46
  v_mfma_f32_16x16x32_bf16 v[112:115], a[224:227], a[176:179], v[112:115]
  v_accvgpr_read_b32 v55, a47
  v_cvt_pk_bf16_f32 v48, v48, v49
  v_mfma_f32_16x16x32_bf16 v[112:115], a[228:231], a[180:183], v[112:115]
  v_mfma_f32_16x16x32_bf16 v[116:119], a[236:239], a[180:183], v[116:119]
  s_add_u32 m0, s41, 49152
  v_cvt_pk_bf16_f32 v49, v50, v51
  v_mfma_f32_16x16x32_bf16 v[116:119], a[232:235], a[176:179], v[116:119]
  v_cvt_pk_bf16_f32 v50, v52, v53
  v_mfma_f32_16x16x32_bf16 v[120:123], a[240:243], a[176:179], v[120:123]
  ds_read_b64_tr_b16 a[218:219], v18 offset:512
  v_cvt_pk_bf16_f32 v51, v54, v55
  v_mfma_f32_16x16x32_bf16 v[120:123], a[244:247], a[180:183], v[120:123]
  s_bfe_u32 s62, s76, 0x40014
  v_mfma_f32_16x16x32_bf16 v[124:127], a[252:255], a[180:183], v[124:127]
  ds_read_b128 a[180:183], v25 offset:16384
  s_add_u32 s5, s54, 0
  v_mfma_f32_16x16x32_bf16 v[124:127], a[248:251], a[176:179], v[124:127]
  ds_read_b128 a[176:179], v12 offset:16384
  s_mul_i32 s62, s62, 524288
  v_mfma_f32_16x16x32_bf16 v[140:143], a[248:251], a[184:187], v[140:143]
  buffer_store_dwordx4 v[48:51], v0, s[16:19], s5 offen offset:3072 sc1
  v_mfma_f32_16x16x32_bf16 v[140:143], a[252:255], a[188:191], v[140:143]
  buffer_load_dwordx4 v6, s[32:35], s62 offen offset:0 lds
  v_mfma_f32_16x16x32_bf16 v[136:139], a[244:247], a[188:191], v[136:139]
  ds_read_b64_tr_b16 a[220:221], v18 offset:4096
  v_accvgpr_read_b32 v40, a48
  v_mfma_f32_16x16x32_bf16 v[136:139], a[240:243], a[184:187], v[136:139]
  v_mfma_f32_16x16x32_bf16 v[132:135], a[232:235], a[184:187], v[132:135]
  v_accvgpr_read_b32 v41, a49
  v_mfma_f32_16x16x32_bf16 v[132:135], a[236:239], a[188:191], v[132:135]
  v_accvgpr_read_b32 v42, a50
  v_mfma_f32_16x16x32_bf16 v[128:131], a[228:231], a[188:191], v[128:131]
  ds_read_b128 a[188:191], v25 offset:20480
  v_accvgpr_read_b32 v43, a51
  v_mfma_f32_16x16x32_bf16 v[128:131], a[224:227], a[184:187], v[128:131]
  ds_read_b128 a[184:187], v12 offset:20480
  v_mfma_f32_16x16x32_bf16 v[144:147], a[224:227], a[192:195], v[144:147]
  buffer_load_dwordx4 v7, s[32:35], s62 offen offset:1024 lds
  v_mfma_f32_16x16x32_bf16 v[144:147], a[228:231], a[196:199], v[144:147]
  ds_read_b64_tr_b16 a[222:223], v18 offset:4608
  v_accvgpr_read_b32 v44, a52
  v_mfma_f32_16x16x32_bf16 v[148:151], a[236:239], a[196:199], v[148:151]
  v_accvgpr_read_b32 v45, a53
  v_mfma_f32_16x16x32_bf16 v[148:151], a[232:235], a[192:195], v[148:151]
  buffer_load_dwordx4 v8, s[32:35], s62 offen offset:2048 lds
  v_mfma_f32_16x16x32_bf16 v[152:155], a[240:243], a[192:195], v[152:155]
  v_accvgpr_read_b32 v46, a54
  v_accvgpr_read_b32 v47, a55
  v_mfma_f32_16x16x32_bf16 v[152:155], a[244:247], a[196:199], v[152:155]
  v_mfma_f32_16x16x32_bf16 v[156:159], a[252:255], a[196:199], v[156:159]
  ds_read_b128 a[196:199], v25 offset:24576
  v_cvt_pk_bf16_f32 v40, v40, v41
  v_mfma_f32_16x16x32_bf16 v[156:159], a[248:251], a[192:195], v[156:159]
  ds_read_b128 a[192:195], v12 offset:24576
  v_cvt_pk_bf16_f32 v41, v42, v43
  v_mfma_f32_16x16x32_bf16 v[172:175], a[248:251], a[200:203], v[172:175]
  buffer_load_dwordx4 v9, s[32:35], s62 offen offset:3072 lds
  v_mfma_f32_16x16x32_bf16 v[172:175], a[252:255], a[204:207], v[172:175]
  v_cvt_pk_bf16_f32 v42, v44, v45
  v_mfma_f32_16x16x32_bf16 v[168:171], a[244:247], a[204:207], v[168:171]
  v_cvt_pk_bf16_f32 v43, v46, v47
  v_mfma_f32_16x16x32_bf16 v[168:171], a[240:243], a[200:203], v[168:171]
  s_add_u32 s5, s54, 8192
  v_mfma_f32_16x16x32_bf16 v[164:167], a[232:235], a[200:203], v[164:167]
  v_mfma_f32_16x16x32_bf16 v[164:167], a[236:239], a[204:207], v[164:167]
  buffer_store_dwordx4 v[40:43], v0, s[16:19], s5 offen offset:0 sc1
  v_mfma_f32_16x16x32_bf16 v[160:163], a[228:231], a[204:207], v[160:163]
  ds_read_b128 a[204:207], v25 offset:28672
  v_mfma_f32_16x16x32_bf16 v[160:163], a[224:227], a[200:203], v[160:163]
  ds_read_b128 a[200:203], v12 offset:28672
  s_waitcnt lgkmcnt(4)
  v_mfma_f32_16x16x32_bf16 v[176:179], a[208:211], a[144:147], v[176:179]
  v_accvgpr_read_b32 v48, a56
  v_mfma_f32_16x16x32_bf16 v[176:179], a[212:215], a[148:151], v[176:179]
  v_mfma_f32_16x16x32_bf16 v[180:183], a[220:223], a[148:151], v[180:183]
  v_accvgpr_read_b32 v49, a57
  v_mfma_f32_16x16x32_bf16 v[180:183], a[216:219], a[144:147], v[180:183]
  v_mfma_f32_16x16x32_bf16 v[188:191], a[216:219], a[152:155], v[188:191]
  v_accvgpr_read_b32 v50, a58
  v_mfma_f32_16x16x32_bf16 v[188:191], a[220:223], a[156:159], v[188:191]
  s_waitcnt vmcnt(19) lgkmcnt(0)
  s_barrier
  v_mfma_f32_16x16x32_bf16 v[184:187], a[212:215], a[156:159], v[184:187]
  s_add_u32 m0, s41, 147456
  ds_read_b64_tr_b16 a[224:225], v13 offset:16384
  v_mfma_f32_16x16x32_bf16 v[184:187], a[208:211], a[152:155], v[184:187]
  s_bfe_u32 s6, s76, 0x40018
  ds_read_b64_tr_b16 a[226:227], v13 offset:17408
  v_mfma_f32_16x16x32_bf16 v[192:195], a[208:211], a[160:163], v[192:195]
  s_mul_i32 s6, s6, 128
  ds_read_b64_tr_b16 a[228:229], v13 offset:24576
  v_mfma_f32_16x16x32_bf16 v[192:195], a[212:215], a[164:167], v[192:195]
  s_add_u32 s6, s6, s50
  v_accvgpr_read_b32 v51, a59
  v_mfma_f32_16x16x32_bf16 v[196:199], a[220:223], a[164:167], v[196:199]
  ds_read_b64_tr_b16 a[230:231], v13 offset:25600
  v_accvgpr_read_b32 v52, a60
  v_mfma_f32_16x16x32_bf16 v[196:199], a[216:219], a[160:163], v[196:199]
  buffer_load_dwordx4 v19, s[28:31], s6 offen offset:0 lds
  v_mfma_f32_16x16x32_bf16 v[204:207], a[216:219], a[168:171], v[204:207]
  ds_read_b64_tr_b16 a[232:233], v14 offset:16384
  v_accvgpr_read_b32 v53, a61
  v_mfma_f32_16x16x32_bf16 v[204:207], a[220:223], a[172:175], v[204:207]
  buffer_load_dwordx4 v20, s[28:31], s6 offen offset:1024 lds
  v_mfma_f32_16x16x32_bf16 v[200:203], a[212:215], a[172:175], v[200:203]
  ds_read_b64_tr_b16 a[234:235], v14 offset:17408
  ds_read_b64_tr_b16 a[236:237], v14 offset:24576
  v_mfma_f32_16x16x32_bf16 v[200:203], a[208:211], a[168:171], v[200:203]
  v_accvgpr_read_b32 v54, a62
  v_accvgpr_read_b32 v55, a63
  v_mfma_f32_16x16x32_bf16 v[208:211], a[208:211], a[176:179], v[208:211]
  buffer_load_dwordx4 v21, s[28:31], s6 offen offset:2048 lds
  v_mfma_f32_16x16x32_bf16 v[208:211], a[212:215], a[180:183], v[208:211]
  ds_read_b64_tr_b16 a[238:239], v14 offset:25600
  ds_read_b64_tr_b16 a[240:241], v15 offset:16384
  v_mfma_f32_16x16x32_bf16 v[212:215], a[220:223], a[180:183], v[212:215]
  ds_read_b64_tr_b16 a[242:243], v15 offset:17408
  v_cvt_pk_bf16_f32 v48, v48, v49
  v_mfma_f32_16x16x32_bf16 v[212:215], a[216:219], a[176:179], v[212:215]
  buffer_load_dwordx4 v22, s[28:31], s6 offen offset:3072 lds
  v_mfma_f32_16x16x32_bf16 v[220:223], a[216:219], a[184:187], v[220:223]
  ds_read_b64_tr_b16 a[244:245], v15 offset:24576
  v_cvt_pk_bf16_f32 v49, v50, v51
  v_mfma_f32_16x16x32_bf16 v[220:223], a[220:223], a[188:191], v[220:223]
  s_lshl_b32 m0, s38, 11
  ds_read_b64_tr_b16 a[246:247], v15 offset:25600
  v_mfma_f32_16x16x32_bf16 v[216:219], a[212:215], a[188:191], v[216:219]
  v_cvt_pk_bf16_f32 v50, v52, v53
  v_mfma_f32_16x16x32_bf16 v[216:219], a[208:211], a[184:187], v[216:219]
  s_bfe_u32 s51, s76, 0x40018
  ds_read_b64_tr_b16 a[248:249], v16 offset:16384
  v_mfma_f32_16x16x32_bf16 v[224:227], a[208:211], a[192:195], v[224:227]
  s_mul_i32 s51, s51, s52
  ds_read_b64_tr_b16 a[250:251], v16 offset:17408
  v_mfma_f32_16x16x32_bf16 v[224:227], a[212:215], a[196:199], v[224:227]
  buffer_load_dwordx4 v23, s[88:91], s51 offen offset:0 lds
  v_mfma_f32_16x16x32_bf16 v[228:231], a[220:223], a[196:199], v[228:231]
  ds_read_b64_tr_b16 a[252:253], v16 offset:24576
  v_cvt_pk_bf16_f32 v51, v54, v55
  v_mfma_f32_16x16x32_bf16 v[228:231], a[216:219], a[192:195], v[228:231]
  ds_read_b64_tr_b16 a[254:255], v16 offset:25600
  s_add_u32 s5, s54, 8192
  v_mfma_f32_16x16x32_bf16 v[236:239], a[216:219], a[200:203], v[236:239]
  buffer_load_dwordx4 v24, s[88:91], s51 offen offset:1024 lds
  v_mfma_f32_16x16x32_bf16 v[236:239], a[220:223], a[204:207], v[236:239]
  buffer_store_dwordx4 v[48:51], v0, s[16:19], s5 offen offset:1024 sc1
  v_mfma_f32_16x16x32_bf16 v[232:235], a[212:215], a[204:207], v[232:235]
  v_mfma_f32_16x16x32_bf16 v[232:235], a[208:211], a[200:203], v[232:235]
  s_waitcnt lgkmcnt(4)
  v_mfma_f32_16x16x32_bf16 v[240:243], a[224:227], a[144:147], v[240:243]
  v_add_u32 v12, 98304, v27
  v_add_u32 v25, 98304, v28
  v_mfma_f32_16x16x32_bf16 v[240:243], a[228:231], a[148:151], v[240:243]
  s_add_u32 s63, s7, L_epi-4096-L_base
  s_min_u32 s63, s63, L_codeend-L_base-4
  v_mfma_f32_16x16x32_bf16 v[244:247], a[236:239], a[148:151], v[244:247]
  v_mov_b32 v29, s63
  v_accvgpr_read_b32 v40, a64
  v_mfma_f32_16x16x32_bf16 v[244:247], a[232:235], a[144:147], v[244:247]
  global_load_dword v63, v29, s[0:1]
  v_mfma_f32_16x16x32_bf16 v[248:251], a[240:243], a[144:147], v[248:251]
  v_accvgpr_read_b32 v41, a65
  v_accvgpr_read_b32 v42, a66
  v_mfma_f32_16x16x32_bf16 v[248:251], a[244:247], a[148:151], v[248:251]
  s_waitcnt vmcnt(20) lgkmcnt(0)
  s_barrier
  v_mfma_f32_16x16x32_bf16 v[252:255], a[252:255], a[148:151], v[252:255]
  ds_read_b128 a[148:151], v25 offset:0
  s_add_u32 m0, s41, 65536
  v_mfma_f32_16x16x32_bf16 v[252:255], a[248:251], a[144:147], v[252:255]
  ds_read_b128 a[144:147], v12 offset:0
  ds_read_b64_tr_b16 a[208:209], v17 offset:32768
  v_mfma_f32_16x16x32_bf16 v[76:79], a[248:251], a[152:155], v[76:79]
  s_bfe_u32 s6, s76, 0x4001c
  v_accvgpr_read_b32 v43, a67
  v_mfma_f32_16x16x32_bf16 v[76:79], a[252:255], a[156:159], v[76:79]
  v_accvgpr_read_b32 v44, a68
  v_mfma_f32_16x16x32_bf16 v[72:75], a[244:247], a[156:159], v[72:75]
  s_mul_i32 s6, s6, 128
  v_accvgpr_read_b32 v45, a69
  v_mfma_f32_16x16x32_bf16 v[72:75], a[240:243], a[152:155], v[72:75]
  v_mfma_f32_16x16x32_bf16 v[68:71], a[232:235], a[152:155], v[68:71]
  ds_read_b64_tr_b16 a[210:211], v17 offset:33280
  v_accvgpr_read_b32 v46, a70
  v_mfma_f32_16x16x32_bf16 v[68:71], a[236:239], a[156:159], v[68:71]
  s_add_u32 s6, s6, s49
  v_mfma_f32_16x16x32_bf16 v[64:67], a[228:231], a[156:159], v[64:67]
  ds_read_b128 a[156:159], v25 offset:4096
  v_accvgpr_read_b32 v47, a71
  v_mfma_f32_16x16x32_bf16 v[64:67], a[224:227], a[152:155], v[64:67]
  ds_read_b128 a[152:155], v12 offset:4096
  v_mfma_f32_16x16x32_bf16 v[80:83], a[224:227], a[160:163], v[80:83]
  buffer_load_dwordx4 v19, s[28:31], s6 offen offset:0 lds
  v_mfma_f32_16x16x32_bf16 v[80:83], a[228:231], a[164:167], v[80:83]
  v_cvt_pk_bf16_f32 v40, v40, v41
  v_mfma_f32_16x16x32_bf16 v[84:87], a[236:239], a[164:167], v[84:87]
  ds_read_b64_tr_b16 a[212:213], v17 offset:36864
  v_mfma_f32_16x16x32_bf16 v[84:87], a[232:235], a[160:163], v[84:87]
  v_cvt_pk_bf16_f32 v41, v42, v43
  v_mfma_f32_16x16x32_bf16 v[88:91], a[240:243], a[160:163], v[88:91]
  buffer_load_dwordx4 v20, s[28:31], s6 offen offset:1024 lds
  v_mfma_f32_16x16x32_bf16 v[88:91], a[244:247], a[164:167], v[88:91]
  v_cvt_pk_bf16_f32 v42, v44, v45
  v_mfma_f32_16x16x32_bf16 v[92:95], a[252:255], a[164:167], v[92:95]
  ds_read_b128 a[164:167], v25 offset:8192
  v_mfma_f32_16x16x32_bf16 v[92:95], a[248:251], a[160:163], v[92:95]
  ds_read_b128 a[160:163], v12 offset:8192
  v_cvt_pk_bf16_f32 v43, v46, v47
  v_mfma_f32_16x16x32_bf16 v[108:111], a[248:251], a[168:171], v[108:111]
  ds_read_b64_tr_b16 a[214:215], v17 offset:37376
  v_mfma_f32_16x16x32_bf16 v[108:111], a[252:255], a[172:175], v[108:111]
  buffer_load_dwordx4 v21, s[28:31], s6 offen offset:2048 lds
  v_mfma_f32_16x16x32_bf16 v[104:107], a[244:247], a[172:175], v[104:107]
  s_add_u32 s5, s54, 8192
  v_mfma_f32_16x16x32_bf16 v[104:107], a[240:243], a[168:171], v[104:107]
  buffer_store_dwordx4 v[40:43], v0, s[16:19], s5 offen offset:2048 sc1
  v_mfma_f32_16x16x32_bf16 v[100:103], a[232:235], a[168:171], v[100:103]
  v_mfma_f32_16x16x32_bf16 v[100:103], a[236:239], a[172:175], v[100:103]
  buffer_load_dwordx4 v22, s[28:31], s6 offen offset:3072 lds
  v_mfma_f32_16x16x32_bf16 v[96:99], a[228:231], a[172:175], v[96:99]
  ds_read_b128 a[172:175], v25 offset:12288
  ds_read_b64_tr_b16 a[216:217], v18 offset:32768
  v_mfma_f32_16x16x32_bf16 v[96:99], a[224:227], a[168:171], v[96:99]
  ds_read_b128 a[168:171], v12 offset:12288
  v_mfma_f32_16x16x32_bf16 v[112:115], a[224:227], a[176:179], v[112:115]
  v_accvgpr_read_b32 v48, a72
  v_mfma_f32_16x16x32_bf16 v[112:115], a[228:231], a[180:183], v[112:115]
  v_mfma_f32_16x16x32_bf16 v[116:119], a[236:239], a[180:183], v[116:119]
  s_add_u32 m0, s41, 16384
  v_accvgpr_read_b32 v49, a73
  v_mfma_f32_16x16x32_bf16 v[116:119], a[232:235], a[176:179], v[116:119]
  v_mfma_f32_16x16x32_bf16 v[120:123], a[240:243], a[176:179], v[120:123]
  ds_read_b64_tr_b16 a[218:219], v18 offset:33280
  v_accvgpr_read_b32 v50, a74
  v_mfma_f32_16x16x32_bf16 v[120:123], a[244:247], a[180:183], v[120:123]
  s_bfe_u32 s62, s76, 0x40018
  v_mfma_f32_16x16x32_bf16 v[124:127], a[252:255], a[180:183], v[124:127]
  ds_read_b128 a[180:183], v25 offset:16384
  v_accvgpr_read_b32 v51, a75
  v_mfma_f32_16x16x32_bf16 v[124:127], a[248:251], a[176:179], v[124:127]
  ds_read_b128 a[176:179], v12 offset:16384
  s_mul_i32 s62, s62, 524288
  v_mfma_f32_16x16x32_bf16 v[140:143], a[248:251], a[184:187], v[140:143]
  v_accvgpr_read_b32 v52, a76
  v_mfma_f32_16x16x32_bf16 v[140:143], a[252:255], a[188:191], v[140:143]
  buffer_load_dwordx4 v6, s[32:35], s62 offen offset:0 lds
  v_mfma_f32_16x16x32_bf16 v[136:139], a[244:247], a[188:191], v[136:139]
  ds_read_b64_tr_b16 a[220:221], v18 offset:36864
  v_accvgpr_read_b32 v53, a77
  v_mfma_f32_16x16x32_bf16 v[136:139], a[240:243], a[184:187], v[136:139]
  v_mfma_f32_16x16x32_bf16 v[132:135], a[232:235], a[184:187], v[132:135]
  v_accvgpr_read_b32 v54, a78
  v_mfma_f32_16x16x32_bf16 v[132:135], a[236:239], a[188:191], v[132:135]
  v_mfma_f32_16x16x32_bf16 v[128:131], a[228:231], a[188:191], v[128:131]
  ds_read_b128 a[188:191], v25 offset:20480
  v_accvgpr_read_b32 v55, a79
  v_mfma_f32_16x16x32_bf16 v[128:131], a[224:227], a[184:187], v[128:131]
  ds_read_b128 a[184:187], v12 offset:20480
  v_mfma_f32_16x16x32_bf16 v[144:147], a[224:227], a[192:195], v[144:147]
  buffer_load_dwordx4 v7, s[32:35], s62 offen offset:1024 lds
  v_mfma_f32_16x16x32_bf16 v[144:147], a[228:231], a[196:199], v[144:147]
  ds_read_b64_tr_b16 a[222:223], v18 offset:37376
  v_cvt_pk_bf16_f32 v48, v48, v49
  v_mfma_f32_16x16x32_bf16 v[148:151], a[236:239], a[196:199], v[148:151]
  v_mfma_f32_16x16x32_bf16 v[148:151], a[232:235], a[192:195], v[148:151]
  buffer_load_dwordx4 v8, s[32:35], s62 offen offset:2048 lds
  v_mfma_f32_16x16x32_bf16 v[152:155], a[240:243], a[192:195], v[152:155]
  v_cvt_pk_bf16_f32 v49, v50, v51
  v_mfma_f32_16x16x32_bf16 v[152:155], a[244:247], a[196:199], v[152:155]
  v_cvt_pk_bf16_f32 v50, v52, v53
  v_mfma_f32_16x16x32_bf16 v[156:159], a[252:255], a[196:199], v[156:159]
  ds_read_b128 a[196:199], v25 offset:24576
  v_mfma_f32_16x16x32_bf16 v[156:159], a[248:251], a[192:195], v[156:159]
  ds_read_b128 a[192:195], v12 offset:24576
  v_cvt_pk_bf16_f32 v51, v54, v55
  v_mfma_f32_16x16x32_bf16 v[172:175], a[248:251], a[200:203], v[172:175]
  buffer_load_dwordx4 v9, s[32:35], s62 offen offset:3072 lds
  v_mfma_f32_16x16x32_bf16 v[172:175], a[252:255], a[204:207], v[172:175]
  s_add_u32 s5, s54, 8192
  v_mfma_f32_16x16x32_bf16 v[168:171], a[244:247], a[204:207], v[168:171]
  v_mfma_f32_16x16x32_bf16 v[168:171], a[240:243], a[200:203], v[168:171]
  buffer_store_dwordx4 v[48:51], v0, s[16:19], s5 offen offset:3072 sc1
  v_mfma_f32_16x16x32_bf16 v[164:167], a[232:235], a[200:203], v[164:167]
  v_mfma_f32_16x16x32_bf16 v[164:167], a[236:239], a[204:207], v[164:167]
  v_mfma_f32_16x16x32_bf16 v[160:163], a[228:231], a[204:207], v[160:163]
  ds_read_b128 a[204:207], v25 offset:28672
  v_mfma_f32_16x16x32_bf16 v[160:163], a[224:227], a[200:203], v[160:163]
  ds_read_b128 a[200:203], v12 offset:28672
  s_waitcnt lgkmcnt(4)
  v_mfma_f32_16x16x32_bf16 v[176:179], a[208:211], a[144:147], v[176:179]
  v_accvgpr_read_b32 v40, a80
  v_mfma_f32_16x16x32_bf16 v[176:179], a[212:215], a[148:151], v[176:179]
  v_mfma_f32_16x16x32_bf16 v[180:183], a[220:223], a[148:151], v[180:183]
  v_accvgpr_read_b32 v41, a81
  v_mfma_f32_16x16x32_bf16 v[180:183], a[216:219], a[144:147], v[180:183]
  v_mfma_f32_16x16x32_bf16 v[188:191], a[216:219], a[152:155], v[188:191]
  v_accvgpr_read_b32 v42, a82
  v_mfma_f32_16x16x32_bf16 v[188:191], a[220:223], a[156:159], v[188:191]
  s_waitcnt vmcnt(19) lgkmcnt(0)
  s_barrier
  v_mfma_f32_16x16x32_bf16 v[184:187], a[212:215], a[156:159], v[184:187]
  s_add_u32 m0, s41, 81920
  ds_read_b64_tr_b16 a[224:225], v13 offset:49152
  v_mfma_f32_16x16x32_bf16 v[184:187], a[208:211], a[152:155], v[184:187]
  s_bfe_u32 s6, s76, 0x4001c
  ds_read_b64_tr_b16 a[226:227], v13 offset:50176
  v_mfma_f32_16x16x32_bf16 v[192:195], a[208:211], a[160:163], v[192:195]
  s_mul_i32 s6, s6, 128
  ds_read_b64_tr_b16 a[228:229], v13 offset:57344
  v_mfma_f32_16x16x32_bf16 v[192:195], a[212:215], a[164:167], v[192:195]
  s_add_u32 s6, s6, s50
  v_accvgpr_read_b32 v43, a83
  v_mfma_f32_16x16x32_bf16 v[196:199], a[220:223], a[164:167], v[196:199]
  ds_read_b64_tr_b16 a[230:231], v13 offset:58368
  v_accvgpr_read_b32 v44, a84
  v_mfma_f32_16x16x32_bf16 v[196:199], a[216:219], a[160:163], v[196:199]
  buffer_load_dwordx4 v19, s[28:31], s6 offen offset:0 lds
  v_mfma_f32_16x16x32_bf16 v[204:207], a[216:219], a[168:171], v[204:207]
  ds_read_b64_tr_b16 a[232:233], v14 offset:49152
  v_accvgpr_read_b32 v45, a85
  v_mfma_f32_16x16x32_bf16 v[204:207], a[220:223], a[172:175], v[204:207]
  buffer_load_dwordx4 v20, s[28:31], s6 offen offset:1024 lds
  v_mfma_f32_16x16x32_bf16 v[200:203], a[212:215], a[172:175], v[200:203]
  ds_read_b64_tr_b16 a[234:235], v14 offset:50176
  ds_read_b64_tr_b16 a[236:237], v14 offset:57344
  v_mfma_f32_16x16x32_bf16 v[200:203], a[208:211], a[168:171], v[200:203]
  v_accvgpr_read_b32 v46, a86
  v_accvgpr_read_b32 v47, a87
  v_mfma_f32_16x16x32_bf16 v[208:211], a[208:211], a[176:179], v[208:211]
  buffer_load_dwordx4 v21, s[28:31], s6 offen offset:2048 lds
  v_mfma_f32_16x16x32_bf16 v[208:211], a[212:215], a[180:183], v[208:211]
  ds_read_b64_tr_b16 a[238:239], v14 offset:58368
  ds_read_b64_tr_b16 a[240:241], v15 offset:49152
  v_mfma_f32_16x16x32_bf16 v[212:215], a[220:223], a[180:183], v[212:215]
  buffer_load_dwordx4 v22, s[28:31], s6 offen offset:3072 lds
  v_mfma_f32_16x16x32_bf16 v[212:215], a[216:219], a[176:179], v[212:215]
  ds_read_b64_tr_b16 a[242:243], v15 offset:50176
  v_cvt_pk_bf16_f32 v40, v40, v41
  v_mfma_f32_16x16x32_bf16 v[220:223], a[216:219], a[184:187], v[220:223]
  ds_read_b64_tr_b16 a[244:245], v15 offset:57344
  v_cvt_pk_bf16_f32 v41, v42, v43
  v_mfma_f32_16x16x32_bf16 v[220:223], a[220:223], a[188:191], v[220:223]
  s_lshl_b32 m0, s38, 11
  ds_read_b64_tr_b16 a[246:247], v15 offset:58368
  v_mfma_f32_16x16x32_bf16 v[216:219], a[212:215], a[188:191], v[216:219]
  s_add_u32 m0, m0, 32768
  v_cvt_pk_bf16_f32 v42, v44, v45
  v_mfma_f32_16x16x32_bf16 v[216:219], a[208:211], a[184:187], v[216:219]
  s_bfe_u32 s51, s76, 0x4001c
  ds_read_b64_tr_b16 a[248:249], v16 offset:49152
  v_mfma_f32_16x16x32_bf16 v[224:227], a[208:211], a[192:195], v[224:227]
  s_mul_i32 s51, s51, s52
  ds_read_b64_tr_b16 a[250:251], v16 offset:50176
  v_mfma_f32_16x16x32_bf16 v[224:227], a[212:215], a[196:199], v[224:227]
  v_cvt_pk_bf16_f32 v43, v46, v47
  s_add_u32 s5, s54, 16384
  v_mfma_f32_16x16x32_bf16 v[228:231], a[220:223], a[196:199], v[228:231]
  buffer_load_dwordx4 v23, s[88:91], s51 offen offset:0 lds
  v_mfma_f32_16x16x32_bf16 v[228:231], a[216:219], a[192:195], v[228:231]
  ds_read_b64_tr_b16 a[252:253], v16 offset:57344
  ds_read_b64_tr_b16 a[254:255], v16 offset:58368
  v_mfma_f32_16x16x32_bf16 v[236:239], a[216:219], a[200:203], v[236:239]
  buffer_load_dwordx4 v24, s[88:91], s51 offen offset:1024 lds
  v_mfma_f32_16x16x32_bf16 v[236:239], a[220:223], a[204:207], v[236:239]
  buffer_store_dwordx4 v[40:43], v0, s[16:19], s5 offen offset:0 sc1
  v_mfma_f32_16x16x32_bf16 v[232:235], a[212:215], a[204:207], v[232:235]
  v_mfma_f32_16x16x32_bf16 v[232:235], a[208:211], a[200:203], v[232:235]
  s_waitcnt lgkmcnt(4)
  v_mfma_f32_16x16x32_bf16 v[240:243], a[224:227], a[144:147], v[240:243]
  v_add_u32 v12, 131072, v27
  v_add_u32 v25, 131072, v28
  v_mfma_f32_16x16x32_bf16 v[240:243], a[228:231], a[148:151], v[240:243]
  v_accvgpr_read_b32 v48, a88
  v_accvgpr_read_b32 v49, a89
  v_mfma_f32_16x16x32_bf16 v[244:247], a[236:239], a[148:151], v[244:247]
  v_accvgpr_read_b32 v50, a90
  v_mfma_f32_16x16x32_bf16 v[244:247], a[232:235], a[144:147], v[244:247]
  v_mfma_f32_16x16x32_bf16 v[248:251], a[240:243], a[144:147], v[248:251]
  v_accvgpr_read_b32 v51, a91
  v_mfma_f32_16x16x32_bf16 v[248:251], a[244:247], a[148:151], v[248:251]
  s_waitcnt vmcnt(19) lgkmcnt(0)
  s_barrier
  v_mfma_f32_16x16x32_bf16 v[252:255], a[252:255], a[148:151], v[252:255]
  ds_read_b128 a[148:151], v25 offset:0
  s_add_u32 m0, s41, 98304
  v_mfma_f32_16x16x32_bf16 v[252:255], a[248:251], a[144:147], v[252:255]
  ds_read_b128 a[144:147], v12 offset:0
  ds_read_b64_tr_b16 a[208:209], v17 offset:0
  v_mfma_f32_16x16x32_bf16 v[76:79], a[248:251], a[152:155], v[76:79]
  s_bfe_u32 s6, s77, 0x40000
  v_accvgpr_read_b32 v52, a92
  v_mfma_f32_16x16x32_bf16 v[76:79], a[252:255], a[156:159], v[76:79]
  v_accvgpr_read_b32 v53, a93
  v_accvgpr_read_b32 v54, a94
  v_mfma_f32_16x16x32_bf16 v[72:75], a[244:247], a[156:159], v[72:75]
  s_mul_i32 s6, s6, 128
  v_accvgpr_read_b32 v55, a95
  v_mfma_f32_16x16x32_bf16 v[72:75], a[240:243], a[152:155], v[72:75]
  v_cvt_pk_bf16_f32 v48, v48, v49
  v_mfma_f32_16x16x32_bf16 v[68:71], a[232:235], a[152:155], v[68:71]
  ds_read_b64_tr_b16 a[210:211], v17 offset:512
  v_cvt_pk_bf16_f32 v49, v50, v51
  v_mfma_f32_16x16x32_bf16 v[68:71], a[236:239], a[156:159], v[68:71]
  s_add_u32 s6, s6, s49
  v_mfma_f32_16x16x32_bf16 v[64:67], a[228:231], a[156:159], v[64:67]
  ds_read_b128 a[156:159], v25 offset:4096
  v_cvt_pk_bf16_f32 v50, v52, v53
  v_mfma_f32_16x16x32_bf16 v[64:67], a[224:227], a[152:155], v[64:67]
  ds_read_b128 a[152:155], v12 offset:4096
  v_cvt_pk_bf16_f32 v51, v54, v55
  v_mfma_f32_16x16x32_bf16 v[80:83], a[224:227], a[160:163], v[80:83]
  buffer_load_dwordx4 v19, s[28:31], s6 offen offset:0 lds
  v_mfma_f32_16x16x32_bf16 v[80:83], a[228:231], a[164:167], v[80:83]
  s_add_u32 s5, s54, 16384
  v_mfma_f32_16x16x32_bf16 v[84:87], a[236:239], a[164:167], v[84:87]
  ds_read_b64_tr_b16 a[212:213], v17 offset:4096
  v_mfma_f32_16x16x32_bf16 v[84:87], a[232:235], a[160:163], v[84:87]
  buffer_store_dwordx4 v[48:51], v0, s[16:19], s5 offen offset:1024 sc1
  v_mfma_f32_16x16x32_bf16 v[88:91], a[240:243], a[160:163], v[88:91]
  buffer_load_dwordx4 v20, s[28:31], s6 offen offset:1024 lds
  v_mfma_f32_16x16x32_bf16 v[88:91], a[244:247], a[164:167], v[88:91]
  v_accvgpr_read_b32 v40, a96
  v_mfma_f32_16x16x32_bf16 v[92:95], a[252:255], a[164:167], v[92:95]
  ds_read_b128 a[164:167], v25 offset:8192
  v_accvgpr_read_b32 v41, a97
  v_mfma_f32_16x16x32_bf16 v[92:95], a[248:251], a[160:163], v[92:95]
  ds_read_b128 a[160:163], v12 offset:8192
  v_mfma_f32_16x16x32_bf16 v[108:111], a[248:251], a[168:171], v[108:111]
  ds_read_b64_tr_b16 a[214:215], v17 offset:4608
  v_accvgpr_read_b32 v42, a98
  v_mfma_f32_16x16x32_bf16 v[108:111], a[252:255], a[172:175], v[108:111]
  buffer_load_dwordx4 v21, s[28:31], s6 offen offset:2048 lds
  v_mfma_f32_16x16x32_bf16 v[104:107], a[244:247], a[172:175], v[104:107]
  v_accvgpr_read_b32 v43, a99
  v_mfma_f32_16x16x32_bf16 v[104:107], a[240:243], a[168:171], v[104:107]
  v_accvgpr_read_b32 v44, a100
  v_mfma_f32_16x16x32_bf16 v[100:103], a[232:235], a[168:171], v[100:103]
  v_accvgpr_read_b32 v45, a101
  v_mfma_f32_16x16x32_bf16 v[100:103], a[236:239], a[172:175], v[100:103]
  buffer_load_dwordx4 v22, s[28:31], s6 offen offset:3072 lds
  v_mfma_f32_16x16x32_bf16 v[96:99], a[228:231], a[172:175], v[96:99]
  ds_read_b128 a[172:175], v25 offset:12288
  ds_read_b64_tr_b16 a[216:217], v18 offset:0
  v_mfma_f32_16x16x32_bf16 v[96:99], a[224:227], a[168:171], v[96:99]
  ds_read_b128 a[168:171], v12 offset:12288
  v_accvgpr_read_b32 v46, a102
  v_mfma_f32_16x16x32_bf16 v[112:115], a[224:227], a[176:179], v[112:115]
  v_accvgpr_read_b32 v47, a103
  v_cvt_pk_bf16_f32 v40, v40, v41
  v_mfma_f32_16x16x32_bf16 v[112:115], a[228:231], a[180:183], v[112:115]
  v_mfma_f32_16x16x32_bf16 v[116:119], a[236:239], a[180:183], v[116:119]
  s_add_u32 m0, s41, 49152
  v_cvt_pk_bf16_f32 v41, v42, v43
  v_mfma_f32_16x16x32_bf16 v[116:119], a[232:235], a[176:179], v[116:119]
  v_cvt_pk_bf16_f32 v42, v44, v45
  v_mfma_f32_16x16x32_bf16 v[120:123], a[240:243], a[176:179], v[120:123]
  ds_read_b64_tr_b16 a[218:219], v18 offset:512
  v_cvt_pk_bf16_f32 v43, v46, v47
  v_mfma_f32_16x16x32_bf16 v[120:123], a[244:247], a[180:183], v[120:123]
  s_bfe_u32 s62, s76, 0x4001c
  v_mfma_f32_16x16x32_bf16 v[124:127], a[252:255], a[180:183], v[124:127]
  ds_read_b128 a[180:183], v25 offset:16384
  s_add_u32 s5, s54, 16384
  v_mfma_f32_16x16x32_bf16 v[124:127], a[248:251], a[176:179], v[124:127]
  ds_read_b128 a[176:179], v12 offset:16384
  s_mul_i32 s62, s62, 524288
  v_mfma_f32_16x16x32_bf16 v[140:143], a[248:251], a[184:187], v[140:143]
  buffer_store_dwordx4 v[40:43], v0, s[16:19], s5 offen offset:2048 sc1
  v_mfma_f32_16x16x32_bf16 v[140:143], a[252:255], a[188:191], v[140:143]
  buffer_load_dwordx4 v6, s[32:35], s62 offen offset:0 lds
  v_mfma_f32_16x16x32_bf16 v[136:139], a[244:247], a[188:191], v[136:139]
  ds_read_b64_tr_b16 a[220:221], v18 offset:4096
  v_accvgpr_read_b32 v48, a104
  v_mfma_f32_16x16x32_bf16 v[136:139], a[240:243], a[184:187], v[136:139]
  v_mfma_f32_16x16x32_bf16 v[132:135], a[232:235], a[184:187], v[132:135]
  v_accvgpr_read_b32 v49, a105
  v_mfma_f32_16x16x32_bf16 v[132:135], a[236:239], a[188:191], v[132:135]
  v_accvgpr_read_b32 v50, a106
  v_mfma_f32_16x16x32_bf16 v[128:131], a[228:231], a[188:191], v[128:131]
  ds_read_b128 a[188:191], v25 offset:20480
  v_accvgpr_read_b32 v51, a107
  v_mfma_f32_16x16x32_bf16 v[128:131], a[224:227], a[184:187], v[128:131]
  ds_read_b128 a[184:187], v12 offset:20480
  v_mfma_f32_16x16x32_bf16 v[144:147], a[224:227], a[192:195], v[144:147]
  buffer_load_dwordx4 v7, s[32:35], s62 offen offset:1024 lds
  v_mfma_f32_16x16x32_bf16 v[144:147], a[228:231], a[196:199], v[144:147]
  ds_read_b64_tr_b16 a[222:223], v18 offset:4608
  v_accvgpr_read_b32 v52, a108
  v_mfma_f32_16x16x32_bf16 v[148:151], a[236:239], a[196:199], v[148:151]
  v_accvgpr_read_b32 v53, a109
  v_mfma_f32_16x16x32_bf16 v[148:151], a[232:235], a[192:195], v[148:151]
  buffer_load_dwordx4 v8, s[32:35], s62 offen offset:2048 lds
  v_mfma_f32_16x16x32_bf16 v[152:155], a[240:243], a[192:195], v[152:155]
  v_accvgpr_read_b32 v54, a110
  v_accvgpr_read_b32 v55, a111
  v_mfma_f32_16x16x32_bf16 v[152:155], a[244:247], a[196:199], v[152:155]
  v_mfma_f32_16x16x32_bf16 v[156:159], a[252:255], a[196:199], v[156:159]
  ds_read_b128 a[196:199], v25 offset:24576
  v_cvt_pk_bf16_f32 v48, v48, v49
  v_mfma_f32_16x16x32_bf16 v[156:159], a[248:251], a[192:195], v[156:159]
  ds_read_b128 a[192:195], v12 offset:24576
  v_cvt_pk_bf16_f32 v49, v50, v51
  v_mfma_f32_16x16x32_bf16 v[172:175], a[248:251], a[200:203], v[172:175]
  buffer_load_dwordx4 v9, s[32:35], s62 offen offset:3072 lds
  v_mfma_f32_16x16x32_bf16 v[172:175], a[252:255], a[204:207], v[172:175]
  v_cvt_pk_bf16_f32 v50, v52, v53
  v_mfma_f32_16x16x32_bf16 v[168:171], a[244:247], a[204:207], v[168:171]
  v_cvt_pk_bf16_f32 v51, v54, v55
  v_mfma_f32_16x16x32_bf16 v[168:171], a[240:243], a[200:203], v[168:171]
  s_add_u32 s5, s54, 16384
  v_mfma_f32_16x16x32_bf16 v[164:167], a[232:235], a[200:203], v[164:167]
  v_mfma_f32_16x16x32_bf16 v[164:167], a[236:239], a[204:207], v[164:167]
  buffer_store_dwordx4 v[48:51], v0, s[16:19], s5 offen offset:3072 sc1
  v_mfma_f32_16x16x32_bf16 v[160:163], a[228:231], a[204:207], v[160:163]
  ds_read_b128 a[204:207], v25 offset:28672
  v_mfma_f32_16x16x32_bf16 v[160:163], a[224:227], a[200:203], v[160:163]
  ds_read_b128 a[200:203], v12 offset:28672
  s_waitcnt lgkmcnt(4)
  v_mfma_f32_16x16x32_bf16 v[176:179], a[208:211], a[144:147], v[176:179]
  v_accvgpr_read_b32 v40, a112
  v_mfma_f32_16x16x32_bf16 v[176:179], a[212:215], a[148:151], v[176:179]
  v_mfma_f32_16x16x32_bf16 v[180:183], a[220:223], a[148:151], v[180:183]
  v_accvgpr_read_b32 v41, a113
  v_mfma_f32_16x16x32_bf16 v[180:183], a[216:219], a[144:147], v[180:183]
  v_mfma_f32_16x16x32_bf16 v[188:191], a[216:219], a[152:155], v[188:191]
  v_accvgpr_read_b32 v42, a114
  v_mfma_f32_16x16x32_bf16 v[188:191], a[220:223], a[156:159], v[188:191]
  s_waitcnt vmcnt(19) lgkmcnt(0)
  s_barrier
  v_mfma_f32_16x16x32_bf16 v[184:187], a[212:215], a[156:159], v[184:187]
  buffer_load_dword v30, v61, s[20:23], 0 offen sc1
  v_mfma_f32_16x16x32_bf16 v[184:187], a[208:211], a[152:155], v[184:187]
  ds_read_b64_tr_b16 a[224:225], v13 offset:16384
  ds_read_b64_tr_b16 a[226:227], v13 offset:17408
  v_mfma_f32_16x16x32_bf16 v[192:195], a[208:211], a[160:163], v[192:195]
  s_add_u32 m0, s41, 114688
  ds_read_b64_tr_b16 a[228:229], v13 offset:24576
  v_mfma_f32_16x16x32_bf16 v[192:195], a[212:215], a[164:167], v[192:195]
  s_bfe_u32 s6, s77, 0x40000
  v_accvgpr_read_b32 v43, a115
  v_mfma_f32_16x16x32_bf16 v[196:199], a[220:223], a[164:167], v[196:199]
  s_mul_i32 s6, s6, 128
  ds_read_b64_tr_b16 a[230:231], v13 offset:25600
  v_mfma_f32_16x16x32_bf16 v[196:199], a[216:219], a[160:163], v[196:199]
  s_add_u32 s6, s6, s50
  ds_read_b64_tr_b16 a[232:233], v14 offset:16384
  v_mfma_f32_16x16x32_bf16 v[204:207], a[216:219], a[168:171], v[204:207]
  v_accvgpr_read_b32 v44, a116
  v_accvgpr_read_b32 v45, a117
  v_mfma_f32_16x16x32_bf16 v[204:207], a[220:223], a[172:175], v[204:207]
  buffer_load_dwordx4 v19, s[28:31], s6 offen offset:0 lds
  v_mfma_f32_16x16x32_bf16 v[200:203], a[212:215], a[172:175], v[200:203]
  ds_read_b64_tr_b16 a[234:235], v14 offset:17408
  ds_read_b64_tr_b16 a[236:237], v14 offset:24576
  v_mfma_f32_16x16x32_bf16 v[200:203], a[208:211], a[168:171], v[200:203]
  buffer_load_dwordx4 v20, s[28:31], s6 offen offset:1024 lds
  v_mfma_f32_16x16x32_bf16 v[208:211], a[208:211], a[176:179], v[208:211]
  ds_read_b64_tr_b16 a[238:239], v14 offset:25600
  v_accvgpr_read_b32 v46, a118
  v_mfma_f32_16x16x32_bf16 v[208:211], a[212:215], a[180:183], v[208:211]
  buffer_load_dwordx4 v21, s[28:31], s6 offen offset:2048 lds
  v_mfma_f32_16x16x32_bf16 v[212:215], a[220:223], a[180:183], v[212:215]
  ds_read_b64_tr_b16 a[240:241], v15 offset:16384
  ds_read_b64_tr_b16 a[242:243], v15 offset:17408
  v_mfma_f32_16x16x32_bf16 v[212:215], a[216:219], a[176:179], v[212:215]
  v_accvgpr_read_b32 v47, a119
  v_cvt_pk_bf16_f32 v40, v40, v41
  v_mfma_f32_16x16x32_bf16 v[220:223], a[216:219], a[184:187], v[220:223]
  buffer_load_dwordx4 v22, s[28:31], s6 offen offset:3072 lds
  v_mfma_f32_16x16x32_bf16 v[220:223], a[220:223], a[188:191], v[220:223]
  ds_read_b64_tr_b16 a[244:245], v15 offset:24576
  ds_read_b64_tr_b16 a[246:247], v15 offset:25600
  v_mfma_f32_16x16x32_bf16 v[216:219], a[212:215], a[188:191], v[216:219]
  s_lshl_b32 m0, s38, 11
  v_cvt_pk_bf16_f32 v41, v42, v43
  v_mfma_f32_16x16x32_bf16 v[216:219], a[208:211], a[184:187], v[216:219]
  s_bfe_u32 s51, s77, 0x40000
  ds_read_b64_tr_b16 a[248:249], v16 offset:16384
  v_mfma_f32_16x16x32_bf16 v[224:227], a[208:211], a[192:195], v[224:227]
  ds_read_b64_tr_b16 a[250:251], v16 offset:17408
  v_cvt_pk_bf16_f32 v42, v44, v45
  v_mfma_f32_16x16x32_bf16 v[224:227], a[212:215], a[196:199], v[224:227]
  s_mul_i32 s51, s51, s52
  v_cvt_pk_bf16_f32 v43, v46, v47
  v_mfma_f32_16x16x32_bf16 v[228:231], a[220:223], a[196:199], v[228:231]
  buffer_load_dwordx4 v23, s[88:91], s51 offen offset:0 lds
  v_mfma_f32_16x16x32_bf16 v[228:231], a[216:219], a[192:195], v[228:231]
  ds_read_b64_tr_b16 a[252:253], v16 offset:24576
  ds_read_b64_tr_b16 a[254:255], v16 offset:25600
  v_mfma_f32_16x16x32_bf16 v[236:239], a[216:219], a[200:203], v[236:239]
  buffer_load_dwordx4 v24, s[88:91], s51 offen offset:1024 lds
  v_mfma_f32_16x16x32_bf16 v[236:239], a[220:223], a[204:207], v[236:239]
  s_add_u32 s5, s54, 24576
  v_mfma_f32_16x16x32_bf16 v[232:235], a[212:215], a[204:207], v[232:235]
  buffer_store_dwordx4 v[40:43], v0, s[16:19], s5 offen offset:0 sc1
  v_mfma_f32_16x16x32_bf16 v[232:235], a[208:211], a[200:203], v[232:235]
  s_waitcnt lgkmcnt(4)
  v_mfma_f32_16x16x32_bf16 v[240:243], a[224:227], a[144:147], v[240:243]
  v_add_u32 v12, 65536, v27
  v_add_u32 v25, 65536, v28
  v_mfma_f32_16x16x32_bf16 v[240:243], a[228:231], a[148:151], v[240:243]
  s_add_u32 s63, s7, L_epi+12288-L_base
  s_min_u32 s63, s63, L_codeend-L_base-4
  v_mfma_f32_16x16x32_bf16 v[244:247], a[236:239], a[148:151], v[244:247]
  v_mov_b32 v29, s63
  v_accvgpr_read_b32 v48, a120
  v_mfma_f32_16x16x32_bf16 v[244:247], a[232:235], a[144:147], v[244:247]
  global_load_dword v63, v29, s[0:1]
  v_mfma_f32_16x16x32_bf16 v[248:251], a[240:243], a[144:147], v[248:251]
  v_accvgpr_read_b32 v49, a121
  v_accvgpr_read_b32 v50, a122
  v_mfma_f32_16x16x32_bf16 v[248:251], a[244:247], a[148:151], v[248:251]
  s_waitcnt vmcnt(21) lgkmcnt(0)
  s_barrier
  v_mfma_f32_16x16x32_bf16 v[252:255], a[252:255], a[148:151], v[252:255]
  ds_read_b128 a[148:151], v25 offset:0
  s_add_u32 m0, s41, 131072
  v_mfma_f32_16x16x32_bf16 v[252:255], a[248:251], a[144:147], v[252:255]
  ds_read_b128 a[144:147], v12 offset:0
  ds_read_b64_tr_b16 a[208:209], v17 offset:32768
  v_mfma_f32_16x16x32_bf16 v[76:79], a[248:251], a[152:155], v[76:79]
  s_bfe_u32 s6, s77, 0x40004
  v_accvgpr_read_b32 v51, a123
  v_mfma_f32_16x16x32_bf16 v[76:79], a[252:255], a[156:159], v[76:79]
  v_accvgpr_read_b32 v52, a124
  v_accvgpr_read_b32 v53, a125
  v_mfma_f32_16x16x32_bf16 v[72:75], a[244:247], a[156:159], v[72:75]
  s_mul_i32 s6, s6, 128
  v_accvgpr_read_b32 v54, a126
  v_mfma_f32_16x16x32_bf16 v[72:75], a[240:243], a[152:155], v[72:75]
  v_accvgpr_read_b32 v55, a127
  v_cvt_pk_bf16_f32 v48, v48, v49
  v_mfma_f32_16x16x32_bf16 v[68:71], a[232:235], a[152:155], v[68:71]
  ds_read_b64_tr_b16 a[210:211], v17 offset:33280
  v_cvt_pk_bf16_f32 v49, v50, v51
  v_mfma_f32_16x16x32_bf16 v[68:71], a[236:239], a[156:159], v[68:71]
  s_add_u32 s6, s6, s49
  v_mfma_f32_16x16x32_bf16 v[64:67], a[228:231], a[156:159], v[64:67]
  ds_read_b128 a[156:159], v25 offset:4096
  v_cvt_pk_bf16_f32 v50, v52, v53
  v_mfma_f32_16x16x32_bf16 v[64:67], a[224:227], a[152:155], v[64:67]
  ds_read_b128 a[152:155], v12 offset:4096
  v_cvt_pk_bf16_f32 v51, v54, v55
  v_mfma_f32_16x16x32_bf16 v[80:83], a[224:227], a[160:163], v[80:83]
  buffer_load_dwordx4 v19, s[28:31], s6 offen offset:0 lds
  v_mfma_f32_16x16x32_bf16 v[80:83], a[228:231], a[164:167], v[80:83]
  s_add_u32 s5, s54, 24576
  v_mfma_f32_16x16x32_bf16 v[84:87], a[236:239], a[164:167], v[84:87]
  ds_read_b64_tr_b16 a[212:213], v17 offset:36864
  v_mfma_f32_16x16x32_bf16 v[84:87], a[232:235], a[160:163], v[84:87]
  buffer_store_dwordx4 v[48:51], v0, s[16:19], s5 offen offset:1024 sc1
  v_mfma_f32_16x16x32_bf16 v[88:91], a[240:243], a[160:163], v[88:91]
  buffer_load_dwordx4 v20, s[28:31], s6 offen offset:1024 lds
  v_mfma_f32_16x16x32_bf16 v[88:91], a[244:247], a[164:167], v[88:91]
  v_accvgpr_read_b32 v40, a128
  v_mfma_f32_16x16x32_bf16 v[92:95], a[252:255], a[164:167], v[92:95]
  ds_read_b128 a[164:167], v25 offset:8192
  v_accvgpr_read_b32 v41, a129
  v_mfma_f32_16x16x32_bf16 v[92:95], a[248:251], a[160:163], v[92:95]
  ds_read_b128 a[160:163], v12 offset:8192
  v_mfma_f32_16x16x32_bf16 v[108:111], a[248:251], a[168:171], v[108:111]
  ds_read_b64_tr_b16 a[214:215], v17 offset:37376
  v_accvgpr_read_b32 v42, a130
  v_mfma_f32_16x16x32_bf16 v[108:111], a[252:255], a[172:175], v[108:111]
  buffer_load_dwordx4 v21, s[28:31], s6 offen offset:2048 lds
  v_mfma_f32_16x16x32_bf16 v[104:107], a[244:247], a[172:175], v[104:107]
  v_accvgpr_read_b32 v43, a131
  v_mfma_f32_16x16x32_bf16 v[104:107], a[240:243], a[168:171], v[104:107]
  v_accvgpr_read_b32 v44, a132
  v_mfma_f32_16x16x32_bf16 v[100:103], a[232:235], a[168:171], v[100:103]
  v_accvgpr_read_b32 v45, a133
  v_mfma_f32_16x16x32_bf16 v[100:103], a[236:239], a[172:175], v[100:103]
  buffer_load_dwordx4 v22, s[28:31], s6 offen offset:3072 lds
  v_mfma_f32_16x16x32_bf16 v[96:99], a[228:231], a[172:175], v[96:99]
  ds_read_b128 a[172:175], v25 offset:12288
  ds_read_b64_tr_b16 a[216:217], v18 offset:32768
  v_mfma_f32_16x16x32_bf16 v[96:99], a[224:227], a[168:171], v[96:99]
  ds_read_b128 a[168:171], v12 offset:12288
  v_accvgpr_read_b32 v46, a134
  v_mfma_f32_16x16x32_bf16 v[112:115], a[224:227], a[176:179], v[112:115]
  v_accvgpr_read_b32 v47, a135
  v_cvt_pk_bf16_f32 v40, v40, v41
  v_mfma_f32_16x16x32_bf16 v[112:115], a[228:231], a[180:183], v[112:115]
  v_mfma_f32_16x16x32_bf16 v[116:119], a[236:239], a[180:183], v[116:119]
  s_add_u32 m0, s41, 16384
  v_cvt_pk_bf16_f32 v41, v42, v43
  v_mfma_f32_16x16x32_bf16 v[116:119], a[232:235], a[176:179], v[116:119]
  v_cvt_pk_bf16_f32 v42, v44, v45
  v_mfma_f32_16x16x32_bf16 v[120:123], a[240:243], a[176:179], v[120:123]
  ds_read_b64_tr_b16 a[218:219], v18 offset:33280
  v_cvt_pk_bf16_f32 v43, v46, v47
  v_mfma_f32_16x16x32_bf16 v[120:123], a[244:247], a[180:183], v[120:123]
  s_bfe_u32 s62, s77, 0x40000
  v_mfma_f32_16x16x32_bf16 v[124:127], a[252:255], a[180:183], v[124:127]
  ds_read_b128 a[180:183], v25 offset:16384
  s_add_u32 s5, s54, 24576
  v_mfma_f32_16x16x32_bf16 v[124:127], a[248:251], a[176:179], v[124:127]
  ds_read_b128 a[176:179], v12 offset:16384
  s_mul_i32 s62, s62, 524288
  v_mfma_f32_16x16x32_bf16 v[140:143], a[248:251], a[184:187], v[140:143]
  buffer_store_dwordx4 v[40:43], v0, s[16:19], s5 offen offset:2048 sc1
  v_mfma_f32_16x16x32_bf16 v[140:143], a[252:255], a[188:191], v[140:143]
  buffer_load_dwordx4 v6, s[32:35], s62 offen offset:0 lds
  v_mfma_f32_16x16x32_bf16 v[136:139], a[244:247], a[188:191], v[136:139]
  ds_read_b64_tr_b16 a[220:221], v18 offset:36864
  v_accvgpr_read_b32 v48, a136
  v_mfma_f32_16x16x32_bf16 v[136:139], a[240:243], a[184:187], v[136:139]
  v_mfma_f32_16x16x32_bf16 v[132:135], a[232:235], a[184:187], v[132:135]
  v_accvgpr_read_b32 v49, a137
  v_mfma_f32_16x16x32_bf16 v[132:135], a[236:239], a[188:191], v[132:135]
  v_accvgpr_read_b32 v50, a138
  v_mfma_f32_16x16x32_bf16 v[128:131], a[228:231], a[188:191], v[128:131]
  ds_read_b128 a[188:191], v25 offset:20480
  v_accvgpr_read_b32 v51, a139
  v_mfma_f32_16x16x32_bf16 v[128:131], a[224:227], a[184:187], v[128:131]
  ds_read_b128 a[184:187], v12 offset:20480
  v_mfma_f32_16x16x32_bf16 v[144:147], a[224:227], a[192:195], v[144:147]
  buffer_load_dwordx4 v7, s[32:35], s62 offen offset:1024 lds
  v_mfma_f32_16x16x32_bf16 v[144:147], a[228:231], a[196:199], v[144:147]
  ds_read_b64_tr_b16 a[222:223], v18 offset:37376
  v_accvgpr_read_b32 v52, a140
  v_mfma_f32_16x16x32_bf16 v[148:151], a[236:239], a[196:199], v[148:151]
  v_accvgpr_read_b32 v53, a141
  v_mfma_f32_16x16x32_bf16 v[148:151], a[232:235], a[192:195], v[148:151]
  buffer_load_dwordx4 v8, s[32:35], s62 offen offset:2048 lds
  v_mfma_f32_16x16x32_bf16 v[152:155], a[240:243], a[192:195], v[152:155]
  v_accvgpr_read_b32 v54, a142
  v_accvgpr_read_b32 v55, a143
  v_mfma_f32_16x16x32_bf16 v[152:155], a[244:247], a[196:199], v[152:155]
  v_mfma_f32_16x16x32_bf16 v[156:159], a[252:255], a[196:199], v[156:159]
  ds_read_b128 a[196:199], v25 offset:24576
  v_cvt_pk_bf16_f32 v48, v48, v49
  v_mfma_f32_16x16x32_bf16 v[156:159], a[248:251], a[192:195], v[156:159]
  ds_read_b128 a[192:195], v12 offset:24576
  v_cvt_pk_bf16_f32 v49, v50, v51
  v_mfma_f32_16x16x32_bf16 v[172:175], a[248:251], a[200:203], v[172:175]
  buffer_load_dwordx4 v9, s[32:35], s62 offen offset:3072 lds
  v_mfma_f32_16x16x32_bf16 v[172:175], a[252:255], a[204:207], v[172:175]
  v_cvt_pk_bf16_f32 v50, v52, v53
  v_mfma_f32_16x16x32_bf16 v[168:171], a[244:247], a[204:207], v[168:171]
  v_cvt_pk_bf16_f32 v51, v54, v55
  v_mfma_f32_16x16x32_bf16 v[168:171], a[240:243], a[200:203], v[168:171]
  s_add_u32 s5, s54, 24576
  v_mfma_f32_16x16x32_bf16 v[164:167], a[232:235], a[200:203], v[164:167]
  v_mfma_f32_16x16x32_bf16 v[164:167], a[236:239], a[204:207], v[164:167]
  buffer_store_dwordx4 v[48:51], v0, s[16:19], s5 offen offset:3072 sc1
  v_mfma_f32_16x16x32_bf16 v[160:163], a[228:231], a[204:207], v[160:163]
  ds_read_b128 a[204:207], v25 offset:28672
  v_mfma_f32_16x16x32_bf16 v[160:163], a[224:227], a[200:203], v[160:163]
  ds_read_b128 a[200:203], v12 offset:28672
  s_waitcnt lgkmcnt(4)
  v_mfma_f32_16x16x32_bf16 v[176:179], a[208:211], a[144:147], v[176:179]
  v_mfma_f32_16x16x32_bf16 v[176:179], a[212:215], a[148:151], v[176:179]
  v_mfma_f32_16x16x32_bf16 v[180:183], a[220:223], a[148:151], v[180:183]
  v_mfma_f32_16x16x32_bf16 v[180:183], a[216:219], a[144:147], v[180:183]
  v_mfma_f32_16x16x32_bf16 v[188:191], a[216:219], a[152:155], v[188:191]
  v_mfma_f32_16x16x32_bf16 v[188:191], a[220:223], a[156:159], v[188:191]
  s_waitcnt vmcnt(21) lgkmcnt(0)
  s_barrier
  v_mfma_f32_16x16x32_bf16 v[184:187], a[212:215], a[156:159], v[184:187]
  s_add_u32 m0, s41, 147456
  ds_read_b64_tr_b16 a[224:225], v13 offset:49152
  v_mfma_f32_16x16x32_bf16 v[184:187], a[208:211], a[152:155], v[184:187]
  s_bfe_u32 s6, s77, 0x40004
  ds_read_b64_tr_b16 a[226:227], v13 offset:50176
  v_mfma_f32_16x16x32_bf16 v[192:195], a[208:211], a[160:163], v[192:195]
  s_mul_i32 s6, s6, 128
  ds_read_b64_tr_b16 a[228:229], v13 offset:57344
  v_mfma_f32_16x16x32_bf16 v[192:195], a[212:215], a[164:167], v[192:195]
  s_add_u32 s6, s6, s50
  v_mfma_f32_16x16x32_bf16 v[196:199], a[220:223], a[164:167], v[196:199]
  ds_read_b64_tr_b16 a[230:231], v13 offset:58368
  v_mfma_f32_16x16x32_bf16 v[196:199], a[216:219], a[160:163], v[196:199]
  buffer_load_dwordx4 v19, s[28:31], s6 offen offset:0 lds
  v_mfma_f32_16x16x32_bf16 v[204:207], a[216:219], a[168:171], v[204:207]
  ds_read_b64_tr_b16 a[232:233], v14 offset:49152
  v_mfma_f32_16x16x32_bf16 v[204:207], a[220:223], a[172:175], v[204:207]
  buffer_load_dwordx4 v20, s[28:31], s6 offen offset:1024 lds
  v_mfma_f32_16x16x32_bf16 v[200:203], a[212:215], a[172:175], v[200:203]
  ds_read_b64_tr_b16 a[234:235], v14 offset:50176
  ds_read_b64_tr_b16 a[236:237], v14 offset:57344
  v_mfma_f32_16x16x32_bf16 v[200:203], a[208:211], a[168:171], v[200:203]
  v_mfma_f32_16x16x32_bf16 v[208:211], a[208:211], a[176:179], v[208:211]
  buffer_load_dwordx4 v21, s[28:31], s6 offen offset:2048 lds
  v_mfma_f32_16x16x32_bf16 v[208:211], a[212:215], a[180:183], v[208:211]
  ds_read_b64_tr_b16 a[238:239], v14 offset:58368
  ds_read_b64_tr_b16 a[240:241], v15 offset:49152
  v_mfma_f32_16x16x32_bf16 v[212:215], a[220:223], a[180:183], v[212:215]
  buffer_load_dwordx4 v22, s[28:31], s6 offen offset:3072 lds
  v_mfma_f32_16x16x32_bf16 v[212:215], a[216:219], a[176:179], v[212:215]
  ds_read_b64_tr_b16 a[242:243], v15 offset:50176
  v_mfma_f32_16x16x32_bf16 v[220:223], a[216:219], a[184:187], v[220:223]
  ds_read_b64_tr_b16 a[244:245], v15 offset:57344
  v_mfma_f32_16x16x32_bf16 v[220:223], a[220:223], a[188:191], v[220:223]
  s_lshl_b32 m0, s38, 11
  ds_read_b64_tr_b16 a[246:247], v15 offset:58368
  v_mfma_f32_16x16x32_bf16 v[216:219], a[212:215], a[188:191], v[216:219]
  s_add_u32 m0, m0, 32768
  v_mfma_f32_16x16x32_bf16 v[216:219], a[208:211], a[184:187], v[216:219]
  s_bfe_u32 s51, s77, 0x40004
  ds_read_b64_tr_b16 a[248:249], v16 offset:49152
  v_mfma_f32_16x16x32_bf16 v[224:227], a[208:211], a[192:195], v[224:227]
  s_mul_i32 s51, s51, s52
  ds_read_b64_tr_b16 a[250:251], v16 offset:50176
  v_mfma_f32_16x16x32_bf16 v[224:227], a[212:215], a[196:199], v[224:227]
  v_mfma_f32_16x16x32_bf16 v[228:231], a[220:223], a[196:199], v[228:231]
  buffer_load_dwordx4 v23, s[88:91], s51 offen offset:0 lds
  v_mfma_f32_16x16x32_bf16 v[228:231], a[216:219], a[192:195], v[228:231]
  ds_read_b64_tr_b16 a[252:253], v16 offset:57344
  ds_read_b64_tr_b16 a[254:255], v16 offset:58368
  v_mfma_f32_16x16x32_bf16 v[236:239], a[216:219], a[200:203], v[236:239]
  buffer_load_dwordx4 v24, s[88:91], s51 offen offset:1024 lds
  v_mfma_f32_16x16x32_bf16 v[236:239], a[220:223], a[204:207], v[236:239]
  v_mfma_f32_16x16x32_bf16 v[232:235], a[212:215], a[204:207], v[232:235]
  v_mfma_f32_16x16x32_bf16 v[232:235], a[208:211], a[200:203], v[232:235]
  s_waitcnt lgkmcnt(4)
  v_mfma_f32_16x16x32_bf16 v[240:243], a[224:227], a[144:147], v[240:243]
  v_add_u32 v12, 98304, v27
  v_add_u32 v25, 98304, v28
  v_mfma_f32_16x16x32_bf16 v[240:243], a[228:231], a[148:151], v[240:243]
  v_mfma_f32_16x16x32_bf16 v[244:247], a[236:239], a[148:151], v[244:247]
  v_mfma_f32_16x16x32_bf16 v[244:247], a[232:235], a[144:147], v[244:247]
  v_mfma_f32_16x16x32_bf16 v[248:251], a[240:243], a[144:147], v[248:251]
  v_mfma_f32_16x16x32_bf16 v[248:251], a[244:247], a[148:151], v[248:251]
  s_waitcnt vmcnt(19) lgkmcnt(0)
  s_barrier
  v_mfma_f32_16x16x32_bf16 v[252:255], a[252:255], a[148:151], v[252:255]
  ds_read_b128 a[148:151], v25 offset:0
  s_lshl_b32 m0, s38, 13
  v_mfma_f32_16x16x32_bf16 v[252:255], a[248:251], a[144:147], v[252:255]
  ds_read_b128 a[144:147], v12 offset:0
  s_add_u32 m0, m0, 65536
  v_mfma_f32_16x16x32_bf16 v[76:79], a[248:251], a[152:155], v[76:79]
  buffer_load_dwordx4 v56, s[24:27], s94 offen offset:0 lds
  v_mfma_f32_16x16x32_bf16 v[76:79], a[252:255], a[156:159], v[76:79]
  ds_read_b64_tr_b16 a[208:209], v17 offset:0
  v_bfe_u32 v31, v1, 2, 3
  v_mfma_f32_16x16x32_bf16 v[72:75], a[244:247], a[156:159], v[72:75]
  v_and_b32 v62, 3, v1
  v_lshlrev_b32 v62, 2, v62
  v_mfma_f32_16x16x32_bf16 v[72:75], a[240:243], a[152:155], v[72:75]
  buffer_load_dwordx4 v57, s[24:27], s94 offen offset:1024 lds
  v_mfma_f32_16x16x32_bf16 v[68:71], a[232:235], a[152:155], v[68:71]
  ds_read_b64_tr_b16 a[210:211], v17 offset:512
  v_lshl_add_u32 v31, v31, 7, v62
  v_mfma_f32_16x16x32_bf16 v[68:71], a[236:239], a[156:159], v[68:71]
  s_lshl_b32 s6, s36, 10
  s_add_u32 s6, s6, 68222976
  v_mfma_f32_16x16x32_bf16 v[64:67], a[228:231], a[156:159], v[64:67]
  ds_read_b128 a[156:159], v25 offset:4096
  s_add_u32 s94, s94, 10240
  v_mfma_f32_16x16x32_bf16 v[64:67], a[224:227], a[152:155], v[64:67]
  ds_read_b128 a[152:155], v12 offset:4096
  s_lshl_b32 m0, s38, 13
  v_mfma_f32_16x16x32_bf16 v[80:83], a[224:227], a[160:163], v[80:83]
  v_mfma_f32_16x16x32_bf16 v[80:83], a[228:231], a[164:167], v[80:83]
  s_add_u32 m0, m0, 67584
  v_mfma_f32_16x16x32_bf16 v[84:87], a[236:239], a[164:167], v[84:87]
  buffer_load_dwordx4 v56, s[24:27], s94 offen offset:0 lds
  v_mfma_f32_16x16x32_bf16 v[84:87], a[232:235], a[160:163], v[84:87]
  ds_read_b64_tr_b16 a[212:213], v17 offset:4096
  v_mfma_f32_16x16x32_bf16 v[88:91], a[240:243], a[160:163], v[88:91]
  v_mfma_f32_16x16x32_bf16 v[88:91], a[244:247], a[164:167], v[88:91]
  buffer_load_dwordx4 v57, s[24:27], s94 offen offset:1024 lds
  v_mfma_f32_16x16x32_bf16 v[92:95], a[252:255], a[164:167], v[92:95]
  ds_read_b128 a[164:167], v25 offset:8192
  v_mfma_f32_16x16x32_bf16 v[92:95], a[248:251], a[160:163], v[92:95]
  ds_read_b128 a[160:163], v12 offset:8192
  v_mfma_f32_16x16x32_bf16 v[108:111], a[248:251], a[168:171], v[108:111]
  s_add_u32 s94, s94, 10240
  ds_read_b64_tr_b16 a[214:215], v17 offset:4608
  v_mfma_f32_16x16x32_bf16 v[108:111], a[252:255], a[172:175], v[108:111]
  s_lshl_b32 m0, s38, 13
  v_mfma_f32_16x16x32_bf16 v[104:107], a[244:247], a[172:175], v[104:107]
  v_mfma_f32_16x16x32_bf16 v[104:107], a[240:243], a[168:171], v[104:107]
  s_add_u32 m0, m0, 69632
  v_mfma_f32_16x16x32_bf16 v[100:103], a[232:235], a[168:171], v[100:103]
  buffer_load_dwordx4 v56, s[24:27], s94 offen offset:0 lds
  v_mfma_f32_16x16x32_bf16 v[100:103], a[236:239], a[172:175], v[100:103]
  v_mfma_f32_16x16x32_bf16 v[96:99], a[228:231], a[172:175], v[96:99]
  ds_read_b128 a[172:175], v25 offset:12288
  ds_read_b64_tr_b16 a[216:217], v18 offset:0
  v_mfma_f32_16x16x32_bf16 v[96:99], a[224:227], a[168:171], v[96:99]
  ds_read_b128 a[168:171], v12 offset:12288
  v_mfma_f32_16x16x32_bf16 v[112:115], a[224:227], a[176:179], v[112:115]
  buffer_load_dwordx4 v57, s[24:27], s94 offen offset:1024 lds
  v_mfma_f32_16x16x32_bf16 v[112:115], a[228:231], a[180:183], v[112:115]
  v_mfma_f32_16x16x32_bf16 v[116:119], a[236:239], a[180:183], v[116:119]
  s_add_u32 s94, s94, 10240
  v_mfma_f32_16x16x32_bf16 v[116:119], a[232:235], a[176:179], v[116:119]
  s_lshl_b32 m0, s38, 13
  v_mfma_f32_16x16x32_bf16 v[120:123], a[240:243], a[176:179], v[120:123]
  ds_read_b64_tr_b16 a[218:219], v18 offset:512
  v_mfma_f32_16x16x32_bf16 v[120:123], a[244:247], a[180:183], v[120:123]
  s_add_u32 m0, m0, 71680
  v_mfma_f32_16x16x32_bf16 v[124:127], a[252:255], a[180:183], v[124:127]
  ds_read_b128 a[180:183], v25 offset:16384
  v_mfma_f32_16x16x32_bf16 v[124:127], a[248:251], a[176:179], v[124:127]
  ds_read_b128 a[176:179], v12 offset:16384
  v_mfma_f32_16x16x32_bf16 v[140:143], a[248:251], a[184:187], v[140:143]
  buffer_load_dwordx4 v56, s[24:27], s94 offen offset:0 lds
  v_mfma_f32_16x16x32_bf16 v[140:143], a[252:255], a[188:191], v[140:143]
  buffer_load_dwordx4 v57, s[24:27], s94 offen offset:1024 lds
  v_mfma_f32_16x16x32_bf16 v[136:139], a[244:247], a[188:191], v[136:139]
  ds_read_b64_tr_b16 a[220:221], v18 offset:4096
  s_waitcnt vmcnt(33)
  v_mfma_f32_16x16x32_bf16 v[136:139], a[240:243], a[184:187], v[136:139]
  v_cmp_eq_u32 vcc, 0, v30
  s_cbranch_vccnz L_go_4
L_goback_5:
  v_mfma_f32_16x16x32_bf16 v[132:135], a[232:235], a[184:187], v[132:135]
  s_add_u32 s94, s94, 10240
  v_mov_b32 v29, 1
  v_mfma_f32_16x16x32_bf16 v[132:135], a[236:239], a[188:191], v[132:135]
  s_add_u32 m0, s41, 49152
  s_waitcnt vmcnt(14)
  v_mfma_f32_16x16x32_bf16 v[128:131], a[228:231], a[188:191], v[128:131]
  ds_read_b128 a[188:191], v25 offset:20480
  s_bfe_u32 s62, s77, 0x40004
  v_mfma_f32_16x16x32_bf16 v[128:131], a[224:227], a[184:187], v[128:131]
  ds_read_b128 a[184:187], v12 offset:20480
  v_mfma_f32_16x16x32_bf16 v[144:147], a[224:227], a[192:195], v[144:147]
  s_mul_i32 s62, s62, 524288
  ds_read_b64_tr_b16 a[222:223], v18 offset:4608
  v_mfma_f32_16x16x32_bf16 v[144:147], a[228:231], a[196:199], v[144:147]
  buffer_load_dwordx4 v6, s[32:35], s62 offen offset:0 lds
  v_mfma_f32_16x16x32_bf16 v[148:151], a[236:239], a[196:199], v[148:151]
  buffer_store_dword v29, off, s[16:19], s55 sc1
  v_mfma_f32_16x16x32_bf16 v[148:151], a[232:235], a[192:195], v[148:151]
  v_mfma_f32_16x16x32_bf16 v[152:155], a[240:243], a[192:195], v[152:155]
  buffer_load_dwordx4 v7, s[32:35], s62 offen offset:1024 lds
  v_mfma_f32_16x16x32_bf16 v[152:155], a[244:247], a[196:199], v[152:155]
  v_mfma_f32_16x16x32_bf16 v[156:159], a[252:255], a[196:199], v[156:159]
  ds_read_b128 a[196:199], v25 offset:24576
  v_mfma_f32_16x16x32_bf16 v[156:159], a[248:251], a[192:195], v[156:159]
  ds_read_b128 a[192:195], v12 offset:24576
  v_mfma_f32_16x16x32_bf16 v[172:175], a[248:251], a[200:203], v[172:175]
  buffer_load_dwordx4 v8, s[32:35], s62 offen offset:2048 lds
  v_mfma_f32_16x16x32_bf16 v[172:175], a[252:255], a[204:207], v[172:175]
  v_mfma_f32_16x16x32_bf16 v[168:171], a[244:247], a[204:207], v[168:171]
  buffer_load_dwordx4 v9, s[32:35], s62 offen offset:3072 lds
  v_mfma_f32_16x16x32_bf16 v[168:171], a[240:243], a[200:203], v[168:171]
  v_mfma_f32_16x16x32_bf16 v[164:167], a[232:235], a[200:203], v[164:167]
  v_mfma_f32_16x16x32_bf16 v[164:167], a[236:239], a[204:207], v[164:167]
  v_mfma_f32_16x16x32_bf16 v[160:163], a[228:231], a[204:207], v[160:163]
  ds_read_b128 a[204:207], v25 offset:28672
  v_mfma_f32_16x16x32_bf16 v[160:163], a[224:227], a[200:203], v[160:163]
  ds_read_b128 a[200:203], v12 offset:28672
  s_waitcnt lgkmcnt(4)
  v_mfma_f32_16x16x32_bf16 v[176:179], a[208:211], a[144:147], v[176:179]
  v_xor_b32 v32, 0, v58
  v_xor_b32 v33, 32, v58
  v_mfma_f32_16x16x32_bf16 v[176:179], a[212:215], a[148:151], v[176:179]
  v_xor_b32 v34, 64, v58
  v_xor_b32 v35, 96, v58
  v_mfma_f32_16x16x32_bf16 v[180:183], a[220:223], a[148:151], v[180:183]
  v_xor_b32 v36, 128, v58
  v_xor_b32 v37, 160, v58
  v_mfma_f32_16x16x32_bf16 v[180:183], a[216:219], a[144:147], v[180:183]
  v_xor_b32 v38, 192, v58
  v_xor_b32 v39, 224, v58
  v_mfma_f32_16x16x32_bf16 v[188:191], a[216:219], a[152:155], v[188:191]
  v_add_u32 v5, 4096, v0
  v_mfma_f32_16x16x32_bf16 v[188:191], a[220:223], a[156:159], v[188:191]
  s_waitcnt lgkmcnt(0)
  s_barrier
  v_mfma_f32_16x16x32_bf16 v[184:187], a[212:215], a[156:159], v[184:187]
  ds_read_b64_tr_b16 a[224:225], v13 offset:16384
  v_mfma_f32_16x16x32_bf16 v[184:187], a[208:211], a[152:155], v[184:187]
  ds_read_b64_tr_b16 a[226:227], v13 offset:17408
  v_mfma_f32_16x16x32_bf16 v[192:195], a[208:211], a[160:163], v[192:195]
  ds_read_b64_tr_b16 a[228:229], v13 offset:24576
  v_mfma_f32_16x16x32_bf16 v[192:195], a[212:215], a[164:167], v[192:195]
  v_mfma_f32_16x16x32_bf16 v[196:199], a[220:223], a[164:167], v[196:199]
  ds_read_b64_tr_b16 a[230:231], v13 offset:25600
  v_mfma_f32_16x16x32_bf16 v[196:199], a[216:219], a[160:163], v[196:199]
  ds_read_b64_tr_b16 a[232:233], v14 offset:16384
  v_mfma_f32_16x16x32_bf16 v[204:207], a[216:219], a[168:171], v[204:207]
  v_mfma_f32_16x16x32_bf16 v[204:207], a[220:223], a[172:175], v[204:207]
  ds_read_b64_tr_b16 a[234:235], v14 offset:17408
  v_mfma_f32_16x16x32_bf16 v[200:203], a[212:215], a[172:175], v[200:203]
  ds_read_b64_tr_b16 a[236:237], v14 offset:24576
  v_mfma_f32_16x16x32_bf16 v[200:203], a[208:211], a[168:171], v[200:203]
  v_mfma_f32_16x16x32_bf16 v[208:211], a[208:211], a[176:179], v[208:211]
  ds_read_b64_tr_b16 a[238:239], v14 offset:25600
  v_mfma_f32_16x16x32_bf16 v[208:211], a[212:215], a[180:183], v[208:211]
  ds_read_b64_tr_b16 a[240:241], v15 offset:16384
  v_mfma_f32_16x16x32_bf16 v[212:215], a[220:223], a[180:183], v[212:215]
  ds_read_b64_tr_b16 a[242:243], v15 offset:17408
  v_mfma_f32_16x16x32_bf16 v[212:215], a[216:219], a[176:179], v[212:215]
  v_mfma_f32_16x16x32_bf16 v[220:223], a[216:219], a[184:187], v[220:223]
  ds_read_b64_tr_b16 a[244:245], v15 offset:24576
  v_mfma_f32_16x16x32_bf16 v[220:223], a[220:223], a[188:191], v[220:223]
  ds_read_b64_tr_b16 a[246:247], v15 offset:25600
  v_mfma_f32_16x16x32_bf16 v[216:219], a[212:215], a[188:191], v[216:219]
  v_mfma_f32_16x16x32_bf16 v[216:219], a[208:211], a[184:187], v[216:219]
  ds_read_b64_tr_b16 a[248:249], v16 offset:16384
  v_mfma_f32_16x16x32_bf16 v[224:227], a[208:211], a[192:195], v[224:227]
  ds_read_b64_tr_b16 a[250:251], v16 offset:17408
  v_mfma_f32_16x16x32_bf16 v[224:227], a[212:215], a[196:199], v[224:227]
  v_mfma_f32_16x16x32_bf16 v[228:231], a[220:223], a[196:199], v[228:231]
  ds_read_b64_tr_b16 a[252:253], v16 offset:24576
  v_mfma_f32_16x16x32_bf16 v[228:231], a[216:219], a[192:195], v[228:231]
  ds_read_b64_tr_b16 a[254:255], v16 offset:25600
  v_mfma_f32_16x16x32_bf16 v[236:239], a[216:219], a[200:203], v[236:239]
  v_mfma_f32_16x16x32_bf16 v[236:239], a[220:223], a[204:207], v[236:239]
  v_mfma_f32_16x16x32_bf16 v[232:235], a[212:215], a[204:207], v[232:235]
  v_mfma_f32_16x16x32_bf16 v[232:235], a[208:211], a[200:203], v[232:235]
  s_waitcnt lgkmcnt(4)
  v_mfma_f32_16x16x32_bf16 v[240:243], a[224:227], a[144:147], v[240:243]
  v_add_u32 v12, 131072, v27
  v_add_u32 v25, 131072, v28
  v_mfma_f32_16x16x32_bf16 v[240:243], a[228:231], a[148:151], v[240:243]
  s_waitcnt vmcnt(5)
  ds_read_b64_tr_b16 a[112:113], v32 offset:0
  v_mfma_f32_16x16x32_bf16 v[244:247], a[236:239], a[148:151], v[244:247]
  ds_read_b64_tr_b16 a[114:115], v32 offset:4096
  v_add_u32 v5, 4096, v0
  v_mfma_f32_16x16x32_bf16 v[244:247], a[232:235], a[144:147], v[244:247]
  ds_read_b64_tr_b16 a[116:117], v33 offset:0
  v_mov_b32 v2, v0
  v_mfma_f32_16x16x32_bf16 v[248:251], a[240:243], a[144:147], v[248:251]
  ds_read_b64_tr_b16 a[118:119], v33 offset:4096
  v_add_u32 v3, 8192, v0
  v_mfma_f32_16x16x32_bf16 v[248:251], a[244:247], a[148:151], v[248:251]
  s_waitcnt lgkmcnt(4)
  s_barrier
  v_mfma_f32_16x16x32_bf16 v[252:255], a[252:255], a[148:151], v[252:255]
  ds_read_b128 a[148:151], v25 offset:0
  ds_read_b64_tr_b16 a[208:209], v17 offset:32768
  v_mfma_f32_16x16x32_bf16 v[252:255], a[248:251], a[144:147], v[252:255]
  ds_read_b128 a[144:147], v12 offset:0
  ds_read_b64_tr_b16 a[120:121], v34 offset:0
  v_mfma_f32_16x16x32_bf16 v[76:79], a[248:251], a[152:155], v[76:79]
  ds_read_b64_tr_b16 a[122:123], v34 offset:4096
  ds_read_b64_tr_b16 a[124:125], v35 offset:0
  v_mfma_f32_16x16x32_bf16 v[76:79], a[252:255], a[156:159], v[76:79]
  ds_read_b64_tr_b16 a[126:127], v35 offset:4096
  v_mov_b32 v9, v0
  v_mfma_f32_16x16x32_bf16 v[72:75], a[244:247], a[156:159], v[72:75]
  v_bfe_i32 v10, v1, 0, 1
  v_and_b32 v10, 0xaaaaaaaa, v10
  v_mfma_f32_16x16x32_bf16 v[72:75], a[240:243], a[152:155], v[72:75]
  ds_read_b64_tr_b16 a[128:129], v36 offset:0
  v_add_u32 v10, 0x44444444, v10
  v_mfma_f32_16x16x32_bf16 v[68:71], a[232:235], a[152:155], v[68:71]
  ds_read_b64_tr_b16 a[210:211], v17 offset:33280
  ds_read_b64_tr_b16 a[130:131], v36 offset:4096
  v_mfma_f32_16x16x32_bf16 v[68:71], a[236:239], a[156:159], v[68:71]
  ds_read_b64_tr_b16 a[132:133], v37 offset:0
  v_and_b32 v6, 15, v1
  v_mfma_f32_16x16x32_bf16 v[64:67], a[228:231], a[156:159], v[64:67]
  ds_read_b128 a[156:159], v25 offset:4096
  ds_read_b64_tr_b16 a[134:135], v37 offset:4096
  v_mfma_f32_16x16x32_bf16 v[64:67], a[224:227], a[152:155], v[64:67]
  ds_read_b128 a[152:155], v12 offset:4096
  v_lshlrev_b32 v6, 2, v6
  v_mfma_f32_16x16x32_bf16 v[80:83], a[224:227], a[160:163], v[80:83]
  ds_read_b64_tr_b16 a[136:137], v38 offset:0
  s_lshl_b32 s3, s39, 14
  v_mfma_f32_16x16x32_bf16 v[80:83], a[228:231], a[164:167], v[80:83]
  ds_read_b64_tr_b16 a[138:139], v38 offset:4096
  s_add_u32 s3, s3, 98304
  v_mfma_f32_16x16x32_bf16 v[84:87], a[236:239], a[164:167], v[84:87]
  ds_read_b64_tr_b16 a[212:213], v17 offset:36864
  ds_read_b64_tr_b16 a[140:141], v39 offset:0
  v_mfma_f32_16x16x32_bf16 v[84:87], a[232:235], a[160:163], v[84:87]
  ds_read_b64_tr_b16 a[142:143], v39 offset:4096
  s_lshl_b32 s4, s40, 11
  v_mfma_f32_16x16x32_bf16 v[88:91], a[240:243], a[160:163], v[88:91]
  s_add_u32 s4, s4, s3
  v_add_u32 v11, s4, v0
  v_mfma_f32_16x16x32_bf16 v[88:91], a[244:247], a[164:167], v[88:91]
  s_lshl_b32 s4, s40, 15
  s_add_u32 s4, s4, s3
  v_mfma_f32_16x16x32_bf16 v[92:95], a[252:255], a[164:167], v[92:95]
  ds_read_b128 a[164:167], v25 offset:8192
  v_add_u32 v8, s4, v0
  v_mfma_f32_16x16x32_bf16 v[92:95], a[248:251], a[160:163], v[92:95]
  ds_read_b128 a[160:163], v12 offset:8192
  s_mov_b32 s49, 0
  v_mfma_f32_16x16x32_bf16 v[108:111], a[248:251], a[168:171], v[108:111]
  ds_read_b64_tr_b16 a[214:215], v17 offset:37376
  s_mov_b32 s53, s92
  v_mfma_f32_16x16x32_bf16 v[108:111], a[252:255], a[172:175], v[108:111]
  s_mov_b32 s24, s16
  s_mov_b32 s25, s17
  v_mfma_f32_16x16x32_bf16 v[104:107], a[244:247], a[172:175], v[104:107]
  s_add_u32 s26, s92, 10240
  s_min_u32 s26, s26, s18
  v_mfma_f32_16x16x32_bf16 v[104:107], a[240:243], a[168:171], v[104:107]
  s_lshl_b32 s54, s2, 2
  s_add_u32 s54, s54, 68354048
  v_mfma_f32_16x16x32_bf16 v[100:103], a[232:235], a[168:171], v[100:103]
  s_waitcnt lgkmcnt(15)
  s_mov_b32 s55, 16384
  v_mfma_f32_16x16x32_bf16 v[100:103], a[236:239], a[172:175], v[100:103]
  s_lshl_b32 s3, s40, 14
  s_sub_u32 s96, 24576, s3
  v_mfma_f32_16x16x32_bf16 v[96:99], a[228:231], a[172:175], v[96:99]
  ds_read_b128 a[172:175], v25 offset:12288
  ds_read_b64_tr_b16 a[216:217], v18 offset:32768
  v_mfma_f32_16x16x32_bf16 v[96:99], a[224:227], a[168:171], v[96:99]
  ds_read_b128 a[168:171], v12 offset:12288
  s_xor_b32 s3, s40, 1
  v_mfma_f32_16x16x32_bf16 v[112:115], a[224:227], a[176:179], v[112:115]
  buffer_store_dwordx4 a[112:115], v0, s[16:19], s95 offen offset:0 sc1
  v_mfma_f32_16x16x32_bf16 v[112:115], a[228:231], a[180:183], v[112:115]
  s_lshl_b32 s3, s3, 6
  s_add_u32 s50, s79, s3
  v_mfma_f32_16x16x32_bf16 v[116:119], a[236:239], a[180:183], v[116:119]
  s_sub_u32 s50, s50, 2
  v_mfma_f32_16x16x32_bf16 v[116:119], a[232:235], a[176:179], v[116:119]
  buffer_load_dword v30, v31, s[16:19], s6 offen sc1
  v_mfma_f32_16x16x32_bf16 v[120:123], a[240:243], a[176:179], v[120:123]
  ds_read_b64_tr_b16 a[218:219], v18 offset:33280
  v_mfma_f32_16x16x32_bf16 v[120:123], a[244:247], a[180:183], v[120:123]
  v_mfma_f32_16x16x32_bf16 v[124:127], a[252:255], a[180:183], v[124:127]
  ds_read_b128 a[180:183], v25 offset:16384
  v_mfma_f32_16x16x32_bf16 v[124:127], a[248:251], a[176:179], v[124:127]
  ds_read_b128 a[176:179], v12 offset:16384
  v_mfma_f32_16x16x32_bf16 v[140:143], a[248:251], a[184:187], v[140:143]
  buffer_store_dwordx4 a[116:119], v0, s[16:19], s95 offen offset:1024 sc1
  v_mfma_f32_16x16x32_bf16 v[140:143], a[252:255], a[188:191], v[140:143]
  v_mfma_f32_16x16x32_bf16 v[136:139], a[244:247], a[188:191], v[136:139]
  ds_read_b64_tr_b16 a[220:221], v18 offset:36864
  v_mfma_f32_16x16x32_bf16 v[136:139], a[240:243], a[184:187], v[136:139]
  v_mfma_f32_16x16x32_bf16 v[132:135], a[232:235], a[184:187], v[132:135]
  v_mfma_f32_16x16x32_bf16 v[132:135], a[236:239], a[188:191], v[132:135]
  v_mfma_f32_16x16x32_bf16 v[128:131], a[228:231], a[188:191], v[128:131]
  ds_read_b128 a[188:191], v25 offset:20480
  v_mfma_f32_16x16x32_bf16 v[128:131], a[224:227], a[184:187], v[128:131]
  ds_read_b128 a[184:187], v12 offset:20480
  v_mfma_f32_16x16x32_bf16 v[144:147], a[224:227], a[192:195], v[144:147]
  ds_read_b64_tr_b16 a[222:223], v18 offset:37376
  v_mfma_f32_16x16x32_bf16 v[144:147], a[228:231], a[196:199], v[144:147]
  buffer_store_dwordx4 a[120:123], v0, s[16:19], s95 offen offset:2048 sc1
  v_mfma_f32_16x16x32_bf16 v[148:151], a[236:239], a[196:199], v[148:151]
  v_mfma_f32_16x16x32_bf16 v[148:151], a[232:235], a[192:195], v[148:151]
  v_mfma_f32_16x16x32_bf16 v[152:155], a[240:243], a[192:195], v[152:155]
  v_mfma_f32_16x16x32_bf16 v[152:155], a[244:247], a[196:199], v[152:155]
  v_mfma_f32_16x16x32_bf16 v[156:159], a[252:255], a[196:199], v[156:159]
  ds_read_b128 a[196:199], v25 offset:24576
  v_mfma_f32_16x16x32_bf16 v[156:159], a[248:251], a[192:195], v[156:159]
  ds_read_b128 a[192:195], v12 offset:24576
  v_mfma_f32_16x16x32_bf16 v[172:175], a[248:251], a[200:203], v[172:175]
  buffer_store_dwordx4 a[124:127], v0, s[16:19], s95 offen offset:3072 sc1
  v_mfma_f32_16x16x32_bf16 v[172:175], a[252:255], a[204:207], v[172:175]
  v_mfma_f32_16x16x32_bf16 v[168:171], a[244:247], a[204:207], v[168:171]
  v_mfma_f32_16x16x32_bf16 v[168:171], a[240:243], a[200:203], v[168:171]
  v_mfma_f32_16x16x32_bf16 v[164:167], a[232:235], a[200:203], v[164:167]
  v_mfma_f32_16x16x32_bf16 v[164:167], a[236:239], a[204:207], v[164:167]
  v_mfma_f32_16x16x32_bf16 v[160:163], a[228:231], a[204:207], v[160:163]
  ds_read_b128 a[204:207], v25 offset:28672
  v_mfma_f32_16x16x32_bf16 v[160:163], a[224:227], a[200:203], v[160:163]
  ds_read_b128 a[200:203], v12 offset:28672
  s_waitcnt lgkmcnt(4)
  v_mfma_f32_16x16x32_bf16 v[176:179], a[208:211], a[144:147], v[176:179]
  buffer_store_dwordx4 a[128:131], v5, s[16:19], s95 offen offset:0 sc1
  v_mfma_f32_16x16x32_bf16 v[176:179], a[212:215], a[148:151], v[176:179]
  v_xor_b32 v28, 229376, v8
  v_and_b32 v40, 15, v1
  v_mfma_f32_16x16x32_bf16 v[180:183], a[220:223], a[148:151], v[180:183]
  s_lshl_b32 s4, s39, 4
  v_add_u32 v40, s4, v40
  v_mfma_f32_16x16x32_bf16 v[180:183], a[216:219], a[144:147], v[180:183]
  v_lshrrev_b32 v41, 4, v1
  v_lshlrev_b32 v41, 2, v41
  v_mfma_f32_16x16x32_bf16 v[188:191], a[216:219], a[152:155], v[188:191]
  v_sub_u32 v40, v40, v41
  v_mov_b32 v41, 0xf149f2ca
  v_mfma_f32_16x16x32_bf16 v[188:191], a[220:223], a[156:159], v[188:191]
  s_waitcnt vmcnt(6) lgkmcnt(0)
  s_barrier
  v_mfma_f32_16x16x32_bf16 v[184:187], a[212:215], a[156:159], v[184:187]
  ds_read_b64_tr_b16 a[224:225], v13 offset:49152
  v_mfma_f32_16x16x32_bf16 v[184:187], a[208:211], a[152:155], v[184:187]
  ds_read_b64_tr_b16 a[226:227], v13 offset:50176
  v_mfma_f32_16x16x32_bf16 v[192:195], a[208:211], a[160:163], v[192:195]
  ds_read_b64_tr_b16 a[228:229], v13 offset:57344
  v_mfma_f32_16x16x32_bf16 v[192:195], a[212:215], a[164:167], v[192:195]
  buffer_store_dwordx4 a[132:135], v5, s[16:19], s95 offen offset:1024 sc1
  v_mfma_f32_16x16x32_bf16 v[196:199], a[220:223], a[164:167], v[196:199]
  ds_read_b64_tr_b16 a[230:231], v13 offset:58368
  v_mfma_f32_16x16x32_bf16 v[196:199], a[216:219], a[160:163], v[196:199]
  ds_read_b64_tr_b16 a[232:233], v14 offset:49152
  v_mfma_f32_16x16x32_bf16 v[204:207], a[216:219], a[168:171], v[204:207]
  v_mfma_f32_16x16x32_bf16 v[204:207], a[220:223], a[172:175], v[204:207]
  ds_read_b64_tr_b16 a[234:235], v14 offset:50176
  v_mfma_f32_16x16x32_bf16 v[200:203], a[212:215], a[172:175], v[200:203]
  ds_read_b64_tr_b16 a[236:237], v14 offset:57344
  v_mfma_f32_16x16x32_bf16 v[200:203], a[208:211], a[168:171], v[200:203]
  buffer_store_dwordx4 a[136:139], v5, s[16:19], s95 offen offset:2048 sc1
  v_mfma_f32_16x16x32_bf16 v[208:211], a[208:211], a[176:179], v[208:211]
  ds_read_b64_tr_b16 a[238:239], v14 offset:58368
  v_mfma_f32_16x16x32_bf16 v[208:211], a[212:215], a[180:183], v[208:211]
  ds_read_b64_tr_b16 a[240:241], v15 offset:49152
  v_mfma_f32_16x16x32_bf16 v[212:215], a[220:223], a[180:183], v[212:215]
  ds_read_b64_tr_b16 a[242:243], v15 offset:50176
  v_mfma_f32_16x16x32_bf16 v[212:215], a[216:219], a[176:179], v[212:215]
  v_mfma_f32_16x16x32_bf16 v[220:223], a[216:219], a[184:187], v[220:223]
  ds_read_b64_tr_b16 a[244:245], v15 offset:57344
  v_mfma_f32_16x16x32_bf16 v[220:223], a[220:223], a[188:191], v[220:223]
  ds_read_b64_tr_b16 a[246:247], v15 offset:58368
  v_mfma_f32_16x16x32_bf16 v[216:219], a[212:215], a[188:191], v[216:219]
  v_mfma_f32_16x16x32_bf16 v[216:219], a[208:211], a[184:187], v[216:219]
  ds_read_b64_tr_b16 a[248:249], v16 offset:49152
  v_mfma_f32_16x16x32_bf16 v[224:227], a[208:211], a[192:195], v[224:227]
  ds_read_b64_tr_b16 a[250:251], v16 offset:50176
  v_mfma_f32_16x16x32_bf16 v[224:227], a[212:215], a[196:199], v[224:227]
  buffer_store_dwordx4 a[140:143], v5, s[16:19], s95 offen offset:3072 sc1
  v_mfma_f32_16x16x32_bf16 v[228:231], a[220:223], a[196:199], v[228:231]
  ds_read_b64_tr_b16 a[252:253], v16 offset:57344
  v_mfma_f32_16x16x32_bf16 v[228:231], a[216:219], a[192:195], v[228:231]
  ds_read_b64_tr_b16 a[254:255], v16 offset:58368
  v_mfma_f32_16x16x32_bf16 v[236:239], a[216:219], a[200:203], v[236:239]
  v_mfma_f32_16x16x32_bf16 v[236:239], a[220:223], a[204:207], v[236:239]
  v_mfma_f32_16x16x32_bf16 v[232:235], a[212:215], a[204:207], v[232:235]
  v_mfma_f32_16x16x32_bf16 v[232:235], a[208:211], a[200:203], v[232:235]
  s_waitcnt lgkmcnt(4)
  v_mfma_f32_16x16x32_bf16 v[240:243], a[224:227], a[144:147], v[240:243]
  v_cmp_le_i32 vcc, 0, v40
  v_mov_b32 v12, 0x3f803f80
  v_mfma_f32_16x16x32_bf16 v[240:243], a[228:231], a[148:151], v[240:243]
  v_cndmask_b32 v16, v41, 0, vcc
  v_cmp_le_i32 vcc, 1, v40
  v_mfma_f32_16x16x32_bf16 v[244:247], a[236:239], a[148:151], v[244:247]
  v_mov_b32 v13, 0x3f803f80
  v_cndmask_b32 v17, v41, 0, vcc
  v_mfma_f32_16x16x32_bf16 v[244:247], a[232:235], a[144:147], v[244:247]
  v_cmp_le_i32 vcc, 2, v40
  v_mov_b32 v14, 0x3f803f80
  v_mfma_f32_16x16x32_bf16 v[248:251], a[240:243], a[144:147], v[248:251]
  v_cndmask_b32 v18, v41, 0, vcc
  v_cmp_le_i32 vcc, 3, v40
  v_mfma_f32_16x16x32_bf16 v[248:251], a[244:247], a[148:151], v[248:251]
  s_waitcnt lgkmcnt(0)
  s_barrier
  v_mfma_f32_16x16x32_bf16 v[252:255], a[252:255], a[148:151], v[252:255]
  v_mov_b32 v15, 0x3f803f80
  v_cndmask_b32 v19, v41, 0, vcc
  v_mfma_f32_16x16x32_bf16 v[252:255], a[248:251], a[144:147], v[252:255]
  v_cmp_le_i32 vcc, 16, v40
  s_nop 0
  v_mfma_f32_16x16x32_bf16 v[76:79], a[248:251], a[152:155], v[76:79]
  v_cndmask_b32 v20, v41, 0, vcc
  v_cmp_le_i32 vcc, 17, v40
  v_mfma_f32_16x16x32_bf16 v[76:79], a[252:255], a[156:159], v[76:79]
  s_nop 0
  v_cndmask_b32 v21, v41, 0, vcc
  v_mfma_f32_16x16x32_bf16 v[72:75], a[244:247], a[156:159], v[72:75]
  v_cmp_le_i32 vcc, 18, v40
  s_nop 0
  v_mfma_f32_16x16x32_bf16 v[72:75], a[240:243], a[152:155], v[72:75]
  v_cndmask_b32 v22, v41, 0, vcc
  v_cmp_le_i32 vcc, 19, v40
  v_mfma_f32_16x16x32_bf16 v[68:71], a[232:235], a[152:155], v[68:71]
  s_nop 0
  v_cndmask_b32 v23, v41, 0, vcc
  v_mfma_f32_16x16x32_bf16 v[68:71], a[236:239], a[156:159], v[68:71]
  v_cvt_pk_bf16_f32 v240, v240, v241
  v_cvt_pk_bf16_f32 v241, v242, v243
  v_mfma_f32_16x16x32_bf16 v[64:67], a[228:231], a[156:159], v[64:67]
  s_waitcnt vmcnt(7)
  v_cmp_eq_u32 vcc, 0, v30
  v_mfma_f32_16x16x32_bf16 v[64:67], a[224:227], a[152:155], v[64:67]
  s_cbranch_vccnz L_kv_7
L_kvback_8:
  v_cvt_pk_bf16_f32 v242, v244, v245
  v_mfma_f32_16x16x32_bf16 v[80:83], a[224:227], a[160:163], v[80:83]
  s_mov_b32 s75, s59
  v_cvt_pk_bf16_f32 v243, v246, v247
  v_mfma_f32_16x16x32_bf16 v[80:83], a[228:231], a[164:167], v[80:83]
  s_mov_b32 m0, s75
  v_cvt_pk_bf16_f32 v248, v248, v249
  v_mfma_f32_16x16x32_bf16 v[84:87], a[236:239], a[164:167], v[84:87]
  v_cvt_pk_bf16_f32 v249, v250, v251
  v_cvt_pk_bf16_f32 v250, v252, v253
  v_mfma_f32_16x16x32_bf16 v[84:87], a[232:235], a[160:163], v[84:87]
  buffer_load_dwordx4 v0, s[8:11], s56 offen offset:0 sc1 lds
  v_mfma_f32_16x16x32_bf16 v[88:91], a[240:243], a[160:163], v[88:91]
  v_cvt_pk_bf16_f32 v251, v254, v255
  v_cvt_pk_bf16_f32 v64, v64, v65
  v_mfma_f32_16x16x32_bf16 v[88:91], a[244:247], a[164:167], v[88:91]
  ds_write_b128 v11, v[240:243] offset:32768
  v_mfma_f32_16x16x32_bf16 v[92:95], a[252:255], a[164:167], v[92:95]
  buffer_load_dwordx4 v0, s[8:11], s56 offen offset:1024 sc1 lds
  v_mfma_f32_16x16x32_bf16 v[92:95], a[248:251], a[160:163], v[92:95]
  ds_write_b128 v11, v[248:251] offset:33792
  v_mfma_f32_16x16x32_bf16 v[108:111], a[248:251], a[168:171], v[108:111]
  v_cvt_pk_bf16_f32 v65, v66, v67
  v_cvt_pk_bf16_f32 v66, v68, v69
  v_mfma_f32_16x16x32_bf16 v[108:111], a[252:255], a[172:175], v[108:111]
  v_cvt_pk_bf16_f32 v67, v70, v71
  v_cvt_pk_bf16_f32 v72, v72, v73
  v_mfma_f32_16x16x32_bf16 v[104:107], a[244:247], a[172:175], v[104:107]
  buffer_load_dwordx4 v0, s[8:11], s56 offen offset:2048 sc1 lds
  v_mfma_f32_16x16x32_bf16 v[104:107], a[240:243], a[168:171], v[104:107]
  v_cvt_pk_bf16_f32 v73, v74, v75
  v_cvt_pk_bf16_f32 v74, v76, v77
  v_mfma_f32_16x16x32_bf16 v[100:103], a[232:235], a[168:171], v[100:103]
  v_cvt_pk_bf16_f32 v75, v78, v79
  v_cvt_pk_bf16_f32 v80, v80, v81
  v_mfma_f32_16x16x32_bf16 v[100:103], a[236:239], a[172:175], v[100:103]
  buffer_load_dwordx4 v0, s[8:11], s56 offen offset:3072 sc1 lds
  v_mfma_f32_16x16x32_bf16 v[96:99], a[228:231], a[172:175], v[96:99]
  ds_write_b128 v11, v[64:67] offset:36864
  v_mfma_f32_16x16x32_bf16 v[96:99], a[224:227], a[168:171], v[96:99]
  ds_write_b128 v11, v[72:75] offset:37888
  v_mfma_f32_16x16x32_bf16 v[112:115], a[224:227], a[176:179], v[112:115]
  v_cvt_pk_bf16_f32 v81, v82, v83
  v_cvt_pk_bf16_f32 v82, v84, v85
  v_mfma_f32_16x16x32_bf16 v[112:115], a[228:231], a[180:183], v[112:115]
  s_add_u32 m0, m0, 4096
  v_cvt_pk_bf16_f32 v83, v86, v87
  v_mfma_f32_16x16x32_bf16 v[116:119], a[236:239], a[180:183], v[116:119]
  buffer_load_dwordx4 v5, s[8:11], s56 offen offset:0 sc1 lds
  v_mfma_f32_16x16x32_bf16 v[116:119], a[232:235], a[176:179], v[116:119]
  v_cvt_pk_bf16_f32 v88, v88, v89
  v_cvt_pk_bf16_f32 v89, v90, v91
  v_mfma_f32_16x16x32_bf16 v[120:123], a[240:243], a[176:179], v[120:123]
  v_cvt_pk_bf16_f32 v90, v92, v93
  v_cvt_pk_bf16_f32 v91, v94, v95
  v_mfma_f32_16x16x32_bf16 v[120:123], a[244:247], a[180:183], v[120:123]
  ds_write_b128 v11, v[80:83] offset:40960
  v_mfma_f32_16x16x32_bf16 v[124:127], a[252:255], a[180:183], v[124:127]
  buffer_load_dwordx4 v5, s[8:11], s56 offen offset:1024 sc1 lds
  v_mfma_f32_16x16x32_bf16 v[124:127], a[248:251], a[176:179], v[124:127]
  ds_write_b128 v11, v[88:91] offset:41984
  v_mfma_f32_16x16x32_bf16 v[140:143], a[248:251], a[184:187], v[140:143]
  v_cvt_pk_bf16_f32 v96, v96, v97
  v_cvt_pk_bf16_f32 v97, v98, v99
  v_mfma_f32_16x16x32_bf16 v[140:143], a[252:255], a[188:191], v[140:143]
  buffer_load_dwordx4 v5, s[8:11], s56 offen offset:2048 sc1 lds
  v_mfma_f32_16x16x32_bf16 v[136:139], a[244:247], a[188:191], v[136:139]
  v_cvt_pk_bf16_f32 v98, v100, v101
  v_cvt_pk_bf16_f32 v99, v102, v103
  v_mfma_f32_16x16x32_bf16 v[136:139], a[240:243], a[184:187], v[136:139]
  v_cvt_pk_bf16_f32 v104, v104, v105
  v_cvt_pk_bf16_f32 v105, v106, v107
  v_mfma_f32_16x16x32_bf16 v[132:135], a[232:235], a[184:187], v[132:135]
  v_cvt_pk_bf16_f32 v106, v108, v109
  v_cvt_pk_bf16_f32 v107, v110, v111
  v_mfma_f32_16x16x32_bf16 v[132:135], a[236:239], a[188:191], v[132:135]
  buffer_load_dwordx4 v5, s[8:11], s56 offen offset:3072 sc1 lds
  v_mfma_f32_16x16x32_bf16 v[128:131], a[228:231], a[188:191], v[128:131]
  ds_write_b128 v11, v[96:99] offset:45056
  v_mfma_f32_16x16x32_bf16 v[128:131], a[224:227], a[184:187], v[128:131]
  ds_write_b128 v11, v[104:107] offset:46080
  v_mfma_f32_16x16x32_bf16 v[144:147], a[224:227], a[192:195], v[144:147]
  s_mov_b32 m0, s72
  v_cvt_pk_bf16_f32 v112, v112, v113
  v_mfma_f32_16x16x32_bf16 v[144:147], a[228:231], a[196:199], v[144:147]
  v_cvt_pk_bf16_f32 v113, v114, v115
  v_cvt_pk_bf16_f32 v114, v116, v117
  v_mfma_f32_16x16x32_bf16 v[148:151], a[236:239], a[196:199], v[148:151]
  buffer_load_dwordx4 v0, s[8:11], s57 offen offset:0 sc1 lds
  v_mfma_f32_16x16x32_bf16 v[148:151], a[232:235], a[192:195], v[148:151]
  v_cvt_pk_bf16_f32 v115, v118, v119
  v_cvt_pk_bf16_f32 v120, v120, v121
  v_mfma_f32_16x16x32_bf16 v[152:155], a[240:243], a[192:195], v[152:155]
  v_cvt_pk_bf16_f32 v121, v122, v123
  v_cvt_pk_bf16_f32 v122, v124, v125
  v_mfma_f32_16x16x32_bf16 v[152:155], a[244:247], a[196:199], v[152:155]
  buffer_load_dwordx4 v0, s[8:11], s57 offen offset:1024 sc1 lds
  v_mfma_f32_16x16x32_bf16 v[156:159], a[252:255], a[196:199], v[156:159]
  v_cvt_pk_bf16_f32 v123, v126, v127
  v_mfma_f32_16x16x32_bf16 v[156:159], a[248:251], a[192:195], v[156:159]
  ds_write_b128 v11, v[112:115] offset:0
  v_mfma_f32_16x16x32_bf16 v[172:175], a[248:251], a[200:203], v[172:175]
  ds_write_b128 v11, v[120:123] offset:1024
  v_mfma_f32_16x16x32_bf16 v[172:175], a[252:255], a[204:207], v[172:175]
  buffer_load_dwordx4 v0, s[8:11], s57 offen offset:2048 sc1 lds
  v_mfma_f32_16x16x32_bf16 v[168:171], a[244:247], a[204:207], v[168:171]
  v_mfma_f32_16x16x32_bf16 v[168:171], a[240:243], a[200:203], v[168:171]
  v_mfma_f32_16x16x32_bf16 v[164:167], a[232:235], a[200:203], v[164:167]
  buffer_load_dwordx4 v0, s[8:11], s57 offen offset:3072 sc1 lds
  v_mfma_f32_16x16x32_bf16 v[164:167], a[236:239], a[204:207], v[164:167]
  v_mfma_f32_16x16x32_bf16 v[160:163], a[228:231], a[204:207], v[160:163]
  v_mfma_f32_16x16x32_bf16 v[160:163], a[224:227], a[200:203], v[160:163]
L_epi:
  s_cmp_ge_u32 s36, 27
  s_cbranch_scc1 L_gate_10
  s_add_u32 s56, s56, 32768
  s_add_u32 s75, s59, 32768
  v_pk_mul_f32 v[40:41], v[176:177], s[98:99] op_sel_hi:[1,0]
  v_pk_mul_f32 v[42:43], v[178:179], s[98:99] op_sel_hi:[1,0]
  v_pk_mul_f32 v[44:45], v[180:181], s[98:99] op_sel_hi:[1,0]
  v_pk_mul_f32 v[46:47], v[182:183], s[98:99] op_sel_hi:[1,0]
  v_exp_f32 v40, v40
  v_exp_f32 v41, v41
  v_exp_f32 v42, v42
  v_exp_f32 v43, v43
  v_exp_f32 v44, v44
  v_exp_f32 v45, v45
  v_exp_f32 v46, v46
  v_exp_f32 v47, v47
  v_pk_fma_f32 v[40:41], v[40:41], s[98:99], s[98:99] op_sel:[0,1,1]
  v_pk_fma_f32 v[42:43], v[42:43], s[98:99], s[98:99] op_sel:[0,1,1]
  v_pk_fma_f32 v[44:45], v[44:45], s[98:99], s[98:99] op_sel:[0,1,1]
  v_pk_fma_f32 v[46:47], v[46:47], s[98:99], s[98:99] op_sel:[0,1,1]
  v_pk_fma_f32 v[40:41], v[40:41], v[40:41], 0.5 op_sel_hi:[1,1,0]
  v_pk_fma_f32 v[42:43], v[42:43], v[42:43], 0.5 op_sel_hi:[1,1,0]
  v_pk_fma_f32 v[44:45], v[44:45], v[44:45], 0.5 op_sel_hi:[1,1,0]
  v_pk_fma_f32 v[46:47], v[46:47], v[46:47], 0.5 op_sel_hi:[1,1,0]
  v_rcp_f32 v40, v40
  v_rcp_f32 v41, v41
  v_rcp_f32 v42, v42
  v_rcp_f32 v43, v43
  v_rcp_f32 v44, v44
  v_rcp_f32 v45, v45
  v_rcp_f32 v46, v46
  v_rcp_f32 v47, v47
  v_pk_fma_f32 v[40:41], v[40:41], v[176:177], v[176:177] neg_lo:[1,0,0] neg_hi:[1,0,0]
  v_pk_fma_f32 v[42:43], v[42:43], v[178:179], v[178:179] neg_lo:[1,0,0] neg_hi:[1,0,0]
  v_pk_fma_f32 v[44:45], v[44:45], v[180:181], v[180:181] neg_lo:[1,0,0] neg_hi:[1,0,0]
  v_pk_fma_f32 v[46:47], v[46:47], v[182:183], v[182:183] neg_lo:[1,0,0] neg_hi:[1,0,0]
  v_cvt_pk_bf16_f32 v240, v40, v41
  v_cvt_pk_bf16_f32 v241, v42, v43
  v_cvt_pk_bf16_f32 v242, v44, v45
  v_cvt_pk_bf16_f32 v243, v46, v47
  buffer_store_dwordx4 v[240:243], v0, s[16:19], s68 offen offset:0 sc1
  v_cvt_pk_bf16_f32 v128, v128, v129
  v_cvt_pk_bf16_f32 v129, v130, v131
  v_cvt_pk_bf16_f32 v130, v132, v133
  v_cvt_pk_bf16_f32 v131, v134, v135
  v_cvt_pk_bf16_f32 v136, v136, v137
  v_cvt_pk_bf16_f32 v137, v138, v139
  v_cvt_pk_bf16_f32 v138, v140, v141
  v_cvt_pk_bf16_f32 v139, v142, v143
  v_cvt_pk_bf16_f32 v144, v144, v145
  v_cvt_pk_bf16_f32 v145, v146, v147
  v_cvt_pk_bf16_f32 v146, v148, v149
  v_cvt_pk_bf16_f32 v147, v150, v151
  v_cvt_pk_bf16_f32 v152, v152, v153
  v_cvt_pk_bf16_f32 v153, v154, v155
  v_cvt_pk_bf16_f32 v154, v156, v157
  v_cvt_pk_bf16_f32 v155, v158, v159
  v_cvt_pk_bf16_f32 v160, v160, v161
  v_cvt_pk_bf16_f32 v161, v162, v163
  v_cvt_pk_bf16_f32 v162, v164, v165
  v_cvt_pk_bf16_f32 v163, v166, v167
  v_cvt_pk_bf16_f32 v168, v168, v169
  v_cvt_pk_bf16_f32 v169, v170, v171
  v_cvt_pk_bf16_f32 v170, v172, v173
  v_cvt_pk_bf16_f32 v171, v174, v175
  ds_write_b128 v11, v[128:131] offset:4096
  ds_write_b128 v11, v[136:139] offset:5120
  ds_write_b128 v11, v[144:147] offset:8192
  ds_write_b128 v11, v[152:155] offset:9216
  ds_write_b128 v11, v[160:163] offset:12288
  ds_write_b128 v11, v[168:171] offset:13312
  v_pk_mul_f32 v[48:49], v[184:185], s[98:99] op_sel_hi:[1,0]
  v_pk_mul_f32 v[50:51], v[186:187], s[98:99] op_sel_hi:[1,0]
  v_pk_mul_f32 v[52:53], v[188:189], s[98:99] op_sel_hi:[1,0]
  v_pk_mul_f32 v[54:55], v[190:191], s[98:99] op_sel_hi:[1,0]
  v_exp_f32 v48, v48
  v_exp_f32 v49, v49
  v_exp_f32 v50, v50
  v_exp_f32 v51, v51
  v_exp_f32 v52, v52
  v_exp_f32 v53, v53
  v_exp_f32 v54, v54
  v_exp_f32 v55, v55
  v_pk_fma_f32 v[48:49], v[48:49], s[98:99], s[98:99] op_sel:[0,1,1]
  v_pk_fma_f32 v[50:51], v[50:51], s[98:99], s[98:99] op_sel:[0,1,1]
  v_pk_fma_f32 v[52:53], v[52:53], s[98:99], s[98:99] op_sel:[0,1,1]
  v_pk_fma_f32 v[54:55], v[54:55], s[98:99], s[98:99] op_sel:[0,1,1]
  v_pk_fma_f32 v[48:49], v[48:49], v[48:49], 0.5 op_sel_hi:[1,1,0]
  v_pk_fma_f32 v[50:51], v[50:51], v[50:51], 0.5 op_sel_hi:[1,1,0]
  v_pk_fma_f32 v[52:53], v[52:53], v[52:53], 0.5 op_sel_hi:[1,1,0]
  v_pk_fma_f32 v[54:55], v[54:55], v[54:55], 0.5 op_sel_hi:[1,1,0]
  v_rcp_f32 v48, v48
  v_rcp_f32 v49, v49
  v_rcp_f32 v50, v50
  v_rcp_f32 v51, v51
  v_rcp_f32 v52, v52
  v_rcp_f32 v53, v53
  v_rcp_f32 v54, v54
  v_rcp_f32 v55, v55
  v_pk_fma_f32 v[48:49], v[48:49], v[184:185], v[184:185] neg_lo:[1,0,0] neg_hi:[1,0,0]
  v_pk_fma_f32 v[50:51], v[50:51], v[186:187], v[186:187] neg_lo:[1,0,0] neg_hi:[1,0,0]
  v_pk_fma_f32 v[52:53], v[52:53], v[188:189], v[188:189] neg_lo:[1,0,0] neg_hi:[1,0,0]
  v_pk_fma_f32 v[54:55], v[54:55], v[190:191], v[190:191] neg_lo:[1,0,0] neg_hi:[1,0,0]
  v_cvt_pk_bf16_f32 v244, v48, v49
  v_cvt_pk_bf16_f32 v245, v50, v51
  v_cvt_pk_bf16_f32 v246, v52, v53
  v_cvt_pk_bf16_f32 v247, v54, v55
  buffer_store_dwordx4 v[244:247], v0, s[16:19], s68 offen offset:1024 sc1
  v_pk_mul_f32 v[40:41], v[192:193], s[98:99] op_sel_hi:[1,0]
  v_pk_mul_f32 v[42:43], v[194:195], s[98:99] op_sel_hi:[1,0]
  v_pk_mul_f32 v[44:45], v[196:197], s[98:99] op_sel_hi:[1,0]
  v_pk_mul_f32 v[46:47], v[198:199], s[98:99] op_sel_hi:[1,0]
  v_exp_f32 v40, v40
  v_exp_f32 v41, v41
  v_exp_f32 v42, v42
  v_exp_f32 v43, v43
  v_exp_f32 v44, v44
  v_exp_f32 v45, v45
  v_exp_f32 v46, v46
  v_exp_f32 v47, v47
  v_pk_fma_f32 v[40:41], v[40:41], s[98:99], s[98:99] op_sel:[0,1,1]
  v_pk_fma_f32 v[42:43], v[42:43], s[98:99], s[98:99] op_sel:[0,1,1]
  v_pk_fma_f32 v[44:45], v[44:45], s[98:99], s[98:99] op_sel:[0,1,1]
  v_pk_fma_f32 v[46:47], v[46:47], s[98:99], s[98:99] op_sel:[0,1,1]
  v_pk_fma_f32 v[40:41], v[40:41], v[40:41], 0.5 op_sel_hi:[1,1,0]
  v_pk_fma_f32 v[42:43], v[42:43], v[42:43], 0.5 op_sel_hi:[1,1,0]
  v_pk_fma_f32 v[44:45], v[44:45], v[44:45], 0.5 op_sel_hi:[1,1,0]
  v_pk_fma_f32 v[46:47], v[46:47], v[46:47], 0.5 op_sel_hi:[1,1,0]
  v_rcp_f32 v40, v40
  v_rcp_f32 v41, v41
  v_rcp_f32 v42, v42
  v_rcp_f32 v43, v43
  v_rcp_f32 v44, v44
  v_rcp_f32 v45, v45
  v_rcp_f32 v46, v46
  v_rcp_f32 v47, v47
  v_pk_fma_f32 v[40:41], v[40:41], v[192:193], v[192:193] neg_lo:[1,0,0] neg_hi:[1,0,0]
  v_pk_fma_f32 v[42:43], v[42:43], v[194:195], v[194:195] neg_lo:[1,0,0] neg_hi:[1,0,0]
  v_pk_fma_f32 v[44:45], v[44:45], v[196:197], v[196:197] neg_lo:[1,0,0] neg_hi:[1,0,0]
  v_pk_fma_f32 v[46:47], v[46:47], v[198:199], v[198:199] neg_lo:[1,0,0] neg_hi:[1,0,0]
  v_cvt_pk_bf16_f32 v248, v40, v41
  v_cvt_pk_bf16_f32 v249, v42, v43
  v_cvt_pk_bf16_f32 v250, v44, v45
  v_cvt_pk_bf16_f32 v251, v46, v47
  buffer_store_dwordx4 v[248:251], v0, s[16:19], s68 offen offset:2048 sc1
  v_pk_mul_f32 v[48:49], v[200:201], s[98:99] op_sel_hi:[1,0]
  v_pk_mul_f32 v[50:51], v[202:203], s[98:99] op_sel_hi:[1,0]
  v_pk_mul_f32 v[52:53], v[204:205], s[98:99] op_sel_hi:[1,0]
  v_pk_mul_f32 v[54:55], v[206:207], s[98:99] op_sel_hi:[1,0]
  v_exp_f32 v48, v48
  v_exp_f32 v49, v49
  v_exp_f32 v50, v50
  v_exp_f32 v51, v51
  v_exp_f32 v52, v52
  v_exp_f32 v53, v53
  v_exp_f32 v54, v54
  v_exp_f32 v55, v55
  v_pk_fma_f32 v[48:49], v[48:49], s[98:99], s[98:99] op_sel:[0,1,1]
  v_pk_fma_f32 v[50:51], v[50:51], s[98:99], s[98:99] op_sel:[0,1,1]
  v_pk_fma_f32 v[52:53], v[52:53], s[98:99], s[98:99] op_sel:[0,1,1]
  v_pk_fma_f32 v[54:55], v[54:55], s[98:99], s[98:99] op_sel:[0,1,1]
  v_pk_fma_f32 v[48:49], v[48:49], v[48:49], 0.5 op_sel_hi:[1,1,0]
  v_pk_fma_f32 v[50:51], v[50:51], v[50:51], 0.5 op_sel_hi:[1,1,0]
  v_pk_fma_f32 v[52:53], v[52:53], v[52:53], 0.5 op_sel_hi:[1,1,0]
  v_pk_fma_f32 v[54:55], v[54:55], v[54:55], 0.5 op_sel_hi:[1,1,0]
  v_rcp_f32 v48, v48
  v_rcp_f32 v49, v49
  v_rcp_f32 v50, v50
  v_rcp_f32 v51, v51
  v_rcp_f32 v52, v52
  v_rcp_f32 v53, v53
  v_rcp_f32 v54, v54
  v_rcp_f32 v55, v55
  v_pk_fma_f32 v[48:49], v[48:49], v[200:201], v[200:201] neg_lo:[1,0,0] neg_hi:[1,0,0]
  v_pk_fma_f32 v[50:51], v[50:51], v[202:203], v[202:203] neg_lo:[1,0,0] neg_hi:[1,0,0]
  v_pk_fma_f32 v[52:53], v[52:53], v[204:205], v[204:205] neg_lo:[1,0,0] neg_hi:[1,0,0]
  v_pk_fma_f32 v[54:55], v[54:55], v[206:207], v[206:207] neg_lo:[1,0,0] neg_hi:[1,0,0]
  v_cvt_pk_bf16_f32 v252, v48, v49
  v_cvt_pk_bf16_f32 v253, v50, v51
  v_cvt_pk_bf16_f32 v254, v52, v53
  v_cvt_pk_bf16_f32 v255, v54, v55
  buffer_store_dwordx4 v[252:255], v0, s[16:19], s68 offen offset:3072 sc1
  v_pk_mul_f32 v[40:41], v[224:225], s[98:99] op_sel_hi:[1,0]
  v_pk_mul_f32 v[42:43], v[226:227], s[98:99] op_sel_hi:[1,0]
  v_pk_mul_f32 v[44:45], v[228:229], s[98:99] op_sel_hi:[1,0]
  v_pk_mul_f32 v[46:47], v[230:231], s[98:99] op_sel_hi:[1,0]
  v_exp_f32 v40, v40
  v_exp_f32 v41, v41
  v_exp_f32 v42, v42
  v_exp_f32 v43, v43
  v_exp_f32 v44, v44
  v_exp_f32 v45, v45
  v_exp_f32 v46, v46
  v_exp_f32 v47, v47
  v_pk_fma_f32 v[40:41], v[40:41], s[98:99], s[98:99] op_sel:[0,1,1]
  v_pk_fma_f32 v[42:43], v[42:43], s[98:99], s[98:99] op_sel:[0,1,1]
  v_pk_fma_f32 v[44:45], v[44:45], s[98:99], s[98:99] op_sel:[0,1,1]
  v_pk_fma_f32 v[46:47], v[46:47], s[98:99], s[98:99] op_sel:[0,1,1]
  v_pk_fma_f32 v[40:41], v[40:41], v[40:41], 0.5 op_sel_hi:[1,1,0]
  v_pk_fma_f32 v[42:43], v[42:43], v[42:43], 0.5 op_sel_hi:[1,1,0]
  v_pk_fma_f32 v[44:45], v[44:45], v[44:45], 0.5 op_sel_hi:[1,1,0]
  v_pk_fma_f32 v[46:47], v[46:47], v[46:47], 0.5 op_sel_hi:[1,1,0]
  v_rcp_f32 v40, v40
  v_rcp_f32 v41, v41
  v_rcp_f32 v42, v42
  v_rcp_f32 v43, v43
  v_rcp_f32 v44, v44
  v_rcp_f32 v45, v45
  v_rcp_f32 v46, v46
  v_rcp_f32 v47, v47
  v_pk_fma_f32 v[40:41], v[40:41], v[224:225], v[224:225] neg_lo:[1,0,0] neg_hi:[1,0,0]
  v_pk_fma_f32 v[42:43], v[42:43], v[226:227], v[226:227] neg_lo:[1,0,0] neg_hi:[1,0,0]
  v_pk_fma_f32 v[44:45], v[44:45], v[228:229], v[228:229] neg_lo:[1,0,0] neg_hi:[1,0,0]
  v_pk_fma_f32 v[46:47], v[46:47], v[230:231], v[230:231] neg_lo:[1,0,0] neg_hi:[1,0,0]
  v_cvt_pk_bf16_f32 v224, v40, v41
  v_cvt_pk_bf16_f32 v225, v42, v43
  v_cvt_pk_bf16_f32 v226, v44, v45
  v_cvt_pk_bf16_f32 v227, v46, v47
  buffer_store_dwordx4 v[224:227], v0, s[16:19], s69 offen offset:2048 sc1
  s_waitcnt vmcnt(9) lgkmcnt(0)
  s_barrier
  ds_read_b128 a[0:3], v28 offset:0
  ds_read_b128 a[4:7], v28 offset:1024
  ds_read_b128 a[8:11], v28 offset:2048
  ds_read_b128 a[12:15], v28 offset:3072
  ds_read_b128 a[16:19], v28 offset:4096
  ds_read_b128 a[20:23], v28 offset:5120
  ds_read_b128 a[24:27], v28 offset:6144
  ds_read_b128 a[28:31], v28 offset:7168
  v_pk_mul_f32 v[48:49], v[232:233], s[98:99] op_sel_hi:[1,0]
  v_pk_mul_f32 v[50:51], v[234:235], s[98:99] op_sel_hi:[1,0]
  v_pk_mul_f32 v[52:53], v[236:237], s[98:99] op_sel_hi:[1,0]
  v_pk_mul_f32 v[54:55], v[238:239], s[98:99] op_sel_hi:[1,0]
  v_exp_f32 v48, v48
  v_exp_f32 v49, v49
  v_exp_f32 v50, v50
  v_exp_f32 v51, v51
  v_exp_f32 v52, v52
  v_exp_f32 v53, v53
  v_exp_f32 v54, v54
  v_exp_f32 v55, v55
  v_pk_fma_f32 v[48:49], v[48:49], s[98:99], s[98:99] op_sel:[0,1,1]
  v_pk_fma_f32 v[50:51], v[50:51], s[98:99], s[98:99] op_sel:[0,1,1]
  v_pk_fma_f32 v[52:53], v[52:53], s[98:99], s[98:99] op_sel:[0,1,1]
  v_pk_fma_f32 v[54:55], v[54:55], s[98:99], s[98:99] op_sel:[0,1,1]
  v_pk_fma_f32 v[48:49], v[48:49], v[48:49], 0.5 op_sel_hi:[1,1,0]
  v_pk_fma_f32 v[50:51], v[50:51], v[50:51], 0.5 op_sel_hi:[1,1,0]
  v_pk_fma_f32 v[52:53], v[52:53], v[52:53], 0.5 op_sel_hi:[1,1,0]
  v_pk_fma_f32 v[54:55], v[54:55], v[54:55], 0.5 op_sel_hi:[1,1,0]
  v_rcp_f32 v48, v48
  v_rcp_f32 v49, v49
  v_rcp_f32 v50, v50
  v_rcp_f32 v51, v51
  v_rcp_f32 v52, v52
  v_rcp_f32 v53, v53
  v_rcp_f32 v54, v54
  v_rcp_f32 v55, v55
  v_pk_fma_f32 v[48:49], v[48:49], v[232:233], v[232:233] neg_lo:[1,0,0] neg_hi:[1,0,0]
  v_pk_fma_f32 v[50:51], v[50:51], v[234:235], v[234:235] neg_lo:[1,0,0] neg_hi:[1,0,0]
  v_pk_fma_f32 v[52:53], v[52:53], v[236:237], v[236:237] neg_lo:[1,0,0] neg_hi:[1,0,0]
  v_pk_fma_f32 v[54:55], v[54:55], v[238:239], v[238:239] neg_lo:[1,0,0] neg_hi:[1,0,0]
  v_cvt_pk_bf16_f32 v232, v48, v49
  v_cvt_pk_bf16_f32 v233, v50, v51
  v_cvt_pk_bf16_f32 v234, v52, v53
  v_cvt_pk_bf16_f32 v235, v54, v55
  buffer_store_dwordx4 v[232:235], v0, s[16:19], s69 offen offset:3072 sc1
  ds_read_b128 a[64:67], v2 offset:0
  ds_read_b128 a[68:71], v2 offset:1024
  ds_read_b128 a[72:75], v2 offset:2048
  ds_read_b128 a[76:79], v2 offset:3072
  ds_read_b128 a[92:95], v2 offset:7168
  ds_read_b128 a[88:91], v2 offset:6144
  ds_read_b128 a[84:87], v2 offset:5120
  ds_read_b128 a[80:83], v2 offset:4096
  v_pk_mul_f32 v[40:41], v[208:209], s[98:99] op_sel_hi:[1,0]
  v_pk_mul_f32 v[42:43], v[210:211], s[98:99] op_sel_hi:[1,0]
  v_pk_mul_f32 v[44:45], v[212:213], s[98:99] op_sel_hi:[1,0]
  v_pk_mul_f32 v[46:47], v[214:215], s[98:99] op_sel_hi:[1,0]
  v_exp_f32 v40, v40
  v_exp_f32 v41, v41
  v_exp_f32 v42, v42
  v_exp_f32 v43, v43
  v_exp_f32 v44, v44
  v_exp_f32 v45, v45
  v_exp_f32 v46, v46
  v_exp_f32 v47, v47
  v_pk_fma_f32 v[40:41], v[40:41], s[98:99], s[98:99] op_sel:[0,1,1]
  v_pk_fma_f32 v[42:43], v[42:43], s[98:99], s[98:99] op_sel:[0,1,1]
  v_pk_fma_f32 v[44:45], v[44:45], s[98:99], s[98:99] op_sel:[0,1,1]
  v_pk_fma_f32 v[46:47], v[46:47], s[98:99], s[98:99] op_sel:[0,1,1]
  v_pk_fma_f32 v[40:41], v[40:41], v[40:41], 0.5 op_sel_hi:[1,1,0]
  v_pk_fma_f32 v[42:43], v[42:43], v[42:43], 0.5 op_sel_hi:[1,1,0]
  v_pk_fma_f32 v[44:45], v[44:45], v[44:45], 0.5 op_sel_hi:[1,1,0]
  v_pk_fma_f32 v[46:47], v[46:47], v[46:47], 0.5 op_sel_hi:[1,1,0]
  v_rcp_f32 v40, v40
  v_rcp_f32 v41, v41
  v_rcp_f32 v42, v42
  v_rcp_f32 v43, v43
  v_rcp_f32 v44, v44
  v_rcp_f32 v45, v45
  v_rcp_f32 v46, v46
  v_rcp_f32 v47, v47
  v_pk_fma_f32 v[40:41], v[40:41], v[208:209], v[208:209] neg_lo:[1,0,0] neg_hi:[1,0,0]
  v_pk_fma_f32 v[42:43], v[42:43], v[210:211], v[210:211] neg_lo:[1,0,0] neg_hi:[1,0,0]
  v_pk_fma_f32 v[44:45], v[44:45], v[212:213], v[212:213] neg_lo:[1,0,0] neg_hi:[1,0,0]
  v_pk_fma_f32 v[46:47], v[46:47], v[214:215], v[214:215] neg_lo:[1,0,0] neg_hi:[1,0,0]
  v_cvt_pk_bf16_f32 v228, v40, v41
  v_cvt_pk_bf16_f32 v229, v42, v43
  v_cvt_pk_bf16_f32 v230, v44, v45
  v_cvt_pk_bf16_f32 v231, v46, v47
  buffer_store_dwordx4 v[228:231], v0, s[16:19], s69 offen offset:0 sc1
  ds_read_b128 a[96:99], v3 offset:0
  ds_read_b128 a[100:103], v3 offset:1024
  ds_read_b128 a[104:107], v3 offset:2048
  ds_read_b128 a[108:111], v3 offset:3072
  ds_read_b128 a[220:223], v3 offset:7168
  ds_read_b128 a[216:219], v3 offset:6144
  ds_read_b128 a[212:215], v3 offset:5120
  ds_read_b128 a[208:211], v3 offset:4096
  v_pk_mul_f32 v[48:49], v[216:217], s[98:99] op_sel_hi:[1,0]
  v_pk_mul_f32 v[50:51], v[218:219], s[98:99] op_sel_hi:[1,0]
  v_pk_mul_f32 v[52:53], v[220:221], s[98:99] op_sel_hi:[1,0]
  v_pk_mul_f32 v[54:55], v[222:223], s[98:99] op_sel_hi:[1,0]
  v_exp_f32 v48, v48
  v_exp_f32 v49, v49
  v_exp_f32 v50, v50
  v_exp_f32 v51, v51
  v_exp_f32 v52, v52
  v_exp_f32 v53, v53
  v_exp_f32 v54, v54
  v_exp_f32 v55, v55
  v_pk_fma_f32 v[48:49], v[48:49], s[98:99], s[98:99] op_sel:[0,1,1]
  v_pk_fma_f32 v[50:51], v[50:51], s[98:99], s[98:99] op_sel:[0,1,1]
  v_pk_fma_f32 v[52:53], v[52:53], s[98:99], s[98:99] op_sel:[0,1,1]
  v_pk_fma_f32 v[54:55], v[54:55], s[98:99], s[98:99] op_sel:[0,1,1]
  v_pk_fma_f32 v[48:49], v[48:49], v[48:49], 0.5 op_sel_hi:[1,1,0]
  v_pk_fma_f32 v[50:51], v[50:51], v[50:51], 0.5 op_sel_hi:[1,1,0]
  v_pk_fma_f32 v[52:53], v[52:53], v[52:53], 0.5 op_sel_hi:[1,1,0]
  v_pk_fma_f32 v[54:55], v[54:55], v[54:55], 0.5 op_sel_hi:[1,1,0]
  v_rcp_f32 v48, v48
  v_rcp_f32 v49, v49
  v_rcp_f32 v50, v50
  v_rcp_f32 v51, v51
  v_rcp_f32 v52, v52
  v_rcp_f32 v53, v53
  v_rcp_f32 v54, v54
  v_rcp_f32 v55, v55
  v_pk_fma_f32 v[48:49], v[48:49], v[216:217], v[216:217] neg_lo:[1,0,0] neg_hi:[1,0,0]
  v_pk_fma_f32 v[50:51], v[50:51], v[218:219], v[218:219] neg_lo:[1,0,0] neg_hi:[1,0,0]
  v_pk_fma_f32 v[52:53], v[52:53], v[220:221], v[220:221] neg_lo:[1,0,0] neg_hi:[1,0,0]
  v_pk_fma_f32 v[54:55], v[54:55], v[222:223], v[222:223] neg_lo:[1,0,0] neg_hi:[1,0,0]
  v_cvt_pk_bf16_f32 v236, v48, v49
  v_cvt_pk_bf16_f32 v237, v50, v51
  v_cvt_pk_bf16_f32 v238, v52, v53
  v_cvt_pk_bf16_f32 v239, v54, v55
  buffer_store_dwordx4 v[236:239], v0, s[16:19], s69 offen offset:1024 sc1
  ds_read_b128 a[32:35], v28 offset:8192
  ds_read_b128 a[36:39], v28 offset:9216
  ds_read_b128 a[40:43], v28 offset:10240
  ds_read_b128 a[44:47], v28 offset:11264
  ds_read_b128 a[48:51], v28 offset:12288
  ds_read_b128 a[52:55], v28 offset:13312
  ds_read_b128 a[56:59], v28 offset:14336
  ds_read_b128 a[60:63], v28 offset:15360
L_epidone_11:
L_block:
  v_mov_b32 v31, 0x3f003f00
  v_accvgpr_write_b32 a224, -1
  v_accvgpr_write_b32 a225, -1
  v_accvgpr_write_b32 a226, -1
  v_accvgpr_write_b32 a227, -1
  v_accvgpr_write_b32 a228, v31
  v_accvgpr_write_b32 a229, v31
  v_accvgpr_write_b32 a230, v31
  v_accvgpr_write_b32 a231, v31
  s_mov_b32 s99, 0x53800000
  v_mov_b32 v11, 0x2b800000
  s_cmp_eq_u32 s50, 0
  s_waitcnt lgkmcnt(0)
  s_cbranch_scc1 L_tj0
L_it0:
  v_mfma_f32_16x16x32_bf16 v[64:67], a[64:67], a[0:3], 0
  v_mov_b32 v57, 0
  v_mov_b32 v58, 0
  v_mfma_f32_16x16x32_bf16 v[64:67], a[68:71], a[4:7], v[64:67]
  v_mov_b32 v56, 0
  v_mov_b32 v59, 0
  v_mfma_f32_16x16x32_bf16 v[64:67], a[72:75], a[8:11], v[64:67]
  s_add_u32 m0, s72, 4096
  v_add_u32 v4, 65536, v2
  v_mfma_f32_16x16x32_bf16 v[64:67], a[76:79], a[12:15], v[64:67]
  buffer_load_dwordx4 v5, s[8:11], s57 offen offset:0 sc1 lds
  v_mfma_f32_16x16x32_bf16 v[68:71], a[92:95], a[12:15], 0
  s_waitcnt lgkmcnt(8)
  v_add_u32 v7, 65536, v3
  v_mfma_f32_16x16x32_bf16 v[68:71], a[88:91], a[8:11], v[68:71]
  ds_read_b128 a[144:147], v4 offset:0
  s_add_u32 s72, s75, 16384
  v_mfma_f32_16x16x32_bf16 v[68:71], a[84:87], a[4:7], v[68:71]
  buffer_load_dwordx4 v5, s[8:11], s57 offen offset:1024 sc1 lds
  v_mfma_f32_16x16x32_bf16 v[68:71], a[80:83], a[0:3], v[68:71]
  ds_read_b128 a[176:179], v7 offset:0
  s_bitcmp1_b32 s78, s48
  v_mfma_f32_16x16x32_bf16 v[72:75], a[96:99], a[0:3], 0
  ds_read_b128 a[180:183], v7 offset:1024
  s_cselect_b32 s71, 32768, s61
  v_mfma_f32_16x16x32_bf16 v[72:75], a[100:103], a[4:7], v[72:75]
  buffer_load_dwordx4 v5, s[8:11], s57 offen offset:2048 sc1 lds
  v_mfma_f32_16x16x32_bf16 v[72:75], a[104:107], a[8:11], v[72:75]
  ds_read_b128 a[148:151], v4 offset:1024
  s_cselect_b32 s72, s72, 163840
  v_mfma_f32_16x16x32_bf16 v[72:75], a[108:111], a[12:15], v[72:75]
  ds_read_b128 a[152:155], v4 offset:2048
  v_mov_b32 v32, 0
  v_mfma_f32_16x16x32_bf16 v[76:79], a[220:223], a[12:15], 0
  ds_read_b128 a[184:187], v7 offset:2048
  v_mov_b32 v33, 0
  v_mfma_f32_16x16x32_bf16 v[76:79], a[216:219], a[8:11], v[76:79]
  ds_read_b128 a[188:191], v7 offset:3072
  v_mov_b32 v36, 0
  v_mfma_f32_16x16x32_bf16 v[76:79], a[212:215], a[4:7], v[76:79]
  ds_read_b128 a[156:159], v4 offset:3072
  v_mov_b32 v37, 0
  v_mfma_f32_16x16x32_bf16 v[76:79], a[208:211], a[0:3], v[76:79]
  ds_read_b128 a[160:163], v4 offset:4096
  v_mov_b32 v40, 0
  v_mfma_f32_16x16x32_bf16 v[192:195], v[12:15], v[56:59], 0
  ds_read_b128 a[192:195], v7 offset:4096
  v_mov_b32 v41, 0
  v_mfma_f32_16x16x32_bf16 v[196:199], v[12:15], v[56:59], 0
  buffer_load_dwordx4 v5, s[8:11], s57 offen offset:3072 sc1 lds
  v_mfma_f32_16x16x32_bf16 v[200:203], v[12:15], v[56:59], 0
  ds_read_b128 a[196:199], v7 offset:5120
  s_cselect_b32 s57, s61, 2146435072
  v_mfma_f32_16x16x32_bf16 v[204:207], v[12:15], v[56:59], 0
  ds_read_b128 a[164:167], v4 offset:5120
  s_add_u32 s57, s57, s56
  v_mfma_f32_16x16x32_bf16 v[208:211], v[12:15], v[56:59], 0
  v_exp_f32 v64, v64
  v_mfma_f32_16x16x32_bf16 v[212:215], v[12:15], v[56:59], 0
  v_exp_f32 v65, v65
  v_mfma_f32_16x16x32_bf16 v[216:219], v[12:15], v[56:59], 0
  v_exp_f32 v66, v66
  v_mfma_f32_16x16x32_bf16 v[220:223], v[12:15], v[56:59], 0
  v_exp_f32 v67, v67
  v_mfma_f32_16x16x32_bf16 v[80:83], a[64:67], a[16:19], 0
  v_exp_f32 v68, v68
  v_mfma_f32_16x16x32_bf16 v[80:83], a[68:71], a[20:23], v[80:83]
  v_exp_f32 v69, v69
  v_mfma_f32_16x16x32_bf16 v[80:83], a[72:75], a[24:27], v[80:83]
  v_exp_f32 v70, v70
  v_mfma_f32_16x16x32_bf16 v[80:83], a[76:79], a[28:31], v[80:83]
  v_exp_f32 v71, v71
  v_mfma_f32_16x16x32_bf16 v[84:87], a[92:95], a[28:31], 0
  v_exp_f32 v72, v72
  v_mfma_f32_16x16x32_bf16 v[84:87], a[88:91], a[24:27], v[84:87]
  v_exp_f32 v73, v73
  v_mfma_f32_16x16x32_bf16 v[84:87], a[84:87], a[20:23], v[84:87]
  v_exp_f32 v74, v74
  v_mfma_f32_16x16x32_bf16 v[84:87], a[80:83], a[16:19], v[84:87]
  v_exp_f32 v75, v75
  v_mfma_f32_16x16x32_bf16 v[88:91], a[96:99], a[16:19], 0
  v_exp_f32 v76, v76
  v_mfma_f32_16x16x32_bf16 v[88:91], a[100:103], a[20:23], v[88:91]
  v_exp_f32 v77, v77
  v_mfma_f32_16x16x32_bf16 v[88:91], a[104:107], a[24:27], v[88:91]
  v_exp_f32 v78, v78
  v_mfma_f32_16x16x32_bf16 v[88:91], a[108:111], a[28:31], v[88:91]
  v_exp_f32 v79, v79
  v_mfma_f32_16x16x32_bf16 v[92:95], a[220:223], a[28:31], 0
  ds_read_b128 a[168:171], v4 offset:6144
  s_add_u32 s70, s70, s55
  v_mfma_f32_16x16x32_bf16 v[92:95], a[216:219], a[24:27], v[92:95]
  ds_read_b128 a[200:203], v7 offset:6144
  s_and_b32 s70, s70, 0xffff
  v_mfma_f32_16x16x32_bf16 v[92:95], a[212:215], a[20:23], v[92:95]
  ds_read_b128 a[204:207], v7 offset:7168
  v_mov_b32 v44, 0
  v_mfma_f32_16x16x32_bf16 v[92:95], a[208:211], a[16:19], v[92:95]
  ds_read_b128 a[172:175], v4 offset:7168
  v_mov_b32 v45, 0
  v_cvt_pk_bf16_f32 v48, v64, v65
  v_cvt_pk_bf16_f32 v49, v66, v67
  v_cvt_pk_bf16_f32 v50, v68, v69
  v_cvt_pk_bf16_f32 v51, v70, v71
  v_cvt_pk_bf16_f32 v52, v72, v73
  v_cvt_pk_bf16_f32 v53, v74, v75
  v_cvt_pk_bf16_f32 v54, v76, v77
  v_cvt_pk_bf16_f32 v55, v78, v79
  s_waitcnt lgkmcnt(9)
  v_mfma_f32_16x16x32_bf16 v[96:99], a[144:147], v[48:51], 0
  buffer_store_dwordx4 a[224:227], v0, s[24:27], s53 offen sc1
  v_mfma_f32_16x16x32_bf16 v[96:99], a[176:179], v[52:55], v[96:99]
  v_exp_f32 v80, v80
  v_mfma_f32_16x16x32_bf16 v[100:103], a[180:183], v[52:55], 0
  s_add_u32 s48, s48, 1
  s_cmp_ge_u32 s48, s79
  v_mfma_f32_16x16x32_bf16 v[100:103], a[148:151], v[48:51], v[100:103]
  v_exp_f32 v81, v81
  v_mfma_f32_16x16x32_bf16 v[104:107], a[152:155], v[48:51], 0
  v_cvt_pk_bf16_f32 v56, v80, v81
  s_cselect_b32 s55, 32768, s61
  v_mfma_f32_16x16x32_bf16 v[104:107], a[184:187], v[52:55], v[104:107]
  v_exp_f32 v82, v82
  v_mfma_f32_16x16x32_bf16 v[108:111], a[188:191], v[52:55], 0
  s_waitcnt lgkmcnt(0)
  s_barrier
  v_mfma_f32_16x16x32_bf16 v[108:111], a[156:159], v[48:51], v[108:111]
  v_exp_f32 v83, v83
  v_mfma_f32_16x16x32_bf16 v[112:115], a[160:163], v[48:51], 0
  v_cvt_pk_bf16_f32 v57, v82, v83
  s_mov_b32 m0, s75
  v_mfma_f32_16x16x32_bf16 v[112:115], a[192:195], v[52:55], v[112:115]
  v_exp_f32 v84, v84
  v_mfma_f32_16x16x32_bf16 v[116:119], a[196:199], v[52:55], 0
  buffer_load_dwordx4 v0, s[8:11], s56 offen offset:0 sc1 lds
  v_mfma_f32_16x16x32_bf16 v[116:119], a[164:167], v[48:51], v[116:119]
  v_exp_f32 v85, v85
  v_mfma_f32_16x16x32_bf16 v[120:123], a[168:171], v[48:51], 0
  v_cvt_pk_bf16_f32 v58, v84, v85
  s_cselect_b32 s62, s96, 8192
  v_mfma_f32_16x16x32_bf16 v[120:123], a[200:203], v[52:55], v[120:123]
  v_exp_f32 v86, v86
  v_mfma_f32_16x16x32_bf16 v[124:127], a[204:207], v[52:55], 0
  buffer_load_dwordx4 v0, s[8:11], s56 offen offset:1024 sc1 lds
  v_mfma_f32_16x16x32_bf16 v[124:127], a[172:175], v[48:51], v[124:127]
  v_exp_f32 v87, v87
  v_smfmac_f32_16x16x64_bf16 v[32:35], v[12:15], v[48:55], v10
  v_cvt_pk_bf16_f32 v59, v86, v87
  v_mfma_f32_16x16x32_bf16 v[64:67], a[64:67], a[32:35], 0
  v_exp_f32 v88, v88
  v_mfma_f32_16x16x32_bf16 v[64:67], a[68:71], a[36:39], v[64:67]
  buffer_load_dwordx4 v0, s[8:11], s56 offen offset:2048 sc1 lds
  v_mfma_f32_16x16x32_bf16 v[64:67], a[72:75], a[40:43], v[64:67]
  v_exp_f32 v89, v89
  v_mfma_f32_16x16x32_bf16 v[64:67], a[76:79], a[44:47], v[64:67]
  v_cvt_pk_bf16_f32 v60, v88, v89
  s_add_u32 s53, s53, 1024
  v_mfma_f32_16x16x32_bf16 v[68:71], a[92:95], a[44:47], 0
  v_exp_f32 v90, v90
  v_mfma_f32_16x16x32_bf16 v[68:71], a[88:91], a[40:43], v[68:71]
  buffer_load_dwordx4 v0, s[8:11], s56 offen offset:3072 sc1 lds
  v_mfma_f32_16x16x32_bf16 v[68:71], a[84:87], a[36:39], v[68:71]
  v_exp_f32 v91, v91
  v_mfma_f32_16x16x32_bf16 v[68:71], a[80:83], a[32:35], v[68:71]
  v_cvt_pk_bf16_f32 v61, v90, v91
  s_add_u32 m0, m0, 4096
  v_mfma_f32_16x16x32_bf16 v[72:75], a[96:99], a[32:35], 0
  v_exp_f32 v92, v92
  v_mfma_f32_16x16x32_bf16 v[72:75], a[100:103], a[36:39], v[72:75]
  buffer_load_dwordx4 v5, s[8:11], s56 offen offset:0 sc1 lds
  v_mfma_f32_16x16x32_bf16 v[72:75], a[104:107], a[40:43], v[72:75]
  v_exp_f32 v93, v93
  v_mfma_f32_16x16x32_bf16 v[72:75], a[108:111], a[44:47], v[72:75]
  v_cvt_pk_bf16_f32 v62, v92, v93
  v_add_u32 v2, s70, v9
  v_mfma_f32_16x16x32_bf16 v[76:79], a[220:223], a[44:47], 0
  v_exp_f32 v94, v94
  v_mfma_f32_16x16x32_bf16 v[76:79], a[216:219], a[40:43], v[76:79]
  buffer_load_dwordx4 v5, s[8:11], s56 offen offset:1024 sc1 lds
  v_mfma_f32_16x16x32_bf16 v[76:79], a[212:215], a[36:39], v[76:79]
  v_exp_f32 v95, v95
  v_mfma_f32_16x16x32_bf16 v[76:79], a[208:211], a[32:35], v[76:79]
  v_cvt_pk_bf16_f32 v63, v94, v95
  v_add_u32 v3, s62, v2
  v_mfma_f32_16x16x32_bf16 v[128:131], a[144:147], v[56:59], 0
  s_add_u32 s75, s75, s71
  s_pack_lh_b32_b16 s75, s75, s59
  v_mfma_f32_16x16x32_bf16 v[128:131], a[176:179], v[60:63], v[128:131]
  v_exp_f32 v64, v64
  v_mfma_f32_16x16x32_bf16 v[132:135], a[180:183], v[60:63], 0
  buffer_load_dwordx4 v5, s[8:11], s56 offen offset:2048 sc1 lds
  v_mfma_f32_16x16x32_bf16 v[132:135], a[148:151], v[56:59], v[132:135]
  v_exp_f32 v65, v65
  v_mfma_f32_16x16x32_bf16 v[136:139], a[152:155], v[56:59], 0
  v_cvt_pk_bf16_f32 v48, v64, v65
  s_waitcnt vmcnt(8)
  v_mfma_f32_16x16x32_bf16 v[136:139], a[184:187], v[60:63], v[136:139]
  v_exp_f32 v66, v66
  v_mfma_f32_16x16x32_bf16 v[140:143], a[188:191], v[60:63], 0
  buffer_load_dwordx4 v5, s[8:11], s56 offen offset:3072 sc1 lds
  v_mfma_f32_16x16x32_bf16 v[140:143], a[156:159], v[56:59], v[140:143]
  v_exp_f32 v67, v67
  v_mfma_f32_16x16x32_bf16 v[144:147], a[160:163], v[56:59], 0
  v_cvt_pk_bf16_f32 v49, v66, v67
  s_mov_b32 m0, s72
  v_mfma_f32_16x16x32_bf16 v[144:147], a[192:195], v[60:63], v[144:147]
  v_exp_f32 v68, v68
  v_mfma_f32_16x16x32_bf16 v[148:151], a[196:199], v[60:63], 0
  buffer_load_dwordx4 v0, s[8:11], s57 offen offset:0 sc1 lds
  v_mfma_f32_16x16x32_bf16 v[148:151], a[164:167], v[56:59], v[148:151]
  v_exp_f32 v69, v69
  v_mfma_f32_16x16x32_bf16 v[152:155], a[168:171], v[56:59], 0
  v_cvt_pk_bf16_f32 v50, v68, v69
  s_barrier
  v_mfma_f32_16x16x32_bf16 v[152:155], a[200:203], v[60:63], v[152:155]
  v_exp_f32 v70, v70
  v_mfma_f32_16x16x32_bf16 v[156:159], a[204:207], v[60:63], 0
  buffer_load_dwordx4 v0, s[8:11], s57 offen offset:1024 sc1 lds
  v_mfma_f32_16x16x32_bf16 v[156:159], a[172:175], v[56:59], v[156:159]
  v_exp_f32 v71, v71
  v_smfmac_f32_16x16x64_bf16 v[36:39], v[12:15], v[56:63], v10
  v_cvt_pk_bf16_f32 v51, v70, v71
  v_mfma_f32_16x16x32_bf16 v[80:83], a[64:67], a[48:51], 0
  v_exp_f32 v72, v72
  v_mfma_f32_16x16x32_bf16 v[80:83], a[68:71], a[52:55], v[80:83]
  ds_read_b128 a[64:67], v2 offset:0
  s_add_u32 s56, s56, s71
  v_mfma_f32_16x16x32_bf16 v[80:83], a[72:75], a[56:59], v[80:83]
  v_exp_f32 v73, v73
  v_mfma_f32_16x16x32_bf16 v[80:83], a[76:79], a[60:63], v[80:83]
  ds_read_b128 a[68:71], v2 offset:1024
  v_cvt_pk_bf16_f32 v52, v72, v73
  v_mfma_f32_16x16x32_bf16 v[84:87], a[92:95], a[60:63], 0
  v_exp_f32 v74, v74
  v_mfma_f32_16x16x32_bf16 v[84:87], a[88:91], a[56:59], v[84:87]
  ds_read_b128 a[72:75], v2 offset:2048
  buffer_load_dwordx4 v0, s[8:11], s57 offen offset:2048 sc1 lds
  v_mfma_f32_16x16x32_bf16 v[84:87], a[84:87], a[52:55], v[84:87]
  v_exp_f32 v75, v75
  v_mfma_f32_16x16x32_bf16 v[84:87], a[80:83], a[48:51], v[84:87]
  ds_read_b128 a[76:79], v2 offset:3072
  v_cvt_pk_bf16_f32 v53, v74, v75
  v_mfma_f32_16x16x32_bf16 v[88:91], a[96:99], a[48:51], 0
  v_exp_f32 v76, v76
  v_mfma_f32_16x16x32_bf16 v[88:91], a[100:103], a[52:55], v[88:91]
  ds_read_b128 a[92:95], v2 offset:7168
  v_mfma_f32_16x16x32_bf16 v[88:91], a[104:107], a[56:59], v[88:91]
  v_exp_f32 v77, v77
  v_mfma_f32_16x16x32_bf16 v[88:91], a[108:111], a[60:63], v[88:91]
  ds_read_b128 a[88:91], v2 offset:6144
  v_cvt_pk_bf16_f32 v54, v76, v77
  v_mfma_f32_16x16x32_bf16 v[92:95], a[220:223], a[60:63], 0
  v_exp_f32 v78, v78
  v_mfma_f32_16x16x32_bf16 v[92:95], a[216:219], a[56:59], v[92:95]
  ds_read_b128 a[84:87], v2 offset:5120
  v_mfma_f32_16x16x32_bf16 v[92:95], a[212:215], a[52:55], v[92:95]
  v_exp_f32 v79, v79
  v_mfma_f32_16x16x32_bf16 v[92:95], a[208:211], a[48:51], v[92:95]
  ds_read_b128 a[80:83], v2 offset:4096
  v_cvt_pk_bf16_f32 v55, v78, v79
  v_mfma_f32_16x16x32_bf16 v[160:163], a[144:147], v[48:51], 0
  ds_read_b128 a[96:99], v3 offset:0
  buffer_load_dwordx4 v0, s[8:11], s57 offen offset:3072 sc1 lds
  v_mfma_f32_16x16x32_bf16 v[160:163], a[176:179], v[52:55], v[160:163]
  v_exp_f32 v80, v80
  v_mfma_f32_16x16x32_bf16 v[164:167], a[180:183], v[52:55], 0
  ds_read_b128 a[100:103], v3 offset:1024
  s_add_u32 m0, s72, 4096
  v_mfma_f32_16x16x32_bf16 v[164:167], a[148:151], v[48:51], v[164:167]
  v_exp_f32 v81, v81
  v_mfma_f32_16x16x32_bf16 v[168:171], a[152:155], v[48:51], 0
  ds_read_b128 a[104:107], v3 offset:2048
  v_cvt_pk_bf16_f32 v56, v80, v81
  v_mfma_f32_16x16x32_bf16 v[168:171], a[184:187], v[52:55], v[168:171]
  v_exp_f32 v82, v82
  v_mfma_f32_16x16x32_bf16 v[172:175], a[188:191], v[52:55], 0
  ds_read_b128 a[108:111], v3 offset:3072
  s_bitcmp0_b32 s80, s48
  v_mfma_f32_16x16x32_bf16 v[172:175], a[156:159], v[48:51], v[172:175]
  v_exp_f32 v83, v83
  v_mfma_f32_16x16x32_bf16 v[176:179], a[160:163], v[48:51], 0
  ds_read_b128 a[220:223], v3 offset:7168
  v_cvt_pk_bf16_f32 v57, v82, v83
  v_mfma_f32_16x16x32_bf16 v[176:179], a[192:195], v[52:55], v[176:179]
  v_exp_f32 v84, v84
  v_mfma_f32_16x16x32_bf16 v[180:183], a[196:199], v[52:55], 0
  ds_read_b128 a[216:219], v3 offset:6144
  v_mfma_f32_16x16x32_bf16 v[180:183], a[164:167], v[48:51], v[180:183]
  v_exp_f32 v85, v85
  v_mfma_f32_16x16x32_bf16 v[184:187], a[168:171], v[48:51], 0
  ds_read_b128 a[212:215], v3 offset:5120
  v_cvt_pk_bf16_f32 v58, v84, v85
  v_mfma_f32_16x16x32_bf16 v[184:187], a[200:203], v[52:55], v[184:187]
  v_exp_f32 v86, v86
  v_mfma_f32_16x16x32_bf16 v[188:191], a[204:207], v[52:55], 0
  ds_read_b128 a[208:211], v3 offset:4096
  s_waitcnt lgkmcnt(8)
  v_mfma_f32_16x16x32_bf16 v[188:191], a[172:175], v[48:51], v[188:191]
  v_exp_f32 v87, v87
  v_smfmac_f32_16x16x64_bf16 v[40:43], v[12:15], v[48:55], v10
  s_cbranch_scc0 L_evt
.p2align 6
L_aloop:
  v_mfma_f32_16x16x32_bf16 v[64:67], a[64:67], a[0:3], 0
  v_exp_f32 v88, v88
  v_mfma_f32_16x16x32_bf16 v[64:67], a[68:71], a[4:7], v[64:67]
  buffer_load_dwordx4 v5, s[8:11], s57 offen offset:0 sc1 lds
  v_mfma_f32_16x16x32_bf16 v[64:67], a[72:75], a[8:11], v[64:67]
  v_exp_f32 v89, v89
  v_mfma_f32_16x16x32_bf16 v[64:67], a[76:79], a[12:15], v[64:67]
  v_cvt_pk_bf16_f32 v59, v86, v87
  v_cvt_pk_bf16_f32 v60, v88, v89
  v_mfma_f32_16x16x32_bf16 v[68:71], a[92:95], a[12:15], 0
  v_exp_f32 v90, v90
  v_mfma_f32_16x16x32_bf16 v[68:71], a[88:91], a[8:11], v[68:71]
  buffer_load_dwordx4 v5, s[8:11], s57 offen offset:1024 sc1 lds
  v_mfma_f32_16x16x32_bf16 v[68:71], a[84:87], a[4:7], v[68:71]
  v_exp_f32 v91, v91
  v_mfma_f32_16x16x32_bf16 v[68:71], a[80:83], a[0:3], v[68:71]
  v_cvt_pk_bf16_f32 v61, v90, v91
  s_waitcnt lgkmcnt(0)
  v_mfma_f32_16x16x32_bf16 v[72:75], a[96:99], a[0:3], 0
  v_exp_f32 v92, v92
  v_mfma_f32_16x16x32_bf16 v[72:75], a[100:103], a[4:7], v[72:75]
  buffer_load_dwordx4 v5, s[8:11], s57 offen offset:2048 sc1 lds
  v_mfma_f32_16x16x32_bf16 v[72:75], a[104:107], a[8:11], v[72:75]
  v_exp_f32 v93, v93
  v_mfma_f32_16x16x32_bf16 v[72:75], a[108:111], a[12:15], v[72:75]
  v_cvt_pk_bf16_f32 v62, v92, v93
  v_add_u32 v4, 65536, v2
  v_mfma_f32_16x16x32_bf16 v[76:79], a[220:223], a[12:15], 0
  v_exp_f32 v94, v94
  v_mfma_f32_16x16x32_bf16 v[76:79], a[216:219], a[8:11], v[76:79]
  buffer_load_dwordx4 v5, s[8:11], s57 offen offset:3072 sc1 lds
  v_mfma_f32_16x16x32_bf16 v[76:79], a[212:215], a[4:7], v[76:79]
  v_exp_f32 v95, v95
  v_mfma_f32_16x16x32_bf16 v[76:79], a[208:211], a[0:3], v[76:79]
  v_cvt_pk_bf16_f32 v63, v94, v95
  v_add_u32 v7, 65536, v3
  v_mfma_f32_16x16x32_bf16 v[192:195], a[144:147], v[56:59], v[192:195]
  ds_read_b128 a[144:147], v4 offset:0
  s_add_u32 s72, s75, 16384
  v_mfma_f32_16x16x32_bf16 v[192:195], a[176:179], v[60:63], v[192:195]
  v_exp_f32 v64, v64
  v_mfma_f32_16x16x32_bf16 v[196:199], a[180:183], v[60:63], v[196:199]
  ds_read_b128 a[176:179], v7 offset:0
  s_bitcmp1_b32 s78, s48
  v_mfma_f32_16x16x32_bf16 v[196:199], a[148:151], v[56:59], v[196:199]
  v_exp_f32 v65, v65
  v_mfma_f32_16x16x32_bf16 v[200:203], a[152:155], v[56:59], v[200:203]
  ds_read_b128 a[180:183], v7 offset:1024
  v_cvt_pk_bf16_f32 v48, v64, v65
  v_mfma_f32_16x16x32_bf16 v[200:203], a[184:187], v[60:63], v[200:203]
  v_exp_f32 v66, v66
  v_mfma_f32_16x16x32_bf16 v[204:207], a[188:191], v[60:63], v[204:207]
  ds_read_b128 a[148:151], v4 offset:1024
  s_cselect_b32 s71, 32768, s61
  v_mfma_f32_16x16x32_bf16 v[204:207], a[156:159], v[56:59], v[204:207]
  v_exp_f32 v67, v67
  v_mfma_f32_16x16x32_bf16 v[208:211], a[160:163], v[56:59], v[208:211]
  ds_read_b128 a[152:155], v4 offset:2048
  v_cvt_pk_bf16_f32 v49, v66, v67
  v_mfma_f32_16x16x32_bf16 v[208:211], a[192:195], v[60:63], v[208:211]
  v_exp_f32 v68, v68
  v_mfma_f32_16x16x32_bf16 v[212:215], a[196:199], v[60:63], v[212:215]
  ds_read_b128 a[184:187], v7 offset:2048
  s_cselect_b32 s72, s72, 163840
  v_mfma_f32_16x16x32_bf16 v[212:215], a[164:167], v[56:59], v[212:215]
  v_exp_f32 v69, v69
  v_mfma_f32_16x16x32_bf16 v[216:219], a[168:171], v[56:59], v[216:219]
  ds_read_b128 a[188:191], v7 offset:3072
  v_cvt_pk_bf16_f32 v50, v68, v69
  v_mfma_f32_16x16x32_bf16 v[216:219], a[200:203], v[60:63], v[216:219]
  v_exp_f32 v70, v70
  v_mfma_f32_16x16x32_bf16 v[220:223], a[204:207], v[60:63], v[220:223]
  ds_read_b128 a[156:159], v4 offset:3072
  s_cselect_b32 s57, s61, 2146435072
  v_mfma_f32_16x16x32_bf16 v[220:223], a[172:175], v[56:59], v[220:223]
  v_exp_f32 v71, v71
  v_smfmac_f32_16x16x64_bf16 v[44:47], v[12:15], v[56:63], v10
  v_cvt_pk_bf16_f32 v51, v70, v71
  v_mfma_f32_16x16x32_bf16 v[80:83], a[64:67], a[16:19], 0
  v_exp_f32 v72, v72
  v_mfma_f32_16x16x32_bf16 v[80:83], a[68:71], a[20:23], v[80:83]
  ds_read_b128 a[160:163], v4 offset:4096
  s_add_u32 s57, s57, s56
  v_mfma_f32_16x16x32_bf16 v[80:83], a[72:75], a[24:27], v[80:83]
  v_exp_f32 v73, v73
  v_mfma_f32_16x16x32_bf16 v[80:83], a[76:79], a[28:31], v[80:83]
  ds_read_b128 a[192:195], v7 offset:4096
  v_cvt_pk_bf16_f32 v52, v72, v73
  v_mfma_f32_16x16x32_bf16 v[84:87], a[92:95], a[28:31], 0
  v_exp_f32 v74, v74
  v_mfma_f32_16x16x32_bf16 v[84:87], a[88:91], a[24:27], v[84:87]
  ds_read_b128 a[196:199], v7 offset:5120
  s_add_u32 s70, s70, s55
  v_mfma_f32_16x16x32_bf16 v[84:87], a[84:87], a[20:23], v[84:87]
  v_exp_f32 v75, v75
  v_mfma_f32_16x16x32_bf16 v[84:87], a[80:83], a[16:19], v[84:87]
  ds_read_b128 a[164:167], v4 offset:5120
  v_cvt_pk_bf16_f32 v53, v74, v75
  v_mfma_f32_16x16x32_bf16 v[88:91], a[96:99], a[16:19], 0
  v_exp_f32 v76, v76
  v_mfma_f32_16x16x32_bf16 v[88:91], a[100:103], a[20:23], v[88:91]
  ds_read_b128 a[168:171], v4 offset:6144
  s_and_b32 s70, s70, 0xffff
  v_mfma_f32_16x16x32_bf16 v[88:91], a[104:107], a[24:27], v[88:91]
  v_exp_f32 v77, v77
  v_mfma_f32_16x16x32_bf16 v[88:91], a[108:111], a[28:31], v[88:91]
  ds_read_b128 a[200:203], v7 offset:6144
  v_cvt_pk_bf16_f32 v54, v76, v77
  v_mfma_f32_16x16x32_bf16 v[92:95], a[220:223], a[28:31], 0
  v_exp_f32 v78, v78
  v_mfma_f32_16x16x32_bf16 v[92:95], a[216:219], a[24:27], v[92:95]
  ds_read_b128 a[204:207], v7 offset:7168
  s_waitcnt lgkmcnt(8)
  v_mfma_f32_16x16x32_bf16 v[92:95], a[212:215], a[20:23], v[92:95]
  v_exp_f32 v79, v79
  v_mfma_f32_16x16x32_bf16 v[92:95], a[208:211], a[16:19], v[92:95]
  ds_read_b128 a[172:175], v4 offset:7168
  v_cvt_pk_bf16_f32 v55, v78, v79
  v_mfma_f32_16x16x32_bf16 v[96:99], a[144:147], v[48:51], v[96:99]
  buffer_store_dwordx4 a[224:227], v0, s[24:27], s53 offen sc1
  v_mfma_f32_16x16x32_bf16 v[96:99], a[176:179], v[52:55], v[96:99]
  v_exp_f32 v80, v80
  v_mfma_f32_16x16x32_bf16 v[100:103], a[180:183], v[52:55], v[100:103]
  s_add_u32 s48, s48, 1
  s_cmp_ge_u32 s48, s79
  v_mfma_f32_16x16x32_bf16 v[100:103], a[148:151], v[48:51], v[100:103]
  v_exp_f32 v81, v81
  v_mfma_f32_16x16x32_bf16 v[104:107], a[152:155], v[48:51], v[104:107]
  v_cvt_pk_bf16_f32 v56, v80, v81
  s_cselect_b32 s55, 32768, s61
  v_mfma_f32_16x16x32_bf16 v[104:107], a[184:187], v[52:55], v[104:107]
  v_exp_f32 v82, v82
  v_mfma_f32_16x16x32_bf16 v[108:111], a[188:191], v[52:55], v[108:111]
  s_waitcnt lgkmcnt(0)
  s_barrier
  v_mfma_f32_16x16x32_bf16 v[108:111], a[156:159], v[48:51], v[108:111]
  v_exp_f32 v83, v83
  v_mfma_f32_16x16x32_bf16 v[112:115], a[160:163], v[48:51], v[112:115]
  v_cvt_pk_bf16_f32 v57, v82, v83
  s_mov_b32 m0, s75
  v_mfma_f32_16x16x32_bf16 v[112:115], a[192:195], v[52:55], v[112:115]
  v_exp_f32 v84, v84
  v_mfma_f32_16x16x32_bf16 v[116:119], a[196:199], v[52:55], v[116:119]
  buffer_load_dwordx4 v0, s[8:11], s56 offen offset:0 sc1 lds
  v_mfma_f32_16x16x32_bf16 v[116:119], a[164:167], v[48:51], v[116:119]
  v_exp_f32 v85, v85
  v_mfma_f32_16x16x32_bf16 v[120:123], a[168:171], v[48:51], v[120:123]
  v_cvt_pk_bf16_f32 v58, v84, v85
  s_cselect_b32 s62, s96, 8192
  v_mfma_f32_16x16x32_bf16 v[120:123], a[200:203], v[52:55], v[120:123]
  v_exp_f32 v86, v86
  v_mfma_f32_16x16x32_bf16 v[124:127], a[204:207], v[52:55], v[124:127]
  buffer_load_dwordx4 v0, s[8:11], s56 offen offset:1024 sc1 lds
  v_mfma_f32_16x16x32_bf16 v[124:127], a[172:175], v[48:51], v[124:127]
  v_exp_f32 v87, v87
  v_smfmac_f32_16x16x64_bf16 v[32:35], v[12:15], v[48:55], v10
  v_cvt_pk_bf16_f32 v59, v86, v87
  v_mfma_f32_16x16x32_bf16 v[64:67], a[64:67], a[32:35], 0
  v_exp_f32 v88, v88
  v_mfma_f32_16x16x32_bf16 v[64:67], a[68:71], a[36:39], v[64:67]
  buffer_load_dwordx4 v0, s[8:11], s56 offen offset:2048 sc1 lds
  v_mfma_f32_16x16x32_bf16 v[64:67], a[72:75], a[40:43], v[64:67]
  v_exp_f32 v89, v89
  v_mfma_f32_16x16x32_bf16 v[64:67], a[76:79], a[44:47], v[64:67]
  v_cvt_pk_bf16_f32 v60, v88, v89
  s_add_u32 s53, s53, 1024
  v_mfma_f32_16x16x32_bf16 v[68:71], a[92:95], a[44:47], 0
  v_exp_f32 v90, v90
  v_mfma_f32_16x16x32_bf16 v[68:71], a[88:91], a[40:43], v[68:71]
  buffer_load_dwordx4 v0, s[8:11], s56 offen offset:3072 sc1 lds
  v_mfma_f32_16x16x32_bf16 v[68:71], a[84:87], a[36:39], v[68:71]
  v_exp_f32 v91, v91
  v_mfma_f32_16x16x32_bf16 v[68:71], a[80:83], a[32:35], v[68:71]
  v_cvt_pk_bf16_f32 v61, v90, v91
  s_add_u32 m0, m0, 4096
  v_mfma_f32_16x16x32_bf16 v[72:75], a[96:99], a[32:35], 0
  v_exp_f32 v92, v92
  v_mfma_f32_16x16x32_bf16 v[72:75], a[100:103], a[36:39], v[72:75]
  buffer_load_dwordx4 v5, s[8:11], s56 offen offset:0 sc1 lds
  v_mfma_f32_16x16x32_bf16 v[72:75], a[104:107], a[40:43], v[72:75]
  v_exp_f32 v93, v93
  v_mfma_f32_16x16x32_bf16 v[72:75], a[108:111], a[44:47], v[72:75]
  v_cvt_pk_bf16_f32 v62, v92, v93
  v_add_u32 v2, s70, v9
  v_mfma_f32_16x16x32_bf16 v[76:79], a[220:223], a[44:47], 0
  v_exp_f32 v94, v94
  v_mfma_f32_16x16x32_bf16 v[76:79], a[216:219], a[40:43], v[76:79]
  buffer_load_dwordx4 v5, s[8:11], s56 offen offset:1024 sc1 lds
  v_mfma_f32_16x16x32_bf16 v[76:79], a[212:215], a[36:39], v[76:79]
  v_exp_f32 v95, v95
  v_mfma_f32_16x16x32_bf16 v[76:79], a[208:211], a[32:35], v[76:79]
  v_cvt_pk_bf16_f32 v63, v94, v95
  v_add_u32 v3, s62, v2
  v_mfma_f32_16x16x32_bf16 v[128:131], a[144:147], v[56:59], v[128:131]
  s_add_u32 s75, s75, s71
  s_pack_lh_b32_b16 s75, s75, s59
  v_mfma_f32_16x16x32_bf16 v[128:131], a[176:179], v[60:63], v[128:131]
  v_exp_f32 v64, v64
  v_mfma_f32_16x16x32_bf16 v[132:135], a[180:183], v[60:63], v[132:135]
  buffer_load_dwordx4 v5, s[8:11], s56 offen offset:2048 sc1 lds
  v_mfma_f32_16x16x32_bf16 v[132:135], a[148:151], v[56:59], v[132:135]
  v_exp_f32 v65, v65
  v_mfma_f32_16x16x32_bf16 v[136:139], a[152:155], v[56:59], v[136:139]
  v_cvt_pk_bf16_f32 v48, v64, v65
  s_waitcnt vmcnt(8)
  v_mfma_f32_16x16x32_bf16 v[136:139], a[184:187], v[60:63], v[136:139]
  v_exp_f32 v66, v66
  v_mfma_f32_16x16x32_bf16 v[140:143], a[188:191], v[60:63], v[140:143]
  buffer_load_dwordx4 v5, s[8:11], s56 offen offset:3072 sc1 lds
  v_mfma_f32_16x16x32_bf16 v[140:143], a[156:159], v[56:59], v[140:143]
  v_exp_f32 v67, v67
  v_mfma_f32_16x16x32_bf16 v[144:147], a[160:163], v[56:59], v[144:147]
  v_cvt_pk_bf16_f32 v49, v66, v67
  s_mov_b32 m0, s72
  v_mfma_f32_16x16x32_bf16 v[144:147], a[192:195], v[60:63], v[144:147]
  v_exp_f32 v68, v68
  v_mfma_f32_16x16x32_bf16 v[148:151], a[196:199], v[60:63], v[148:151]
  buffer_load_dwordx4 v0, s[8:11], s57 offen offset:0 sc1 lds
  v_mfma_f32_16x16x32_bf16 v[148:151], a[164:167], v[56:59], v[148:151]
  v_exp_f32 v69, v69
  v_mfma_f32_16x16x32_bf16 v[152:155], a[168:171], v[56:59], v[152:155]
  v_cvt_pk_bf16_f32 v50, v68, v69
  s_barrier
  v_mfma_f32_16x16x32_bf16 v[152:155], a[200:203], v[60:63], v[152:155]
  v_exp_f32 v70, v70
  v_mfma_f32_16x16x32_bf16 v[156:159], a[204:207], v[60:63], v[156:159]
  buffer_load_dwordx4 v0, s[8:11], s57 offen offset:1024 sc1 lds
  v_mfma_f32_16x16x32_bf16 v[156:159], a[172:175], v[56:59], v[156:159]
  v_exp_f32 v71, v71
  v_smfmac_f32_16x16x64_bf16 v[36:39], v[12:15], v[56:63], v10
  v_cvt_pk_bf16_f32 v51, v70, v71
  v_mfma_f32_16x16x32_bf16 v[80:83], a[64:67], a[48:51], 0
  v_exp_f32 v72, v72
  v_mfma_f32_16x16x32_bf16 v[80:83], a[68:71], a[52:55], v[80:83]
  ds_read_b128 a[64:67], v2 offset:0
  s_add_u32 s56, s56, s71
  v_mfma_f32_16x16x32_bf16 v[80:83], a[72:75], a[56:59], v[80:83]
  v_exp_f32 v73, v73
  v_mfma_f32_16x16x32_bf16 v[80:83], a[76:79], a[60:63], v[80:83]
  ds_read_b128 a[68:71], v2 offset:1024
  v_cvt_pk_bf16_f32 v52, v72, v73
  v_mfma_f32_16x16x32_bf16 v[84:87], a[92:95], a[60:63], 0
  v_exp_f32 v74, v74
  v_mfma_f32_16x16x32_bf16 v[84:87], a[88:91], a[56:59], v[84:87]
  ds_read_b128 a[72:75], v2 offset:2048
  buffer_load_dwordx4 v0, s[8:11], s57 offen offset:2048 sc1 lds
  v_mfma_f32_16x16x32_bf16 v[84:87], a[84:87], a[52:55], v[84:87]
  v_exp_f32 v75, v75
  v_mfma_f32_16x16x32_bf16 v[84:87], a[80:83], a[48:51], v[84:87]
  ds_read_b128 a[76:79], v2 offset:3072
  v_cvt_pk_bf16_f32 v53, v74, v75
  v_mfma_f32_16x16x32_bf16 v[88:91], a[96:99], a[48:51], 0
  v_exp_f32 v76, v76
  v_mfma_f32_16x16x32_bf16 v[88:91], a[100:103], a[52:55], v[88:91]
  ds_read_b128 a[92:95], v2 offset:7168
  v_mfma_f32_16x16x32_bf16 v[88:91], a[104:107], a[56:59], v[88:91]
  v_exp_f32 v77, v77
  v_mfma_f32_16x16x32_bf16 v[88:91], a[108:111], a[60:63], v[88:91]
  ds_read_b128 a[88:91], v2 offset:6144
  v_cvt_pk_bf16_f32 v54, v76, v77
  v_mfma_f32_16x16x32_bf16 v[92:95], a[220:223], a[60:63], 0
  v_exp_f32 v78, v78
  v_mfma_f32_16x16x32_bf16 v[92:95], a[216:219], a[56:59], v[92:95]
  ds_read_b128 a[84:87], v2 offset:5120
  v_mfma_f32_16x16x32_bf16 v[92:95], a[212:215], a[52:55], v[92:95]
  v_exp_f32 v79, v79
  v_mfma_f32_16x16x32_bf16 v[92:95], a[208:211], a[48:51], v[92:95]
  ds_read_b128 a[80:83], v2 offset:4096
  v_cvt_pk_bf16_f32 v55, v78, v79
  v_mfma_f32_16x16x32_bf16 v[160:163], a[144:147], v[48:51], v[160:163]
  ds_read_b128 a[96:99], v3 offset:0
  buffer_load_dwordx4 v0, s[8:11], s57 offen offset:3072 sc1 lds
  v_mfma_f32_16x16x32_bf16 v[160:163], a[176:179], v[52:55], v[160:163]
  v_exp_f32 v80, v80
  v_mfma_f32_16x16x32_bf16 v[164:167], a[180:183], v[52:55], v[164:167]
  ds_read_b128 a[100:103], v3 offset:1024
  s_add_u32 m0, s72, 4096
  v_mfma_f32_16x16x32_bf16 v[164:167], a[148:151], v[48:51], v[164:167]
  v_exp_f32 v81, v81
  v_mfma_f32_16x16x32_bf16 v[168:171], a[152:155], v[48:51], v[168:171]
  ds_read_b128 a[104:107], v3 offset:2048
  v_cvt_pk_bf16_f32 v56, v80, v81
  v_mfma_f32_16x16x32_bf16 v[168:171], a[184:187], v[52:55], v[168:171]
  v_exp_f32 v82, v82
  v_mfma_f32_16x16x32_bf16 v[172:175], a[188:191], v[52:55], v[172:175]
  ds_read_b128 a[108:111], v3 offset:3072
  s_bitcmp0_b32 s80, s48
  v_mfma_f32_16x16x32_bf16 v[172:175], a[156:159], v[48:51], v[172:175]
  v_exp_f32 v83, v83
  v_mfma_f32_16x16x32_bf16 v[176:179], a[160:163], v[48:51], v[176:179]
  ds_read_b128 a[220:223], v3 offset:7168
  v_cvt_pk_bf16_f32 v57, v82, v83
  v_mfma_f32_16x16x32_bf16 v[176:179], a[192:195], v[52:55], v[176:179]
  v_exp_f32 v84, v84
  v_mfma_f32_16x16x32_bf16 v[180:183], a[196:199], v[52:55], v[180:183]
  ds_read_b128 a[216:219], v3 offset:6144
  v_mfma_f32_16x16x32_bf16 v[180:183], a[164:167], v[48:51], v[180:183]
  v_exp_f32 v85, v85
  v_mfma_f32_16x16x32_bf16 v[184:187], a[168:171], v[48:51], v[184:187]
  ds_read_b128 a[212:215], v3 offset:5120
  v_cvt_pk_bf16_f32 v58, v84, v85
  v_mfma_f32_16x16x32_bf16 v[184:187], a[200:203], v[52:55], v[184:187]
  v_exp_f32 v86, v86
  v_mfma_f32_16x16x32_bf16 v[188:191], a[204:207], v[52:55], v[188:191]
  ds_read_b128 a[208:211], v3 offset:4096
  s_waitcnt lgkmcnt(8)
  v_mfma_f32_16x16x32_bf16 v[188:191], a[172:175], v[48:51], v[188:191]
  v_exp_f32 v87, v87
  v_smfmac_f32_16x16x64_bf16 v[40:43], v[12:15], v[48:55], v10
  s_cbranch_scc1 L_aloop
L_evt:
L_evt1:
  s_cmp_eq_u32 s48, 16
  s_cbranch_scc1 L_evt16
  s_cmp_eq_u32 s48, 13
  s_cbranch_scc1 L_evtf
  s_sub_u32 s3, s48, s50
  s_and_b32 s3, s3, -3
  s_cbranch_scc1 L_aloop
  s_branch L_evt2
L_evtf:
  buffer_store_dword v12, off, s[16:19], s54 sc1
  v_and_b32 v29, 3, v1
  v_lshl_add_u32 v29, v29, 7, s7
  v_add_u32 v29, L_tj-L_base, v29
  global_load_dword v31, v29, s[0:1]
  s_branch L_aloop
L_evt16:
  s_cmp_eq_u32 s40, 0
  s_cbranch_scc1 L_tf0
  s_branch L_tf1
L_gate_10:
  s_mov_b32 s6, 2146435072
  s_cmp_lg_u32 s36, 27
  s_cbranch_scc1 L_nogate_12
  s_cmp_lg_u32 s40, 0
  s_cbranch_scc1 L_nogate_12
  v_lshlrev_b32 v48, 2, v1
  s_nop 2
  v_permlane32_swap_b32 v177, v178
  s_nop 1
  v_add_f32 v40, v176, v178
  v_mul_f32 v40, 0xbfb8aa3b, v40
  v_exp_f32 v40, v40
  s_nop 0
  v_add_f32 v40, 1.0, v40
  v_rcp_f32 v40, v40
  v_permlane32_swap_b32 v185, v186
  s_nop 1
  v_add_f32 v41, v184, v186
  v_mul_f32 v41, 0xbfb8aa3b, v41
  v_exp_f32 v41, v41
  s_nop 0
  v_add_f32 v41, 1.0, v41
  v_rcp_f32 v41, v41
  v_permlane32_swap_b32 v193, v194
  s_nop 1
  v_add_f32 v42, v192, v194
  v_mul_f32 v42, 0xbfb8aa3b, v42
  v_exp_f32 v42, v42
  s_nop 0
  v_add_f32 v42, 1.0, v42
  v_rcp_f32 v42, v42
  v_permlane32_swap_b32 v201, v202
  s_nop 1
  v_add_f32 v43, v200, v202
  v_mul_f32 v43, 0xbfb8aa3b, v43
  v_exp_f32 v43, v43
  s_nop 0
  v_add_f32 v43, 1.0, v43
  v_rcp_f32 v43, v43
  v_permlane32_swap_b32 v209, v210
  s_nop 1
  v_add_f32 v44, v208, v210
  v_mul_f32 v44, 0xbfb8aa3b, v44
  v_exp_f32 v44, v44
  s_nop 0
  v_add_f32 v44, 1.0, v44
  v_rcp_f32 v44, v44
  v_permlane32_swap_b32 v217, v218
  s_nop 1
  v_add_f32 v45, v216, v218
  v_mul_f32 v45, 0xbfb8aa3b, v45
  v_exp_f32 v45, v45
  s_nop 0
  v_add_f32 v45, 1.0, v45
  v_rcp_f32 v45, v45
  v_permlane32_swap_b32 v225, v226
  s_nop 1
  v_add_f32 v46, v224, v226
  v_mul_f32 v46, 0xbfb8aa3b, v46
  v_exp_f32 v46, v46
  s_nop 0
  v_add_f32 v46, 1.0, v46
  v_rcp_f32 v46, v46
  v_permlane32_swap_b32 v233, v234
  s_nop 1
  v_add_f32 v47, v232, v234
  v_mul_f32 v47, 0xbfb8aa3b, v47
  v_exp_f32 v47, v47
  s_nop 0
  v_add_f32 v47, 1.0, v47
  v_rcp_f32 v47, v47
  s_mov_b64 exec, 0xffff
  buffer_store_dword v40, v48, s[16:19], s64 offen offset:0 sc1
  buffer_store_dword v41, v48, s[16:19], s64 offen offset:128 sc1
  buffer_store_dword v42, v48, s[16:19], s64 offen offset:256 sc1
  buffer_store_dword v43, v48, s[16:19], s64 offen offset:384 sc1
  buffer_store_dword v44, v48, s[16:19], s65 offen offset:0 sc1
  buffer_store_dword v45, v48, s[16:19], s65 offen offset:128 sc1
  buffer_store_dword v46, v48, s[16:19], s65 offen offset:256 sc1
  buffer_store_dword v47, v48, s[16:19], s65 offen offset:384 sc1
  s_mov_b64 exec, -1
  s_mov_b32 s6, s97
L_nogate_12:
  s_mov_b32 s68, 2146435072
  s_mov_b32 s69, 2146435072
  s_add_u32 s56, s56, 32768
  s_add_u32 s75, s59, 32768
  v_cvt_pk_bf16_f32 v128, v128, v129
  v_cvt_pk_bf16_f32 v129, v130, v131
  v_cvt_pk_bf16_f32 v130, v132, v133
  v_cvt_pk_bf16_f32 v131, v134, v135
  v_cvt_pk_bf16_f32 v136, v136, v137
  v_cvt_pk_bf16_f32 v137, v138, v139
  v_cvt_pk_bf16_f32 v138, v140, v141
  v_cvt_pk_bf16_f32 v139, v142, v143
  v_cvt_pk_bf16_f32 v144, v144, v145
  v_cvt_pk_bf16_f32 v145, v146, v147
  v_cvt_pk_bf16_f32 v146, v148, v149
  v_cvt_pk_bf16_f32 v147, v150, v151
  v_cvt_pk_bf16_f32 v152, v152, v153
  v_cvt_pk_bf16_f32 v153, v154, v155
  v_cvt_pk_bf16_f32 v154, v156, v157
  v_cvt_pk_bf16_f32 v155, v158, v159
  v_cvt_pk_bf16_f32 v160, v160, v161
  v_cvt_pk_bf16_f32 v161, v162, v163
  v_cvt_pk_bf16_f32 v162, v164, v165
  v_cvt_pk_bf16_f32 v163, v166, v167
  v_cvt_pk_bf16_f32 v168, v168, v169
  v_cvt_pk_bf16_f32 v169, v170, v171
  v_cvt_pk_bf16_f32 v170, v172, v173
  v_cvt_pk_bf16_f32 v171, v174, v175
  ds_write_b128 v11, v[128:131] offset:4096
  ds_write_b128 v11, v[136:139] offset:5120
  ds_write_b128 v11, v[144:147] offset:8192
  ds_write_b128 v11, v[152:155] offset:9216
  ds_write_b128 v11, v[160:163] offset:12288
  ds_write_b128 v11, v[168:171] offset:13312
  s_waitcnt vmcnt(4) lgkmcnt(0)
  s_barrier
  ds_read_b128 a[0:3], v28 offset:0
  ds_read_b128 a[4:7], v28 offset:1024
  ds_read_b128 a[8:11], v28 offset:2048
  ds_read_b128 a[12:15], v28 offset:3072
  ds_read_b128 a[16:19], v28 offset:4096
  ds_read_b128 a[20:23], v28 offset:5120
  ds_read_b128 a[24:27], v28 offset:6144
  ds_read_b128 a[28:31], v28 offset:7168
  ds_read_b128 a[64:67], v2 offset:0
  ds_read_b128 a[68:71], v2 offset:1024
  ds_read_b128 a[72:75], v2 offset:2048
  ds_read_b128 a[76:79], v2 offset:3072
  ds_read_b128 a[92:95], v2 offset:7168
  ds_read_b128 a[88:91], v2 offset:6144
  ds_read_b128 a[84:87], v2 offset:5120
  ds_read_b128 a[80:83], v2 offset:4096
  ds_read_b128 a[96:99], v3 offset:0
  ds_read_b128 a[100:103], v3 offset:1024
  ds_read_b128 a[104:107], v3 offset:2048
  ds_read_b128 a[108:111], v3 offset:3072
  ds_read_b128 a[220:223], v3 offset:7168
  ds_read_b128 a[216:219], v3 offset:6144
  ds_read_b128 a[212:215], v3 offset:5120
  ds_read_b128 a[208:211], v3 offset:4096
  ds_read_b128 a[32:35], v28 offset:8192
  ds_read_b128 a[36:39], v28 offset:9216
  ds_read_b128 a[40:43], v28 offset:10240
  ds_read_b128 a[44:47], v28 offset:11264
  ds_read_b128 a[48:51], v28 offset:12288
  ds_read_b128 a[52:55], v28 offset:13312
  ds_read_b128 a[56:59], v28 offset:14336
  ds_read_b128 a[60:63], v28 offset:15360
  v_mov_b32 v29, 1
  s_waitcnt vmcnt(0)
  buffer_store_dword v29, off, s[16:19], s6 sc1
  s_branch L_epidone_11
L_tj0:
  v_mfma_f32_16x16x32_bf16 v[64:67], a[64:67], a[48:51], 0
  v_add_u32 v4, 65536, v2
  v_add_u32 v7, 65536, v3
  v_mfma_f32_16x16x32_bf16 v[64:67], a[68:71], a[52:55], v[64:67]
  ds_read_b128 a[144:147], v4 offset:0
  s_add_u32 m0, s72, 4096
  v_mfma_f32_16x16x32_bf16 v[64:67], a[72:75], a[56:59], v[64:67]
  ds_read_b128 a[176:179], v7 offset:0
  s_add_u32 s72, s75, 16384
  v_mfma_f32_16x16x32_bf16 v[64:67], a[76:79], a[60:63], v[64:67]
  ds_read_b128 a[180:183], v7 offset:1024
  s_bitcmp1_b32 s78, s48
  v_mfma_f32_16x16x32_bf16 v[68:71], a[92:95], a[60:63], 0
  ds_read_b128 a[148:151], v4 offset:1024
  v_mfma_f32_16x16x32_bf16 v[68:71], a[88:91], a[56:59], v[68:71]
  ds_read_b128 a[152:155], v4 offset:2048
  s_cselect_b32 s71, 32768, s61
  v_mfma_f32_16x16x32_bf16 v[68:71], a[84:87], a[52:55], v[68:71]
  ds_read_b128 a[184:187], v7 offset:2048
  s_cselect_b32 s72, s72, 163840
  v_mfma_f32_16x16x32_bf16 v[68:71], a[80:83], a[48:51], v[68:71]
  ds_read_b128 a[188:191], v7 offset:3072
  v_mfma_f32_16x16x32_bf16 v[72:75], a[96:99], a[48:51], 0
  ds_read_b128 a[156:159], v4 offset:3072
  v_mfma_f32_16x16x32_bf16 v[72:75], a[100:103], a[52:55], v[72:75]
  ds_read_b128 a[160:163], v4 offset:4096
  v_mfma_f32_16x16x32_bf16 v[72:75], a[104:107], a[56:59], v[72:75]
  ds_read_b128 a[192:195], v7 offset:4096
  v_mfma_f32_16x16x32_bf16 v[72:75], a[108:111], a[60:63], v[72:75]
  ds_read_b128 a[196:199], v7 offset:5120
  v_mfma_f32_16x16x32_bf16 v[76:79], a[220:223], a[60:63], 0
  ds_read_b128 a[164:167], v4 offset:5120
  v_mfma_f32_16x16x32_bf16 v[76:79], a[216:219], a[56:59], v[76:79]
  ds_read_b128 a[168:171], v4 offset:6144
  v_mfma_f32_16x16x32_bf16 v[76:79], a[212:215], a[52:55], v[76:79]
  ds_read_b128 a[200:203], v7 offset:6144
  v_mfma_f32_16x16x32_bf16 v[76:79], a[208:211], a[48:51], v[76:79]
  ds_read_b128 a[204:207], v7 offset:7168
  v_mfma_f32_16x16x32_bf16 v[80:83], a[64:67], a[32:35], 0
  v_exp_f32 v64, v64
  v_mfma_f32_16x16x32_bf16 v[80:83], a[68:71], a[36:39], v[80:83]
  v_exp_f32 v65, v65
  v_mfma_f32_16x16x32_bf16 v[80:83], a[72:75], a[40:43], v[80:83]
  v_exp_f32 v66, v66
  v_mfma_f32_16x16x32_bf16 v[80:83], a[76:79], a[44:47], v[80:83]
  v_exp_f32 v67, v67
  v_mfma_f32_16x16x32_bf16 v[84:87], a[92:95], a[44:47], 0
  v_exp_f32 v68, v68
  v_mfma_f32_16x16x32_bf16 v[84:87], a[88:91], a[40:43], v[84:87]
  v_exp_f32 v69, v69
  v_mfma_f32_16x16x32_bf16 v[84:87], a[84:87], a[36:39], v[84:87]
  v_exp_f32 v70, v70
  v_mfma_f32_16x16x32_bf16 v[84:87], a[80:83], a[32:35], v[84:87]
  v_exp_f32 v71, v71
  v_mfma_f32_16x16x32_bf16 v[88:91], a[96:99], a[32:35], 0
  ds_read_b128 a[172:175], v4 offset:7168
  v_cvt_pk_bf16_f32 v48, v64, v65
  v_mfma_f32_16x16x32_bf16 v[88:91], a[100:103], a[36:39], v[88:91]
  v_cvt_pk_bf16_f32 v49, v66, v67
  v_cvt_pk_bf16_f32 v50, v68, v69
  v_mfma_f32_16x16x32_bf16 v[88:91], a[104:107], a[40:43], v[88:91]
  v_cvt_pk_bf16_f32 v51, v70, v71
  s_waitcnt lgkmcnt(7)
  v_mfma_f32_16x16x32_bf16 v[88:91], a[108:111], a[44:47], v[88:91]
  v_exp_f32 v72, v72
  v_mfma_f32_16x16x32_bf16 v[92:95], a[220:223], a[44:47], 0
  v_exp_f32 v73, v73
  v_mfma_f32_16x16x32_bf16 v[92:95], a[216:219], a[40:43], v[92:95]
  v_exp_f32 v74, v74
  v_mfma_f32_16x16x32_bf16 v[92:95], a[212:215], a[36:39], v[92:95]
  v_exp_f32 v75, v75
  v_mfma_f32_16x16x32_bf16 v[92:95], a[208:211], a[32:35], v[92:95]
  v_exp_f32 v76, v76
  v_mfma_f32_16x16x32_bf16 v[192:195], a[144:147], v[48:51], 0
  v_exp_f32 v77, v77
  v_exp_f32 v78, v78
  v_exp_f32 v79, v79
  v_cvt_pk_bf16_f32 v52, v72, v73
  v_cvt_pk_bf16_f32 v53, v74, v75
  v_cvt_pk_bf16_f32 v54, v76, v77
  v_cvt_pk_bf16_f32 v55, v78, v79
  buffer_load_dword v30, off, s[16:19], s97 sc1
  buffer_load_dwordx4 v5, s[8:11], s57 offen offset:0 sc1 lds
  v_mfma_f32_16x16x32_bf16 v[192:195], a[176:179], v[52:55], v[192:195]
  v_exp_f32 v80, v80
  v_mfma_f32_16x16x32_bf16 v[196:199], a[180:183], v[52:55], 0
  v_exp_f32 v81, v81
  v_mfma_f32_16x16x32_bf16 v[196:199], a[148:151], v[48:51], v[196:199]
  buffer_load_dwordx4 v5, s[8:11], s57 offen offset:1024 sc1 lds
  v_mfma_f32_16x16x32_bf16 v[200:203], a[152:155], v[48:51], 0
  v_exp_f32 v82, v82
  v_mfma_f32_16x16x32_bf16 v[200:203], a[184:187], v[52:55], v[200:203]
  v_exp_f32 v83, v83
  v_mfma_f32_16x16x32_bf16 v[204:207], a[188:191], v[52:55], 0
  buffer_load_dwordx4 v5, s[8:11], s57 offen offset:2048 sc1 lds
  v_mfma_f32_16x16x32_bf16 v[204:207], a[156:159], v[48:51], v[204:207]
  v_exp_f32 v84, v84
  v_mfma_f32_16x16x32_bf16 v[208:211], a[160:163], v[48:51], 0
  s_waitcnt lgkmcnt(0)
  s_barrier
  v_mfma_f32_16x16x32_bf16 v[208:211], a[192:195], v[52:55], v[208:211]
  buffer_load_dwordx4 v5, s[8:11], s57 offen offset:3072 sc1 lds
  v_mfma_f32_16x16x32_bf16 v[212:215], a[196:199], v[52:55], 0
  s_cselect_b32 s57, s61, 2146435072
  s_waitcnt vmcnt(4)
  v_mfma_f32_16x16x32_bf16 v[212:215], a[164:167], v[48:51], v[212:215]
  s_add_u32 s57, s57, s56
  v_cmp_eq_u32 vcc, 0, v30
  v_mfma_f32_16x16x32_bf16 v[216:219], a[168:171], v[48:51], 0
  s_cbranch_vccnz L_gt_13
L_gtback_14:
  s_mov_b32 m0, s75
  v_mfma_f32_16x16x32_bf16 v[216:219], a[200:203], v[52:55], v[216:219]
  buffer_load_dword v24, v6, s[16:19], s65 offen offset:0 sc1
  v_mfma_f32_16x16x32_bf16 v[220:223], a[204:207], v[52:55], 0
  buffer_load_dword v25, v6, s[16:19], s65 offen offset:128 sc1
  v_mfma_f32_16x16x32_bf16 v[220:223], a[172:175], v[48:51], v[220:223]
  buffer_load_dword v26, v6, s[16:19], s65 offen offset:256 sc1
  v_mfma_f32_16x16x32_bf16 v[44:47], a[228:231], v[48:51], 0
  buffer_load_dword v27, v6, s[16:19], s65 offen offset:384 sc1
  v_mfma_f32_16x16x32_bf16 v[44:47], a[228:231], v[52:55], v[44:47]
  v_exp_f32 v85, v85
  v_mfma_f32_16x16x32_bf16 v[64:67], a[64:67], a[16:19], 0
  v_exp_f32 v86, v86
  v_mfma_f32_16x16x32_bf16 v[64:67], a[68:71], a[20:23], v[64:67]
  v_exp_f32 v87, v87
  v_mfma_f32_16x16x32_bf16 v[64:67], a[72:75], a[24:27], v[64:67]
  buffer_load_dwordx4 v0, s[8:11], s56 offen offset:0 sc1 lds
  v_mfma_f32_16x16x32_bf16 v[64:67], a[76:79], a[28:31], v[64:67]
  v_cvt_pk_bf16_f32 v56, v80, v81
  v_cvt_pk_bf16_f32 v57, v82, v83
  v_mfma_f32_16x16x32_bf16 v[68:71], a[92:95], a[28:31], 0
  v_cvt_pk_bf16_f32 v58, v84, v85
  v_cvt_pk_bf16_f32 v59, v86, v87
  v_mfma_f32_16x16x32_bf16 v[68:71], a[88:91], a[24:27], v[68:71]
  v_exp_f32 v88, v88
  v_mfma_f32_16x16x32_bf16 v[68:71], a[84:87], a[20:23], v[68:71]
  v_exp_f32 v89, v89
  v_mfma_f32_16x16x32_bf16 v[68:71], a[80:83], a[16:19], v[68:71]
  v_exp_f32 v90, v90
  v_mfma_f32_16x16x32_bf16 v[72:75], a[96:99], a[16:19], v[16:19]
  v_exp_f32 v91, v91
  v_mfma_f32_16x16x32_bf16 v[72:75], a[100:103], a[20:23], v[72:75]
  v_exp_f32 v92, v92
  v_mfma_f32_16x16x32_bf16 v[72:75], a[104:107], a[24:27], v[72:75]
  v_exp_f32 v93, v93
  v_mfma_f32_16x16x32_bf16 v[72:75], a[108:111], a[28:31], v[72:75]
  v_exp_f32 v94, v94
  v_mfma_f32_16x16x32_bf16 v[76:79], a[220:223], a[28:31], v[20:23]
  v_exp_f32 v95, v95
  v_mfma_f32_16x16x32_bf16 v[76:79], a[216:219], a[24:27], v[76:79]
  v_cvt_pk_bf16_f32 v60, v88, v89
  v_cvt_pk_bf16_f32 v61, v90, v91
  v_mfma_f32_16x16x32_bf16 v[76:79], a[212:215], a[20:23], v[76:79]
  v_cvt_pk_bf16_f32 v62, v92, v93
  v_cvt_pk_bf16_f32 v63, v94, v95
  v_mfma_f32_16x16x32_bf16 v[76:79], a[208:211], a[16:19], v[76:79]
  buffer_load_dwordx4 v0, s[8:11], s56 offen offset:1024 sc1 lds
  v_mfma_f32_16x16x32_bf16 v[160:163], a[144:147], v[56:59], 0
  v_exp_f32 v64, v64
  v_mfma_f32_16x16x32_bf16 v[160:163], a[176:179], v[60:63], v[160:163]
  v_exp_f32 v65, v65
  v_mfma_f32_16x16x32_bf16 v[164:167], a[180:183], v[60:63], 0
  buffer_load_dwordx4 v0, s[8:11], s56 offen offset:2048 sc1 lds
  v_mfma_f32_16x16x32_bf16 v[164:167], a[148:151], v[56:59], v[164:167]
  v_exp_f32 v66, v66
  v_mfma_f32_16x16x32_bf16 v[168:171], a[152:155], v[56:59], 0
  v_exp_f32 v67, v67
  v_mfma_f32_16x16x32_bf16 v[168:171], a[184:187], v[60:63], v[168:171]
  buffer_load_dwordx4 v0, s[8:11], s56 offen offset:3072 sc1 lds
  v_mfma_f32_16x16x32_bf16 v[172:175], a[188:191], v[60:63], 0
  s_add_u32 m0, m0, 4096
  v_cvt_pk_bf16_f32 v48, v64, v65
  v_mfma_f32_16x16x32_bf16 v[172:175], a[156:159], v[56:59], v[172:175]
  v_exp_f32 v68, v68
  v_mfma_f32_16x16x32_bf16 v[176:179], a[160:163], v[56:59], 0
  buffer_load_dwordx4 v5, s[8:11], s56 offen offset:0 sc1 lds
  v_mfma_f32_16x16x32_bf16 v[176:179], a[192:195], v[60:63], v[176:179]
  v_exp_f32 v69, v69
  v_mfma_f32_16x16x32_bf16 v[180:183], a[196:199], v[60:63], 0
  v_exp_f32 v70, v70
  v_mfma_f32_16x16x32_bf16 v[180:183], a[164:167], v[56:59], v[180:183]
  s_waitcnt vmcnt(9)
  s_barrier
  v_mfma_f32_16x16x32_bf16 v[184:187], a[168:171], v[56:59], 0
  buffer_load_dwordx4 v5, s[8:11], s56 offen offset:1024 sc1 lds
  v_mfma_f32_16x16x32_bf16 v[184:187], a[200:203], v[60:63], v[184:187]
  v_exp_f32 v71, v71
  v_mfma_f32_16x16x32_bf16 v[188:191], a[204:207], v[60:63], 0
  v_cvt_pk_bf16_f32 v49, v66, v67
  v_cvt_pk_bf16_f32 v50, v68, v69
  v_mfma_f32_16x16x32_bf16 v[188:191], a[172:175], v[56:59], v[188:191]
  buffer_load_dwordx4 v5, s[8:11], s56 offen offset:2048 sc1 lds
  v_mfma_f32_16x16x32_bf16 v[40:43], a[228:231], v[56:59], 0
  v_exp_f32 v72, v72
  v_mfma_f32_16x16x32_bf16 v[40:43], a[228:231], v[60:63], v[40:43]
  v_exp_f32 v73, v73
  v_mfma_f32_16x16x32_bf16 v[80:83], a[64:67], a[0:3], v[16:19]
  buffer_load_dwordx4 v5, s[8:11], s56 offen offset:3072 sc1 lds
  v_mfma_f32_16x16x32_bf16 v[80:83], a[68:71], a[4:7], v[80:83]
  s_mov_b32 m0, s72
  v_cvt_pk_bf16_f32 v51, v70, v71
  v_mfma_f32_16x16x32_bf16 v[80:83], a[72:75], a[8:11], v[80:83]
  v_exp_f32 v74, v74
  v_mfma_f32_16x16x32_bf16 v[80:83], a[76:79], a[12:15], v[80:83]
  buffer_load_dwordx4 v0, s[8:11], s57 offen offset:0 sc1 lds
  v_mfma_f32_16x16x32_bf16 v[84:87], a[92:95], a[12:15], v[20:23]
  v_exp_f32 v75, v75
  v_mfma_f32_16x16x32_bf16 v[84:87], a[88:91], a[8:11], v[84:87]
  v_exp_f32 v76, v76
  v_mfma_f32_16x16x32_bf16 v[84:87], a[84:87], a[4:7], v[84:87]
  v_exp_f32 v77, v77
  v_mfma_f32_16x16x32_bf16 v[84:87], a[80:83], a[0:3], v[84:87]
  v_exp_f32 v78, v78
  v_mfma_f32_16x16x32_bf16 v[128:131], a[144:147], v[48:51], 0
  v_exp_f32 v79, v79
  buffer_load_dwordx4 v0, s[8:11], s57 offen offset:1024 sc1 lds
  v_cvt_pk_bf16_f32 v52, v72, v73
  v_cvt_pk_bf16_f32 v53, v74, v75
  v_cvt_pk_bf16_f32 v54, v76, v77
  v_cvt_pk_bf16_f32 v55, v78, v79
  s_add_u32 s56, s56, s71
  s_add_u32 s75, s75, s71
  v_mfma_f32_16x16x32_bf16 v[128:131], a[176:179], v[52:55], v[128:131]
  v_exp_f32 v80, v80
  v_mfma_f32_16x16x32_bf16 v[132:135], a[180:183], v[52:55], 0
  buffer_load_dwordx4 v0, s[8:11], s57 offen offset:2048 sc1 lds
  v_mfma_f32_16x16x32_bf16 v[132:135], a[148:151], v[48:51], v[132:135]
  v_exp_f32 v81, v81
  v_mfma_f32_16x16x32_bf16 v[136:139], a[152:155], v[48:51], 0
  v_exp_f32 v82, v82
  v_mfma_f32_16x16x32_bf16 v[136:139], a[184:187], v[52:55], v[136:139]
  buffer_load_dwordx4 v0, s[8:11], s57 offen offset:3072 sc1 lds
  v_mfma_f32_16x16x32_bf16 v[140:143], a[188:191], v[52:55], 0
  s_add_u32 m0, s72, 4096
  s_add_u32 s70, s70, s55
  v_mfma_f32_16x16x32_bf16 v[140:143], a[156:159], v[48:51], v[140:143]
  s_and_b32 s70, s70, 0xffff
  v_add_u32 v2, s70, v9
  v_mfma_f32_16x16x32_bf16 v[144:147], a[160:163], v[48:51], 0
  ds_read_b128 a[64:67], v2 offset:0
  s_add_u32 s48, s48, 1
  v_mfma_f32_16x16x32_bf16 v[144:147], a[192:195], v[52:55], v[144:147]
  ds_read_b128 a[68:71], v2 offset:1024
  s_cmp_ge_u32 s48, s79
  v_mfma_f32_16x16x32_bf16 v[148:151], a[196:199], v[52:55], 0
  ds_read_b128 a[72:75], v2 offset:2048
  s_cselect_b32 s62, s96, 8192
  v_mfma_f32_16x16x32_bf16 v[148:151], a[164:167], v[48:51], v[148:151]
  ds_read_b128 a[76:79], v2 offset:3072
  v_add_u32 v3, s62, v2
  v_mfma_f32_16x16x32_bf16 v[152:155], a[168:171], v[48:51], 0
  ds_read_b128 a[92:95], v2 offset:7168
  v_cvt_pk_bf16_f32 v56, v80, v81
  v_mfma_f32_16x16x32_bf16 v[152:155], a[200:203], v[52:55], v[152:155]
  ds_read_b128 a[88:91], v2 offset:6144
  v_add_u32 v4, 65536, v2
  v_mfma_f32_16x16x32_bf16 v[156:159], a[204:207], v[52:55], 0
  ds_read_b128 a[84:87], v2 offset:5120
  v_add_u32 v7, 65536, v3
  v_mfma_f32_16x16x32_bf16 v[156:159], a[172:175], v[48:51], v[156:159]
  ds_read_b128 a[80:83], v2 offset:4096
  s_pack_lh_b32_b16 s75, s75, s59
  v_mfma_f32_16x16x32_bf16 v[36:39], a[228:231], v[48:51], 0
  ds_read_b128 a[96:99], v3 offset:0
  s_cselect_b32 s55, 32768, s61
  v_mfma_f32_16x16x32_bf16 v[36:39], a[228:231], v[52:55], v[36:39]
  ds_read_b128 a[100:103], v3 offset:1024
  v_exp_f32 v83, v83
  ds_read_b128 a[104:107], v3 offset:2048
  v_exp_f32 v84, v84
  ds_read_b128 a[108:111], v3 offset:3072
  v_exp_f32 v85, v85
  v_exp_f32 v86, v86
  v_exp_f32 v87, v87
  ds_read_b128 a[220:223], v3 offset:7168
  v_cvt_pk_bf16_f32 v57, v82, v83
  v_cvt_pk_bf16_f32 v58, v84, v85
  ds_read_b128 a[216:219], v3 offset:6144
  v_cvt_pk_bf16_f32 v59, v86, v87
  buffer_load_dwordx4 v5, s[8:11], s57 offen offset:0 sc1 lds
  ds_read_b128 a[212:215], v3 offset:5120
  v_mfma_f32_16x16x32_bf16 v[96:99], a[144:147], v[56:59], 0
  ds_read_b128 a[208:211], v3 offset:4096
  s_waitcnt lgkmcnt(15)
  v_mfma_f32_16x16x32_bf16 v[100:103], a[148:151], v[56:59], 0
  ds_read_b128 a[144:147], v4 offset:0
  s_add_u32 s72, s75, 16384
  v_mfma_f32_16x16x32_bf16 v[104:107], a[152:155], v[56:59], 0
  ds_read_b128 a[176:179], v7 offset:0
  s_bitcmp1_b32 s78, s48
  v_mfma_f32_16x16x32_bf16 v[108:111], a[156:159], v[56:59], 0
  ds_read_b128 a[180:183], v7 offset:1024
  s_cselect_b32 s71, 32768, s61
  v_mfma_f32_16x16x32_bf16 v[112:115], a[160:163], v[56:59], 0
  ds_read_b128 a[148:151], v4 offset:1024
  s_cselect_b32 s72, s72, 163840
  v_mfma_f32_16x16x32_bf16 v[116:119], a[164:167], v[56:59], 0
  ds_read_b128 a[152:155], v4 offset:2048
  v_add_u32 v9, 8192, v9
  v_mfma_f32_16x16x32_bf16 v[120:123], a[168:171], v[56:59], 0
  ds_read_b128 a[184:187], v7 offset:2048
  v_add_f32 v36, v36, v37
  v_mfma_f32_16x16x32_bf16 v[124:127], a[172:175], v[56:59], 0
  ds_read_b128 a[188:191], v7 offset:3072
  v_mfma_f32_16x16x32_bf16 v[32:35], a[228:231], v[56:59], 0
  ds_read_b128 a[156:159], v4 offset:3072
  v_mfma_f32_16x16x32_bf16 v[64:67], a[64:67], a[48:51], 0
  ds_read_b128 a[160:163], v4 offset:4096
  s_waitcnt lgkmcnt(9)
  v_mfma_f32_16x16x32_bf16 v[64:67], a[68:71], a[52:55], v[64:67]
  ds_read_b128 a[192:195], v7 offset:4096
  v_mfma_f32_16x16x32_bf16 v[64:67], a[72:75], a[56:59], v[64:67]
  ds_read_b128 a[196:199], v7 offset:5120
  v_add_f32 v32, v32, v33
  v_mfma_f32_16x16x32_bf16 v[64:67], a[76:79], a[60:63], v[64:67]
  ds_read_b128 a[164:167], v4 offset:5120
  v_mfma_f32_16x16x32_bf16 v[68:71], a[92:95], a[60:63], 0
  ds_read_b128 a[168:171], v4 offset:6144
  v_mfma_f32_16x16x32_bf16 v[68:71], a[88:91], a[56:59], v[68:71]
  ds_read_b128 a[200:203], v7 offset:6144
  v_mfma_f32_16x16x32_bf16 v[68:71], a[84:87], a[52:55], v[68:71]
  ds_read_b128 a[204:207], v7 offset:7168
  v_mfma_f32_16x16x32_bf16 v[68:71], a[80:83], a[48:51], v[68:71]
  ds_read_b128 a[172:175], v4 offset:7168
  v_mfma_f32_16x16x32_bf16 v[72:75], a[96:99], a[48:51], v[16:19]
  v_exp_f32 v64, v64
  v_mfma_f32_16x16x32_bf16 v[72:75], a[100:103], a[52:55], v[72:75]
  v_exp_f32 v65, v65
  v_mfma_f32_16x16x32_bf16 v[72:75], a[104:107], a[56:59], v[72:75]
  v_exp_f32 v66, v66
  v_mfma_f32_16x16x32_bf16 v[72:75], a[108:111], a[60:63], v[72:75]
  v_exp_f32 v67, v67
  v_mfma_f32_16x16x32_bf16 v[76:79], a[220:223], a[60:63], v[20:23]
  v_exp_f32 v68, v68
  v_mfma_f32_16x16x32_bf16 v[76:79], a[216:219], a[56:59], v[76:79]
  v_exp_f32 v69, v69
  v_mfma_f32_16x16x32_bf16 v[76:79], a[212:215], a[52:55], v[76:79]
  v_exp_f32 v70, v70
  v_mfma_f32_16x16x32_bf16 v[76:79], a[208:211], a[48:51], v[76:79]
  v_exp_f32 v71, v71
  v_mfma_f32_16x16x32_bf16 v[88:91], a[64:67], a[32:35], v[16:19]
  buffer_load_dwordx4 v5, s[8:11], s57 offen offset:1024 sc1 lds
  v_mfma_f32_16x16x32_bf16 v[88:91], a[68:71], a[36:39], v[88:91]
  v_exp_f32 v72, v72
  v_mfma_f32_16x16x32_bf16 v[88:91], a[72:75], a[40:43], v[88:91]
  v_exp_f32 v73, v73
  v_mfma_f32_16x16x32_bf16 v[88:91], a[76:79], a[44:47], v[88:91]
  v_exp_f32 v74, v74
  v_mfma_f32_16x16x32_bf16 v[92:95], a[92:95], a[44:47], v[20:23]
  v_exp_f32 v75, v75
  v_mfma_f32_16x16x32_bf16 v[92:95], a[88:91], a[40:43], v[92:95]
  v_exp_f32 v76, v76
  v_mfma_f32_16x16x32_bf16 v[92:95], a[84:87], a[36:39], v[92:95]
  v_exp_f32 v77, v77
  v_mfma_f32_16x16x32_bf16 v[92:95], a[80:83], a[32:35], v[92:95]
  v_exp_f32 v78, v78
  v_exp_f32 v79, v79
  v_cvt_pk_bf16_f32 v48, v64, v65
  v_cvt_pk_bf16_f32 v49, v66, v67
  v_cvt_pk_bf16_f32 v50, v68, v69
  v_cvt_pk_bf16_f32 v51, v70, v71
  v_cvt_pk_bf16_f32 v52, v72, v73
  v_cvt_pk_bf16_f32 v53, v74, v75
  v_cvt_pk_bf16_f32 v54, v76, v77
  v_cvt_pk_bf16_f32 v55, v78, v79
  s_waitcnt lgkmcnt(14)
  v_mfma_f32_16x16x32_bf16 v[192:195], a[144:147], v[48:51], v[192:195]
  buffer_load_dwordx4 v5, s[8:11], s57 offen offset:2048 sc1 lds
  v_mfma_f32_16x16x32_bf16 v[192:195], a[176:179], v[52:55], v[192:195]
  s_waitcnt lgkmcnt(0)
  v_mfma_f32_16x16x32_bf16 v[196:199], a[180:183], v[52:55], v[196:199]
  v_exp_f32 v88, v88
  v_mfma_f32_16x16x32_bf16 v[196:199], a[148:151], v[48:51], v[196:199]
  buffer_load_dwordx4 v5, s[8:11], s57 offen offset:3072 sc1 lds
  v_mfma_f32_16x16x32_bf16 v[200:203], a[152:155], v[48:51], v[200:203]
  s_mov_b32 m0, s75
  s_cselect_b32 s57, s61, 2146435072
  v_mfma_f32_16x16x32_bf16 v[200:203], a[184:187], v[52:55], v[200:203]
  v_exp_f32 v89, v89
  v_mfma_f32_16x16x32_bf16 v[204:207], a[188:191], v[52:55], v[204:207]
  v_exp_f32 v90, v90
  v_mfma_f32_16x16x32_bf16 v[204:207], a[156:159], v[48:51], v[204:207]
  v_exp_f32 v91, v91
  v_mfma_f32_16x16x32_bf16 v[208:211], a[160:163], v[48:51], v[208:211]
  v_exp_f32 v92, v92
  v_mfma_f32_16x16x32_bf16 v[208:211], a[192:195], v[52:55], v[208:211]
  v_exp_f32 v93, v93
  v_mfma_f32_16x16x32_bf16 v[212:215], a[196:199], v[52:55], v[212:215]
  v_exp_f32 v94, v94
  v_mfma_f32_16x16x32_bf16 v[212:215], a[164:167], v[48:51], v[212:215]
  v_exp_f32 v95, v95
  v_mfma_f32_16x16x32_bf16 v[216:219], a[168:171], v[48:51], v[216:219]
  v_cvt_pk_bf16_f32 v60, v88, v89
  v_cvt_pk_bf16_f32 v61, v90, v91
  v_mfma_f32_16x16x32_bf16 v[216:219], a[200:203], v[52:55], v[216:219]
  v_cvt_pk_bf16_f32 v62, v92, v93
  v_cvt_pk_bf16_f32 v63, v94, v95
  v_mfma_f32_16x16x32_bf16 v[220:223], a[204:207], v[52:55], v[220:223]
  s_add_u32 s57, s57, s56
  s_add_u32 s70, s70, s55
  v_mfma_f32_16x16x32_bf16 v[220:223], a[172:175], v[48:51], v[220:223]
  s_and_b32 s70, s70, 0xffff
  s_add_u32 s48, s48, 1
  v_smfmac_f32_16x16x64_bf16 v[44:47], v[12:15], v[48:55], v10
  s_cmp_ge_u32 s48, s79
  v_mfma_f32_16x16x32_bf16 v[160:163], a[144:147], v[60:63], v[160:163]
  v_add_u32 v2, s70, v9
  s_cselect_b32 s62, s96, 8192
  v_mfma_f32_16x16x32_bf16 v[164:167], a[148:151], v[60:63], v[164:167]
  s_cselect_b32 s55, 32768, s61
  v_add_u32 v3, s62, v2
  v_mfma_f32_16x16x32_bf16 v[168:171], a[152:155], v[60:63], v[168:171]
  s_add_u32 s51, s67, 8192
  v_mfma_f32_16x16x32_bf16 v[172:175], a[156:159], v[60:63], v[172:175]
  s_barrier
  v_mfma_f32_16x16x32_bf16 v[176:179], a[160:163], v[60:63], v[176:179]
  buffer_load_dwordx4 v0, s[8:11], s56 offen offset:0 sc1 lds
  v_mfma_f32_16x16x32_bf16 v[180:183], a[164:167], v[60:63], v[180:183]
  v_add_f32 v44, v44, v45
  v_mfma_f32_16x16x32_bf16 v[184:187], a[168:171], v[60:63], v[184:187]
  v_mfma_f32_16x16x32_bf16 v[188:191], a[172:175], v[60:63], v[188:191]
  buffer_load_dwordx4 v0, s[8:11], s56 offen offset:1024 sc1 lds
  v_mfma_f32_16x16x32_bf16 v[40:43], a[228:231], v[60:63], v[40:43]
  buffer_load_dwordx4 v0, s[8:11], s56 offen offset:2048 sc1 lds
  buffer_load_dwordx4 v0, s[8:11], s56 offen offset:3072 sc1 lds
  s_nop 0
  s_nop 0
  s_nop 0
  s_nop 0
  s_nop 0
  s_nop 0
  v_add_f32 v40, v40, v41
  v_med3_f32 v64, v32, v11, s99
  v_med3_f32 v65, v36, v11, s99
  v_med3_f32 v66, v40, v11, s99
  v_med3_f32 v67, v44, v11, s99
  v_cmp_neq_f32 vcc, v32, v64
  v_cmp_neq_f32 s[4:5], v36, v65
  s_or_b64 vcc, s[4:5], vcc
  v_cmp_neq_f32 s[4:5], v40, v66
  s_or_b64 vcc, s[4:5], vcc
  v_cmp_neq_f32 s[4:5], v44, v67
  s_or_b64 vcc, s[4:5], vcc
  s_cbranch_vccnz L_slowj1
L_slowj1back:
  ds_read_b128 a[0:3], v8 offset:8192
  ds_read_b128 a[4:7], v8 offset:9216
  ds_read_b128 a[8:11], v8 offset:10240
  ds_read_b128 a[12:15], v8 offset:11264
  ds_read_b128 a[16:19], v8 offset:12288
  ds_read_b128 a[20:23], v8 offset:13312
  ds_read_b128 a[24:27], v8 offset:14336
  ds_read_b128 a[28:31], v8 offset:15360
  v_rcp_f32 v64, v32
  v_rcp_f32 v66, v36
  v_rcp_f32 v68, v40
  v_rcp_f32 v70, v44
  s_waitcnt vmcnt(20)
  v_mul_f32 v64, v64, v24
  v_mul_f32 v66, v66, v25
  v_mul_f32 v68, v68, v26
  v_mul_f32 v70, v70, v27
  v_pk_mul_f32 v[96:97], v[96:97], v[64:65] op_sel_hi:[1,0]
  v_pk_mul_f32 v[98:99], v[98:99], v[64:65] op_sel_hi:[1,0]
  v_pk_mul_f32 v[100:101], v[100:101], v[64:65] op_sel_hi:[1,0]
  v_pk_mul_f32 v[102:103], v[102:103], v[64:65] op_sel_hi:[1,0]
  v_cvt_pk_bf16_f32 v96, v96, v97
  v_cvt_pk_bf16_f32 v97, v98, v99
  v_cvt_pk_bf16_f32 v98, v100, v101
  v_cvt_pk_bf16_f32 v99, v102, v103
  v_pk_mul_f32 v[104:105], v[104:105], v[64:65] op_sel_hi:[1,0]
  v_pk_mul_f32 v[106:107], v[106:107], v[64:65] op_sel_hi:[1,0]
  v_pk_mul_f32 v[108:109], v[108:109], v[64:65] op_sel_hi:[1,0]
  v_pk_mul_f32 v[110:111], v[110:111], v[64:65] op_sel_hi:[1,0]
  v_cvt_pk_bf16_f32 v104, v104, v105
  v_cvt_pk_bf16_f32 v105, v106, v107
  v_cvt_pk_bf16_f32 v106, v108, v109
  v_cvt_pk_bf16_f32 v107, v110, v111
  v_pk_mul_f32 v[112:113], v[112:113], v[64:65] op_sel_hi:[1,0]
  v_pk_mul_f32 v[114:115], v[114:115], v[64:65] op_sel_hi:[1,0]
  v_pk_mul_f32 v[116:117], v[116:117], v[64:65] op_sel_hi:[1,0]
  v_pk_mul_f32 v[118:119], v[118:119], v[64:65] op_sel_hi:[1,0]
  v_cvt_pk_bf16_f32 v112, v112, v113
  v_cvt_pk_bf16_f32 v113, v114, v115
  v_cvt_pk_bf16_f32 v114, v116, v117
  v_cvt_pk_bf16_f32 v115, v118, v119
  v_pk_mul_f32 v[120:121], v[120:121], v[64:65] op_sel_hi:[1,0]
  v_pk_mul_f32 v[122:123], v[122:123], v[64:65] op_sel_hi:[1,0]
  v_pk_mul_f32 v[124:125], v[124:125], v[64:65] op_sel_hi:[1,0]
  v_pk_mul_f32 v[126:127], v[126:127], v[64:65] op_sel_hi:[1,0]
  v_cvt_pk_bf16_f32 v120, v120, v121
  v_cvt_pk_bf16_f32 v121, v122, v123
  v_cvt_pk_bf16_f32 v122, v124, v125
  v_cvt_pk_bf16_f32 v123, v126, v127
  s_add_u32 m0, m0, 4096
  buffer_store_dwordx4 v[96:99], v0, s[16:19], s67 offen offset:0 sc1
  buffer_store_dwordx4 v[104:107], v5, s[16:19], s67 offen offset:0 sc1
  buffer_store_dwordx4 v[112:115], v0, s[16:19], s51 offen offset:0 sc1
  buffer_store_dwordx4 v[120:123], v5, s[16:19], s51 offen offset:0 sc1
  buffer_load_dwordx4 v5, s[8:11], s56 offen offset:0 sc1 lds
  buffer_load_dwordx4 v5, s[8:11], s56 offen offset:1024 sc1 lds
  buffer_load_dwordx4 v5, s[8:11], s56 offen offset:2048 sc1 lds
  buffer_load_dwordx4 v5, s[8:11], s56 offen offset:3072 sc1 lds
  v_pk_mul_f32 v[128:129], v[128:129], v[66:67] op_sel_hi:[1,0]
  v_pk_mul_f32 v[130:131], v[130:131], v[66:67] op_sel_hi:[1,0]
  v_pk_mul_f32 v[132:133], v[132:133], v[66:67] op_sel_hi:[1,0]
  v_pk_mul_f32 v[134:135], v[134:135], v[66:67] op_sel_hi:[1,0]
  v_cvt_pk_bf16_f32 v128, v128, v129
  v_cvt_pk_bf16_f32 v129, v130, v131
  v_cvt_pk_bf16_f32 v130, v132, v133
  v_cvt_pk_bf16_f32 v131, v134, v135
  v_pk_mul_f32 v[136:137], v[136:137], v[66:67] op_sel_hi:[1,0]
  v_pk_mul_f32 v[138:139], v[138:139], v[66:67] op_sel_hi:[1,0]
  v_pk_mul_f32 v[140:141], v[140:141], v[66:67] op_sel_hi:[1,0]
  v_pk_mul_f32 v[142:143], v[142:143], v[66:67] op_sel_hi:[1,0]
  v_cvt_pk_bf16_f32 v136, v136, v137
  v_cvt_pk_bf16_f32 v137, v138, v139
  v_cvt_pk_bf16_f32 v138, v140, v141
  v_cvt_pk_bf16_f32 v139, v142, v143
  v_pk_mul_f32 v[144:145], v[144:145], v[66:67] op_sel_hi:[1,0]
  v_pk_mul_f32 v[146:147], v[146:147], v[66:67] op_sel_hi:[1,0]
  v_pk_mul_f32 v[148:149], v[148:149], v[66:67] op_sel_hi:[1,0]
  v_pk_mul_f32 v[150:151], v[150:151], v[66:67] op_sel_hi:[1,0]
  v_cvt_pk_bf16_f32 v144, v144, v145
  v_cvt_pk_bf16_f32 v145, v146, v147
  v_cvt_pk_bf16_f32 v146, v148, v149
  v_cvt_pk_bf16_f32 v147, v150, v151
  v_pk_mul_f32 v[152:153], v[152:153], v[66:67] op_sel_hi:[1,0]
  v_pk_mul_f32 v[154:155], v[154:155], v[66:67] op_sel_hi:[1,0]
  v_pk_mul_f32 v[156:157], v[156:157], v[66:67] op_sel_hi:[1,0]
  v_pk_mul_f32 v[158:159], v[158:159], v[66:67] op_sel_hi:[1,0]
  v_cvt_pk_bf16_f32 v152, v152, v153
  v_cvt_pk_bf16_f32 v153, v154, v155
  v_cvt_pk_bf16_f32 v154, v156, v157
  v_cvt_pk_bf16_f32 v155, v158, v159
  s_mov_b32 m0, s72
  s_waitcnt vmcnt(12)
  s_barrier
  ds_read_b128 a[64:67], v2 offset:0
  ds_read_b128 a[68:71], v2 offset:1024
  ds_read_b128 a[72:75], v2 offset:2048
  ds_read_b128 a[76:79], v2 offset:3072
  ds_read_b128 a[92:95], v2 offset:7168
  ds_read_b128 a[88:91], v2 offset:6144
  ds_read_b128 a[84:87], v2 offset:5120
  ds_read_b128 a[80:83], v2 offset:4096
  buffer_store_dwordx4 v[128:131], v0, s[16:19], s67 offen offset:1024 sc1
  buffer_store_dwordx4 v[136:139], v5, s[16:19], s67 offen offset:1024 sc1
  buffer_store_dwordx4 v[144:147], v0, s[16:19], s51 offen offset:1024 sc1
  buffer_store_dwordx4 v[152:155], v5, s[16:19], s51 offen offset:1024 sc1
  buffer_load_dwordx4 v0, s[8:11], s57 offen offset:0 sc1 lds
  buffer_load_dwordx4 v0, s[8:11], s57 offen offset:1024 sc1 lds
  buffer_load_dwordx4 v0, s[8:11], s57 offen offset:2048 sc1 lds
  buffer_load_dwordx4 v0, s[8:11], s57 offen offset:3072 sc1 lds
  s_add_u32 s56, s56, s71
  s_add_u32 s75, s75, s71
  s_pack_lh_b32_b16 s75, s75, s59
  v_pk_mul_f32 v[160:161], v[160:161], v[68:69] op_sel_hi:[1,0]
  v_pk_mul_f32 v[162:163], v[162:163], v[68:69] op_sel_hi:[1,0]
  v_pk_mul_f32 v[164:165], v[164:165], v[68:69] op_sel_hi:[1,0]
  v_pk_mul_f32 v[166:167], v[166:167], v[68:69] op_sel_hi:[1,0]
  v_cvt_pk_bf16_f32 v160, v160, v161
  v_cvt_pk_bf16_f32 v161, v162, v163
  v_cvt_pk_bf16_f32 v162, v164, v165
  v_cvt_pk_bf16_f32 v163, v166, v167
  v_pk_mul_f32 v[168:169], v[168:169], v[68:69] op_sel_hi:[1,0]
  v_pk_mul_f32 v[170:171], v[170:171], v[68:69] op_sel_hi:[1,0]
  v_pk_mul_f32 v[172:173], v[172:173], v[68:69] op_sel_hi:[1,0]
  v_pk_mul_f32 v[174:175], v[174:175], v[68:69] op_sel_hi:[1,0]
  v_cvt_pk_bf16_f32 v168, v168, v169
  v_cvt_pk_bf16_f32 v169, v170, v171
  v_cvt_pk_bf16_f32 v170, v172, v173
  v_cvt_pk_bf16_f32 v171, v174, v175
  v_pk_mul_f32 v[176:177], v[176:177], v[68:69] op_sel_hi:[1,0]
  v_pk_mul_f32 v[178:179], v[178:179], v[68:69] op_sel_hi:[1,0]
  v_pk_mul_f32 v[180:181], v[180:181], v[68:69] op_sel_hi:[1,0]
  v_pk_mul_f32 v[182:183], v[182:183], v[68:69] op_sel_hi:[1,0]
  v_cvt_pk_bf16_f32 v176, v176, v177
  v_cvt_pk_bf16_f32 v177, v178, v179
  v_cvt_pk_bf16_f32 v178, v180, v181
  v_cvt_pk_bf16_f32 v179, v182, v183
  v_pk_mul_f32 v[184:185], v[184:185], v[68:69] op_sel_hi:[1,0]
  v_pk_mul_f32 v[186:187], v[186:187], v[68:69] op_sel_hi:[1,0]
  v_pk_mul_f32 v[188:189], v[188:189], v[68:69] op_sel_hi:[1,0]
  v_pk_mul_f32 v[190:191], v[190:191], v[68:69] op_sel_hi:[1,0]
  v_cvt_pk_bf16_f32 v184, v184, v185
  v_cvt_pk_bf16_f32 v185, v186, v187
  v_cvt_pk_bf16_f32 v186, v188, v189
  v_cvt_pk_bf16_f32 v187, v190, v191
  buffer_store_dwordx4 v[160:163], v0, s[16:19], s67 offen offset:2048 sc1
  buffer_store_dwordx4 v[168:171], v5, s[16:19], s67 offen offset:2048 sc1
  buffer_store_dwordx4 v[176:179], v0, s[16:19], s51 offen offset:2048 sc1
  buffer_store_dwordx4 v[184:187], v5, s[16:19], s51 offen offset:2048 sc1
  ds_read_b128 a[96:99], v3 offset:0
  ds_read_b128 a[100:103], v3 offset:1024
  ds_read_b128 a[104:107], v3 offset:2048
  ds_read_b128 a[108:111], v3 offset:3072
  ds_read_b128 a[220:223], v3 offset:7168
  ds_read_b128 a[216:219], v3 offset:6144
  ds_read_b128 a[212:215], v3 offset:5120
  ds_read_b128 a[208:211], v3 offset:4096
  ds_read_b128 a[32:35], v8 offset:0
  ds_read_b128 a[36:39], v8 offset:1024
  ds_read_b128 a[40:43], v8 offset:2048
  ds_read_b128 a[44:47], v8 offset:3072
  ds_read_b128 a[48:51], v8 offset:4096
  ds_read_b128 a[52:55], v8 offset:5120
  ds_read_b128 a[56:59], v8 offset:6144
  ds_read_b128 a[60:63], v8 offset:7168
  v_pk_mul_f32 v[192:193], v[192:193], v[70:71] op_sel_hi:[1,0]
  v_pk_mul_f32 v[194:195], v[194:195], v[70:71] op_sel_hi:[1,0]
  v_pk_mul_f32 v[196:197], v[196:197], v[70:71] op_sel_hi:[1,0]
  v_pk_mul_f32 v[198:199], v[198:199], v[70:71] op_sel_hi:[1,0]
  v_cvt_pk_bf16_f32 v192, v192, v193
  v_cvt_pk_bf16_f32 v193, v194, v195
  v_cvt_pk_bf16_f32 v194, v196, v197
  v_cvt_pk_bf16_f32 v195, v198, v199
  v_pk_mul_f32 v[200:201], v[200:201], v[70:71] op_sel_hi:[1,0]
  v_pk_mul_f32 v[202:203], v[202:203], v[70:71] op_sel_hi:[1,0]
  v_pk_mul_f32 v[204:205], v[204:205], v[70:71] op_sel_hi:[1,0]
  v_pk_mul_f32 v[206:207], v[206:207], v[70:71] op_sel_hi:[1,0]
  v_cvt_pk_bf16_f32 v200, v200, v201
  v_cvt_pk_bf16_f32 v201, v202, v203
  v_cvt_pk_bf16_f32 v202, v204, v205
  v_cvt_pk_bf16_f32 v203, v206, v207
  v_pk_mul_f32 v[208:209], v[208:209], v[70:71] op_sel_hi:[1,0]
  v_pk_mul_f32 v[210:211], v[210:211], v[70:71] op_sel_hi:[1,0]
  v_pk_mul_f32 v[212:213], v[212:213], v[70:71] op_sel_hi:[1,0]
  v_pk_mul_f32 v[214:215], v[214:215], v[70:71] op_sel_hi:[1,0]
  v_cvt_pk_bf16_f32 v208, v208, v209
  v_cvt_pk_bf16_f32 v209, v210, v211
  v_cvt_pk_bf16_f32 v210, v212, v213
  v_cvt_pk_bf16_f32 v211, v214, v215
  v_pk_mul_f32 v[216:217], v[216:217], v[70:71] op_sel_hi:[1,0]
  v_pk_mul_f32 v[218:219], v[218:219], v[70:71] op_sel_hi:[1,0]
  v_pk_mul_f32 v[220:221], v[220:221], v[70:71] op_sel_hi:[1,0]
  v_pk_mul_f32 v[222:223], v[222:223], v[70:71] op_sel_hi:[1,0]
  v_cvt_pk_bf16_f32 v216, v216, v217
  v_cvt_pk_bf16_f32 v217, v218, v219
  v_cvt_pk_bf16_f32 v218, v220, v221
  v_cvt_pk_bf16_f32 v219, v222, v223
  buffer_store_dwordx4 v[192:195], v0, s[16:19], s67 offen offset:3072 sc1
  buffer_store_dwordx4 v[200:203], v5, s[16:19], s67 offen offset:3072 sc1
  buffer_store_dwordx4 v[208:211], v0, s[16:19], s51 offen offset:3072 sc1
  buffer_store_dwordx4 v[216:219], v5, s[16:19], s51 offen offset:3072 sc1
  s_waitcnt lgkmcnt(15)
  s_branch L_it0
L_evt2:
  s_cmp_lg_u32 s48, s50
  s_cbranch_scc1 L_it0
L_tj:
  v_mfma_f32_16x16x32_bf16 v[64:67], a[64:67], a[48:51], 0
  v_cvt_pk_bf16_f32 v59, v86, v87
  v_add_u32 v4, 65536, v2
  v_mfma_f32_16x16x32_bf16 v[64:67], a[68:71], a[52:55], v[64:67]
  v_exp_f32 v94, v94
  v_mfma_f32_16x16x32_bf16 v[64:67], a[72:75], a[56:59], v[64:67]
  v_exp_f32 v95, v95
  v_mfma_f32_16x16x32_bf16 v[64:67], a[76:79], a[60:63], v[64:67]
  v_exp_f32 v88, v88
  v_mfma_f32_16x16x32_bf16 v[68:71], a[92:95], a[60:63], 0
  s_waitcnt lgkmcnt(0)
  v_cvt_pk_bf16_f32 v63, v94, v95
  v_mfma_f32_16x16x32_bf16 v[68:71], a[88:91], a[56:59], v[68:71]
  v_exp_f32 v89, v89
  v_mfma_f32_16x16x32_bf16 v[68:71], a[84:87], a[52:55], v[68:71]
  v_exp_f32 v90, v90
  v_mfma_f32_16x16x32_bf16 v[68:71], a[80:83], a[48:51], v[68:71]
  v_exp_f32 v91, v91
  v_mfma_f32_16x16x32_bf16 v[72:75], a[96:99], a[48:51], 0
  v_exp_f32 v92, v92
  v_mfma_f32_16x16x32_bf16 v[72:75], a[100:103], a[52:55], v[72:75]
  v_exp_f32 v93, v93
  v_mfma_f32_16x16x32_bf16 v[72:75], a[104:107], a[56:59], v[72:75]
  v_cvt_pk_bf16_f32 v60, v88, v89
  v_cvt_pk_bf16_f32 v61, v90, v91
  v_mfma_f32_16x16x32_bf16 v[72:75], a[108:111], a[60:63], v[72:75]
  v_cvt_pk_bf16_f32 v62, v92, v93
  v_add_u32 v7, 65536, v3
  v_mfma_f32_16x16x32_bf16 v[76:79], a[220:223], a[60:63], 0
  v_exp_f32 v64, v64
  v_mfma_f32_16x16x32_bf16 v[76:79], a[216:219], a[56:59], v[76:79]
  v_exp_f32 v65, v65
  v_mfma_f32_16x16x32_bf16 v[76:79], a[212:215], a[52:55], v[76:79]
  v_exp_f32 v66, v66
  v_mfma_f32_16x16x32_bf16 v[76:79], a[208:211], a[48:51], v[76:79]
  v_exp_f32 v67, v67
  v_mfma_f32_16x16x32_bf16 v[192:195], a[144:147], v[56:59], v[192:195]
  ds_read_b128 a[144:147], v4 offset:0
  v_cvt_pk_bf16_f32 v48, v64, v65
  v_mfma_f32_16x16x32_bf16 v[192:195], a[176:179], v[60:63], v[192:195]
  ds_read_b128 a[176:179], v7 offset:0
  v_cvt_pk_bf16_f32 v49, v66, v67
  v_mfma_f32_16x16x32_bf16 v[196:199], a[180:183], v[60:63], v[196:199]
  ds_read_b128 a[180:183], v7 offset:1024
  s_add_u32 m0, s72, 4096
  v_mfma_f32_16x16x32_bf16 v[196:199], a[148:151], v[56:59], v[196:199]
  ds_read_b128 a[148:151], v4 offset:1024
  s_add_u32 s72, s75, 16384
  v_mfma_f32_16x16x32_bf16 v[200:203], a[152:155], v[56:59], v[200:203]
  ds_read_b128 a[152:155], v4 offset:2048
  s_bitcmp1_b32 s78, s48
  v_mfma_f32_16x16x32_bf16 v[200:203], a[184:187], v[60:63], v[200:203]
  ds_read_b128 a[184:187], v7 offset:2048
  s_cselect_b32 s71, 32768, s61
  v_mfma_f32_16x16x32_bf16 v[204:207], a[188:191], v[60:63], v[204:207]
  ds_read_b128 a[188:191], v7 offset:3072
  s_cselect_b32 s72, s72, 163840
  v_mfma_f32_16x16x32_bf16 v[204:207], a[156:159], v[56:59], v[204:207]
  ds_read_b128 a[156:159], v4 offset:3072
  v_mfma_f32_16x16x32_bf16 v[208:211], a[160:163], v[56:59], v[208:211]
  ds_read_b128 a[160:163], v4 offset:4096
  v_mfma_f32_16x16x32_bf16 v[208:211], a[192:195], v[60:63], v[208:211]
  ds_read_b128 a[192:195], v7 offset:4096
  v_mfma_f32_16x16x32_bf16 v[212:215], a[196:199], v[60:63], v[212:215]
  ds_read_b128 a[196:199], v7 offset:5120
  v_mfma_f32_16x16x32_bf16 v[212:215], a[164:167], v[56:59], v[212:215]
  ds_read_b128 a[164:167], v4 offset:5120
  v_mfma_f32_16x16x32_bf16 v[216:219], a[168:171], v[56:59], v[216:219]
  ds_read_b128 a[168:171], v4 offset:6144
  v_mfma_f32_16x16x32_bf16 v[216:219], a[200:203], v[60:63], v[216:219]
  ds_read_b128 a[200:203], v7 offset:6144
  v_mfma_f32_16x16x32_bf16 v[220:223], a[204:207], v[60:63], v[220:223]
  ds_read_b128 a[204:207], v7 offset:7168
  s_waitcnt lgkmcnt(10)
  v_mfma_f32_16x16x32_bf16 v[220:223], a[172:175], v[56:59], v[220:223]
  ds_read_b128 a[172:175], v4 offset:7168
  v_smfmac_f32_16x16x64_bf16 v[44:47], v[12:15], v[56:63], v10
  v_mfma_f32_16x16x32_bf16 v[80:83], a[64:67], a[32:35], 0
  v_exp_f32 v68, v68
  v_mfma_f32_16x16x32_bf16 v[80:83], a[68:71], a[36:39], v[80:83]
  v_exp_f32 v69, v69
  v_mfma_f32_16x16x32_bf16 v[80:83], a[72:75], a[40:43], v[80:83]
  v_exp_f32 v70, v70
  v_mfma_f32_16x16x32_bf16 v[80:83], a[76:79], a[44:47], v[80:83]
  v_exp_f32 v71, v71
  v_mfma_f32_16x16x32_bf16 v[84:87], a[92:95], a[44:47], 0
  v_cvt_pk_bf16_f32 v50, v68, v69
  v_cvt_pk_bf16_f32 v51, v70, v71
  v_mfma_f32_16x16x32_bf16 v[84:87], a[88:91], a[40:43], v[84:87]
  v_exp_f32 v72, v72
  v_mfma_f32_16x16x32_bf16 v[84:87], a[84:87], a[36:39], v[84:87]
  v_exp_f32 v73, v73
  v_mfma_f32_16x16x32_bf16 v[84:87], a[80:83], a[32:35], v[84:87]
  v_exp_f32 v74, v74
  v_mfma_f32_16x16x32_bf16 v[88:91], a[96:99], a[32:35], 0
  v_exp_f32 v75, v75
  v_mfma_f32_16x16x32_bf16 v[88:91], a[100:103], a[36:39], v[88:91]
  v_exp_f32 v76, v76
  v_mfma_f32_16x16x32_bf16 v[88:91], a[104:107], a[40:43], v[88:91]
  v_exp_f32 v77, v77
  v_mfma_f32_16x16x32_bf16 v[88:91], a[108:111], a[44:47], v[88:91]
  v_exp_f32 v78, v78
  v_mfma_f32_16x16x32_bf16 v[92:95], a[220:223], a[44:47], 0
  v_exp_f32 v79, v79
  v_mfma_f32_16x16x32_bf16 v[92:95], a[216:219], a[40:43], v[92:95]
  v_cvt_pk_bf16_f32 v52, v72, v73
  v_cvt_pk_bf16_f32 v53, v74, v75
  v_mfma_f32_16x16x32_bf16 v[92:95], a[212:215], a[36:39], v[92:95]
  v_cvt_pk_bf16_f32 v54, v76, v77
  v_cvt_pk_bf16_f32 v55, v78, v79
  v_mfma_f32_16x16x32_bf16 v[92:95], a[208:211], a[32:35], v[92:95]
  buffer_load_dword v30, off, s[16:19], s97 sc1
  v_mfma_f32_16x16x32_bf16 v[192:195], a[144:147], v[48:51], v[192:195]
  buffer_load_dwordx4 v5, s[8:11], s57 offen offset:0 sc1 lds
  v_mfma_f32_16x16x32_bf16 v[192:195], a[176:179], v[52:55], v[192:195]
  v_exp_f32 v80, v80
  v_mfma_f32_16x16x32_bf16 v[196:199], a[180:183], v[52:55], v[196:199]
  v_exp_f32 v81, v81
  v_mfma_f32_16x16x32_bf16 v[196:199], a[148:151], v[48:51], v[196:199]
  buffer_load_dwordx4 v5, s[8:11], s57 offen offset:1024 sc1 lds
  v_mfma_f32_16x16x32_bf16 v[200:203], a[152:155], v[48:51], v[200:203]
  s_waitcnt lgkmcnt(0)
  s_barrier
  v_mfma_f32_16x16x32_bf16 v[200:203], a[184:187], v[52:55], v[200:203]
  s_waitcnt vmcnt(2)
  v_cvt_pk_bf16_f32 v56, v80, v81
  v_mfma_f32_16x16x32_bf16 v[204:207], a[188:191], v[52:55], v[204:207]
  v_exp_f32 v82, v82
  v_mfma_f32_16x16x32_bf16 v[204:207], a[156:159], v[48:51], v[204:207]
  v_exp_f32 v83, v83
  v_mfma_f32_16x16x32_bf16 v[208:211], a[160:163], v[48:51], v[208:211]
  v_exp_f32 v84, v84
  v_mfma_f32_16x16x32_bf16 v[208:211], a[192:195], v[52:55], v[208:211]
  v_exp_f32 v85, v85
  v_mfma_f32_16x16x32_bf16 v[212:215], a[196:199], v[52:55], v[212:215]
  v_exp_f32 v86, v86
  v_mfma_f32_16x16x32_bf16 v[212:215], a[164:167], v[48:51], v[212:215]
  v_exp_f32 v87, v87
  v_mfma_f32_16x16x32_bf16 v[216:219], a[168:171], v[48:51], v[216:219]
  v_cvt_pk_bf16_f32 v57, v82, v83
  v_cvt_pk_bf16_f32 v58, v84, v85
  v_mfma_f32_16x16x32_bf16 v[216:219], a[200:203], v[52:55], v[216:219]
  v_cvt_pk_bf16_f32 v59, v86, v87
  v_cmp_eq_u32 vcc, 0, v30
  v_mfma_f32_16x16x32_bf16 v[220:223], a[204:207], v[52:55], v[220:223]
  v_exp_f32 v88, v88
  v_mfma_f32_16x16x32_bf16 v[220:223], a[172:175], v[48:51], v[220:223]
  v_exp_f32 v89, v89
  v_smfmac_f32_16x16x64_bf16 v[44:47], v[12:15], v[48:55], v10
  v_cvt_pk_bf16_f32 v60, v88, v89
  v_mfma_f32_16x16x32_bf16 v[64:67], a[64:67], a[16:19], 0
  v_exp_f32 v90, v90
  v_mfma_f32_16x16x32_bf16 v[64:67], a[68:71], a[20:23], v[64:67]
  v_exp_f32 v91, v91
  v_mfma_f32_16x16x32_bf16 v[64:67], a[72:75], a[24:27], v[64:67]
  v_exp_f32 v92, v92
  v_mfma_f32_16x16x32_bf16 v[64:67], a[76:79], a[28:31], v[64:67]
  v_exp_f32 v93, v93
  v_mfma_f32_16x16x32_bf16 v[68:71], a[92:95], a[28:31], 0
  v_exp_f32 v94, v94
  v_mfma_f32_16x16x32_bf16 v[68:71], a[88:91], a[24:27], v[68:71]
  v_exp_f32 v95, v95
  v_mfma_f32_16x16x32_bf16 v[68:71], a[84:87], a[20:23], v[68:71]
  buffer_load_dwordx4 v5, s[8:11], s57 offen offset:2048 sc1 lds
  v_mfma_f32_16x16x32_bf16 v[68:71], a[80:83], a[16:19], v[68:71]
  v_cvt_pk_bf16_f32 v61, v90, v91
  v_cvt_pk_bf16_f32 v62, v92, v93
  v_mfma_f32_16x16x32_bf16 v[72:75], a[96:99], a[16:19], v[16:19]
  v_cvt_pk_bf16_f32 v63, v94, v95
  v_mfma_f32_16x16x32_bf16 v[72:75], a[100:103], a[20:23], v[72:75]
  buffer_load_dwordx4 v5, s[8:11], s57 offen offset:3072 sc1 lds
  v_mfma_f32_16x16x32_bf16 v[72:75], a[104:107], a[24:27], v[72:75]
  s_cselect_b32 s57, s61, 2146435072
  s_add_u32 s57, s57, s56
  v_mfma_f32_16x16x32_bf16 v[72:75], a[108:111], a[28:31], v[72:75]
  s_cbranch_vccnz L_gt_16
L_gtback_17:
  s_mov_b32 m0, s75
  v_mfma_f32_16x16x32_bf16 v[76:79], a[220:223], a[28:31], v[20:23]
  buffer_load_dword v24, v6, s[16:19], s65 offen offset:0 sc1
  v_mfma_f32_16x16x32_bf16 v[76:79], a[216:219], a[24:27], v[76:79]
  buffer_load_dword v25, v6, s[16:19], s65 offen offset:128 sc1
  v_mfma_f32_16x16x32_bf16 v[76:79], a[212:215], a[20:23], v[76:79]
  buffer_load_dword v26, v6, s[16:19], s65 offen offset:256 sc1
  v_mfma_f32_16x16x32_bf16 v[76:79], a[208:211], a[16:19], v[76:79]
  buffer_load_dword v27, v6, s[16:19], s65 offen offset:384 sc1
  v_mfma_f32_16x16x32_bf16 v[160:163], a[144:147], v[56:59], v[160:163]
  buffer_load_dwordx4 v0, s[8:11], s56 offen offset:0 sc1 lds
  v_mfma_f32_16x16x32_bf16 v[160:163], a[176:179], v[60:63], v[160:163]
  v_exp_f32 v64, v64
  v_mfma_f32_16x16x32_bf16 v[164:167], a[180:183], v[60:63], v[164:167]
  v_exp_f32 v65, v65
  v_mfma_f32_16x16x32_bf16 v[164:167], a[148:151], v[56:59], v[164:167]
  buffer_load_dwordx4 v0, s[8:11], s56 offen offset:1024 sc1 lds
  v_mfma_f32_16x16x32_bf16 v[168:171], a[152:155], v[56:59], v[168:171]
  v_exp_f32 v66, v66
  v_mfma_f32_16x16x32_bf16 v[168:171], a[184:187], v[60:63], v[168:171]
  v_exp_f32 v67, v67
  v_mfma_f32_16x16x32_bf16 v[172:175], a[188:191], v[60:63], v[172:175]
  buffer_load_dwordx4 v0, s[8:11], s56 offen offset:2048 sc1 lds
  v_mfma_f32_16x16x32_bf16 v[172:175], a[156:159], v[56:59], v[172:175]
  v_exp_f32 v68, v68
  v_mfma_f32_16x16x32_bf16 v[176:179], a[160:163], v[56:59], v[176:179]
  s_barrier
  v_mfma_f32_16x16x32_bf16 v[176:179], a[192:195], v[60:63], v[176:179]
  buffer_load_dwordx4 v0, s[8:11], s56 offen offset:3072 sc1 lds
  v_mfma_f32_16x16x32_bf16 v[180:183], a[196:199], v[60:63], v[180:183]
  s_add_u32 m0, m0, 4096
  v_cvt_pk_bf16_f32 v48, v64, v65
  v_mfma_f32_16x16x32_bf16 v[180:183], a[164:167], v[56:59], v[180:183]
  v_exp_f32 v69, v69
  v_mfma_f32_16x16x32_bf16 v[184:187], a[168:171], v[56:59], v[184:187]
  buffer_load_dwordx4 v5, s[8:11], s56 offen offset:0 sc1 lds
  v_mfma_f32_16x16x32_bf16 v[184:187], a[200:203], v[60:63], v[184:187]
  v_exp_f32 v70, v70
  v_mfma_f32_16x16x32_bf16 v[188:191], a[204:207], v[60:63], v[188:191]
  v_exp_f32 v71, v71
  v_mfma_f32_16x16x32_bf16 v[188:191], a[172:175], v[56:59], v[188:191]
  buffer_load_dwordx4 v5, s[8:11], s56 offen offset:1024 sc1 lds
  v_smfmac_f32_16x16x64_bf16 v[40:43], v[12:15], v[56:63], v10
  v_cvt_pk_bf16_f32 v49, v66, v67
  v_mfma_f32_16x16x32_bf16 v[80:83], a[64:67], a[0:3], v[16:19]
  v_cvt_pk_bf16_f32 v50, v68, v69
  v_cvt_pk_bf16_f32 v51, v70, v71
  v_mfma_f32_16x16x32_bf16 v[80:83], a[68:71], a[4:7], v[80:83]
  v_exp_f32 v72, v72
  v_mfma_f32_16x16x32_bf16 v[80:83], a[72:75], a[8:11], v[80:83]
  v_exp_f32 v73, v73
  v_mfma_f32_16x16x32_bf16 v[80:83], a[76:79], a[12:15], v[80:83]
  v_exp_f32 v74, v74
  v_mfma_f32_16x16x32_bf16 v[84:87], a[92:95], a[12:15], v[20:23]
  v_exp_f32 v75, v75
  v_mfma_f32_16x16x32_bf16 v[84:87], a[88:91], a[8:11], v[84:87]
  v_exp_f32 v76, v76
  v_mfma_f32_16x16x32_bf16 v[84:87], a[84:87], a[4:7], v[84:87]
  v_exp_f32 v77, v77
  v_mfma_f32_16x16x32_bf16 v[84:87], a[80:83], a[0:3], v[84:87]
  v_exp_f32 v78, v78
  v_mfma_f32_16x16x32_bf16 v[128:131], a[144:147], v[48:51], v[128:131]
  v_exp_f32 v79, v79
  v_cvt_pk_bf16_f32 v52, v72, v73
  v_cvt_pk_bf16_f32 v53, v74, v75
  v_cvt_pk_bf16_f32 v54, v76, v77
  v_cvt_pk_bf16_f32 v55, v78, v79
  buffer_load_dwordx4 v5, s[8:11], s56 offen offset:2048 sc1 lds
  v_exp_f32 v80, v80
  v_mfma_f32_16x16x32_bf16 v[128:131], a[176:179], v[52:55], v[128:131]
  v_exp_f32 v81, v81
  v_mfma_f32_16x16x32_bf16 v[132:135], a[180:183], v[52:55], v[132:135]
  v_exp_f32 v82, v82
  v_mfma_f32_16x16x32_bf16 v[132:135], a[148:151], v[48:51], v[132:135]
  buffer_load_dwordx4 v5, s[8:11], s56 offen offset:3072 sc1 lds
  v_mfma_f32_16x16x32_bf16 v[136:139], a[152:155], v[48:51], v[136:139]
  s_add_u32 s56, s56, s71
  s_add_u32 s75, s75, s71
  v_mfma_f32_16x16x32_bf16 v[136:139], a[184:187], v[52:55], v[136:139]
  s_add_u32 s70, s70, s55
  s_and_b32 s70, s70, 0xffff
  v_mfma_f32_16x16x32_bf16 v[140:143], a[188:191], v[52:55], v[140:143]
  v_add_u32 v2, s70, v9
  s_add_u32 s48, s48, 1
  v_mfma_f32_16x16x32_bf16 v[140:143], a[156:159], v[48:51], v[140:143]
  ds_read_b128 a[64:67], v2 offset:0
  s_cmp_ge_u32 s48, s79
  v_mfma_f32_16x16x32_bf16 v[144:147], a[160:163], v[48:51], v[144:147]
  ds_read_b128 a[68:71], v2 offset:1024
  s_cselect_b32 s62, s96, 8192
  v_mfma_f32_16x16x32_bf16 v[144:147], a[192:195], v[52:55], v[144:147]
  ds_read_b128 a[72:75], v2 offset:2048
  v_add_u32 v3, s62, v2
  v_mfma_f32_16x16x32_bf16 v[148:151], a[196:199], v[52:55], v[148:151]
  ds_read_b128 a[76:79], v2 offset:3072
  v_cvt_pk_bf16_f32 v56, v80, v81
  v_mfma_f32_16x16x32_bf16 v[148:151], a[164:167], v[48:51], v[148:151]
  ds_read_b128 a[92:95], v2 offset:7168
  v_add_u32 v4, 65536, v2
  v_mfma_f32_16x16x32_bf16 v[152:155], a[168:171], v[48:51], v[152:155]
  ds_read_b128 a[88:91], v2 offset:6144
  v_add_u32 v7, 65536, v3
  v_mfma_f32_16x16x32_bf16 v[152:155], a[200:203], v[52:55], v[152:155]
  ds_read_b128 a[84:87], v2 offset:5120
  s_pack_lh_b32_b16 s75, s75, s59
  v_mfma_f32_16x16x32_bf16 v[156:159], a[204:207], v[52:55], v[156:159]
  ds_read_b128 a[80:83], v2 offset:4096
  s_mov_b32 m0, s75
  v_mfma_f32_16x16x32_bf16 v[156:159], a[172:175], v[48:51], v[156:159]
  ds_read_b128 a[96:99], v3 offset:0
  s_cselect_b32 s55, 32768, s61
  v_smfmac_f32_16x16x64_bf16 v[36:39], v[12:15], v[48:55], v10
  ds_read_b128 a[100:103], v3 offset:1024
  v_exp_f32 v83, v83
  ds_read_b128 a[104:107], v3 offset:2048
  v_exp_f32 v84, v84
  ds_read_b128 a[108:111], v3 offset:3072
  v_exp_f32 v85, v85
  v_exp_f32 v86, v86
  v_exp_f32 v87, v87
  ds_read_b128 a[220:223], v3 offset:7168
  v_cvt_pk_bf16_f32 v57, v82, v83
  v_cvt_pk_bf16_f32 v58, v84, v85
  ds_read_b128 a[216:219], v3 offset:6144
  v_cvt_pk_bf16_f32 v59, v86, v87
  s_add_u32 s72, s75, 16384
  ds_read_b128 a[212:215], v3 offset:5120
  v_mfma_f32_16x16x32_bf16 v[96:99], a[144:147], v[56:59], v[96:99]
  ds_read_b128 a[208:211], v3 offset:4096
  s_waitcnt lgkmcnt(15)
  v_mfma_f32_16x16x32_bf16 v[100:103], a[148:151], v[56:59], v[100:103]
  ds_read_b128 a[144:147], v4 offset:0
  s_bitcmp1_b32 s78, s48
  v_mfma_f32_16x16x32_bf16 v[104:107], a[152:155], v[56:59], v[104:107]
  ds_read_b128 a[176:179], v7 offset:0
  s_cselect_b32 s71, 32768, s61
  v_mfma_f32_16x16x32_bf16 v[108:111], a[156:159], v[56:59], v[108:111]
  ds_read_b128 a[180:183], v7 offset:1024
  s_cselect_b32 s72, s72, 163840
  v_mfma_f32_16x16x32_bf16 v[112:115], a[160:163], v[56:59], v[112:115]
  ds_read_b128 a[148:151], v4 offset:1024
  s_cselect_b32 s57, s61, 2146435072
  v_mfma_f32_16x16x32_bf16 v[116:119], a[164:167], v[56:59], v[116:119]
  ds_read_b128 a[152:155], v4 offset:2048
  s_add_u32 s57, s57, s56
  v_mfma_f32_16x16x32_bf16 v[120:123], a[168:171], v[56:59], v[120:123]
  ds_read_b128 a[184:187], v7 offset:2048
  s_add_u32 s70, s70, s55
  v_mfma_f32_16x16x32_bf16 v[124:127], a[172:175], v[56:59], v[124:127]
  ds_read_b128 a[188:191], v7 offset:3072
  s_and_b32 s70, s70, 0xffff
  v_mfma_f32_16x16x32_bf16 v[32:35], a[228:231], v[56:59], v[32:35]
  ds_read_b128 a[156:159], v4 offset:3072
  s_add_u32 s48, s48, 1
  v_mfma_f32_16x16x32_bf16 v[64:67], a[64:67], a[48:51], 0
  ds_read_b128 a[160:163], v4 offset:4096
  s_waitcnt lgkmcnt(9)
  v_mfma_f32_16x16x32_bf16 v[64:67], a[68:71], a[52:55], v[64:67]
  ds_read_b128 a[192:195], v7 offset:4096
  s_cmp_ge_u32 s48, s79
  v_mfma_f32_16x16x32_bf16 v[64:67], a[72:75], a[56:59], v[64:67]
  ds_read_b128 a[196:199], v7 offset:5120
  v_add_u32 v9, 8192, v9
  v_mfma_f32_16x16x32_bf16 v[64:67], a[76:79], a[60:63], v[64:67]
  ds_read_b128 a[164:167], v4 offset:5120
  s_cselect_b32 s62, s96, 8192
  v_mfma_f32_16x16x32_bf16 v[68:71], a[92:95], a[60:63], 0
  ds_read_b128 a[168:171], v4 offset:6144
  v_add_u32 v2, s70, v9
  v_mfma_f32_16x16x32_bf16 v[68:71], a[88:91], a[56:59], v[68:71]
  ds_read_b128 a[200:203], v7 offset:6144
  s_cselect_b32 s55, 32768, s61
  v_mfma_f32_16x16x32_bf16 v[68:71], a[84:87], a[52:55], v[68:71]
  ds_read_b128 a[204:207], v7 offset:7168
  v_add_u32 v3, s62, v2
  v_mfma_f32_16x16x32_bf16 v[68:71], a[80:83], a[48:51], v[68:71]
  ds_read_b128 a[172:175], v4 offset:7168
  s_add_u32 s51, s67, 8192
  v_mfma_f32_16x16x32_bf16 v[72:75], a[96:99], a[48:51], v[16:19]
  v_exp_f32 v64, v64
  v_mfma_f32_16x16x32_bf16 v[72:75], a[100:103], a[52:55], v[72:75]
  v_exp_f32 v65, v65
  v_mfma_f32_16x16x32_bf16 v[72:75], a[104:107], a[56:59], v[72:75]
  v_exp_f32 v66, v66
  v_mfma_f32_16x16x32_bf16 v[72:75], a[108:111], a[60:63], v[72:75]
  v_exp_f32 v67, v67
  v_mfma_f32_16x16x32_bf16 v[76:79], a[220:223], a[60:63], v[20:23]
  v_exp_f32 v68, v68
  v_mfma_f32_16x16x32_bf16 v[76:79], a[216:219], a[56:59], v[76:79]
  v_exp_f32 v69, v69
  v_mfma_f32_16x16x32_bf16 v[76:79], a[212:215], a[52:55], v[76:79]
  v_exp_f32 v70, v70
  v_mfma_f32_16x16x32_bf16 v[76:79], a[208:211], a[48:51], v[76:79]
  v_exp_f32 v71, v71
  v_mfma_f32_16x16x32_bf16 v[88:91], a[64:67], a[32:35], v[16:19]
  v_exp_f32 v72, v72
  v_mfma_f32_16x16x32_bf16 v[88:91], a[68:71], a[36:39], v[88:91]
  v_exp_f32 v73, v73
  v_mfma_f32_16x16x32_bf16 v[88:91], a[72:75], a[40:43], v[88:91]
  v_exp_f32 v74, v74
  v_mfma_f32_16x16x32_bf16 v[88:91], a[76:79], a[44:47], v[88:91]
  v_exp_f32 v75, v75
  v_mfma_f32_16x16x32_bf16 v[92:95], a[92:95], a[44:47], v[20:23]
  v_exp_f32 v76, v76
  v_mfma_f32_16x16x32_bf16 v[92:95], a[88:91], a[40:43], v[92:95]
  v_exp_f32 v77, v77
  v_mfma_f32_16x16x32_bf16 v[92:95], a[84:87], a[36:39], v[92:95]
  v_exp_f32 v78, v78
  v_mfma_f32_16x16x32_bf16 v[92:95], a[80:83], a[32:35], v[92:95]
  v_exp_f32 v79, v79
  v_cvt_pk_bf16_f32 v48, v64, v65
  v_cvt_pk_bf16_f32 v49, v66, v67
  v_cvt_pk_bf16_f32 v50, v68, v69
  v_cvt_pk_bf16_f32 v51, v70, v71
  v_cvt_pk_bf16_f32 v52, v72, v73
  v_cvt_pk_bf16_f32 v53, v74, v75
  v_cvt_pk_bf16_f32 v54, v76, v77
  v_cvt_pk_bf16_f32 v55, v78, v79
  s_waitcnt lgkmcnt(15)
  v_mfma_f32_16x16x32_bf16 v[192:195], a[144:147], v[48:51], v[192:195]
  s_waitcnt lgkmcnt(0)
  v_add_f32 v32, v32, v33
  v_mfma_f32_16x16x32_bf16 v[192:195], a[176:179], v[52:55], v[192:195]
  v_exp_f32 v94, v94
  v_mfma_f32_16x16x32_bf16 v[196:199], a[180:183], v[52:55], v[196:199]
  v_exp_f32 v95, v95
  v_mfma_f32_16x16x32_bf16 v[196:199], a[148:151], v[48:51], v[196:199]
  v_exp_f32 v88, v88
  v_mfma_f32_16x16x32_bf16 v[200:203], a[152:155], v[48:51], v[200:203]
  v_exp_f32 v89, v89
  v_mfma_f32_16x16x32_bf16 v[200:203], a[184:187], v[52:55], v[200:203]
  v_exp_f32 v90, v90
  v_mfma_f32_16x16x32_bf16 v[204:207], a[188:191], v[52:55], v[204:207]
  v_exp_f32 v91, v91
  v_mfma_f32_16x16x32_bf16 v[204:207], a[156:159], v[48:51], v[204:207]
  v_exp_f32 v92, v92
  v_mfma_f32_16x16x32_bf16 v[208:211], a[160:163], v[48:51], v[208:211]
  v_exp_f32 v93, v93
  v_mfma_f32_16x16x32_bf16 v[208:211], a[192:195], v[52:55], v[208:211]
  v_cvt_pk_bf16_f32 v60, v88, v89
  v_cvt_pk_bf16_f32 v61, v90, v91
  v_mfma_f32_16x16x32_bf16 v[212:215], a[196:199], v[52:55], v[212:215]
  v_cvt_pk_bf16_f32 v62, v92, v93
  v_cvt_pk_bf16_f32 v63, v94, v95
  v_mfma_f32_16x16x32_bf16 v[212:215], a[164:167], v[48:51], v[212:215]
  v_add_f32 v36, v36, v37
  v_mfma_f32_16x16x32_bf16 v[216:219], a[168:171], v[48:51], v[216:219]
  v_mfma_f32_16x16x32_bf16 v[216:219], a[200:203], v[52:55], v[216:219]
  v_mfma_f32_16x16x32_bf16 v[220:223], a[204:207], v[52:55], v[220:223]
  v_mfma_f32_16x16x32_bf16 v[220:223], a[172:175], v[48:51], v[220:223]
  s_barrier
  v_smfmac_f32_16x16x64_bf16 v[44:47], v[12:15], v[48:55], v10
  v_mfma_f32_16x16x32_bf16 v[160:163], a[144:147], v[60:63], v[160:163]
  buffer_load_dwordx4 v0, s[8:11], s56 offen offset:0 sc1 lds
  v_mfma_f32_16x16x32_bf16 v[164:167], a[148:151], v[60:63], v[164:167]
  v_mfma_f32_16x16x32_bf16 v[168:171], a[152:155], v[60:63], v[168:171]
  v_mfma_f32_16x16x32_bf16 v[172:175], a[156:159], v[60:63], v[172:175]
  buffer_load_dwordx4 v0, s[8:11], s56 offen offset:1024 sc1 lds
  v_mfma_f32_16x16x32_bf16 v[176:179], a[160:163], v[60:63], v[176:179]
  v_mfma_f32_16x16x32_bf16 v[180:183], a[164:167], v[60:63], v[180:183]
  v_mfma_f32_16x16x32_bf16 v[184:187], a[168:171], v[60:63], v[184:187]
  buffer_load_dwordx4 v0, s[8:11], s56 offen offset:2048 sc1 lds
  v_mfma_f32_16x16x32_bf16 v[188:191], a[172:175], v[60:63], v[188:191]
  v_mfma_f32_16x16x32_bf16 v[40:43], a[228:231], v[60:63], v[40:43]
  v_add_f32 v44, v44, v45
  buffer_load_dwordx4 v0, s[8:11], s56 offen offset:3072 sc1 lds
  s_nop 0
  s_nop 0
  s_nop 0
  s_nop 0
  s_nop 0
  s_nop 0
  v_add_f32 v40, v40, v41
  v_med3_f32 v64, v32, v11, s99
  v_med3_f32 v65, v36, v11, s99
  v_med3_f32 v66, v40, v11, s99
  v_med3_f32 v67, v44, v11, s99
  v_cmp_neq_f32 vcc, v32, v64
  v_cmp_neq_f32 s[4:5], v36, v65
  s_or_b64 vcc, s[4:5], vcc
  v_cmp_neq_f32 s[4:5], v40, v66
  s_or_b64 vcc, s[4:5], vcc
  v_cmp_neq_f32 s[4:5], v44, v67
  s_or_b64 vcc, s[4:5], vcc
  s_cbranch_vccnz L_slowj0
L_slowj0back:
  ds_read_b128 a[0:3], v8 offset:8192
  ds_read_b128 a[4:7], v8 offset:9216
  ds_read_b128 a[8:11], v8 offset:10240
  ds_read_b128 a[12:15], v8 offset:11264
  ds_read_b128 a[16:19], v8 offset:12288
  ds_read_b128 a[20:23], v8 offset:13312
  ds_read_b128 a[24:27], v8 offset:14336
  ds_read_b128 a[28:31], v8 offset:15360
  v_rcp_f32 v64, v32
  v_rcp_f32 v66, v36
  v_rcp_f32 v68, v40
  v_rcp_f32 v70, v44
  s_waitcnt vmcnt(12)
  v_mul_f32 v64, v64, v24
  v_mul_f32 v66, v66, v25
  v_mul_f32 v68, v68, v26
  v_mul_f32 v70, v70, v27
  v_pk_mul_f32 v[96:97], v[96:97], v[64:65] op_sel_hi:[1,0]
  v_pk_mul_f32 v[98:99], v[98:99], v[64:65] op_sel_hi:[1,0]
  v_pk_mul_f32 v[100:101], v[100:101], v[64:65] op_sel_hi:[1,0]
  v_pk_mul_f32 v[102:103], v[102:103], v[64:65] op_sel_hi:[1,0]
  v_cvt_pk_bf16_f32 v96, v96, v97
  v_cvt_pk_bf16_f32 v97, v98, v99
  v_cvt_pk_bf16_f32 v98, v100, v101
  v_cvt_pk_bf16_f32 v99, v102, v103
  v_pk_mul_f32 v[104:105], v[104:105], v[64:65] op_sel_hi:[1,0]
  v_pk_mul_f32 v[106:107], v[106:107], v[64:65] op_sel_hi:[1,0]
  v_pk_mul_f32 v[108:109], v[108:109], v[64:65] op_sel_hi:[1,0]
  v_pk_mul_f32 v[110:111], v[110:111], v[64:65] op_sel_hi:[1,0]
  v_cvt_pk_bf16_f32 v104, v104, v105
  v_cvt_pk_bf16_f32 v105, v106, v107
  v_cvt_pk_bf16_f32 v106, v108, v109
  v_cvt_pk_bf16_f32 v107, v110, v111
  v_pk_mul_f32 v[112:113], v[112:113], v[64:65] op_sel_hi:[1,0]
  v_pk_mul_f32 v[114:115], v[114:115], v[64:65] op_sel_hi:[1,0]
  v_pk_mul_f32 v[116:117], v[116:117], v[64:65] op_sel_hi:[1,0]
  v_pk_mul_f32 v[118:119], v[118:119], v[64:65] op_sel_hi:[1,0]
  v_cvt_pk_bf16_f32 v112, v112, v113
  v_cvt_pk_bf16_f32 v113, v114, v115
  v_cvt_pk_bf16_f32 v114, v116, v117
  v_cvt_pk_bf16_f32 v115, v118, v119
  v_pk_mul_f32 v[120:121], v[120:121], v[64:65] op_sel_hi:[1,0]
  v_pk_mul_f32 v[122:123], v[122:123], v[64:65] op_sel_hi:[1,0]
  v_pk_mul_f32 v[124:125], v[124:125], v[64:65] op_sel_hi:[1,0]
  v_pk_mul_f32 v[126:127], v[126:127], v[64:65] op_sel_hi:[1,0]
  v_cvt_pk_bf16_f32 v120, v120, v121
  v_cvt_pk_bf16_f32 v121, v122, v123
  v_cvt_pk_bf16_f32 v122, v124, v125
  v_cvt_pk_bf16_f32 v123, v126, v127
  s_add_u32 m0, m0, 4096
  buffer_store_dwordx4 v[96:99], v0, s[16:19], s67 offen offset:0 sc1
  buffer_store_dwordx4 v[104:107], v5, s[16:19], s67 offen offset:0 sc1
  buffer_store_dwordx4 v[112:115], v0, s[16:19], s51 offen offset:0 sc1
  buffer_store_dwordx4 v[120:123], v5, s[16:19], s51 offen offset:0 sc1
  buffer_load_dwordx4 v5, s[8:11], s56 offen offset:0 sc1 lds
  buffer_load_dwordx4 v5, s[8:11], s56 offen offset:1024 sc1 lds
  buffer_load_dwordx4 v5, s[8:11], s56 offen offset:2048 sc1 lds
  buffer_load_dwordx4 v5, s[8:11], s56 offen offset:3072 sc1 lds
  v_pk_mul_f32 v[128:129], v[128:129], v[66:67] op_sel_hi:[1,0]
  v_pk_mul_f32 v[130:131], v[130:131], v[66:67] op_sel_hi:[1,0]
  v_pk_mul_f32 v[132:133], v[132:133], v[66:67] op_sel_hi:[1,0]
  v_pk_mul_f32 v[134:135], v[134:135], v[66:67] op_sel_hi:[1,0]
  v_cvt_pk_bf16_f32 v128, v128, v129
  v_cvt_pk_bf16_f32 v129, v130, v131
  v_cvt_pk_bf16_f32 v130, v132, v133
  v_cvt_pk_bf16_f32 v131, v134, v135
  v_pk_mul_f32 v[136:137], v[136:137], v[66:67] op_sel_hi:[1,0]
  v_pk_mul_f32 v[138:139], v[138:139], v[66:67] op_sel_hi:[1,0]
  v_pk_mul_f32 v[140:141], v[140:141], v[66:67] op_sel_hi:[1,0]
  v_pk_mul_f32 v[142:143], v[142:143], v[66:67] op_sel_hi:[1,0]
  v_cvt_pk_bf16_f32 v136, v136, v137
  v_cvt_pk_bf16_f32 v137, v138, v139
  v_cvt_pk_bf16_f32 v138, v140, v141
  v_cvt_pk_bf16_f32 v139, v142, v143
  v_pk_mul_f32 v[144:145], v[144:145], v[66:67] op_sel_hi:[1,0]
  v_pk_mul_f32 v[146:147], v[146:147], v[66:67] op_sel_hi:[1,0]
  v_pk_mul_f32 v[148:149], v[148:149], v[66:67] op_sel_hi:[1,0]
  v_pk_mul_f32 v[150:151], v[150:151], v[66:67] op_sel_hi:[1,0]
  v_cvt_pk_bf16_f32 v144, v144, v145
  v_cvt_pk_bf16_f32 v145, v146, v147
  v_cvt_pk_bf16_f32 v146, v148, v149
  v_cvt_pk_bf16_f32 v147, v150, v151
  v_pk_mul_f32 v[152:153], v[152:153], v[66:67] op_sel_hi:[1,0]
  v_pk_mul_f32 v[154:155], v[154:155], v[66:67] op_sel_hi:[1,0]
  v_pk_mul_f32 v[156:157], v[156:157], v[66:67] op_sel_hi:[1,0]
  v_pk_mul_f32 v[158:159], v[158:159], v[66:67] op_sel_hi:[1,0]
  v_cvt_pk_bf16_f32 v152, v152, v153
  v_cvt_pk_bf16_f32 v153, v154, v155
  v_cvt_pk_bf16_f32 v154, v156, v157
  v_cvt_pk_bf16_f32 v155, v158, v159
  s_barrier
  ds_read_b128 a[64:67], v2 offset:0
  ds_read_b128 a[68:71], v2 offset:1024
  ds_read_b128 a[72:75], v2 offset:2048
  ds_read_b128 a[76:79], v2 offset:3072
  ds_read_b128 a[92:95], v2 offset:7168
  ds_read_b128 a[88:91], v2 offset:6144
  ds_read_b128 a[84:87], v2 offset:5120
  ds_read_b128 a[80:83], v2 offset:4096
  buffer_store_dwordx4 v[128:131], v0, s[16:19], s67 offen offset:1024 sc1
  buffer_store_dwordx4 v[136:139], v5, s[16:19], s67 offen offset:1024 sc1
  buffer_store_dwordx4 v[144:147], v0, s[16:19], s51 offen offset:1024 sc1
  buffer_store_dwordx4 v[152:155], v5, s[16:19], s51 offen offset:1024 sc1
  s_add_u32 s56, s56, s71
  s_add_u32 s75, s75, s71
  s_pack_lh_b32_b16 s75, s75, s59
  v_pk_mul_f32 v[160:161], v[160:161], v[68:69] op_sel_hi:[1,0]
  v_pk_mul_f32 v[162:163], v[162:163], v[68:69] op_sel_hi:[1,0]
  v_pk_mul_f32 v[164:165], v[164:165], v[68:69] op_sel_hi:[1,0]
  v_pk_mul_f32 v[166:167], v[166:167], v[68:69] op_sel_hi:[1,0]
  v_cvt_pk_bf16_f32 v160, v160, v161
  v_cvt_pk_bf16_f32 v161, v162, v163
  v_cvt_pk_bf16_f32 v162, v164, v165
  v_cvt_pk_bf16_f32 v163, v166, v167
  v_pk_mul_f32 v[168:169], v[168:169], v[68:69] op_sel_hi:[1,0]
  v_pk_mul_f32 v[170:171], v[170:171], v[68:69] op_sel_hi:[1,0]
  v_pk_mul_f32 v[172:173], v[172:173], v[68:69] op_sel_hi:[1,0]
  v_pk_mul_f32 v[174:175], v[174:175], v[68:69] op_sel_hi:[1,0]
  v_cvt_pk_bf16_f32 v168, v168, v169
  v_cvt_pk_bf16_f32 v169, v170, v171
  v_cvt_pk_bf16_f32 v170, v172, v173
  v_cvt_pk_bf16_f32 v171, v174, v175
  v_pk_mul_f32 v[176:177], v[176:177], v[68:69] op_sel_hi:[1,0]
  v_pk_mul_f32 v[178:179], v[178:179], v[68:69] op_sel_hi:[1,0]
  v_pk_mul_f32 v[180:181], v[180:181], v[68:69] op_sel_hi:[1,0]
  v_pk_mul_f32 v[182:183], v[182:183], v[68:69] op_sel_hi:[1,0]
  v_cvt_pk_bf16_f32 v176, v176, v177
  v_cvt_pk_bf16_f32 v177, v178, v179
  v_cvt_pk_bf16_f32 v178, v180, v181
  v_cvt_pk_bf16_f32 v179, v182, v183
  v_pk_mul_f32 v[184:185], v[184:185], v[68:69] op_sel_hi:[1,0]
  v_pk_mul_f32 v[186:187], v[186:187], v[68:69] op_sel_hi:[1,0]
  v_pk_mul_f32 v[188:189], v[188:189], v[68:69] op_sel_hi:[1,0]
  v_pk_mul_f32 v[190:191], v[190:191], v[68:69] op_sel_hi:[1,0]
  v_cvt_pk_bf16_f32 v184, v184, v185
  v_cvt_pk_bf16_f32 v185, v186, v187
  v_cvt_pk_bf16_f32 v186, v188, v189
  v_cvt_pk_bf16_f32 v187, v190, v191
  buffer_store_dwordx4 v[160:163], v0, s[16:19], s67 offen offset:2048 sc1
  buffer_store_dwordx4 v[168:171], v5, s[16:19], s67 offen offset:2048 sc1
  buffer_store_dwordx4 v[176:179], v0, s[16:19], s51 offen offset:2048 sc1
  buffer_store_dwordx4 v[184:187], v5, s[16:19], s51 offen offset:2048 sc1
  ds_read_b128 a[96:99], v3 offset:0
  ds_read_b128 a[100:103], v3 offset:1024
  ds_read_b128 a[104:107], v3 offset:2048
  ds_read_b128 a[108:111], v3 offset:3072
  ds_read_b128 a[220:223], v3 offset:7168
  ds_read_b128 a[216:219], v3 offset:6144
  ds_read_b128 a[212:215], v3 offset:5120
  ds_read_b128 a[208:211], v3 offset:4096
  ds_read_b128 a[32:35], v8 offset:0
  ds_read_b128 a[36:39], v8 offset:1024
  ds_read_b128 a[40:43], v8 offset:2048
  ds_read_b128 a[44:47], v8 offset:3072
  ds_read_b128 a[48:51], v8 offset:4096
  ds_read_b128 a[52:55], v8 offset:5120
  ds_read_b128 a[56:59], v8 offset:6144
  ds_read_b128 a[60:63], v8 offset:7168
  v_pk_mul_f32 v[192:193], v[192:193], v[70:71] op_sel_hi:[1,0]
  v_pk_mul_f32 v[194:195], v[194:195], v[70:71] op_sel_hi:[1,0]
  v_pk_mul_f32 v[196:197], v[196:197], v[70:71] op_sel_hi:[1,0]
  v_pk_mul_f32 v[198:199], v[198:199], v[70:71] op_sel_hi:[1,0]
  v_cvt_pk_bf16_f32 v192, v192, v193
  v_cvt_pk_bf16_f32 v193, v194, v195
  v_cvt_pk_bf16_f32 v194, v196, v197
  v_cvt_pk_bf16_f32 v195, v198, v199
  v_pk_mul_f32 v[200:201], v[200:201], v[70:71] op_sel_hi:[1,0]
  v_pk_mul_f32 v[202:203], v[202:203], v[70:71] op_sel_hi:[1,0]
  v_pk_mul_f32 v[204:205], v[204:205], v[70:71] op_sel_hi:[1,0]
  v_pk_mul_f32 v[206:207], v[206:207], v[70:71] op_sel_hi:[1,0]
  v_cvt_pk_bf16_f32 v200, v200, v201
  v_cvt_pk_bf16_f32 v201, v202, v203
  v_cvt_pk_bf16_f32 v202, v204, v205
  v_cvt_pk_bf16_f32 v203, v206, v207
  v_pk_mul_f32 v[208:209], v[208:209], v[70:71] op_sel_hi:[1,0]
  v_pk_mul_f32 v[210:211], v[210:211], v[70:71] op_sel_hi:[1,0]
  v_pk_mul_f32 v[212:213], v[212:213], v[70:71] op_sel_hi:[1,0]
  v_pk_mul_f32 v[214:215], v[214:215], v[70:71] op_sel_hi:[1,0]
  v_cvt_pk_bf16_f32 v208, v208, v209
  v_cvt_pk_bf16_f32 v209, v210, v211
  v_cvt_pk_bf16_f32 v210, v212, v213
  v_cvt_pk_bf16_f32 v211, v214, v215
  v_pk_mul_f32 v[216:217], v[216:217], v[70:71] op_sel_hi:[1,0]
  v_pk_mul_f32 v[218:219], v[218:219], v[70:71] op_sel_hi:[1,0]
  v_pk_mul_f32 v[220:221], v[220:221], v[70:71] op_sel_hi:[1,0]
  v_pk_mul_f32 v[222:223], v[222:223], v[70:71] op_sel_hi:[1,0]
  v_cvt_pk_bf16_f32 v216, v216, v217
  v_cvt_pk_bf16_f32 v217, v218, v219
  v_cvt_pk_bf16_f32 v218, v220, v221
  v_cvt_pk_bf16_f32 v219, v222, v223
  buffer_store_dwordx4 v[192:195], v0, s[16:19], s67 offen offset:3072 sc1
  buffer_store_dwordx4 v[200:203], v5, s[16:19], s67 offen offset:3072 sc1
  buffer_store_dwordx4 v[208:211], v0, s[16:19], s51 offen offset:3072 sc1
  buffer_store_dwordx4 v[216:219], v5, s[16:19], s51 offen offset:3072 sc1
  s_cmp_lg_u32 s48, 16
  s_waitcnt lgkmcnt(0)
  s_cbranch_scc1 L_evt
  v_mov_b64 v[32:33], 0
  v_mov_b64 v[34:35], 0
  v_mov_b64 v[36:37], 0
  v_mov_b64 v[38:39], 0
  v_mov_b64 v[40:41], 0
  v_mov_b64 v[42:43], 0
  v_mov_b64 v[44:45], 0
  v_mov_b64 v[46:47], 0
  v_mov_b64 v[96:97], 0
  v_mov_b64 v[98:99], 0
  v_mov_b64 v[100:101], 0
  v_mov_b64 v[102:103], 0
  v_mov_b64 v[104:105], 0
  v_mov_b64 v[106:107], 0
  v_mov_b64 v[108:109], 0
  v_mov_b64 v[110:111], 0
  v_mov_b64 v[112:113], 0
  v_mov_b64 v[114:115], 0
  v_mov_b64 v[116:117], 0
  v_mov_b64 v[118:119], 0
  v_mov_b64 v[120:121], 0
  v_mov_b64 v[122:123], 0
  v_mov_b64 v[124:125], 0
  v_mov_b64 v[126:127], 0
  v_mov_b64 v[128:129], 0
  v_mov_b64 v[130:131], 0
  v_mov_b64 v[132:133], 0
  v_mov_b64 v[134:135], 0
  v_mov_b64 v[136:137], 0
  v_mov_b64 v[138:139], 0
  v_mov_b64 v[140:141], 0
  v_mov_b64 v[142:143], 0
  v_mov_b64 v[144:145], 0
  v_mov_b64 v[146:147], 0
  v_mov_b64 v[148:149], 0
  v_mov_b64 v[150:151], 0
  v_mov_b64 v[152:153], 0
  v_mov_b64 v[154:155], 0
  v_mov_b64 v[156:157], 0
  v_mov_b64 v[158:159], 0
  v_mov_b64 v[160:161], 0
  v_mov_b64 v[162:163], 0
  v_mov_b64 v[164:165], 0
  v_mov_b64 v[166:167], 0
  v_mov_b64 v[168:169], 0
  v_mov_b64 v[170:171], 0
  v_mov_b64 v[172:173], 0
  v_mov_b64 v[174:175], 0
  v_mov_b64 v[176:177], 0
  v_mov_b64 v[178:179], 0
  v_mov_b64 v[180:181], 0
  v_mov_b64 v[182:183], 0
  v_mov_b64 v[184:185], 0
  v_mov_b64 v[186:187], 0
  v_mov_b64 v[188:189], 0
  v_mov_b64 v[190:191], 0
  v_mov_b64 v[192:193], 0
  v_mov_b64 v[194:195], 0
  v_mov_b64 v[196:197], 0
  v_mov_b64 v[198:199], 0
  v_mov_b64 v[200:201], 0
  v_mov_b64 v[202:203], 0
  v_mov_b64 v[204:205], 0
  v_mov_b64 v[206:207], 0
  v_mov_b64 v[208:209], 0
  v_mov_b64 v[210:211], 0
  v_mov_b64 v[212:213], 0
  v_mov_b64 v[214:215], 0
  v_mov_b64 v[216:217], 0
  v_mov_b64 v[218:219], 0
  v_mov_b64 v[220:221], 0
  v_mov_b64 v[222:223], 0
  v_mov_b32 v56, 0
  v_mov_b32 v57, 0
  v_mov_b32 v58, 0
  v_mov_b32 v86, 0
  v_mov_b32 v87, 0
  v_mov_b32 v88, 0xf149f2ca
  v_mov_b32 v89, 0xf149f2ca
  v_mov_b32 v90, 0xf149f2ca
  v_mov_b32 v91, 0xf149f2ca
  v_mov_b32 v92, 0xf149f2ca
  v_mov_b32 v93, 0xf149f2ca
  v_mov_b32 v94, 0xf149f2ca
  v_mov_b32 v95, 0xf149f2ca
  s_branch L_tf1
.p2align 12
L_tf0:
  v_mfma_f32_16x16x32_bf16 v[64:67], a[64:67], a[32:35], 0
  v_exp_f32 v88, v88
  v_mfma_f32_16x16x32_bf16 v[64:67], a[68:71], a[36:39], v[64:67]
  v_exp_f32 v89, v89
  v_mfma_f32_16x16x32_bf16 v[64:67], a[72:75], a[40:43], v[64:67]
  v_exp_f32 v90, v90
  v_mfma_f32_16x16x32_bf16 v[64:67], a[76:79], a[44:47], v[64:67]
  v_exp_f32 v91, v91
  v_mfma_f32_16x16x32_bf16 v[68:71], a[92:95], a[44:47], 0
  v_cvt_pk_bf16_f32 v59, v86, v87
  v_mfma_f32_16x16x32_bf16 v[68:71], a[88:91], a[40:43], v[68:71]
  v_exp_f32 v92, v92
  v_mfma_f32_16x16x32_bf16 v[68:71], a[84:87], a[36:39], v[68:71]
  v_exp_f32 v93, v93
  v_mfma_f32_16x16x32_bf16 v[68:71], a[80:83], a[32:35], v[68:71]
  v_exp_f32 v94, v94
  v_mfma_f32_16x16x32_bf16 v[72:75], a[64:67], a[48:51], 0
  v_exp_f32 v95, v95
  v_mfma_f32_16x16x32_bf16 v[72:75], a[68:71], a[52:55], v[72:75]
  v_cvt_pk_bf16_f32 v60, v88, v89
  v_cvt_pk_bf16_f32 v61, v90, v91
  v_mfma_f32_16x16x32_bf16 v[72:75], a[72:75], a[56:59], v[72:75]
  v_cvt_pk_bf16_f32 v62, v92, v93
  v_cvt_pk_bf16_f32 v63, v94, v95
  v_mfma_f32_16x16x32_bf16 v[72:75], a[76:79], a[60:63], v[72:75]
  v_add_u32 v4, 65536, v2
  v_add_u32 v7, 65536, v3
  v_mfma_f32_16x16x32_bf16 v[76:79], a[92:95], a[60:63], 0
  buffer_load_dwordx4 v[240:243], v0, s[16:19], s81 offen sc1
  v_mfma_f32_16x16x32_bf16 v[76:79], a[88:91], a[56:59], v[76:79]
  s_lshl_b32 s3, s38, 9
  s_add_u32 s3, s3, 81920
  v_mfma_f32_16x16x32_bf16 v[76:79], a[84:87], a[52:55], v[76:79]
  v_exp_f32 v64, v64
  v_mfma_f32_16x16x32_bf16 v[76:79], a[80:83], a[48:51], v[76:79]
  v_exp_f32 v65, v65
  v_mfma_f32_16x16x32_bf16 v[192:195], a[144:147], v[56:59], v[192:195]
  ds_read_b128 a[144:147], v4 offset:0
  v_cvt_pk_bf16_f32 v48, v64, v65
  v_mfma_f32_16x16x32_bf16 v[192:195], a[176:179], v[60:63], v[192:195]
  ds_read_b128 a[176:179], v7 offset:0
  v_lshl_add_u32 v2, v1, 2, s3
  v_mfma_f32_16x16x32_bf16 v[196:199], a[180:183], v[60:63], v[196:199]
  ds_read_b128 a[180:183], v7 offset:1024
  v_xor_b32 v3, 1024, v2
  v_mfma_f32_16x16x32_bf16 v[196:199], a[148:151], v[56:59], v[196:199]
  ds_read_b128 a[148:151], v4 offset:1024
  v_mfma_f32_16x16x32_bf16 v[200:203], a[152:155], v[56:59], v[200:203]
  ds_read_b128 a[152:155], v4 offset:2048
  v_mfma_f32_16x16x32_bf16 v[200:203], a[184:187], v[60:63], v[200:203]
  ds_read_b128 a[184:187], v7 offset:2048
  v_mfma_f32_16x16x32_bf16 v[204:207], a[188:191], v[60:63], v[204:207]
  ds_read_b128 a[188:191], v7 offset:3072
  v_mfma_f32_16x16x32_bf16 v[204:207], a[156:159], v[56:59], v[204:207]
  ds_read_b128 a[156:159], v4 offset:3072
  v_mfma_f32_16x16x32_bf16 v[208:211], a[160:163], v[56:59], v[208:211]
  ds_read_b128 a[160:163], v4 offset:4096
  v_mfma_f32_16x16x32_bf16 v[208:211], a[192:195], v[60:63], v[208:211]
  ds_read_b128 a[192:195], v7 offset:4096
  v_mfma_f32_16x16x32_bf16 v[212:215], a[196:199], v[60:63], v[212:215]
  ds_read_b128 a[196:199], v7 offset:5120
  v_mfma_f32_16x16x32_bf16 v[212:215], a[164:167], v[56:59], v[212:215]
  ds_read_b128 a[164:167], v4 offset:5120
  v_mfma_f32_16x16x32_bf16 v[216:219], a[168:171], v[56:59], v[216:219]
  ds_read_b128 a[168:171], v4 offset:6144
  v_mfma_f32_16x16x32_bf16 v[216:219], a[200:203], v[60:63], v[216:219]
  ds_read_b128 a[200:203], v7 offset:6144
  v_mfma_f32_16x16x32_bf16 v[220:223], a[204:207], v[60:63], v[220:223]
  ds_read_b128 a[204:207], v7 offset:7168
  v_mfma_f32_16x16x32_bf16 v[220:223], a[172:175], v[56:59], v[220:223]
  ds_read_b128 a[172:175], v4 offset:7168
  v_smfmac_f32_16x16x64_bf16 v[44:47], v[12:15], v[56:63], v10
  s_waitcnt lgkmcnt(15)
  v_mfma_f32_16x16x32_bf16 v[80:83], a[96:99], a[48:51], v[16:19]
  v_exp_f32 v66, v66
  v_mfma_f32_16x16x32_bf16 v[80:83], a[100:103], a[52:55], v[80:83]
  v_exp_f32 v67, v67
  v_mfma_f32_16x16x32_bf16 v[80:83], a[104:107], a[56:59], v[80:83]
  v_exp_f32 v68, v68
  v_mfma_f32_16x16x32_bf16 v[80:83], a[108:111], a[60:63], v[80:83]
  v_exp_f32 v69, v69
  v_mfma_f32_16x16x32_bf16 v[84:87], a[220:223], a[60:63], v[20:23]
  v_exp_f32 v70, v70
  v_mfma_f32_16x16x32_bf16 v[84:87], a[216:219], a[56:59], v[84:87]
  v_exp_f32 v71, v71
  v_mfma_f32_16x16x32_bf16 v[84:87], a[212:215], a[52:55], v[84:87]
  v_cvt_pk_bf16_f32 v49, v66, v67
  v_cvt_pk_bf16_f32 v50, v68, v69
  v_mfma_f32_16x16x32_bf16 v[84:87], a[208:211], a[48:51], v[84:87]
  v_cvt_pk_bf16_f32 v51, v70, v71
  v_mfma_f32_16x16x32_bf16 v[88:91], a[64:67], a[0:3], v[16:19]
  v_exp_f32 v72, v72
  v_mfma_f32_16x16x32_bf16 v[88:91], a[68:71], a[4:7], v[88:91]
  v_exp_f32 v73, v73
  v_mfma_f32_16x16x32_bf16 v[88:91], a[72:75], a[8:11], v[88:91]
  v_exp_f32 v74, v74
  v_mfma_f32_16x16x32_bf16 v[88:91], a[76:79], a[12:15], v[88:91]
  v_exp_f32 v75, v75
  v_mfma_f32_16x16x32_bf16 v[92:95], a[92:95], a[12:15], v[20:23]
  v_exp_f32 v76, v76
  v_mfma_f32_16x16x32_bf16 v[92:95], a[88:91], a[8:11], v[92:95]
  v_exp_f32 v77, v77
  v_mfma_f32_16x16x32_bf16 v[92:95], a[84:87], a[4:7], v[92:95]
  v_exp_f32 v78, v78
  v_mfma_f32_16x16x32_bf16 v[92:95], a[80:83], a[0:3], v[92:95]
  v_exp_f32 v79, v79
  v_mfma_f32_16x16x32_bf16 v[160:163], a[144:147], v[48:51], v[160:163]
  s_waitcnt vmcnt(1) lgkmcnt(0)
  s_barrier
  v_mfma_f32_16x16x32_bf16 v[164:167], a[148:151], v[48:51], v[164:167]
  s_waitcnt vmcnt(0)
  v_min3_u32 v240, v240, v241, v242
  v_mfma_f32_16x16x32_bf16 v[168:171], a[152:155], v[48:51], v[168:171]
  v_min_u32 v240, v240, v243
  v_cmp_eq_u32 vcc, 0, v240
  v_mfma_f32_16x16x32_bf16 v[172:175], a[156:159], v[48:51], v[172:175]
  s_cbranch_vccnz L_p2_19
L_p2back_20:
  s_add_u32 s63, s7, L_adone-L_base
  v_mfma_f32_16x16x32_bf16 v[176:179], a[160:163], v[48:51], v[176:179]
  buffer_load_dword v24, v6, s[16:19], s64 offen offset:0 sc1
  v_mfma_f32_16x16x32_bf16 v[180:183], a[164:167], v[48:51], v[180:183]
  buffer_load_dword v25, v6, s[16:19], s64 offen offset:128 sc1
  v_mfma_f32_16x16x32_bf16 v[184:187], a[168:171], v[48:51], v[184:187]
  s_min_u32 s63, s63, L_codeend-L_base-4
  v_mov_b32 v29, s63
  v_mfma_f32_16x16x32_bf16 v[188:191], a[172:175], v[48:51], v[188:191]
  global_load_dword v244, v29, s[0:1]
  v_mfma_f32_16x16x32_bf16 v[40:43], a[228:231], v[48:51], v[40:43]
  s_add_u32 m0, s47, 36864
  ds_write_b128 v8, v[160:163] offset:0
  buffer_load_dwordx4 v0, s[16:19], s85 offen offset:0 sc1 lds
  v_exp_f32 v80, v80
  v_exp_f32 v81, v81
  v_exp_f32 v82, v82
  ds_write_b128 v8, v[164:167] offset:1024
  v_exp_f32 v83, v83
  buffer_load_dwordx4 v0, s[16:19], s85 offen offset:1024 sc1 lds
  v_exp_f32 v84, v84
  ds_write_b128 v8, v[168:171] offset:2048
  v_exp_f32 v85, v85
  v_exp_f32 v86, v86
  v_exp_f32 v87, v87
  buffer_load_dwordx4 v0, s[16:19], s85 offen offset:2048 sc1 lds
  ds_write_b128 v8, v[172:175] offset:3072
  v_cvt_pk_bf16_f32 v52, v72, v73
  v_cvt_pk_bf16_f32 v55, v78, v79
  v_cvt_pk_bf16_f32 v53, v74, v75
  v_cvt_pk_bf16_f32 v54, v76, v77
  v_cvt_pk_bf16_f32 v56, v80, v81
  v_cvt_pk_bf16_f32 v57, v82, v83
  v_mfma_f32_16x16x32_bf16 v[192:195], a[144:147], v[52:55], v[192:195]
  ds_write_b128 v8, v[176:179] offset:4096
  buffer_load_dwordx4 v0, s[16:19], s85 offen offset:3072 sc1 lds
  s_add_u32 m0, m0, 4096
  v_cvt_pk_bf16_f32 v58, v84, v85
  v_cvt_pk_bf16_f32 v59, v86, v87
  v_add_f32 v40, v40, v41
  v_exp_f32 v88, v88
  v_mfma_f32_16x16x32_bf16 v[192:195], a[176:179], v[56:59], v[192:195]
  ds_write_b128 v8, v[180:183] offset:5120
  v_mfma_f32_16x16x32_bf16 v[196:199], a[180:183], v[56:59], v[196:199]
  buffer_load_dwordx4 v5, s[16:19], s85 offen offset:0 sc1 lds
  v_mfma_f32_16x16x32_bf16 v[196:199], a[148:151], v[52:55], v[196:199]
  v_exp_f32 v89, v89
  v_mfma_f32_16x16x32_bf16 v[200:203], a[152:155], v[52:55], v[200:203]
  ds_write_b128 v8, v[184:187] offset:6144
  v_mfma_f32_16x16x32_bf16 v[200:203], a[184:187], v[56:59], v[200:203]
  v_exp_f32 v90, v90
  v_mfma_f32_16x16x32_bf16 v[204:207], a[188:191], v[56:59], v[204:207]
  buffer_load_dwordx4 v5, s[16:19], s85 offen offset:1024 sc1 lds
  v_mfma_f32_16x16x32_bf16 v[204:207], a[156:159], v[52:55], v[204:207]
  ds_write_b128 v8, v[188:191] offset:7168
  v_mfma_f32_16x16x32_bf16 v[208:211], a[160:163], v[52:55], v[208:211]
  v_exp_f32 v91, v91
  v_mfma_f32_16x16x32_bf16 v[208:211], a[192:195], v[56:59], v[208:211]
  v_exp_f32 v92, v92
  v_mfma_f32_16x16x32_bf16 v[212:215], a[196:199], v[56:59], v[212:215]
  buffer_load_dwordx4 v5, s[16:19], s85 offen offset:2048 sc1 lds
  v_mfma_f32_16x16x32_bf16 v[212:215], a[164:167], v[52:55], v[212:215]
  ds_write_b128 v8, v[192:195] offset:8192
  v_mfma_f32_16x16x32_bf16 v[216:219], a[168:171], v[52:55], v[216:219]
  v_exp_f32 v93, v93
  v_mfma_f32_16x16x32_bf16 v[216:219], a[200:203], v[56:59], v[216:219]
  v_exp_f32 v94, v94
  v_mfma_f32_16x16x32_bf16 v[220:223], a[204:207], v[56:59], v[220:223]
  buffer_load_dwordx4 v5, s[16:19], s85 offen offset:3072 sc1 lds
  v_mfma_f32_16x16x32_bf16 v[220:223], a[172:175], v[52:55], v[220:223]
  ds_write_b128 v8, v[196:199] offset:9216
  v_smfmac_f32_16x16x64_bf16 v[44:47], v[12:15], v[52:59], v10
  s_add_u32 m0, m0, 4096
  v_mfma_f32_16x16x32_bf16 v[64:67], a[64:67], a[16:19], 0
  s_add_u32 s42, s42, s46
  s_add_u32 s43, s43, 81920
  v_mfma_f32_16x16x32_bf16 v[64:67], a[68:71], a[20:23], v[64:67]
  buffer_load_dwordx4 v0, s[16:19], s84 offen sc1 lds
  v_mfma_f32_16x16x32_bf16 v[64:67], a[72:75], a[24:27], v[64:67]
  ds_write_b128 v8, v[200:203] offset:10240
  v_mfma_f32_16x16x32_bf16 v[64:67], a[76:79], a[28:31], v[64:67]
  s_add_u32 m0, s47, 0
  v_cvt_pk_bf16_f32 v60, v88, v89
  v_mfma_f32_16x16x32_bf16 v[68:71], a[92:95], a[28:31], 0
  v_add_f32 v44, v44, v45
  v_cvt_pk_bf16_f32 v61, v90, v91
  v_mfma_f32_16x16x32_bf16 v[68:71], a[88:91], a[24:27], v[68:71]
  ds_write_b128 v8, v[204:207] offset:11264
  v_mfma_f32_16x16x32_bf16 v[68:71], a[84:87], a[20:23], v[68:71]
  buffer_load_dwordx4 v0, s[16:19], s42 offen offset:0 sc1 lds
  v_mfma_f32_16x16x32_bf16 v[68:71], a[80:83], a[16:19], v[68:71]
  v_exp_f32 v95, v95
  ds_write_b128 v8, v[208:211] offset:12288
  v_cvt_pk_bf16_f32 v62, v92, v93
  v_cvt_pk_bf16_f32 v63, v94, v95
  v_exp_f32 v64, v64
  buffer_load_dwordx4 v0, s[16:19], s42 offen offset:1024 sc1 lds
  v_mfma_f32_16x16x32_bf16 v[96:99], a[144:147], v[60:63], v[96:99]
  ds_write_b128 v8, v[212:215] offset:13312
  v_mfma_f32_16x16x32_bf16 v[100:103], a[148:151], v[60:63], v[100:103]
  v_exp_f32 v65, v65
  v_mfma_f32_16x16x32_bf16 v[104:107], a[152:155], v[60:63], v[104:107]
  v_exp_f32 v66, v66
  v_mfma_f32_16x16x32_bf16 v[108:111], a[156:159], v[60:63], v[108:111]
  buffer_load_dwordx4 v0, s[16:19], s42 offen offset:2048 sc1 lds
  v_mfma_f32_16x16x32_bf16 v[112:115], a[160:163], v[60:63], v[112:115]
  ds_write_b128 v8, v[216:219] offset:14336
  v_mfma_f32_16x16x32_bf16 v[116:119], a[164:167], v[60:63], v[116:119]
  v_exp_f32 v67, v67
  v_mfma_f32_16x16x32_bf16 v[120:123], a[168:171], v[60:63], v[120:123]
  v_exp_f32 v68, v68
  v_mfma_f32_16x16x32_bf16 v[124:127], a[172:175], v[60:63], v[124:127]
  buffer_load_dwordx4 v0, s[16:19], s42 offen offset:3072 sc1 lds
  v_mfma_f32_16x16x32_bf16 v[32:35], a[228:231], v[60:63], v[32:35]
  ds_write_b128 v8, v[220:223] offset:15360
  s_add_u32 m0, m0, 4096
  v_exp_f32 v69, v69
  v_exp_f32 v70, v70
  v_exp_f32 v71, v71
  buffer_load_dwordx4 v5, s[16:19], s42 offen offset:0 sc1 lds
  ds_write_b32 v2, v40
  v_cvt_pk_bf16_f32 v48, v64, v65
  v_cvt_pk_bf16_f32 v49, v66, v67
  v_cvt_pk_bf16_f32 v50, v68, v69
  v_cvt_pk_bf16_f32 v51, v70, v71
  v_add_f32 v32, v32, v33
  ds_write_b32 v2, v44 offset:256
  v_mfma_f32_16x16x32_bf16 v[128:131], a[144:147], v[48:51], v[128:131]
  v_mfma_f32_16x16x32_bf16 v[132:135], a[148:151], v[48:51], v[132:135]
  buffer_load_dwordx4 v5, s[16:19], s42 offen offset:1024 sc1 lds
  v_mfma_f32_16x16x32_bf16 v[136:139], a[152:155], v[48:51], v[136:139]
  v_mfma_f32_16x16x32_bf16 v[140:143], a[156:159], v[48:51], v[140:143]
  v_mfma_f32_16x16x32_bf16 v[144:147], a[160:163], v[48:51], v[144:147]
  v_mfma_f32_16x16x32_bf16 v[148:151], a[164:167], v[48:51], v[148:151]
  buffer_load_dwordx4 v5, s[16:19], s42 offen offset:2048 sc1 lds
  v_mfma_f32_16x16x32_bf16 v[152:155], a[168:171], v[48:51], v[152:155]
  v_mfma_f32_16x16x32_bf16 v[156:159], a[172:175], v[48:51], v[156:159]
  v_mfma_f32_16x16x32_bf16 v[36:39], a[228:231], v[48:51], v[36:39]
  s_waitcnt lgkmcnt(0)
  s_barrier
  buffer_load_dwordx4 v5, s[16:19], s42 offen offset:3072 sc1 lds
  ds_read_b32 v68, v3
  ds_read_b32 v69, v3 offset:256
  ds_read_b128 v[160:163], v28 offset:0
  ds_read_b128 v[164:167], v28 offset:1024
  ds_read_b128 v[192:195], v28 offset:8192
  s_add_u32 m0, m0, 4096
  s_add_u32 s42, s42, s46
  v_add_f32 v36, v36, v37
  ds_read_b128 v[196:199], v28 offset:9216
  ds_read_b128 v[168:171], v28 offset:2048
  ds_read_b128 v[172:175], v28 offset:3072
  ds_read_b128 v[200:203], v28 offset:10240
  buffer_load_dwordx4 v0, s[16:19], s43 offen sc1 lds
  s_add_u32 s43, s43, 81920
  s_add_u32 s51, s66, 8192
  ds_read_b128 v[204:207], v28 offset:11264
  ds_read_b128 v[176:179], v28 offset:4096
  ds_read_b128 v[180:183], v28 offset:5120
  ds_read_b128 v[208:211], v28 offset:12288
  ds_read_b128 v[212:215], v28 offset:13312
  ds_read_b128 v[184:187], v28 offset:6144
  ds_read_b128 v[188:191], v28 offset:7168
  ds_read_b128 v[216:219], v28 offset:14336
  ds_read_b128 v[220:223], v28 offset:15360
  s_waitcnt lgkmcnt(15)
  v_add_f32 v32, v32, v68
  v_add_f32 v36, v36, v69
  v_med3_f32 v64, v32, v11, s99
  v_med3_f32 v65, v36, v11, s99
  v_cmp_neq_f32 vcc, v32, v64
  v_cmp_neq_f32 s[4:5], v36, v65
  s_or_b64 vcc, s[4:5], vcc
  s_cbranch_vccnz L_slowf0
L_slowf0back:
  v_rcp_f32 v64, v32
  s_waitcnt vmcnt(19)
  s_waitcnt lgkmcnt(12)
  v_mul_f32 v64, v64, v24
  v_pk_add_f32 v[96:97], v[96:97], v[160:161]
  v_pk_add_f32 v[98:99], v[98:99], v[162:163]
  v_pk_mul_f32 v[96:97], v[96:97], v[64:65] op_sel_hi:[1,0]
  v_pk_add_f32 v[100:101], v[100:101], v[164:165]
  v_pk_add_f32 v[102:103], v[102:103], v[166:167]
  v_pk_mul_f32 v[98:99], v[98:99], v[64:65] op_sel_hi:[1,0]
  v_cvt_pk_bf16_f32 v96, v96, v97
  v_pk_mul_f32 v[100:101], v[100:101], v[64:65] op_sel_hi:[1,0]
  v_pk_mul_f32 v[102:103], v[102:103], v[64:65] op_sel_hi:[1,0]
  v_cvt_pk_bf16_f32 v97, v98, v99
  v_cvt_pk_bf16_f32 v98, v100, v101
  v_cvt_pk_bf16_f32 v99, v102, v103
  v_rcp_f32 v66, v36
  buffer_store_dwordx4 v[96:99], v0, s[16:19], s66 offen offset:0 sc1
  v_mul_f32 v66, v66, v25
  v_pk_add_f32 v[128:129], v[128:129], v[192:193]
  v_pk_add_f32 v[130:131], v[130:131], v[194:195]
  v_pk_mul_f32 v[128:129], v[128:129], v[66:67] op_sel_hi:[1,0]
  v_pk_add_f32 v[132:133], v[132:133], v[196:197]
  v_pk_add_f32 v[134:135], v[134:135], v[198:199]
  v_pk_mul_f32 v[130:131], v[130:131], v[66:67] op_sel_hi:[1,0]
  v_cvt_pk_bf16_f32 v128, v128, v129
  v_pk_mul_f32 v[132:133], v[132:133], v[66:67] op_sel_hi:[1,0]
  v_pk_mul_f32 v[134:135], v[134:135], v[66:67] op_sel_hi:[1,0]
  v_cvt_pk_bf16_f32 v129, v130, v131
  v_cvt_pk_bf16_f32 v130, v132, v133
  v_cvt_pk_bf16_f32 v131, v134, v135
  buffer_store_dwordx4 v[128:131], v0, s[16:19], s66 offen offset:1024 sc1
  s_waitcnt lgkmcnt(8)
  v_pk_add_f32 v[104:105], v[104:105], v[168:169]
  v_pk_add_f32 v[106:107], v[106:107], v[170:171]
  v_pk_mul_f32 v[104:105], v[104:105], v[64:65] op_sel_hi:[1,0]
  v_pk_add_f32 v[108:109], v[108:109], v[172:173]
  v_pk_add_f32 v[110:111], v[110:111], v[174:175]
  v_pk_mul_f32 v[106:107], v[106:107], v[64:65] op_sel_hi:[1,0]
  v_cvt_pk_bf16_f32 v104, v104, v105
  v_pk_mul_f32 v[108:109], v[108:109], v[64:65] op_sel_hi:[1,0]
  v_pk_mul_f32 v[110:111], v[110:111], v[64:65] op_sel_hi:[1,0]
  v_cvt_pk_bf16_f32 v105, v106, v107
  v_cvt_pk_bf16_f32 v106, v108, v109
  v_cvt_pk_bf16_f32 v107, v110, v111
  buffer_store_dwordx4 v[104:107], v5, s[16:19], s66 offen offset:0 sc1
  v_pk_add_f32 v[136:137], v[136:137], v[200:201]
  v_pk_add_f32 v[138:139], v[138:139], v[202:203]
  v_pk_mul_f32 v[136:137], v[136:137], v[66:67] op_sel_hi:[1,0]
  v_pk_add_f32 v[140:141], v[140:141], v[204:205]
  v_pk_add_f32 v[142:143], v[142:143], v[206:207]
  v_pk_mul_f32 v[138:139], v[138:139], v[66:67] op_sel_hi:[1,0]
  v_cvt_pk_bf16_f32 v136, v136, v137
  v_pk_mul_f32 v[140:141], v[140:141], v[66:67] op_sel_hi:[1,0]
  v_pk_mul_f32 v[142:143], v[142:143], v[66:67] op_sel_hi:[1,0]
  v_cvt_pk_bf16_f32 v137, v138, v139
  v_cvt_pk_bf16_f32 v138, v140, v141
  v_cvt_pk_bf16_f32 v139, v142, v143
  buffer_store_dwordx4 v[136:139], v5, s[16:19], s66 offen offset:1024 sc1
  s_waitcnt vmcnt(13) lgkmcnt(0)
  s_barrier
  v_pk_add_f32 v[112:113], v[112:113], v[176:177]
  v_pk_add_f32 v[114:115], v[114:115], v[178:179]
  v_pk_mul_f32 v[112:113], v[112:113], v[64:65] op_sel_hi:[1,0]
  v_pk_add_f32 v[116:117], v[116:117], v[180:181]
  v_pk_add_f32 v[118:119], v[118:119], v[182:183]
  v_pk_mul_f32 v[114:115], v[114:115], v[64:65] op_sel_hi:[1,0]
  v_cvt_pk_bf16_f32 v112, v112, v113
  v_pk_mul_f32 v[116:117], v[116:117], v[64:65] op_sel_hi:[1,0]
  v_pk_mul_f32 v[118:119], v[118:119], v[64:65] op_sel_hi:[1,0]
  v_cvt_pk_bf16_f32 v113, v114, v115
  v_cvt_pk_bf16_f32 v114, v116, v117
  v_cvt_pk_bf16_f32 v115, v118, v119
  buffer_store_dwordx4 v[112:115], v0, s[16:19], s51 offen offset:0 sc1
  v_pk_add_f32 v[144:145], v[144:145], v[208:209]
  s_mul_i32 s3, s39, 9216
  v_pk_add_f32 v[146:147], v[146:147], v[210:211]
  v_pk_mul_f32 v[144:145], v[144:145], v[66:67] op_sel_hi:[1,0]
  v_add_u32 v12, s3, v0
  v_pk_add_f32 v[148:149], v[148:149], v[212:213]
  v_pk_add_f32 v[150:151], v[150:151], v[214:215]
  v_pk_mul_f32 v[146:147], v[146:147], v[66:67] op_sel_hi:[1,0]
  v_cvt_pk_bf16_f32 v144, v144, v145
  s_mul_i32 s3, s40, 5120
  v_pk_mul_f32 v[148:149], v[148:149], v[66:67] op_sel_hi:[1,0]
  v_pk_mul_f32 v[150:151], v[150:151], v[66:67] op_sel_hi:[1,0]
  v_cvt_pk_bf16_f32 v145, v146, v147
  s_add_u32 s3, s3, 18432
  ds_read_b128 a[32:35], v12 offset:36864
  ds_read_b128 a[36:39], v12 offset:40960
  v_cvt_pk_bf16_f32 v146, v148, v149
  v_cvt_pk_bf16_f32 v147, v150, v151
  v_add_u32 v14, s3, v0
  buffer_store_dwordx4 v[144:147], v0, s[16:19], s51 offen offset:1024 sc1
  ds_read_b128 a[64:67], v14 offset:36864
  ds_read_b128 a[68:71], v14 offset:46080
  ds_read_b128 a[72:75], v14 offset:37888
  ds_read_b128 a[76:79], v14 offset:47104
  ds_read_b128 a[80:83], v14 offset:38912
  ds_read_b128 a[84:87], v14 offset:48128
  ds_read_b128 a[88:91], v14 offset:39936
  ds_read_b128 a[92:95], v14 offset:49152
  v_pk_add_f32 v[120:121], v[120:121], v[184:185]
  v_pk_add_f32 v[122:123], v[122:123], v[186:187]
  v_pk_mul_f32 v[120:121], v[120:121], v[64:65] op_sel_hi:[1,0]
  v_pk_add_f32 v[124:125], v[124:125], v[188:189]
  v_pk_add_f32 v[126:127], v[126:127], v[190:191]
  v_pk_mul_f32 v[122:123], v[122:123], v[64:65] op_sel_hi:[1,0]
  v_cvt_pk_bf16_f32 v120, v120, v121
  s_mul_i32 s3, s40, 14336
  v_pk_mul_f32 v[124:125], v[124:125], v[64:65] op_sel_hi:[1,0]
  v_pk_mul_f32 v[126:127], v[126:127], v[64:65] op_sel_hi:[1,0]
  v_cvt_pk_bf16_f32 v121, v122, v123
  s_sub_u32 s3, 22528, s3
  v_cvt_pk_bf16_f32 v122, v124, v125
  v_cvt_pk_bf16_f32 v123, v126, v127
  v_add_u32 v16, s3, v0
  buffer_store_dwordx4 v[120:123], v5, s[16:19], s51 offen offset:0 sc1
  ds_read_b128 a[96:99], v16 offset:36864
  ds_read_b128 a[100:103], v16 offset:46080
  ds_read_b128 a[40:43], v12 offset:37888
  ds_read_b128 a[44:47], v12 offset:41984
  ds_read_b128 a[48:51], v12 offset:38912
  ds_read_b128 a[52:55], v12 offset:43008
  ds_read_b128 a[56:59], v12 offset:39936
  ds_read_b128 a[60:63], v12 offset:44032
  v_pk_add_f32 v[152:153], v[152:153], v[216:217]
  v_pk_add_f32 v[154:155], v[154:155], v[218:219]
  v_pk_mul_f32 v[152:153], v[152:153], v[66:67] op_sel_hi:[1,0]
  v_pk_add_f32 v[156:157], v[156:157], v[220:221]
  v_pk_add_f32 v[158:159], v[158:159], v[222:223]
  v_pk_mul_f32 v[154:155], v[154:155], v[66:67] op_sel_hi:[1,0]
  v_cvt_pk_bf16_f32 v152, v152, v153
  v_pk_mul_f32 v[156:157], v[156:157], v[66:67] op_sel_hi:[1,0]
  v_pk_mul_f32 v[158:159], v[158:159], v[66:67] op_sel_hi:[1,0]
  v_cvt_pk_bf16_f32 v153, v154, v155
  v_cvt_pk_bf16_f32 v154, v156, v157
  v_cvt_pk_bf16_f32 v155, v158, v159
  v_add_u32 v13, 73728, v12
  v_add_u32 v15, 73728, v14
  v_add_u32 v17, 73728, v16
  buffer_store_dwordx4 v[152:155], v5, s[16:19], s51 offen offset:1024 sc1
  s_branch L_adone
.p2align 12
L_tf1:
  v_mfma_f32_16x16x32_bf16 v[64:67], a[64:67], a[48:51], v[16:19]
  ds_write_b128 v8, v[160:163] offset:0
  v_mfma_f32_16x16x32_bf16 v[64:67], a[68:71], a[52:55], v[64:67]
  v_exp_f32 v88, v88
  v_mfma_f32_16x16x32_bf16 v[64:67], a[72:75], a[56:59], v[64:67]
  v_exp_f32 v89, v89
  v_mfma_f32_16x16x32_bf16 v[64:67], a[76:79], a[60:63], v[64:67]
  ds_write_b128 v8, v[164:167] offset:1024
  v_mfma_f32_16x16x32_bf16 v[68:71], a[92:95], a[60:63], v[20:23]
  s_waitcnt lgkmcnt(8)
  v_cvt_pk_bf16_f32 v59, v86, v87
  v_mfma_f32_16x16x32_bf16 v[68:71], a[88:91], a[56:59], v[68:71]
  v_exp_f32 v90, v90
  v_mfma_f32_16x16x32_bf16 v[68:71], a[84:87], a[52:55], v[68:71]
  v_exp_f32 v91, v91
  v_mfma_f32_16x16x32_bf16 v[68:71], a[80:83], a[48:51], v[68:71]
  v_exp_f32 v92, v92
  v_mfma_f32_16x16x32_bf16 v[72:75], a[64:67], a[0:3], 0
  v_exp_f32 v93, v93
  v_mfma_f32_16x16x32_bf16 v[72:75], a[68:71], a[4:7], v[72:75]
  v_exp_f32 v94, v94
  v_mfma_f32_16x16x32_bf16 v[72:75], a[72:75], a[8:11], v[72:75]
  v_exp_f32 v95, v95
  v_mfma_f32_16x16x32_bf16 v[72:75], a[76:79], a[12:15], v[72:75]
  v_cvt_pk_bf16_f32 v60, v88, v89
  v_cvt_pk_bf16_f32 v61, v90, v91
  v_mfma_f32_16x16x32_bf16 v[76:79], a[92:95], a[12:15], 0
  v_cvt_pk_bf16_f32 v62, v92, v93
  v_cvt_pk_bf16_f32 v63, v94, v95
  v_mfma_f32_16x16x32_bf16 v[76:79], a[88:91], a[8:11], v[76:79]
  ds_write_b128 v8, v[168:171] offset:2048
  v_mfma_f32_16x16x32_bf16 v[76:79], a[84:87], a[4:7], v[76:79]
  v_add_u32 v4, 65536, v2
  v_add_u32 v7, 65536, v3
  v_mfma_f32_16x16x32_bf16 v[76:79], a[80:83], a[0:3], v[76:79]
  buffer_load_dwordx4 v[240:243], v0, s[16:19], s81 offen sc1
  v_mfma_f32_16x16x32_bf16 v[192:195], a[144:147], v[56:59], v[192:195]
  ds_write_b128 v8, v[172:175] offset:3072
  v_mfma_f32_16x16x32_bf16 v[192:195], a[176:179], v[60:63], v[192:195]
  ds_read_b128 a[144:147], v4 offset:0
  s_lshl_b32 s3, s38, 9
  v_mfma_f32_16x16x32_bf16 v[196:199], a[180:183], v[60:63], v[196:199]
  ds_read_b128 a[176:179], v7 offset:0
  s_add_u32 s3, s3, 81920
  v_mfma_f32_16x16x32_bf16 v[196:199], a[148:151], v[56:59], v[196:199]
  ds_read_b128 a[180:183], v7 offset:1024
  v_mov_b32 v30, 1
  v_mfma_f32_16x16x32_bf16 v[200:203], a[152:155], v[56:59], v[200:203]
  ds_read_b128 a[148:151], v4 offset:1024
  v_mov_b32 v31, 1
  v_mfma_f32_16x16x32_bf16 v[200:203], a[184:187], v[60:63], v[200:203]
  ds_read_b128 a[152:155], v4 offset:2048
  v_add_f32 v40, v40, v41
  v_mfma_f32_16x16x32_bf16 v[204:207], a[188:191], v[60:63], v[204:207]
  ds_read_b128 a[184:187], v7 offset:2048
  v_lshl_add_u32 v2, v1, 2, s3
  v_mfma_f32_16x16x32_bf16 v[204:207], a[156:159], v[56:59], v[204:207]
  ds_read_b128 a[188:191], v7 offset:3072
  v_xor_b32 v3, 1024, v2
  v_mfma_f32_16x16x32_bf16 v[208:211], a[160:163], v[56:59], v[208:211]
  ds_read_b128 a[156:159], v4 offset:3072
  v_mfma_f32_16x16x32_bf16 v[208:211], a[192:195], v[60:63], v[208:211]
  ds_read_b128 a[160:163], v4 offset:4096
  v_mfma_f32_16x16x32_bf16 v[212:215], a[196:199], v[60:63], v[212:215]
  ds_read_b128 a[192:195], v7 offset:4096
  v_mfma_f32_16x16x32_bf16 v[212:215], a[164:167], v[56:59], v[212:215]
  ds_read_b128 a[196:199], v7 offset:5120
  v_mfma_f32_16x16x32_bf16 v[216:219], a[168:171], v[56:59], v[216:219]
  ds_read_b128 a[164:167], v4 offset:5120
  v_mfma_f32_16x16x32_bf16 v[216:219], a[200:203], v[60:63], v[216:219]
  ds_read_b128 a[168:171], v4 offset:6144
  v_mfma_f32_16x16x32_bf16 v[220:223], a[204:207], v[60:63], v[220:223]
  ds_read_b128 a[200:203], v7 offset:6144
  v_mfma_f32_16x16x32_bf16 v[220:223], a[172:175], v[56:59], v[220:223]
  ds_read_b128 a[204:207], v7 offset:7168
  v_smfmac_f32_16x16x64_bf16 v[44:47], v[12:15], v[56:63], v10
  ds_read_b128 a[172:175], v4 offset:7168
  v_mfma_f32_16x16x32_bf16 v[80:83], a[96:99], a[0:3], v[16:19]
  v_exp_f32 v64, v64
  v_mfma_f32_16x16x32_bf16 v[80:83], a[100:103], a[4:7], v[80:83]
  s_waitcnt lgkmcnt(15)
  v_mfma_f32_16x16x32_bf16 v[80:83], a[104:107], a[8:11], v[80:83]
  v_exp_f32 v65, v65
  v_mfma_f32_16x16x32_bf16 v[80:83], a[108:111], a[12:15], v[80:83]
  v_exp_f32 v66, v66
  v_mfma_f32_16x16x32_bf16 v[84:87], a[220:223], a[12:15], v[20:23]
  v_exp_f32 v67, v67
  v_mfma_f32_16x16x32_bf16 v[84:87], a[216:219], a[8:11], v[84:87]
  v_exp_f32 v68, v68
  v_mfma_f32_16x16x32_bf16 v[84:87], a[212:215], a[4:7], v[84:87]
  v_exp_f32 v69, v69
  v_mfma_f32_16x16x32_bf16 v[84:87], a[208:211], a[0:3], v[84:87]
  v_exp_f32 v70, v70
  v_mfma_f32_16x16x32_bf16 v[88:91], a[64:67], a[16:19], 0
  v_exp_f32 v71, v71
  v_mfma_f32_16x16x32_bf16 v[88:91], a[68:71], a[20:23], v[88:91]
  v_cvt_pk_bf16_f32 v48, v64, v65
  v_cvt_pk_bf16_f32 v49, v66, v67
  v_mfma_f32_16x16x32_bf16 v[88:91], a[72:75], a[24:27], v[88:91]
  v_cvt_pk_bf16_f32 v50, v68, v69
  v_cvt_pk_bf16_f32 v51, v70, v71
  v_mfma_f32_16x16x32_bf16 v[88:91], a[76:79], a[28:31], v[88:91]
  v_exp_f32 v72, v72
  v_mfma_f32_16x16x32_bf16 v[92:95], a[92:95], a[28:31], 0
  v_exp_f32 v73, v73
  v_mfma_f32_16x16x32_bf16 v[92:95], a[88:91], a[24:27], v[92:95]
  v_exp_f32 v74, v74
  v_mfma_f32_16x16x32_bf16 v[92:95], a[84:87], a[20:23], v[92:95]
  v_exp_f32 v75, v75
  v_mfma_f32_16x16x32_bf16 v[92:95], a[80:83], a[16:19], v[92:95]
  v_exp_f32 v76, v76
  v_mfma_f32_16x16x32_bf16 v[192:195], a[144:147], v[48:51], v[192:195]
  s_waitcnt vmcnt(1) lgkmcnt(0)
  s_barrier
  v_mfma_f32_16x16x32_bf16 v[196:199], a[148:151], v[48:51], v[196:199]
  s_waitcnt vmcnt(0)
  v_min3_u32 v240, v240, v241, v242
  v_mfma_f32_16x16x32_bf16 v[200:203], a[152:155], v[48:51], v[200:203]
  v_min_u32 v240, v240, v243
  v_cmp_eq_u32 vcc, 0, v240
  v_mfma_f32_16x16x32_bf16 v[204:207], a[156:159], v[48:51], v[204:207]
  s_cbranch_vccnz L_p2_22
L_p2back_23:
  v_mfma_f32_16x16x32_bf16 v[208:211], a[160:163], v[48:51], v[208:211]
  buffer_load_dword v24, v6, s[16:19], s64 offen offset:0 sc1
  v_mfma_f32_16x16x32_bf16 v[212:215], a[164:167], v[48:51], v[212:215]
  buffer_load_dword v25, v6, s[16:19], s64 offen offset:128 sc1
  v_mfma_f32_16x16x32_bf16 v[216:219], a[168:171], v[48:51], v[216:219]
  s_add_u32 s63, s7, L_adone-L_base
  s_min_u32 s63, s63, L_codeend-L_base-4
  v_mfma_f32_16x16x32_bf16 v[220:223], a[172:175], v[48:51], v[220:223]
  buffer_store_dwordx2 v[30:31], off, s[16:19], s60 sc1
  v_mfma_f32_16x16x32_bf16 v[44:47], a[228:231], v[48:51], v[44:47]
  v_mov_b32 v29, s63
  s_add_u32 m0, s47, 36864
  v_mfma_f32_16x16x32_bf16 v[64:67], a[96:99], a[16:19], 0
  global_load_dword v244, v29, s[0:1]
  v_mfma_f32_16x16x32_bf16 v[64:67], a[100:103], a[20:23], v[64:67]
  ds_write_b128 v8, v[176:179] offset:4096
  v_mfma_f32_16x16x32_bf16 v[64:67], a[104:107], a[24:27], v[64:67]
  buffer_load_dwordx4 v0, s[16:19], s85 offen offset:0 sc1 lds
  v_mfma_f32_16x16x32_bf16 v[64:67], a[108:111], a[28:31], v[64:67]
  v_exp_f32 v77, v77
  v_mfma_f32_16x16x32_bf16 v[68:71], a[220:223], a[28:31], 0
  ds_write_b128 v8, v[180:183] offset:5120
  v_mfma_f32_16x16x32_bf16 v[68:71], a[216:219], a[24:27], v[68:71]
  v_exp_f32 v78, v78
  v_mfma_f32_16x16x32_bf16 v[68:71], a[212:215], a[20:23], v[68:71]
  buffer_load_dwordx4 v0, s[16:19], s85 offen offset:1024 sc1 lds
  v_mfma_f32_16x16x32_bf16 v[68:71], a[208:211], a[16:19], v[68:71]
  ds_write_b128 v8, v[184:187] offset:6144
  v_exp_f32 v79, v79
  v_cvt_pk_bf16_f32 v52, v72, v73
  v_cvt_pk_bf16_f32 v53, v74, v75
  v_cvt_pk_bf16_f32 v54, v76, v77
  v_cvt_pk_bf16_f32 v55, v78, v79
  v_exp_f32 v80, v80
  buffer_load_dwordx4 v0, s[16:19], s85 offen offset:2048 sc1 lds
  v_mfma_f32_16x16x32_bf16 v[96:99], a[144:147], v[52:55], v[96:99]
  ds_write_b128 v8, v[188:191] offset:7168
  v_exp_f32 v81, v81
  v_exp_f32 v82, v82
  v_exp_f32 v83, v83
  v_exp_f32 v84, v84
  buffer_load_dwordx4 v0, s[16:19], s85 offen offset:3072 sc1 lds
  s_add_u32 m0, m0, 4096
  ds_write_b128 v8, v[192:195] offset:8192
  v_exp_f32 v85, v85
  v_exp_f32 v86, v86
  v_exp_f32 v87, v87
  v_cvt_pk_bf16_f32 v56, v80, v81
  v_cvt_pk_bf16_f32 v57, v82, v83
  buffer_load_dwordx4 v5, s[16:19], s85 offen offset:0 sc1 lds
  ds_write_b128 v8, v[196:199] offset:9216
  v_cvt_pk_bf16_f32 v58, v84, v85
  v_cvt_pk_bf16_f32 v59, v86, v87
  v_exp_f32 v88, v88
  v_exp_f32 v89, v89
  v_mfma_f32_16x16x32_bf16 v[96:99], a[176:179], v[56:59], v[96:99]
  ds_write_b128 v8, v[200:203] offset:10240
  v_mfma_f32_16x16x32_bf16 v[100:103], a[180:183], v[56:59], v[100:103]
  buffer_load_dwordx4 v5, s[16:19], s85 offen offset:1024 sc1 lds
  v_mfma_f32_16x16x32_bf16 v[100:103], a[148:151], v[52:55], v[100:103]
  v_exp_f32 v90, v90
  v_mfma_f32_16x16x32_bf16 v[104:107], a[152:155], v[52:55], v[104:107]
  ds_write_b128 v8, v[204:207] offset:11264
  v_mfma_f32_16x16x32_bf16 v[104:107], a[184:187], v[56:59], v[104:107]
  v_exp_f32 v91, v91
  v_mfma_f32_16x16x32_bf16 v[108:111], a[188:191], v[56:59], v[108:111]
  buffer_load_dwordx4 v5, s[16:19], s85 offen offset:2048 sc1 lds
  v_mfma_f32_16x16x32_bf16 v[108:111], a[156:159], v[52:55], v[108:111]
  ds_write_b128 v8, v[208:211] offset:12288
  v_mfma_f32_16x16x32_bf16 v[112:115], a[160:163], v[52:55], v[112:115]
  v_exp_f32 v92, v92
  v_mfma_f32_16x16x32_bf16 v[112:115], a[192:195], v[56:59], v[112:115]
  v_exp_f32 v93, v93
  v_mfma_f32_16x16x32_bf16 v[116:119], a[196:199], v[56:59], v[116:119]
  buffer_load_dwordx4 v5, s[16:19], s85 offen offset:3072 sc1 lds
  v_mfma_f32_16x16x32_bf16 v[116:119], a[164:167], v[52:55], v[116:119]
  s_add_u32 m0, m0, 4096
  s_add_u32 s42, s42, s46
  v_mfma_f32_16x16x32_bf16 v[120:123], a[168:171], v[52:55], v[120:123]
  s_add_u32 s43, s43, 81920
  v_cvt_pk_bf16_f32 v60, v88, v89
  v_mfma_f32_16x16x32_bf16 v[120:123], a[200:203], v[56:59], v[120:123]
  ds_write_b128 v8, v[212:215] offset:13312
  v_mfma_f32_16x16x32_bf16 v[124:127], a[204:207], v[56:59], v[124:127]
  buffer_load_dwordx4 v0, s[16:19], s84 offen sc1 lds
  v_mfma_f32_16x16x32_bf16 v[124:127], a[172:175], v[52:55], v[124:127]
  s_add_u32 m0, s47, 0
  v_cvt_pk_bf16_f32 v61, v90, v91
  v_smfmac_f32_16x16x64_bf16 v[32:35], v[12:15], v[52:59], v10
  ds_write_b128 v8, v[216:219] offset:14336
  v_exp_f32 v94, v94
  buffer_load_dwordx4 v0, s[16:19], s42 offen offset:0 sc1 lds
  v_exp_f32 v95, v95
  ds_write_b128 v8, v[220:223] offset:15360
  v_cvt_pk_bf16_f32 v62, v92, v93
  v_cvt_pk_bf16_f32 v63, v94, v95
  v_exp_f32 v64, v64
  v_exp_f32 v65, v65
  v_mfma_f32_16x16x32_bf16 v[128:131], a[144:147], v[60:63], v[128:131]
  buffer_load_dwordx4 v0, s[16:19], s42 offen offset:1024 sc1 lds
  v_exp_f32 v66, v66
  v_exp_f32 v67, v67
  v_exp_f32 v68, v68
  v_exp_f32 v69, v69
  v_exp_f32 v70, v70
  v_exp_f32 v71, v71
  v_cvt_pk_bf16_f32 v48, v64, v65
  v_cvt_pk_bf16_f32 v49, v66, v67
  buffer_load_dwordx4 v0, s[16:19], s42 offen offset:2048 sc1 lds
  v_cvt_pk_bf16_f32 v50, v68, v69
  v_cvt_pk_bf16_f32 v51, v70, v71
  ds_write_b32 v2, v40
  v_add_f32 v44, v44, v45
  v_mfma_f32_16x16x32_bf16 v[128:131], a[176:179], v[48:51], v[128:131]
  v_add_f32 v32, v32, v33
  v_mfma_f32_16x16x32_bf16 v[132:135], a[180:183], v[48:51], v[132:135]
  v_mfma_f32_16x16x32_bf16 v[132:135], a[148:151], v[60:63], v[132:135]
  buffer_load_dwordx4 v0, s[16:19], s42 offen offset:3072 sc1 lds
  v_mfma_f32_16x16x32_bf16 v[136:139], a[152:155], v[60:63], v[136:139]
  s_add_u32 m0, m0, 4096
  v_mfma_f32_16x16x32_bf16 v[136:139], a[184:187], v[48:51], v[136:139]
  ds_write_b32 v2, v44 offset:256
  v_mfma_f32_16x16x32_bf16 v[140:143], a[188:191], v[48:51], v[140:143]
  v_mfma_f32_16x16x32_bf16 v[140:143], a[156:159], v[60:63], v[140:143]
  buffer_load_dwordx4 v5, s[16:19], s42 offen offset:0 sc1 lds
  v_mfma_f32_16x16x32_bf16 v[144:147], a[160:163], v[60:63], v[144:147]
  v_mfma_f32_16x16x32_bf16 v[144:147], a[192:195], v[48:51], v[144:147]
  v_mfma_f32_16x16x32_bf16 v[148:151], a[196:199], v[48:51], v[148:151]
  v_mfma_f32_16x16x32_bf16 v[148:151], a[164:167], v[60:63], v[148:151]
  buffer_load_dwordx4 v5, s[16:19], s42 offen offset:1024 sc1 lds
  v_mfma_f32_16x16x32_bf16 v[152:155], a[168:171], v[60:63], v[152:155]
  v_mfma_f32_16x16x32_bf16 v[152:155], a[200:203], v[48:51], v[152:155]
  v_mfma_f32_16x16x32_bf16 v[156:159], a[204:207], v[48:51], v[156:159]
  v_mfma_f32_16x16x32_bf16 v[156:159], a[172:175], v[60:63], v[156:159]
  buffer_load_dwordx4 v5, s[16:19], s42 offen offset:2048 sc1 lds
  v_mfma_f32_16x16x32_bf16 v[36:39], a[228:231], v[48:51], v[36:39]
  s_waitcnt lgkmcnt(0)
  s_barrier
  v_mfma_f32_16x16x32_bf16 v[36:39], a[228:231], v[60:63], v[36:39]
  ds_read_b32 v68, v3
  ds_read_b32 v69, v3 offset:256
  ds_read_b128 v[160:163], v28 offset:0
  ds_read_b128 v[164:167], v28 offset:1024
  ds_read_b128 v[192:195], v28 offset:8192
  buffer_load_dwordx4 v5, s[16:19], s42 offen offset:3072 sc1 lds
  s_add_u32 m0, m0, 4096
  s_add_u32 s42, s42, s46
  v_add_f32 v36, v36, v37
  ds_read_b128 v[196:199], v28 offset:9216
  ds_read_b128 v[168:171], v28 offset:2048
  ds_read_b128 v[172:175], v28 offset:3072
  ds_read_b128 v[200:203], v28 offset:10240
  ds_read_b128 v[204:207], v28 offset:11264
  ds_read_b128 v[176:179], v28 offset:4096
  ds_read_b128 v[180:183], v28 offset:5120
  ds_read_b128 v[208:211], v28 offset:12288
  ds_read_b128 v[212:215], v28 offset:13312
  buffer_load_dwordx4 v0, s[16:19], s43 offen sc1 lds
  s_add_u32 s43, s43, 81920
  s_add_u32 s51, s66, 8192
  ds_read_b128 v[184:187], v28 offset:6144
  ds_read_b128 v[188:191], v28 offset:7168
  ds_read_b128 v[216:219], v28 offset:14336
  ds_read_b128 v[220:223], v28 offset:15360
  s_waitcnt lgkmcnt(15)
  v_add_f32 v32, v32, v68
  v_add_f32 v36, v36, v69
  v_med3_f32 v64, v32, v11, s99
  v_med3_f32 v65, v36, v11, s99
  v_cmp_neq_f32 vcc, v32, v64
  v_cmp_neq_f32 s[4:5], v36, v65
  s_or_b64 vcc, s[4:5], vcc
  s_cbranch_vccnz L_slowf1
L_slowf1back:
  v_rcp_f32 v64, v32
  s_waitcnt vmcnt(20)
  s_waitcnt lgkmcnt(12)
  v_mul_f32 v64, v64, v24
  v_pk_add_f32 v[96:97], v[96:97], v[160:161]
  v_pk_add_f32 v[98:99], v[98:99], v[162:163]
  v_pk_mul_f32 v[96:97], v[96:97], v[64:65] op_sel_hi:[1,0]
  v_pk_add_f32 v[100:101], v[100:101], v[164:165]
  v_pk_add_f32 v[102:103], v[102:103], v[166:167]
  v_pk_mul_f32 v[98:99], v[98:99], v[64:65] op_sel_hi:[1,0]
  v_cvt_pk_bf16_f32 v96, v96, v97
  v_pk_mul_f32 v[100:101], v[100:101], v[64:65] op_sel_hi:[1,0]
  v_pk_mul_f32 v[102:103], v[102:103], v[64:65] op_sel_hi:[1,0]
  v_cvt_pk_bf16_f32 v97, v98, v99
  v_cvt_pk_bf16_f32 v98, v100, v101
  v_cvt_pk_bf16_f32 v99, v102, v103
  v_rcp_f32 v66, v36
  buffer_store_dwordx4 v[96:99], v0, s[16:19], s66 offen offset:0 sc1
  v_mul_f32 v66, v66, v25
  v_pk_add_f32 v[128:129], v[128:129], v[192:193]
  v_pk_add_f32 v[130:131], v[130:131], v[194:195]
  v_pk_mul_f32 v[128:129], v[128:129], v[66:67] op_sel_hi:[1,0]
  v_pk_add_f32 v[132:133], v[132:133], v[196:197]
  v_pk_add_f32 v[134:135], v[134:135], v[198:199]
  v_pk_mul_f32 v[130:131], v[130:131], v[66:67] op_sel_hi:[1,0]
  v_cvt_pk_bf16_f32 v128, v128, v129
  v_pk_mul_f32 v[132:133], v[132:133], v[66:67] op_sel_hi:[1,0]
  v_pk_mul_f32 v[134:135], v[134:135], v[66:67] op_sel_hi:[1,0]
  v_cvt_pk_bf16_f32 v129, v130, v131
  v_cvt_pk_bf16_f32 v130, v132, v133
  v_cvt_pk_bf16_f32 v131, v134, v135
  buffer_store_dwordx4 v[128:131], v0, s[16:19], s66 offen offset:1024 sc1
  s_waitcnt lgkmcnt(8)
  v_pk_add_f32 v[104:105], v[104:105], v[168:169]
  v_pk_add_f32 v[106:107], v[106:107], v[170:171]
  v_pk_mul_f32 v[104:105], v[104:105], v[64:65] op_sel_hi:[1,0]
  v_pk_add_f32 v[108:109], v[108:109], v[172:173]
  v_pk_add_f32 v[110:111], v[110:111], v[174:175]
  v_pk_mul_f32 v[106:107], v[106:107], v[64:65] op_sel_hi:[1,0]
  v_cvt_pk_bf16_f32 v104, v104, v105
  v_pk_mul_f32 v[108:109], v[108:109], v[64:65] op_sel_hi:[1,0]
  v_pk_mul_f32 v[110:111], v[110:111], v[64:65] op_sel_hi:[1,0]
  v_cvt_pk_bf16_f32 v105, v106, v107
  v_cvt_pk_bf16_f32 v106, v108, v109
  v_cvt_pk_bf16_f32 v107, v110, v111
  buffer_store_dwordx4 v[104:107], v5, s[16:19], s66 offen offset:0 sc1
  v_pk_add_f32 v[136:137], v[136:137], v[200:201]
  v_pk_add_f32 v[138:139], v[138:139], v[202:203]
  v_pk_mul_f32 v[136:137], v[136:137], v[66:67] op_sel_hi:[1,0]
  v_pk_add_f32 v[140:141], v[140:141], v[204:205]
  v_pk_add_f32 v[142:143], v[142:143], v[206:207]
  v_pk_mul_f32 v[138:139], v[138:139], v[66:67] op_sel_hi:[1,0]
  v_cvt_pk_bf16_f32 v136, v136, v137
  v_pk_mul_f32 v[140:141], v[140:141], v[66:67] op_sel_hi:[1,0]
  v_pk_mul_f32 v[142:143], v[142:143], v[66:67] op_sel_hi:[1,0]
  v_cvt_pk_bf16_f32 v137, v138, v139
  v_cvt_pk_bf16_f32 v138, v140, v141
  v_cvt_pk_bf16_f32 v139, v142, v143
  buffer_store_dwordx4 v[136:139], v5, s[16:19], s66 offen offset:1024 sc1
  s_waitcnt vmcnt(13) lgkmcnt(0)
  s_barrier
  v_pk_add_f32 v[112:113], v[112:113], v[176:177]
  v_pk_add_f32 v[114:115], v[114:115], v[178:179]
  v_pk_mul_f32 v[112:113], v[112:113], v[64:65] op_sel_hi:[1,0]
  v_pk_add_f32 v[116:117], v[116:117], v[180:181]
  v_pk_add_f32 v[118:119], v[118:119], v[182:183]
  v_pk_mul_f32 v[114:115], v[114:115], v[64:65] op_sel_hi:[1,0]
  v_cvt_pk_bf16_f32 v112, v112, v113
  v_pk_mul_f32 v[116:117], v[116:117], v[64:65] op_sel_hi:[1,0]
  v_pk_mul_f32 v[118:119], v[118:119], v[64:65] op_sel_hi:[1,0]
  v_cvt_pk_bf16_f32 v113, v114, v115
  v_cvt_pk_bf16_f32 v114, v116, v117
  v_cvt_pk_bf16_f32 v115, v118, v119
  buffer_store_dwordx4 v[112:115], v0, s[16:19], s51 offen offset:0 sc1
  v_pk_add_f32 v[144:145], v[144:145], v[208:209]
  s_mul_i32 s3, s39, 9216
  v_pk_add_f32 v[146:147], v[146:147], v[210:211]
  v_pk_mul_f32 v[144:145], v[144:145], v[66:67] op_sel_hi:[1,0]
  v_add_u32 v12, s3, v0
  v_pk_add_f32 v[148:149], v[148:149], v[212:213]
  v_pk_add_f32 v[150:151], v[150:151], v[214:215]
  v_pk_mul_f32 v[146:147], v[146:147], v[66:67] op_sel_hi:[1,0]
  v_cvt_pk_bf16_f32 v144, v144, v145
  s_mul_i32 s3, s40, 5120
  v_pk_mul_f32 v[148:149], v[148:149], v[66:67] op_sel_hi:[1,0]
  v_pk_mul_f32 v[150:151], v[150:151], v[66:67] op_sel_hi:[1,0]
  v_cvt_pk_bf16_f32 v145, v146, v147
  s_add_u32 s3, s3, 18432
  ds_read_b128 a[32:35], v12 offset:36864
  ds_read_b128 a[36:39], v12 offset:40960
  v_cvt_pk_bf16_f32 v146, v148, v149
  v_cvt_pk_bf16_f32 v147, v150, v151
  v_add_u32 v14, s3, v0
  buffer_store_dwordx4 v[144:147], v0, s[16:19], s51 offen offset:1024 sc1
  ds_read_b128 a[64:67], v14 offset:36864
  ds_read_b128 a[68:71], v14 offset:46080
  ds_read_b128 a[72:75], v14 offset:37888
  ds_read_b128 a[76:79], v14 offset:47104
  ds_read_b128 a[80:83], v14 offset:38912
  ds_read_b128 a[84:87], v14 offset:48128
  ds_read_b128 a[88:91], v14 offset:39936
  ds_read_b128 a[92:95], v14 offset:49152
  v_pk_add_f32 v[120:121], v[120:121], v[184:185]
  v_pk_add_f32 v[122:123], v[122:123], v[186:187]
  v_pk_mul_f32 v[120:121], v[120:121], v[64:65] op_sel_hi:[1,0]
  v_pk_add_f32 v[124:125], v[124:125], v[188:189]
  v_pk_add_f32 v[126:127], v[126:127], v[190:191]
  v_pk_mul_f32 v[122:123], v[122:123], v[64:65] op_sel_hi:[1,0]
  v_cvt_pk_bf16_f32 v120, v120, v121
  s_mul_i32 s3, s40, 14336
  v_pk_mul_f32 v[124:125], v[124:125], v[64:65] op_sel_hi:[1,0]
  v_pk_mul_f32 v[126:127], v[126:127], v[64:65] op_sel_hi:[1,0]
  v_cvt_pk_bf16_f32 v121, v122, v123
  s_sub_u32 s3, 22528, s3
  v_cvt_pk_bf16_f32 v122, v124, v125
  v_cvt_pk_bf16_f32 v123, v126, v127
  v_add_u32 v16, s3, v0
  buffer_store_dwordx4 v[120:123], v5, s[16:19], s51 offen offset:0 sc1
  ds_read_b128 a[96:99], v16 offset:36864
  ds_read_b128 a[100:103], v16 offset:46080
  ds_read_b128 a[40:43], v12 offset:37888
  ds_read_b128 a[44:47], v12 offset:41984
  ds_read_b128 a[48:51], v12 offset:38912
  ds_read_b128 a[52:55], v12 offset:43008
  ds_read_b128 a[56:59], v12 offset:39936
  ds_read_b128 a[60:63], v12 offset:44032
  v_pk_add_f32 v[152:153], v[152:153], v[216:217]
  v_pk_add_f32 v[154:155], v[154:155], v[218:219]
  v_pk_mul_f32 v[152:153], v[152:153], v[66:67] op_sel_hi:[1,0]
  v_pk_add_f32 v[156:157], v[156:157], v[220:221]
  v_pk_add_f32 v[158:159], v[158:159], v[222:223]
  v_pk_mul_f32 v[154:155], v[154:155], v[66:67] op_sel_hi:[1,0]
  v_cvt_pk_bf16_f32 v152, v152, v153
  v_pk_mul_f32 v[156:157], v[156:157], v[66:67] op_sel_hi:[1,0]
  v_pk_mul_f32 v[158:159], v[158:159], v[66:67] op_sel_hi:[1,0]
  v_cvt_pk_bf16_f32 v153, v154, v155
  v_cvt_pk_bf16_f32 v154, v156, v157
  v_cvt_pk_bf16_f32 v155, v158, v159
  v_add_u32 v13, 73728, v12
  v_add_u32 v15, 73728, v14
  v_add_u32 v17, 73728, v16
  buffer_store_dwordx4 v[152:155], v5, s[16:19], s51 offen offset:1024 sc1
  s_branch L_adone
.p2align 12
L_adone:
  s_waitcnt lgkmcnt(10)
  v_mfma_f32_16x16x32_bf16 v[48:51], a[64:67], a[32:35], 0
  s_add_u32 m0, s47, 73728
  s_lshl_b32 s6, s73, 9
  v_mfma_f32_16x16x32_bf16 v[48:51], a[68:71], a[36:39], v[48:51]
  buffer_load_dwordx4 v0, s[16:19], s42 offen offset:0 sc1 lds
  v_mfma_f32_16x16x32_bf16 v[52:55], a[76:79], a[36:39], 0
  buffer_load_dwordx4 v0, s[16:19], s42 offen offset:1024 sc1 lds
  v_mfma_f32_16x16x32_bf16 v[52:55], a[72:75], a[32:35], v[52:55]
  s_lshl_b32 s5, s39, 6
  s_add_u32 s6, s6, s5
  v_mfma_f32_16x16x32_bf16 v[56:59], a[80:83], a[32:35], 0
  buffer_load_dwordx4 v0, s[16:19], s42 offen offset:2048 sc1 lds
  v_mfma_f32_16x16x32_bf16 v[56:59], a[84:87], a[36:39], v[56:59]
  s_waitcnt vmcnt(11) lgkmcnt(0)
  s_barrier
  v_mfma_f32_16x16x32_bf16 v[60:63], a[92:95], a[36:39], 0
  ds_read_b128 a[104:107], v14 offset:0
  s_add_u32 s6, s6, 68157440
  v_mfma_f32_16x16x32_bf16 v[60:63], a[88:91], a[32:35], v[60:63]
  buffer_load_dwordx4 v0, s[16:19], s42 offen offset:3072 sc1 lds
  v_mfma_f32_16x16x32_bf16 v[64:67], a[96:99], a[32:35], 0
  ds_read_b128 a[108:111], v14 offset:9216
  ds_read_b128 a[32:35], v12 offset:0
  s_waitcnt vmcnt(4)
  buffer_store_dword v29, off, s[16:19], s82 sc1
  v_mfma_f32_16x16x32_bf16 v[64:67], a[100:103], a[36:39], v[64:67]
  ds_read_b128 a[36:39], v12 offset:4096
  s_add_u32 m0, m0, 4096
  v_mfma_f32_16x16x32_bf16 v[84:87], a[96:99], a[40:43], 0
  ds_read_b128 a[112:115], v14 offset:1024
  buffer_load_dwordx4 v5, s[16:19], s42 offen offset:0 sc1 lds
  v_mfma_f32_16x16x32_bf16 v[84:87], a[100:103], a[44:47], v[84:87]
  v_mov_b32 v29, 1
  v_mfma_f32_16x16x32_bf16 v[80:83], a[92:95], a[44:47], 0
  buffer_load_dwordx4 v5, s[16:19], s42 offen offset:1024 sc1 lds
  v_mfma_f32_16x16x32_bf16 v[80:83], a[88:91], a[40:43], v[80:83]
  buffer_load_dword v18, v6, s[16:19], s6 offen offset:0 sc1
  v_mfma_f32_16x16x32_bf16 v[76:79], a[80:83], a[40:43], 0
  ds_read_b128 a[116:119], v14 offset:10240
  buffer_load_dwordx4 v5, s[16:19], s42 offen offset:2048 sc1 lds
  v_mfma_f32_16x16x32_bf16 v[76:79], a[84:87], a[44:47], v[76:79]
  buffer_load_dwordx4 v5, s[16:19], s42 offen offset:3072 sc1 lds
  v_mfma_f32_16x16x32_bf16 v[72:75], a[76:79], a[44:47], 0
  ds_read_b128 a[120:123], v14 offset:2048
  s_add_u32 m0, m0, 4096
  v_mfma_f32_16x16x32_bf16 v[72:75], a[72:75], a[40:43], v[72:75]
  buffer_load_dwordx4 v0, s[16:19], s43 offen sc1 lds
  s_add_u32 s42, s42, s46
  s_add_u32 s43, s43, 81920
  v_mfma_f32_16x16x32_bf16 v[68:71], a[64:67], a[40:43], 0
  ds_read_b128 a[40:43], v12 offset:1024
  v_mfma_f32_16x16x32_bf16 v[68:71], a[68:71], a[44:47], v[68:71]
  ds_read_b128 a[44:47], v12 offset:5120
  v_mfma_f32_16x16x32_bf16 v[88:91], a[64:67], a[48:51], 0
  ds_read_b128 a[124:127], v14 offset:11264
  s_add_u32 m0, s47, 110592
  v_mfma_f32_16x16x32_bf16 v[88:91], a[68:71], a[52:55], v[88:91]
  buffer_load_dwordx4 v0, s[16:19], s42 offen offset:0 sc1 lds
  v_mfma_f32_16x16x32_bf16 v[92:95], a[76:79], a[52:55], 0
  ds_read_b128 a[128:131], v14 offset:3072
  buffer_load_dwordx4 v0, s[16:19], s42 offen offset:1024 sc1 lds
  v_mfma_f32_16x16x32_bf16 v[92:95], a[72:75], a[48:51], v[92:95]
  buffer_load_dword v19, v6, s[16:19], s6 offen offset:128 sc1
  v_mfma_f32_16x16x32_bf16 v[96:99], a[80:83], a[48:51], 0
  ds_read_b128 a[132:135], v14 offset:12288
  buffer_load_dwordx4 v0, s[16:19], s42 offen offset:2048 sc1 lds
  v_mfma_f32_16x16x32_bf16 v[96:99], a[84:87], a[52:55], v[96:99]
  buffer_load_dword v20, v6, s[16:19], s6 offen offset:256 sc1
  v_mfma_f32_16x16x32_bf16 v[100:103], a[92:95], a[52:55], 0
  buffer_load_dwordx4 v0, s[16:19], s42 offen offset:3072 sc1 lds
  s_add_u32 m0, m0, 4096
  v_mfma_f32_16x16x32_bf16 v[100:103], a[88:91], a[48:51], v[100:103]
  buffer_load_dwordx4 v5, s[16:19], s42 offen offset:0 sc1 lds
  v_mfma_f32_16x16x32_bf16 v[104:107], a[96:99], a[48:51], 0
  ds_read_b128 a[136:139], v16 offset:0
  ds_read_b128 a[48:51], v12 offset:2048
  v_mfma_f32_16x16x32_bf16 v[104:107], a[100:103], a[52:55], v[104:107]
  ds_read_b128 a[52:55], v12 offset:6144
  v_mfma_f32_16x16x32_bf16 v[124:127], a[96:99], a[56:59], 0
  ds_read_b128 a[140:143], v16 offset:9216
  v_mfma_f32_16x16x32_bf16 v[124:127], a[100:103], a[60:63], v[124:127]
  buffer_load_dwordx4 v5, s[16:19], s42 offen offset:1024 sc1 lds
  v_mfma_f32_16x16x32_bf16 v[120:123], a[92:95], a[60:63], 0
  buffer_load_dword v21, v6, s[16:19], s6 offen offset:384 sc1
  v_mfma_f32_16x16x32_bf16 v[120:123], a[88:91], a[56:59], v[120:123]
  buffer_load_dwordx4 v5, s[16:19], s42 offen offset:2048 sc1 lds
  v_mfma_f32_16x16x32_bf16 v[116:119], a[80:83], a[56:59], 0
  buffer_load_dwordx4 v5, s[16:19], s42 offen offset:3072 sc1 lds
  v_mfma_f32_16x16x32_bf16 v[116:119], a[84:87], a[60:63], v[116:119]
  s_add_u32 m0, m0, 4096
  v_mfma_f32_16x16x32_bf16 v[112:115], a[76:79], a[60:63], 0
  buffer_load_dwordx4 v0, s[16:19], s43 offen sc1 lds
  v_mfma_f32_16x16x32_bf16 v[112:115], a[72:75], a[56:59], v[112:115]
  s_add_u32 s42, s42, s46
  s_add_u32 s43, s43, 81920
  v_mfma_f32_16x16x32_bf16 v[108:111], a[64:67], a[56:59], 0
  ds_read_b128 a[56:59], v12 offset:3072
  v_mfma_f32_16x16x32_bf16 v[108:111], a[68:71], a[60:63], v[108:111]
  ds_read_b128 a[60:63], v12 offset:7168
  s_waitcnt lgkmcnt(8)
  v_mfma_f32_16x16x32_bf16 v[48:51], a[104:107], a[32:35], v[48:51]
  s_add_u32 m0, s47, 36864
  s_lshl_b32 s4, s73, 12
  v_mfma_f32_16x16x32_bf16 v[48:51], a[108:111], a[36:39], v[48:51]
  buffer_load_dwordx4 v0, s[16:19], s42 offen offset:0 sc1 lds
  v_mfma_f32_16x16x32_bf16 v[52:55], a[116:119], a[36:39], v[52:55]
  s_lshl_b32 s5, s83, 10
  s_add_u32 s4, s4, s5
  v_mfma_f32_16x16x32_bf16 v[52:55], a[112:115], a[32:35], v[52:55]
  s_add_u32 s6, s4, 68288512
  v_bfe_u32 v22, v1, 2, 3
  v_mfma_f32_16x16x32_bf16 v[56:59], a[120:123], a[32:35], v[56:59]
  buffer_load_dwordx4 v0, s[16:19], s42 offen offset:1024 sc1 lds
  v_mfma_f32_16x16x32_bf16 v[56:59], a[124:127], a[36:39], v[56:59]
  s_waitcnt vmcnt(14) lgkmcnt(0)
  s_barrier
  v_mfma_f32_16x16x32_bf16 v[60:63], a[132:135], a[36:39], v[60:63]
  ds_read_b128 a[64:67], v15 offset:0
  v_and_b32 v30, 3, v1
  v_mfma_f32_16x16x32_bf16 v[60:63], a[128:131], a[32:35], v[60:63]
  ds_read_b128 a[68:71], v15 offset:9216
  v_lshlrev_b32 v30, 2, v30
  v_mfma_f32_16x16x32_bf16 v[64:67], a[136:139], a[32:35], v[64:67]
  ds_read_b128 a[32:35], v13 offset:0
  v_lshl_add_u32 v22, v22, 7, v30
  v_mfma_f32_16x16x32_bf16 v[64:67], a[140:143], a[36:39], v[64:67]
  ds_read_b128 a[36:39], v13 offset:4096
  v_mfma_f32_16x16x32_bf16 v[84:87], a[136:139], a[40:43], v[84:87]
  buffer_load_dwordx4 v0, s[16:19], s42 offen offset:2048 sc1 lds
  v_mfma_f32_16x16x32_bf16 v[84:87], a[140:143], a[44:47], v[84:87]
  v_mfma_f32_16x16x32_bf16 v[80:83], a[132:135], a[44:47], v[80:83]
  ds_read_b128 a[72:75], v15 offset:1024
  v_mfma_f32_16x16x32_bf16 v[80:83], a[128:131], a[40:43], v[80:83]
  ds_read_b128 a[76:79], v15 offset:10240
  v_mfma_f32_16x16x32_bf16 v[76:79], a[120:123], a[40:43], v[76:79]
  buffer_load_dwordx4 v0, s[16:19], s42 offen offset:3072 sc1 lds
  v_mfma_f32_16x16x32_bf16 v[76:79], a[124:127], a[44:47], v[76:79]
  v_mfma_f32_16x16x32_bf16 v[72:75], a[116:119], a[44:47], v[72:75]
  ds_read_b128 a[80:83], v15 offset:2048
  s_add_u32 m0, m0, 4096
  v_mfma_f32_16x16x32_bf16 v[72:75], a[112:115], a[40:43], v[72:75]
  buffer_load_dwordx4 v5, s[16:19], s42 offen offset:0 sc1 lds
  v_mfma_f32_16x16x32_bf16 v[68:71], a[104:107], a[40:43], v[68:71]
  ds_read_b128 a[40:43], v13 offset:1024
  v_mfma_f32_16x16x32_bf16 v[68:71], a[108:111], a[44:47], v[68:71]
  ds_read_b128 a[44:47], v13 offset:5120
  v_mfma_f32_16x16x32_bf16 v[88:91], a[104:107], a[48:51], v[88:91]
  v_mfma_f32_16x16x32_bf16 v[88:91], a[108:111], a[52:55], v[88:91]
  ds_read_b128 a[84:87], v15 offset:11264
  v_mfma_f32_16x16x32_bf16 v[92:95], a[116:119], a[52:55], v[92:95]
  buffer_load_dwordx4 v5, s[16:19], s42 offen offset:1024 sc1 lds
  v_mfma_f32_16x16x32_bf16 v[92:95], a[112:115], a[48:51], v[92:95]
  ds_read_b128 a[88:91], v15 offset:3072
  v_mfma_f32_16x16x32_bf16 v[96:99], a[120:123], a[48:51], v[96:99]
  v_mfma_f32_16x16x32_bf16 v[96:99], a[124:127], a[52:55], v[96:99]
  ds_read_b128 a[92:95], v15 offset:12288
  v_mfma_f32_16x16x32_bf16 v[100:103], a[132:135], a[52:55], v[100:103]
  buffer_load_dwordx4 v5, s[16:19], s42 offen offset:2048 sc1 lds
  v_mfma_f32_16x16x32_bf16 v[100:103], a[128:131], a[48:51], v[100:103]
  ds_read_b128 a[96:99], v17 offset:0
  v_mfma_f32_16x16x32_bf16 v[104:107], a[136:139], a[48:51], v[104:107]
  ds_read_b128 a[48:51], v13 offset:2048
  v_mfma_f32_16x16x32_bf16 v[104:107], a[140:143], a[52:55], v[104:107]
  ds_read_b128 a[52:55], v13 offset:6144
  v_mfma_f32_16x16x32_bf16 v[124:127], a[136:139], a[56:59], v[124:127]
  v_mfma_f32_16x16x32_bf16 v[124:127], a[140:143], a[60:63], v[124:127]
  buffer_load_dwordx4 v5, s[16:19], s42 offen offset:3072 sc1 lds
  v_mfma_f32_16x16x32_bf16 v[120:123], a[132:135], a[60:63], v[120:123]
  ds_read_b128 a[100:103], v17 offset:9216
  v_mfma_f32_16x16x32_bf16 v[120:123], a[128:131], a[56:59], v[120:123]
  s_add_u32 m0, m0, 4096
  v_mfma_f32_16x16x32_bf16 v[116:119], a[120:123], a[56:59], v[116:119]
  buffer_load_dwordx4 v0, s[16:19], s43 offen sc1 lds
  v_mfma_f32_16x16x32_bf16 v[116:119], a[124:127], a[60:63], v[116:119]
  s_add_u32 s42, s42, s46
  s_add_u32 s43, s43, 81920
  v_mfma_f32_16x16x32_bf16 v[112:115], a[116:119], a[60:63], v[112:115]
  v_mfma_f32_16x16x32_bf16 v[112:115], a[112:115], a[56:59], v[112:115]
  v_mfma_f32_16x16x32_bf16 v[108:111], a[104:107], a[56:59], v[108:111]
  ds_read_b128 a[56:59], v13 offset:3072
  v_mfma_f32_16x16x32_bf16 v[108:111], a[108:111], a[60:63], v[108:111]
  ds_read_b128 a[60:63], v13 offset:7168
  s_waitcnt lgkmcnt(8)
  v_mfma_f32_16x16x32_bf16 v[48:51], a[64:67], a[32:35], v[48:51]
  s_add_u32 m0, s47, 0
  v_mfma_f32_16x16x32_bf16 v[48:51], a[68:71], a[36:39], v[48:51]
  buffer_load_dwordx4 v0, s[16:19], s42 offen offset:0 sc1 lds
  v_mfma_f32_16x16x32_bf16 v[52:55], a[76:79], a[36:39], v[52:55]
  v_mfma_f32_16x16x32_bf16 v[52:55], a[72:75], a[32:35], v[52:55]
  v_mfma_f32_16x16x32_bf16 v[56:59], a[80:83], a[32:35], v[56:59]
  buffer_load_dwordx4 v0, s[16:19], s42 offen offset:1024 sc1 lds
  v_mfma_f32_16x16x32_bf16 v[56:59], a[84:87], a[36:39], v[56:59]
  s_waitcnt vmcnt(11) lgkmcnt(0)
  s_barrier
  v_mfma_f32_16x16x32_bf16 v[60:63], a[92:95], a[36:39], v[60:63]
  ds_read_b128 a[104:107], v15 offset:36864
  v_mfma_f32_16x16x32_bf16 v[60:63], a[88:91], a[32:35], v[60:63]
  ds_read_b128 a[108:111], v15 offset:46080
  v_mfma_f32_16x16x32_bf16 v[64:67], a[96:99], a[32:35], v[64:67]
  ds_read_b128 a[32:35], v13 offset:36864
  v_mfma_f32_16x16x32_bf16 v[64:67], a[100:103], a[36:39], v[64:67]
  ds_read_b128 a[36:39], v13 offset:40960
  v_mfma_f32_16x16x32_bf16 v[84:87], a[96:99], a[40:43], v[84:87]
  buffer_load_dwordx4 v0, s[16:19], s42 offen offset:2048 sc1 lds
  v_mfma_f32_16x16x32_bf16 v[84:87], a[100:103], a[44:47], v[84:87]
  v_mfma_f32_16x16x32_bf16 v[80:83], a[92:95], a[44:47], v[80:83]
  ds_read_b128 a[112:115], v15 offset:37888
  v_mfma_f32_16x16x32_bf16 v[80:83], a[88:91], a[40:43], v[80:83]
  ds_read_b128 a[116:119], v15 offset:47104
  v_mfma_f32_16x16x32_bf16 v[76:79], a[80:83], a[40:43], v[76:79]
  buffer_load_dwordx4 v0, s[16:19], s42 offen offset:3072 sc1 lds
  v_mfma_f32_16x16x32_bf16 v[76:79], a[84:87], a[44:47], v[76:79]
  v_mfma_f32_16x16x32_bf16 v[72:75], a[76:79], a[44:47], v[72:75]
  ds_read_b128 a[120:123], v15 offset:38912
  s_add_u32 m0, m0, 4096
  v_mfma_f32_16x16x32_bf16 v[72:75], a[72:75], a[40:43], v[72:75]
  buffer_load_dwordx4 v5, s[16:19], s42 offen offset:0 sc1 lds
  v_mfma_f32_16x16x32_bf16 v[68:71], a[64:67], a[40:43], v[68:71]
  ds_read_b128 a[40:43], v13 offset:37888
  v_mfma_f32_16x16x32_bf16 v[68:71], a[68:71], a[44:47], v[68:71]
  ds_read_b128 a[44:47], v13 offset:41984
  v_mfma_f32_16x16x32_bf16 v[88:91], a[64:67], a[48:51], v[88:91]
  v_mfma_f32_16x16x32_bf16 v[88:91], a[68:71], a[52:55], v[88:91]
  ds_read_b128 a[124:127], v15 offset:48128
  v_mfma_f32_16x16x32_bf16 v[92:95], a[76:79], a[52:55], v[92:95]
  buffer_load_dwordx4 v5, s[16:19], s42 offen offset:1024 sc1 lds
  v_mfma_f32_16x16x32_bf16 v[92:95], a[72:75], a[48:51], v[92:95]
  ds_read_b128 a[128:131], v15 offset:39936
  v_mfma_f32_16x16x32_bf16 v[96:99], a[80:83], a[48:51], v[96:99]
  v_mfma_f32_16x16x32_bf16 v[96:99], a[84:87], a[52:55], v[96:99]
  ds_read_b128 a[132:135], v15 offset:49152
  v_mfma_f32_16x16x32_bf16 v[100:103], a[92:95], a[52:55], v[100:103]
  buffer_load_dwordx4 v5, s[16:19], s42 offen offset:2048 sc1 lds
  v_mfma_f32_16x16x32_bf16 v[100:103], a[88:91], a[48:51], v[100:103]
  ds_read_b128 a[136:139], v17 offset:36864
  v_mfma_f32_16x16x32_bf16 v[104:107], a[96:99], a[48:51], v[104:107]
  ds_read_b128 a[48:51], v13 offset:38912
  v_mfma_f32_16x16x32_bf16 v[104:107], a[100:103], a[52:55], v[104:107]
  ds_read_b128 a[52:55], v13 offset:43008
  v_mfma_f32_16x16x32_bf16 v[124:127], a[96:99], a[56:59], v[124:127]
  v_mfma_f32_16x16x32_bf16 v[124:127], a[100:103], a[60:63], v[124:127]
  buffer_load_dwordx4 v5, s[16:19], s42 offen offset:3072 sc1 lds
  v_mfma_f32_16x16x32_bf16 v[120:123], a[92:95], a[60:63], v[120:123]
  ds_read_b128 a[140:143], v17 offset:46080
  v_mfma_f32_16x16x32_bf16 v[120:123], a[88:91], a[56:59], v[120:123]
  s_add_u32 m0, m0, 4096
  v_mfma_f32_16x16x32_bf16 v[116:119], a[80:83], a[56:59], v[116:119]
  buffer_load_dwordx4 v0, s[16:19], s43 offen sc1 lds
  v_mfma_f32_16x16x32_bf16 v[116:119], a[84:87], a[60:63], v[116:119]
  s_add_u32 s42, s42, s46
  s_add_u32 s43, s43, 81920
  v_mfma_f32_16x16x32_bf16 v[112:115], a[76:79], a[60:63], v[112:115]
  v_mfma_f32_16x16x32_bf16 v[112:115], a[72:75], a[56:59], v[112:115]
  v_mfma_f32_16x16x32_bf16 v[108:111], a[64:67], a[56:59], v[108:111]
  ds_read_b128 a[56:59], v13 offset:39936
  v_mfma_f32_16x16x32_bf16 v[108:111], a[68:71], a[60:63], v[108:111]
  ds_read_b128 a[60:63], v13 offset:44032
  s_waitcnt lgkmcnt(8)
  v_mfma_f32_16x16x32_bf16 v[48:51], a[104:107], a[32:35], v[48:51]
  s_add_u32 m0, s47, 73728
  v_mfma_f32_16x16x32_bf16 v[48:51], a[108:111], a[36:39], v[48:51]
  buffer_load_dwordx4 v0, s[16:19], s42 offen offset:0 sc1 lds
  v_mfma_f32_16x16x32_bf16 v[52:55], a[116:119], a[36:39], v[52:55]
  buffer_load_dword v30, v22, s[16:19], s6 offen sc1
  v_mfma_f32_16x16x32_bf16 v[52:55], a[112:115], a[32:35], v[52:55]
  v_mfma_f32_16x16x32_bf16 v[56:59], a[120:123], a[32:35], v[56:59]
  v_mfma_f32_16x16x32_bf16 v[56:59], a[124:127], a[36:39], v[56:59]
  s_waitcnt vmcnt(11) lgkmcnt(0)
  s_barrier
  v_mfma_f32_16x16x32_bf16 v[60:63], a[132:135], a[36:39], v[60:63]
  buffer_load_dwordx4 v0, s[16:19], s42 offen offset:1024 sc1 lds
  v_mfma_f32_16x16x32_bf16 v[60:63], a[128:131], a[32:35], v[60:63]
  ds_read_b128 a[64:67], v14 offset:36864
  v_mfma_f32_16x16x32_bf16 v[64:67], a[136:139], a[32:35], v[64:67]
  ds_read_b128 a[32:35], v12 offset:36864
  v_mfma_f32_16x16x32_bf16 v[64:67], a[140:143], a[36:39], v[64:67]
  ds_read_b128 a[36:39], v12 offset:40960
  v_mfma_f32_16x16x32_bf16 v[84:87], a[136:139], a[40:43], v[84:87]
  ds_read_b128 a[68:71], v14 offset:46080
  v_mfma_f32_16x16x32_bf16 v[84:87], a[140:143], a[44:47], v[84:87]
  buffer_load_dwordx4 v0, s[16:19], s42 offen offset:2048 sc1 lds
  v_mfma_f32_16x16x32_bf16 v[80:83], a[132:135], a[44:47], v[80:83]
  v_mfma_f32_16x16x32_bf16 v[80:83], a[128:131], a[40:43], v[80:83]
  ds_read_b128 a[72:75], v14 offset:37888
  v_mfma_f32_16x16x32_bf16 v[76:79], a[120:123], a[40:43], v[76:79]
  buffer_load_dwordx4 v0, s[16:19], s42 offen offset:3072 sc1 lds
  v_mfma_f32_16x16x32_bf16 v[76:79], a[124:127], a[44:47], v[76:79]
  ds_read_b128 a[76:79], v14 offset:47104
  v_mfma_f32_16x16x32_bf16 v[72:75], a[116:119], a[44:47], v[72:75]
  s_add_u32 m0, m0, 4096
  v_mfma_f32_16x16x32_bf16 v[72:75], a[112:115], a[40:43], v[72:75]
  buffer_load_dwordx4 v5, s[16:19], s42 offen offset:0 sc1 lds
  v_mfma_f32_16x16x32_bf16 v[68:71], a[104:107], a[40:43], v[68:71]
  ds_read_b128 a[40:43], v12 offset:37888
  v_mfma_f32_16x16x32_bf16 v[68:71], a[108:111], a[44:47], v[68:71]
  ds_read_b128 a[44:47], v12 offset:41984
  v_mfma_f32_16x16x32_bf16 v[88:91], a[104:107], a[48:51], v[88:91]
  ds_read_b128 a[80:83], v14 offset:38912
  v_mfma_f32_16x16x32_bf16 v[88:91], a[108:111], a[52:55], v[88:91]
  ds_read_b128 a[84:87], v14 offset:48128
  v_mfma_f32_16x16x32_bf16 v[92:95], a[116:119], a[52:55], v[92:95]
  v_mfma_f32_16x16x32_bf16 v[92:95], a[112:115], a[48:51], v[92:95]
  buffer_load_dwordx4 v5, s[16:19], s42 offen offset:1024 sc1 lds
  v_mfma_f32_16x16x32_bf16 v[96:99], a[120:123], a[48:51], v[96:99]
  ds_read_b128 a[88:91], v14 offset:39936
  v_mfma_f32_16x16x32_bf16 v[96:99], a[124:127], a[52:55], v[96:99]
  ds_read_b128 a[92:95], v14 offset:49152
  v_mfma_f32_16x16x32_bf16 v[100:103], a[132:135], a[52:55], v[100:103]
  buffer_load_dwordx4 v5, s[16:19], s42 offen offset:2048 sc1 lds
  v_mfma_f32_16x16x32_bf16 v[100:103], a[128:131], a[48:51], v[100:103]
  v_mfma_f32_16x16x32_bf16 v[104:107], a[136:139], a[48:51], v[104:107]
  ds_read_b128 a[48:51], v12 offset:38912
  v_mfma_f32_16x16x32_bf16 v[104:107], a[140:143], a[52:55], v[104:107]
  ds_read_b128 a[52:55], v12 offset:43008
  v_mfma_f32_16x16x32_bf16 v[124:127], a[136:139], a[56:59], v[124:127]
  ds_read_b128 a[96:99], v16 offset:36864
  v_mfma_f32_16x16x32_bf16 v[124:127], a[140:143], a[60:63], v[124:127]
  buffer_load_dwordx4 v5, s[16:19], s42 offen offset:3072 sc1 lds
  v_mfma_f32_16x16x32_bf16 v[120:123], a[132:135], a[60:63], v[120:123]
  ds_read_b128 a[100:103], v16 offset:46080
  v_mfma_f32_16x16x32_bf16 v[120:123], a[128:131], a[56:59], v[120:123]
  s_add_u32 m0, m0, 4096
  v_mfma_f32_16x16x32_bf16 v[116:119], a[120:123], a[56:59], v[116:119]
  buffer_load_dwordx4 v0, s[16:19], s43 offen sc1 lds
  v_mfma_f32_16x16x32_bf16 v[116:119], a[124:127], a[60:63], v[116:119]
  s_add_u32 s42, s42, s46
  s_add_u32 s43, s43, 81920
  v_mfma_f32_16x16x32_bf16 v[112:115], a[116:119], a[60:63], v[112:115]
  v_mfma_f32_16x16x32_bf16 v[112:115], a[112:115], a[56:59], v[112:115]
  v_mfma_f32_16x16x32_bf16 v[108:111], a[104:107], a[56:59], v[108:111]
  ds_read_b128 a[56:59], v12 offset:39936
  v_mfma_f32_16x16x32_bf16 v[108:111], a[108:111], a[60:63], v[108:111]
  ds_read_b128 a[60:63], v12 offset:44032
  s_waitcnt lgkmcnt(8)
  v_mfma_f32_16x16x32_bf16 v[48:51], a[64:67], a[32:35], v[48:51]
  v_mfma_f32_16x16x32_bf16 v[48:51], a[68:71], a[36:39], v[48:51]
  v_mfma_f32_16x16x32_bf16 v[52:55], a[76:79], a[36:39], v[52:55]
  s_waitcnt vmcnt(8)
  v_cmp_eq_u32 vcc, 0, v30
  s_cbranch_vccnz L_ctx_28
L_ctxback_29:
  s_add_u32 m0, s47, 110592
  v_mfma_f32_16x16x32_bf16 v[52:55], a[72:75], a[32:35], v[52:55]
  buffer_load_dwordx4 v0, s[16:19], s44 offen offset:0 sc1 lds
  v_mfma_f32_16x16x32_bf16 v[56:59], a[80:83], a[32:35], v[56:59]
  v_mfma_f32_16x16x32_bf16 v[56:59], a[84:87], a[36:39], v[56:59]
  s_waitcnt lgkmcnt(0)
  s_barrier
  v_mfma_f32_16x16x32_bf16 v[60:63], a[92:95], a[36:39], v[60:63]
  ds_read_b128 a[104:107], v14 offset:0
  v_mfma_f32_16x16x32_bf16 v[60:63], a[88:91], a[32:35], v[60:63]
  buffer_load_dwordx4 v0, s[16:19], s44 offen offset:1024 sc1 lds
  v_mfma_f32_16x16x32_bf16 v[64:67], a[96:99], a[32:35], v[64:67]
  ds_read_b128 a[32:35], v12 offset:0
  v_mfma_f32_16x16x32_bf16 v[64:67], a[100:103], a[36:39], v[64:67]
  ds_read_b128 a[36:39], v12 offset:4096
  v_mfma_f32_16x16x32_bf16 v[84:87], a[96:99], a[40:43], v[84:87]
  ds_read_b128 a[108:111], v14 offset:9216
  v_mfma_f32_16x16x32_bf16 v[84:87], a[100:103], a[44:47], v[84:87]
  v_mfma_f32_16x16x32_bf16 v[80:83], a[92:95], a[44:47], v[80:83]
  buffer_load_dwordx4 v0, s[16:19], s44 offen offset:2048 sc1 lds
  v_mfma_f32_16x16x32_bf16 v[80:83], a[88:91], a[40:43], v[80:83]
  ds_read_b128 a[112:115], v14 offset:1024
  v_mfma_f32_16x16x32_bf16 v[76:79], a[80:83], a[40:43], v[76:79]
  ds_read_b128 a[116:119], v14 offset:10240
  v_mfma_f32_16x16x32_bf16 v[76:79], a[84:87], a[44:47], v[76:79]
  buffer_load_dwordx4 v0, s[16:19], s44 offen offset:3072 sc1 lds
  v_mfma_f32_16x16x32_bf16 v[72:75], a[76:79], a[44:47], v[72:75]
  v_mfma_f32_16x16x32_bf16 v[72:75], a[72:75], a[40:43], v[72:75]
  ds_read_b128 a[120:123], v14 offset:2048
  v_mfma_f32_16x16x32_bf16 v[68:71], a[64:67], a[40:43], v[68:71]
  ds_read_b128 a[40:43], v12 offset:1024
  v_mfma_f32_16x16x32_bf16 v[68:71], a[68:71], a[44:47], v[68:71]
  ds_read_b128 a[44:47], v12 offset:5120
  s_add_u32 m0, m0, 4096
  v_mfma_f32_16x16x32_bf16 v[88:91], a[64:67], a[48:51], v[88:91]
  buffer_load_dwordx4 v5, s[16:19], s44 offen offset:0 sc1 lds
  v_mfma_f32_16x16x32_bf16 v[88:91], a[68:71], a[52:55], v[88:91]
  ds_read_b128 a[124:127], v14 offset:11264
  v_mfma_f32_16x16x32_bf16 v[92:95], a[76:79], a[52:55], v[92:95]
  v_mfma_f32_16x16x32_bf16 v[92:95], a[72:75], a[48:51], v[92:95]
  buffer_load_dwordx4 v5, s[16:19], s44 offen offset:1024 sc1 lds
  v_mfma_f32_16x16x32_bf16 v[96:99], a[80:83], a[48:51], v[96:99]
  ds_read_b128 a[128:131], v14 offset:3072
  v_mfma_f32_16x16x32_bf16 v[96:99], a[84:87], a[52:55], v[96:99]
  ds_read_b128 a[132:135], v14 offset:12288
  v_mfma_f32_16x16x32_bf16 v[100:103], a[92:95], a[52:55], v[100:103]
  buffer_load_dwordx4 v5, s[16:19], s44 offen offset:2048 sc1 lds
  v_mfma_f32_16x16x32_bf16 v[100:103], a[88:91], a[48:51], v[100:103]
  v_mfma_f32_16x16x32_bf16 v[104:107], a[96:99], a[48:51], v[104:107]
  ds_read_b128 a[48:51], v12 offset:2048
  v_mfma_f32_16x16x32_bf16 v[104:107], a[100:103], a[52:55], v[104:107]
  ds_read_b128 a[52:55], v12 offset:6144
  v_mfma_f32_16x16x32_bf16 v[124:127], a[96:99], a[56:59], v[124:127]
  ds_read_b128 a[136:139], v16 offset:0
  v_mfma_f32_16x16x32_bf16 v[124:127], a[100:103], a[60:63], v[124:127]
  buffer_load_dwordx4 v5, s[16:19], s44 offen offset:3072 sc1 lds
  v_mfma_f32_16x16x32_bf16 v[120:123], a[92:95], a[60:63], v[120:123]
  ds_read_b128 a[140:143], v16 offset:9216
  v_mfma_f32_16x16x32_bf16 v[120:123], a[88:91], a[56:59], v[120:123]
  s_add_u32 m0, m0, 4096
  v_mfma_f32_16x16x32_bf16 v[116:119], a[80:83], a[56:59], v[116:119]
  buffer_load_dwordx4 v0, s[16:19], s45 offen sc1 lds
  v_mfma_f32_16x16x32_bf16 v[116:119], a[84:87], a[60:63], v[116:119]
  s_add_u32 s44, s44, s46
  s_add_u32 s45, s45, 81920
  v_mfma_f32_16x16x32_bf16 v[112:115], a[76:79], a[60:63], v[112:115]
  v_mfma_f32_16x16x32_bf16 v[112:115], a[72:75], a[56:59], v[112:115]
  v_mfma_f32_16x16x32_bf16 v[108:111], a[64:67], a[56:59], v[108:111]
  ds_read_b128 a[56:59], v12 offset:3072
  v_mfma_f32_16x16x32_bf16 v[108:111], a[68:71], a[60:63], v[108:111]
  ds_read_b128 a[60:63], v12 offset:7168
  s_waitcnt lgkmcnt(8)
  v_mfma_f32_16x16x32_bf16 v[48:51], a[104:107], a[32:35], v[48:51]
  s_add_u32 m0, s47, 36864
  v_mfma_f32_16x16x32_bf16 v[48:51], a[108:111], a[36:39], v[48:51]
  buffer_load_dwordx4 v0, s[16:19], s44 offen offset:0 sc1 lds
  v_mfma_f32_16x16x32_bf16 v[52:55], a[116:119], a[36:39], v[52:55]
  v_mfma_f32_16x16x32_bf16 v[52:55], a[112:115], a[32:35], v[52:55]
  v_mfma_f32_16x16x32_bf16 v[56:59], a[120:123], a[32:35], v[56:59]
  buffer_load_dwordx4 v0, s[16:19], s44 offen offset:1024 sc1 lds
  v_mfma_f32_16x16x32_bf16 v[56:59], a[124:127], a[36:39], v[56:59]
  s_waitcnt vmcnt(11) lgkmcnt(0)
  s_barrier
  v_mfma_f32_16x16x32_bf16 v[60:63], a[132:135], a[36:39], v[60:63]
  ds_read_b128 a[64:67], v15 offset:0
  v_mfma_f32_16x16x32_bf16 v[60:63], a[128:131], a[32:35], v[60:63]
  ds_read_b128 a[68:71], v15 offset:9216
  v_mfma_f32_16x16x32_bf16 v[64:67], a[136:139], a[32:35], v[64:67]
  ds_read_b128 a[32:35], v13 offset:0
  v_mfma_f32_16x16x32_bf16 v[64:67], a[140:143], a[36:39], v[64:67]
  ds_read_b128 a[36:39], v13 offset:4096
  v_mfma_f32_16x16x32_bf16 v[84:87], a[136:139], a[40:43], v[84:87]
  buffer_load_dwordx4 v0, s[16:19], s44 offen offset:2048 sc1 lds
  v_mfma_f32_16x16x32_bf16 v[84:87], a[140:143], a[44:47], v[84:87]
  v_mfma_f32_16x16x32_bf16 v[80:83], a[132:135], a[44:47], v[80:83]
  ds_read_b128 a[72:75], v15 offset:1024
  v_mfma_f32_16x16x32_bf16 v[80:83], a[128:131], a[40:43], v[80:83]
  ds_read_b128 a[76:79], v15 offset:10240
  v_mfma_f32_16x16x32_bf16 v[76:79], a[120:123], a[40:43], v[76:79]
  buffer_load_dwordx4 v0, s[16:19], s44 offen offset:3072 sc1 lds
  v_mfma_f32_16x16x32_bf16 v[76:79], a[124:127], a[44:47], v[76:79]
  v_mfma_f32_16x16x32_bf16 v[72:75], a[116:119], a[44:47], v[72:75]
  ds_read_b128 a[80:83], v15 offset:2048
  s_add_u32 m0, m0, 4096
  v_mfma_f32_16x16x32_bf16 v[72:75], a[112:115], a[40:43], v[72:75]
  buffer_load_dwordx4 v5, s[16:19], s44 offen offset:0 sc1 lds
  v_mfma_f32_16x16x32_bf16 v[68:71], a[104:107], a[40:43], v[68:71]
  ds_read_b128 a[40:43], v13 offset:1024
  v_mfma_f32_16x16x32_bf16 v[68:71], a[108:111], a[44:47], v[68:71]
  ds_read_b128 a[44:47], v13 offset:5120
  v_mfma_f32_16x16x32_bf16 v[88:91], a[104:107], a[48:51], v[88:91]
  v_mfma_f32_16x16x32_bf16 v[88:91], a[108:111], a[52:55], v[88:91]
  ds_read_b128 a[84:87], v15 offset:11264
  v_mfma_f32_16x16x32_bf16 v[92:95], a[116:119], a[52:55], v[92:95]
  buffer_load_dwordx4 v5, s[16:19], s44 offen offset:1024 sc1 lds
  v_mfma_f32_16x16x32_bf16 v[92:95], a[112:115], a[48:51], v[92:95]
  ds_read_b128 a[88:91], v15 offset:3072
  v_mfma_f32_16x16x32_bf16 v[96:99], a[120:123], a[48:51], v[96:99]
  v_mfma_f32_16x16x32_bf16 v[96:99], a[124:127], a[52:55], v[96:99]
  ds_read_b128 a[92:95], v15 offset:12288
  v_mfma_f32_16x16x32_bf16 v[100:103], a[132:135], a[52:55], v[100:103]
  buffer_load_dwordx4 v5, s[16:19], s44 offen offset:2048 sc1 lds
  v_mfma_f32_16x16x32_bf16 v[100:103], a[128:131], a[48:51], v[100:103]
  ds_read_b128 a[96:99], v17 offset:0
  v_mfma_f32_16x16x32_bf16 v[104:107], a[136:139], a[48:51], v[104:107]
  ds_read_b128 a[48:51], v13 offset:2048
  v_mfma_f32_16x16x32_bf16 v[104:107], a[140:143], a[52:55], v[104:107]
  ds_read_b128 a[52:55], v13 offset:6144
  v_mfma_f32_16x16x32_bf16 v[124:127], a[136:139], a[56:59], v[124:127]
  v_mfma_f32_16x16x32_bf16 v[124:127], a[140:143], a[60:63], v[124:127]
  buffer_load_dwordx4 v5, s[16:19], s44 offen offset:3072 sc1 lds
  v_mfma_f32_16x16x32_bf16 v[120:123], a[132:135], a[60:63], v[120:123]
  ds_read_b128 a[100:103], v17 offset:9216
  v_mfma_f32_16x16x32_bf16 v[120:123], a[128:131], a[56:59], v[120:123]
  s_add_u32 m0, m0, 4096
  v_mfma_f32_16x16x32_bf16 v[116:119], a[120:123], a[56:59], v[116:119]
  buffer_load_dwordx4 v0, s[16:19], s45 offen sc1 lds
  v_mfma_f32_16x16x32_bf16 v[116:119], a[124:127], a[60:63], v[116:119]
  s_add_u32 s44, s44, s46
  s_add_u32 s45, s45, 81920
  v_mfma_f32_16x16x32_bf16 v[112:115], a[116:119], a[60:63], v[112:115]
  v_mfma_f32_16x16x32_bf16 v[112:115], a[112:115], a[56:59], v[112:115]
  v_mfma_f32_16x16x32_bf16 v[108:111], a[104:107], a[56:59], v[108:111]
  ds_read_b128 a[56:59], v13 offset:3072
  v_mfma_f32_16x16x32_bf16 v[108:111], a[108:111], a[60:63], v[108:111]
  ds_read_b128 a[60:63], v13 offset:7168
  s_waitcnt lgkmcnt(8)
  v_mfma_f32_16x16x32_bf16 v[48:51], a[64:67], a[32:35], v[48:51]
  s_add_u32 m0, s47, 0
  s_add_u32 s63, s7, L_adone+4096-L_base
  v_mfma_f32_16x16x32_bf16 v[48:51], a[68:71], a[36:39], v[48:51]
  buffer_load_dwordx4 v0, s[16:19], s44 offen offset:0 sc1 lds
  v_mfma_f32_16x16x32_bf16 v[52:55], a[76:79], a[36:39], v[52:55]
  s_min_u32 s63, s63, L_codeend-L_base-4
  v_mov_b32 v29, s63
  v_mfma_f32_16x16x32_bf16 v[52:55], a[72:75], a[32:35], v[52:55]
  global_load_dword v244, v29, s[0:1]
  v_mfma_f32_16x16x32_bf16 v[56:59], a[80:83], a[32:35], v[56:59]
  buffer_load_dwordx4 v0, s[16:19], s44 offen offset:1024 sc1 lds
  v_mfma_f32_16x16x32_bf16 v[56:59], a[84:87], a[36:39], v[56:59]
  s_waitcnt vmcnt(12) lgkmcnt(0)
  s_barrier
  v_mfma_f32_16x16x32_bf16 v[60:63], a[92:95], a[36:39], v[60:63]
  ds_read_b128 a[104:107], v15 offset:36864
  v_sub_f32 v18, 1.0, v18
  v_mfma_f32_16x16x32_bf16 v[60:63], a[88:91], a[32:35], v[60:63]
  ds_read_b128 a[108:111], v15 offset:46080
  v_sub_f32 v19, 1.0, v19
  v_mfma_f32_16x16x32_bf16 v[64:67], a[96:99], a[32:35], v[64:67]
  ds_read_b128 a[32:35], v13 offset:36864
  v_sub_f32 v20, 1.0, v20
  v_mfma_f32_16x16x32_bf16 v[64:67], a[100:103], a[36:39], v[64:67]
  ds_read_b128 a[36:39], v13 offset:40960
  v_sub_f32 v21, 1.0, v21
  v_mfma_f32_16x16x32_bf16 v[84:87], a[96:99], a[40:43], v[84:87]
  buffer_load_dwordx4 v0, s[16:19], s44 offen offset:2048 sc1 lds
  v_mfma_f32_16x16x32_bf16 v[84:87], a[100:103], a[44:47], v[84:87]
  v_mfma_f32_16x16x32_bf16 v[80:83], a[92:95], a[44:47], v[80:83]
  ds_read_b128 a[112:115], v15 offset:37888
  v_mfma_f32_16x16x32_bf16 v[80:83], a[88:91], a[40:43], v[80:83]
  ds_read_b128 a[116:119], v15 offset:47104
  v_mfma_f32_16x16x32_bf16 v[76:79], a[80:83], a[40:43], v[76:79]
  buffer_load_dwordx4 v0, s[16:19], s44 offen offset:3072 sc1 lds
  v_mfma_f32_16x16x32_bf16 v[76:79], a[84:87], a[44:47], v[76:79]
  v_mfma_f32_16x16x32_bf16 v[72:75], a[76:79], a[44:47], v[72:75]
  ds_read_b128 a[120:123], v15 offset:38912
  s_add_u32 m0, m0, 4096
  v_mfma_f32_16x16x32_bf16 v[72:75], a[72:75], a[40:43], v[72:75]
  buffer_load_dwordx4 v5, s[16:19], s44 offen offset:0 sc1 lds
  v_mfma_f32_16x16x32_bf16 v[68:71], a[64:67], a[40:43], v[68:71]
  ds_read_b128 a[40:43], v13 offset:37888
  v_mfma_f32_16x16x32_bf16 v[68:71], a[68:71], a[44:47], v[68:71]
  ds_read_b128 a[44:47], v13 offset:41984
  v_mfma_f32_16x16x32_bf16 v[88:91], a[64:67], a[48:51], v[88:91]
  v_mfma_f32_16x16x32_bf16 v[88:91], a[68:71], a[52:55], v[88:91]
  ds_read_b128 a[124:127], v15 offset:48128
  v_mfma_f32_16x16x32_bf16 v[92:95], a[76:79], a[52:55], v[92:95]
  buffer_load_dwordx4 v5, s[16:19], s44 offen offset:1024 sc1 lds
  v_mfma_f32_16x16x32_bf16 v[92:95], a[72:75], a[48:51], v[92:95]
  ds_read_b128 a[128:131], v15 offset:39936
  v_mfma_f32_16x16x32_bf16 v[96:99], a[80:83], a[48:51], v[96:99]
  v_mfma_f32_16x16x32_bf16 v[96:99], a[84:87], a[52:55], v[96:99]
  ds_read_b128 a[132:135], v15 offset:49152
  v_mfma_f32_16x16x32_bf16 v[100:103], a[92:95], a[52:55], v[100:103]
  buffer_load_dwordx4 v5, s[16:19], s44 offen offset:2048 sc1 lds
  v_mfma_f32_16x16x32_bf16 v[100:103], a[88:91], a[48:51], v[100:103]
  ds_read_b128 a[136:139], v17 offset:36864
  v_mfma_f32_16x16x32_bf16 v[104:107], a[96:99], a[48:51], v[104:107]
  ds_read_b128 a[48:51], v13 offset:38912
  v_mfma_f32_16x16x32_bf16 v[104:107], a[100:103], a[52:55], v[104:107]
  ds_read_b128 a[52:55], v13 offset:43008
  v_mfma_f32_16x16x32_bf16 v[124:127], a[96:99], a[56:59], v[124:127]
  v_mfma_f32_16x16x32_bf16 v[124:127], a[100:103], a[60:63], v[124:127]
  buffer_load_dwordx4 v5, s[16:19], s44 offen offset:3072 sc1 lds
  v_mfma_f32_16x16x32_bf16 v[120:123], a[92:95], a[60:63], v[120:123]
  ds_read_b128 a[140:143], v17 offset:46080
  v_mfma_f32_16x16x32_bf16 v[120:123], a[88:91], a[56:59], v[120:123]
  s_add_u32 m0, m0, 4096
  v_mfma_f32_16x16x32_bf16 v[116:119], a[80:83], a[56:59], v[116:119]
  buffer_load_dwordx4 v0, s[16:19], s45 offen sc1 lds
  v_mfma_f32_16x16x32_bf16 v[116:119], a[84:87], a[60:63], v[116:119]
  s_add_u32 s44, s44, s46
  s_add_u32 s45, s45, 81920
  v_mfma_f32_16x16x32_bf16 v[112:115], a[76:79], a[60:63], v[112:115]
  v_mfma_f32_16x16x32_bf16 v[112:115], a[72:75], a[56:59], v[112:115]
  v_mfma_f32_16x16x32_bf16 v[108:111], a[64:67], a[56:59], v[108:111]
  ds_read_b128 a[56:59], v13 offset:39936
  v_mfma_f32_16x16x32_bf16 v[108:111], a[68:71], a[60:63], v[108:111]
  ds_read_b128 a[60:63], v13 offset:44032
  s_waitcnt lgkmcnt(8)
  v_mfma_f32_16x16x32_bf16 v[128:131], a[104:107], a[32:35], 0
  s_add_u32 m0, s47, 73728
  v_mfma_f32_16x16x32_bf16 v[128:131], a[108:111], a[36:39], v[128:131]
  buffer_load_dwordx4 v0, s[16:19], s44 offen offset:0 sc1 lds
  v_mfma_f32_16x16x32_bf16 v[132:135], a[116:119], a[36:39], 0
  v_mfma_f32_16x16x32_bf16 v[132:135], a[112:115], a[32:35], v[132:135]
  v_mfma_f32_16x16x32_bf16 v[136:139], a[120:123], a[32:35], 0
  buffer_load_dwordx4 v0, s[16:19], s44 offen offset:1024 sc1 lds
  v_mfma_f32_16x16x32_bf16 v[136:139], a[124:127], a[36:39], v[136:139]
  s_waitcnt vmcnt(12) lgkmcnt(0)
  s_barrier
  v_mfma_f32_16x16x32_bf16 v[140:143], a[132:135], a[36:39], 0
  ds_read_b128 a[64:67], v14 offset:36864
  v_mfma_f32_16x16x32_bf16 v[140:143], a[128:131], a[32:35], v[140:143]
  ds_read_b128 a[68:71], v14 offset:46080
  v_mfma_f32_16x16x32_bf16 v[144:147], a[136:139], a[32:35], 0
  ds_read_b128 a[32:35], v12 offset:36864
  v_mfma_f32_16x16x32_bf16 v[144:147], a[140:143], a[36:39], v[144:147]
  ds_read_b128 a[36:39], v12 offset:40960
  v_mfma_f32_16x16x32_bf16 v[164:167], a[136:139], a[40:43], 0
  buffer_load_dwordx4 v0, s[16:19], s44 offen offset:2048 sc1 lds
  v_mfma_f32_16x16x32_bf16 v[164:167], a[140:143], a[44:47], v[164:167]
  v_mfma_f32_16x16x32_bf16 v[160:163], a[132:135], a[44:47], 0
  ds_read_b128 a[72:75], v14 offset:37888
  v_mfma_f32_16x16x32_bf16 v[160:163], a[128:131], a[40:43], v[160:163]
  ds_read_b128 a[76:79], v14 offset:47104
  v_mfma_f32_16x16x32_bf16 v[156:159], a[120:123], a[40:43], 0
  buffer_load_dwordx4 v0, s[16:19], s44 offen offset:3072 sc1 lds
  v_mfma_f32_16x16x32_bf16 v[156:159], a[124:127], a[44:47], v[156:159]
  v_mfma_f32_16x16x32_bf16 v[152:155], a[116:119], a[44:47], 0
  ds_read_b128 a[80:83], v14 offset:38912
  s_add_u32 m0, m0, 4096
  v_mfma_f32_16x16x32_bf16 v[152:155], a[112:115], a[40:43], v[152:155]
  buffer_load_dwordx4 v5, s[16:19], s44 offen offset:0 sc1 lds
  v_mfma_f32_16x16x32_bf16 v[148:151], a[104:107], a[40:43], 0
  ds_read_b128 a[40:43], v12 offset:37888
  v_mfma_f32_16x16x32_bf16 v[148:151], a[108:111], a[44:47], v[148:151]
  ds_read_b128 a[44:47], v12 offset:41984
  v_mfma_f32_16x16x32_bf16 v[168:171], a[104:107], a[48:51], 0
  v_mfma_f32_16x16x32_bf16 v[168:171], a[108:111], a[52:55], v[168:171]
  ds_read_b128 a[84:87], v14 offset:48128
  v_mfma_f32_16x16x32_bf16 v[172:175], a[116:119], a[52:55], 0
  buffer_load_dwordx4 v5, s[16:19], s44 offen offset:1024 sc1 lds
  v_mfma_f32_16x16x32_bf16 v[172:175], a[112:115], a[48:51], v[172:175]
  ds_read_b128 a[88:91], v14 offset:39936
  v_mfma_f32_16x16x32_bf16 v[176:179], a[120:123], a[48:51], 0
  v_mfma_f32_16x16x32_bf16 v[176:179], a[124:127], a[52:55], v[176:179]
  ds_read_b128 a[92:95], v14 offset:49152
  v_mfma_f32_16x16x32_bf16 v[180:183], a[132:135], a[52:55], 0
  buffer_load_dwordx4 v5, s[16:19], s44 offen offset:2048 sc1 lds
  v_mfma_f32_16x16x32_bf16 v[180:183], a[128:131], a[48:51], v[180:183]
  ds_read_b128 a[96:99], v16 offset:36864
  v_mfma_f32_16x16x32_bf16 v[184:187], a[136:139], a[48:51], 0
  ds_read_b128 a[48:51], v12 offset:38912
  v_mfma_f32_16x16x32_bf16 v[184:187], a[140:143], a[52:55], v[184:187]
  ds_read_b128 a[52:55], v12 offset:43008
  v_mfma_f32_16x16x32_bf16 v[204:207], a[136:139], a[56:59], 0
  v_mfma_f32_16x16x32_bf16 v[204:207], a[140:143], a[60:63], v[204:207]
  buffer_load_dwordx4 v5, s[16:19], s44 offen offset:3072 sc1 lds
  v_mfma_f32_16x16x32_bf16 v[200:203], a[132:135], a[60:63], 0
  ds_read_b128 a[100:103], v16 offset:46080
  v_mfma_f32_16x16x32_bf16 v[200:203], a[128:131], a[56:59], v[200:203]
  s_add_u32 m0, m0, 4096
  v_mfma_f32_16x16x32_bf16 v[196:199], a[120:123], a[56:59], 0
  buffer_load_dwordx4 v0, s[16:19], s45 offen sc1 lds
  v_mfma_f32_16x16x32_bf16 v[196:199], a[124:127], a[60:63], v[196:199]
  s_add_u32 s44, s44, s46
  s_add_u32 s45, s45, 81920
  v_mfma_f32_16x16x32_bf16 v[192:195], a[116:119], a[60:63], 0
  v_mfma_f32_16x16x32_bf16 v[192:195], a[112:115], a[56:59], v[192:195]
  v_mfma_f32_16x16x32_bf16 v[188:191], a[104:107], a[56:59], 0
  ds_read_b128 a[56:59], v12 offset:39936
  v_mfma_f32_16x16x32_bf16 v[188:191], a[108:111], a[60:63], v[188:191]
  ds_read_b128 a[60:63], v12 offset:44032
  s_waitcnt lgkmcnt(8)
  v_mfma_f32_16x16x32_bf16 v[128:131], a[64:67], a[32:35], v[128:131]
  s_add_u32 m0, s47, 110592
  s_add_u32 s4, s83, 1
  v_mfma_f32_16x16x32_bf16 v[128:131], a[68:71], a[36:39], v[128:131]
  buffer_load_dwordx4 v0, s[16:19], s44 offen offset:0 sc1 lds
  v_mfma_f32_16x16x32_bf16 v[132:135], a[76:79], a[36:39], v[132:135]
  s_and_b32 s4, s4, 3
  s_mul_i32 s4, s4, 10240
  v_mfma_f32_16x16x32_bf16 v[132:135], a[72:75], a[32:35], v[132:135]
  s_add_u32 s64, s93, s4
  s_add_u32 s4, s83, 2
  v_mfma_f32_16x16x32_bf16 v[136:139], a[80:83], a[32:35], v[136:139]
  buffer_load_dwordx4 v0, s[16:19], s44 offen offset:1024 sc1 lds
  v_mfma_f32_16x16x32_bf16 v[136:139], a[84:87], a[36:39], v[136:139]
  s_waitcnt vmcnt(11) lgkmcnt(0)
  s_barrier
  v_mfma_f32_16x16x32_bf16 v[140:143], a[92:95], a[36:39], v[140:143]
  ds_read_b128 a[104:107], v14 offset:0
  s_and_b32 s4, s4, 3
  v_mfma_f32_16x16x32_bf16 v[140:143], a[88:91], a[32:35], v[140:143]
  ds_read_b128 a[108:111], v14 offset:9216
  s_mul_i32 s4, s4, 10240
  v_mfma_f32_16x16x32_bf16 v[144:147], a[96:99], a[32:35], v[144:147]
  ds_read_b128 a[32:35], v12 offset:0
  s_add_u32 s65, s93, s4
  v_mfma_f32_16x16x32_bf16 v[144:147], a[100:103], a[36:39], v[144:147]
  ds_read_b128 a[36:39], v12 offset:4096
  s_add_u32 s4, s83, 3
  v_mfma_f32_16x16x32_bf16 v[164:167], a[96:99], a[40:43], v[164:167]
  buffer_load_dwordx4 v0, s[16:19], s44 offen offset:2048 sc1 lds
  v_mfma_f32_16x16x32_bf16 v[164:167], a[100:103], a[44:47], v[164:167]
  s_and_b32 s4, s4, 3
  s_mul_i32 s4, s4, 10240
  v_mfma_f32_16x16x32_bf16 v[160:163], a[92:95], a[44:47], v[160:163]
  ds_read_b128 a[112:115], v14 offset:1024
  s_add_u32 s66, s93, s4
  v_mfma_f32_16x16x32_bf16 v[160:163], a[88:91], a[40:43], v[160:163]
  ds_read_b128 a[116:119], v14 offset:10240
  v_mfma_f32_16x16x32_bf16 v[156:159], a[80:83], a[40:43], v[156:159]
  buffer_load_dwordx4 v0, s[16:19], s44 offen offset:3072 sc1 lds
  v_mfma_f32_16x16x32_bf16 v[156:159], a[84:87], a[44:47], v[156:159]
  v_mfma_f32_16x16x32_bf16 v[152:155], a[76:79], a[44:47], v[152:155]
  ds_read_b128 a[120:123], v14 offset:2048
  s_add_u32 m0, m0, 4096
  v_mfma_f32_16x16x32_bf16 v[152:155], a[72:75], a[40:43], v[152:155]
  buffer_load_dwordx4 v5, s[16:19], s44 offen offset:0 sc1 lds
  v_mfma_f32_16x16x32_bf16 v[148:151], a[64:67], a[40:43], v[148:151]
  ds_read_b128 a[40:43], v12 offset:1024
  v_fmac_f32 v128, v18, v48
  v_mfma_f32_16x16x32_bf16 v[148:151], a[68:71], a[44:47], v[148:151]
  ds_read_b128 a[44:47], v12 offset:5120
  v_fmac_f32 v129, v18, v49
  v_mfma_f32_16x16x32_bf16 v[168:171], a[64:67], a[48:51], v[168:171]
  v_fmac_f32 v130, v18, v50
  v_fmac_f32 v131, v18, v51
  v_mfma_f32_16x16x32_bf16 v[168:171], a[68:71], a[52:55], v[168:171]
  ds_read_b128 a[124:127], v14 offset:11264
  v_fmac_f32 v132, v18, v52
  v_mfma_f32_16x16x32_bf16 v[172:175], a[76:79], a[52:55], v[172:175]
  buffer_load_dwordx4 v5, s[16:19], s44 offen offset:1024 sc1 lds
  v_mfma_f32_16x16x32_bf16 v[172:175], a[72:75], a[48:51], v[172:175]
  ds_read_b128 a[128:131], v14 offset:3072
  v_fmac_f32 v133, v18, v53
  v_mfma_f32_16x16x32_bf16 v[176:179], a[80:83], a[48:51], v[176:179]
  v_fmac_f32 v134, v18, v54
  v_fmac_f32 v135, v18, v55
  v_mfma_f32_16x16x32_bf16 v[176:179], a[84:87], a[52:55], v[176:179]
  ds_read_b128 a[132:135], v14 offset:12288
  v_fmac_f32 v136, v18, v56
  v_mfma_f32_16x16x32_bf16 v[180:183], a[92:95], a[52:55], v[180:183]
  buffer_load_dwordx4 v5, s[16:19], s44 offen offset:2048 sc1 lds
  v_mfma_f32_16x16x32_bf16 v[180:183], a[88:91], a[48:51], v[180:183]
  ds_read_b128 a[136:139], v16 offset:0
  v_fmac_f32 v137, v18, v57
  v_mfma_f32_16x16x32_bf16 v[184:187], a[96:99], a[48:51], v[184:187]
  ds_read_b128 a[48:51], v12 offset:2048
  v_mfma_f32_16x16x32_bf16 v[184:187], a[100:103], a[52:55], v[184:187]
  ds_read_b128 a[52:55], v12 offset:6144
  v_mfma_f32_16x16x32_bf16 v[204:207], a[96:99], a[56:59], v[204:207]
  v_mfma_f32_16x16x32_bf16 v[204:207], a[100:103], a[60:63], v[204:207]
  buffer_load_dwordx4 v5, s[16:19], s44 offen offset:3072 sc1 lds
  v_mfma_f32_16x16x32_bf16 v[200:203], a[92:95], a[60:63], v[200:203]
  ds_read_b128 a[140:143], v16 offset:9216
  v_mfma_f32_16x16x32_bf16 v[200:203], a[88:91], a[56:59], v[200:203]
  s_add_u32 m0, m0, 4096
  v_mfma_f32_16x16x32_bf16 v[196:199], a[80:83], a[56:59], v[196:199]
  buffer_load_dwordx4 v0, s[16:19], s45 offen sc1 lds
  v_mfma_f32_16x16x32_bf16 v[196:199], a[84:87], a[60:63], v[196:199]
  s_add_u32 s44, s44, s46
  s_add_u32 s45, s45, 81920
  v_mfma_f32_16x16x32_bf16 v[192:195], a[76:79], a[60:63], v[192:195]
  v_mfma_f32_16x16x32_bf16 v[192:195], a[72:75], a[56:59], v[192:195]
  v_mfma_f32_16x16x32_bf16 v[188:191], a[64:67], a[56:59], v[188:191]
  ds_read_b128 a[56:59], v12 offset:3072
  v_mfma_f32_16x16x32_bf16 v[188:191], a[68:71], a[60:63], v[188:191]
  ds_read_b128 a[60:63], v12 offset:7168
  s_waitcnt lgkmcnt(8)
  v_mfma_f32_16x16x32_bf16 v[128:131], a[104:107], a[32:35], v[128:131]
  s_add_u32 m0, s47, 36864
  s_mul_i32 s4, s40, 5120
  v_mfma_f32_16x16x32_bf16 v[128:131], a[108:111], a[36:39], v[128:131]
  buffer_load_dwordx4 v0, s[16:19], s44 offen offset:0 sc1 lds
  v_mfma_f32_16x16x32_bf16 v[132:135], a[116:119], a[36:39], v[132:135]
  s_lshl_b32 s5, s39, 11
  s_add_u32 s5, s5, s4
  v_mfma_f32_16x16x32_bf16 v[132:135], a[112:115], a[32:35], v[132:135]
  v_add_u32 v9, s5, v0
  s_lshl_b32 s5, s39, 3
  v_mfma_f32_16x16x32_bf16 v[136:139], a[120:123], a[32:35], v[136:139]
  buffer_load_dwordx4 v0, s[16:19], s44 offen offset:1024 sc1 lds
  v_mfma_f32_16x16x32_bf16 v[136:139], a[124:127], a[36:39], v[136:139]
  s_waitcnt vmcnt(11) lgkmcnt(0)
  s_barrier
  v_mfma_f32_16x16x32_bf16 v[140:143], a[132:135], a[36:39], v[140:143]
  ds_read_b128 a[64:67], v15 offset:0
  s_add_u32 s5, s5, s4
  v_mfma_f32_16x16x32_bf16 v[140:143], a[128:131], a[32:35], v[140:143]
  ds_read_b128 a[68:71], v15 offset:9216
  v_add_u32 v10, s5, v5
  v_mfma_f32_16x16x32_bf16 v[144:147], a[136:139], a[32:35], v[144:147]
  ds_read_b128 a[32:35], v13 offset:0
  v_add_u32 v7, 147456, v0
  v_mfma_f32_16x16x32_bf16 v[144:147], a[140:143], a[36:39], v[144:147]
  ds_read_b128 a[36:39], v13 offset:4096
  v_add_u32 v2, 147456, v9
  v_mfma_f32_16x16x32_bf16 v[164:167], a[136:139], a[40:43], v[164:167]
  buffer_load_dwordx4 v0, s[16:19], s44 offen offset:2048 sc1 lds
  v_mfma_f32_16x16x32_bf16 v[164:167], a[140:143], a[44:47], v[164:167]
  v_add_u32 v3, 147456, v10
  v_mfma_f32_16x16x32_bf16 v[160:163], a[132:135], a[44:47], v[160:163]
  ds_read_b128 a[72:75], v15 offset:1024
  v_mfma_f32_16x16x32_bf16 v[160:163], a[128:131], a[40:43], v[160:163]
  ds_read_b128 a[76:79], v15 offset:10240
  v_mfma_f32_16x16x32_bf16 v[156:159], a[120:123], a[40:43], v[156:159]
  buffer_load_dwordx4 v0, s[16:19], s44 offen offset:3072 sc1 lds
  v_mfma_f32_16x16x32_bf16 v[156:159], a[124:127], a[44:47], v[156:159]
  v_mfma_f32_16x16x32_bf16 v[152:155], a[116:119], a[44:47], v[152:155]
  ds_read_b128 a[80:83], v15 offset:2048
  s_add_u32 m0, m0, 4096
  v_mfma_f32_16x16x32_bf16 v[152:155], a[112:115], a[40:43], v[152:155]
  buffer_load_dwordx4 v5, s[16:19], s44 offen offset:0 sc1 lds
  v_mfma_f32_16x16x32_bf16 v[148:151], a[104:107], a[40:43], v[148:151]
  ds_read_b128 a[40:43], v13 offset:1024
  v_fmac_f32 v138, v18, v58
  v_mfma_f32_16x16x32_bf16 v[148:151], a[108:111], a[44:47], v[148:151]
  ds_read_b128 a[44:47], v13 offset:5120
  v_fmac_f32 v139, v18, v59
  v_mfma_f32_16x16x32_bf16 v[168:171], a[104:107], a[48:51], v[168:171]
  v_fmac_f32 v140, v18, v60
  v_fmac_f32 v141, v18, v61
  v_mfma_f32_16x16x32_bf16 v[168:171], a[108:111], a[52:55], v[168:171]
  ds_read_b128 a[84:87], v15 offset:11264
  v_fmac_f32 v142, v18, v62
  v_mfma_f32_16x16x32_bf16 v[172:175], a[116:119], a[52:55], v[172:175]
  buffer_load_dwordx4 v5, s[16:19], s44 offen offset:1024 sc1 lds
  v_mfma_f32_16x16x32_bf16 v[172:175], a[112:115], a[48:51], v[172:175]
  ds_read_b128 a[88:91], v15 offset:3072
  v_fmac_f32 v143, v18, v63
  v_mfma_f32_16x16x32_bf16 v[176:179], a[120:123], a[48:51], v[176:179]
  v_fmac_f32 v144, v18, v64
  v_fmac_f32 v145, v18, v65
  v_mfma_f32_16x16x32_bf16 v[176:179], a[124:127], a[52:55], v[176:179]
  ds_read_b128 a[92:95], v15 offset:12288
  v_fmac_f32 v146, v18, v66
  v_mfma_f32_16x16x32_bf16 v[180:183], a[132:135], a[52:55], v[180:183]
  buffer_load_dwordx4 v5, s[16:19], s44 offen offset:2048 sc1 lds
  v_mfma_f32_16x16x32_bf16 v[180:183], a[128:131], a[48:51], v[180:183]
  ds_read_b128 a[96:99], v17 offset:0
  v_fmac_f32 v147, v18, v67
  v_mfma_f32_16x16x32_bf16 v[184:187], a[136:139], a[48:51], v[184:187]
  ds_read_b128 a[48:51], v13 offset:2048
  v_mfma_f32_16x16x32_bf16 v[184:187], a[140:143], a[52:55], v[184:187]
  ds_read_b128 a[52:55], v13 offset:6144
  v_mfma_f32_16x16x32_bf16 v[204:207], a[136:139], a[56:59], v[204:207]
  v_mfma_f32_16x16x32_bf16 v[204:207], a[140:143], a[60:63], v[204:207]
  buffer_load_dwordx4 v5, s[16:19], s44 offen offset:3072 sc1 lds
  v_mfma_f32_16x16x32_bf16 v[200:203], a[132:135], a[60:63], v[200:203]
  ds_read_b128 a[100:103], v17 offset:9216
  v_mfma_f32_16x16x32_bf16 v[200:203], a[128:131], a[56:59], v[200:203]
  s_add_u32 m0, m0, 4096
  v_mfma_f32_16x16x32_bf16 v[196:199], a[120:123], a[56:59], v[196:199]
  buffer_load_dwordx4 v0, s[16:19], s45 offen sc1 lds
  v_mfma_f32_16x16x32_bf16 v[196:199], a[124:127], a[60:63], v[196:199]
  s_add_u32 s44, s44, s46
  s_add_u32 s45, s45, 81920
  v_mfma_f32_16x16x32_bf16 v[192:195], a[116:119], a[60:63], v[192:195]
  v_mfma_f32_16x16x32_bf16 v[192:195], a[112:115], a[56:59], v[192:195]
  v_mfma_f32_16x16x32_bf16 v[188:191], a[104:107], a[56:59], v[188:191]
  ds_read_b128 a[56:59], v13 offset:3072
  v_mfma_f32_16x16x32_bf16 v[188:191], a[108:111], a[60:63], v[188:191]
  ds_read_b128 a[60:63], v13 offset:7168
  s_waitcnt lgkmcnt(8)
  v_mfma_f32_16x16x32_bf16 v[128:131], a[64:67], a[32:35], v[128:131]
  s_add_u32 m0, s47, 0
  s_lshl_b32 s3, s73, 3
  v_mfma_f32_16x16x32_bf16 v[128:131], a[68:71], a[36:39], v[128:131]
  buffer_load_dwordx4 v0, s[16:19], s44 offen offset:0 sc1 lds
  v_mfma_f32_16x16x32_bf16 v[132:135], a[76:79], a[36:39], v[132:135]
  s_and_b32 s4, s83, 1
  s_add_u32 s3, s3, s4
  v_mfma_f32_16x16x32_bf16 v[132:135], a[72:75], a[32:35], v[132:135]
  s_lshl_b32 s4, s38, 1
  s_add_u32 s3, s3, s4
  v_mfma_f32_16x16x32_bf16 v[136:139], a[80:83], a[32:35], v[136:139]
  buffer_load_dwordx4 v0, s[16:19], s44 offen offset:1024 sc1 lds
  v_mfma_f32_16x16x32_bf16 v[136:139], a[84:87], a[36:39], v[136:139]
  s_waitcnt vmcnt(11) lgkmcnt(0)
  s_barrier
  v_mfma_f32_16x16x32_bf16 v[140:143], a[92:95], a[36:39], v[140:143]
  ds_read_b128 a[104:107], v15 offset:36864
  s_mul_i32 s3, s3, 20480
  v_mfma_f32_16x16x32_bf16 v[140:143], a[88:91], a[32:35], v[140:143]
  ds_read_b128 a[108:111], v15 offset:46080
  s_mul_i32 s4, s74, 320
  v_mfma_f32_16x16x32_bf16 v[144:147], a[96:99], a[32:35], v[144:147]
  ds_read_b128 a[32:35], v13 offset:36864
  s_add_u32 s3, s3, s4
  v_mfma_f32_16x16x32_bf16 v[144:147], a[100:103], a[36:39], v[144:147]
  ds_read_b128 a[36:39], v13 offset:40960
  s_lshr_b32 s4, s83, 1
  v_mfma_f32_16x16x32_bf16 v[164:167], a[96:99], a[40:43], v[164:167]
  buffer_load_dwordx4 v0, s[16:19], s44 offen offset:2048 sc1 lds
  v_mfma_f32_16x16x32_bf16 v[164:167], a[100:103], a[44:47], v[164:167]
  s_mul_i32 s4, s4, 160
  s_add_u32 s3, s3, s4
  v_mfma_f32_16x16x32_bf16 v[160:163], a[92:95], a[44:47], v[160:163]
  ds_read_b128 a[112:115], v15 offset:37888
  v_mfma_f32_16x16x32_bf16 v[160:163], a[88:91], a[40:43], v[160:163]
  ds_read_b128 a[116:119], v15 offset:47104
  v_mfma_f32_16x16x32_bf16 v[156:159], a[80:83], a[40:43], v[156:159]
  buffer_load_dwordx4 v0, s[16:19], s44 offen offset:3072 sc1 lds
  v_mfma_f32_16x16x32_bf16 v[156:159], a[84:87], a[44:47], v[156:159]
  v_mfma_f32_16x16x32_bf16 v[152:155], a[76:79], a[44:47], v[152:155]
  ds_read_b128 a[120:123], v15 offset:38912
  s_add_u32 m0, m0, 4096
  v_mfma_f32_16x16x32_bf16 v[152:155], a[72:75], a[40:43], v[152:155]
  buffer_load_dwordx4 v5, s[16:19], s44 offen offset:0 sc1 lds
  v_mfma_f32_16x16x32_bf16 v[148:151], a[64:67], a[40:43], v[148:151]
  ds_read_b128 a[40:43], v13 offset:37888
  v_mfma_f32_16x16x32_bf16 v[148:151], a[68:71], a[44:47], v[148:151]
  ds_read_b128 a[44:47], v13 offset:41984
  v_mfma_f32_16x16x32_bf16 v[168:171], a[64:67], a[48:51], v[168:171]
  v_mfma_f32_16x16x32_bf16 v[168:171], a[68:71], a[52:55], v[168:171]
  ds_read_b128 a[124:127], v15 offset:48128
  v_mfma_f32_16x16x32_bf16 v[172:175], a[76:79], a[52:55], v[172:175]
  buffer_load_dwordx4 v5, s[16:19], s44 offen offset:1024 sc1 lds
  v_mfma_f32_16x16x32_bf16 v[172:175], a[72:75], a[48:51], v[172:175]
  ds_read_b128 a[128:131], v15 offset:39936
  v_mfma_f32_16x16x32_bf16 v[176:179], a[80:83], a[48:51], v[176:179]
  v_mfma_f32_16x16x32_bf16 v[176:179], a[84:87], a[52:55], v[176:179]
  ds_read_b128 a[132:135], v15 offset:49152
  v_mfma_f32_16x16x32_bf16 v[180:183], a[92:95], a[52:55], v[180:183]
  buffer_load_dwordx4 v5, s[16:19], s44 offen offset:2048 sc1 lds
  v_mfma_f32_16x16x32_bf16 v[180:183], a[88:91], a[48:51], v[180:183]
  ds_read_b128 a[136:139], v17 offset:36864
  v_fmac_f32 v148, v19, v68
  v_mfma_f32_16x16x32_bf16 v[184:187], a[96:99], a[48:51], v[184:187]
  ds_read_b128 a[48:51], v13 offset:38912
  v_fmac_f32 v149, v19, v69
  v_mfma_f32_16x16x32_bf16 v[184:187], a[100:103], a[52:55], v[184:187]
  ds_read_b128 a[52:55], v13 offset:43008
  v_fmac_f32 v150, v19, v70
  v_mfma_f32_16x16x32_bf16 v[204:207], a[96:99], a[56:59], v[204:207]
  v_fmac_f32 v151, v19, v71
  v_fmac_f32 v152, v19, v72
  v_mfma_f32_16x16x32_bf16 v[204:207], a[100:103], a[60:63], v[204:207]
  buffer_load_dwordx4 v5, s[16:19], s44 offen offset:3072 sc1 lds
  v_mfma_f32_16x16x32_bf16 v[200:203], a[92:95], a[60:63], v[200:203]
  ds_read_b128 a[140:143], v17 offset:46080
  v_fmac_f32 v153, v19, v73
  v_mfma_f32_16x16x32_bf16 v[200:203], a[88:91], a[56:59], v[200:203]
  s_add_u32 m0, m0, 4096
  v_fmac_f32 v154, v19, v74
  v_mfma_f32_16x16x32_bf16 v[196:199], a[80:83], a[56:59], v[196:199]
  buffer_load_dwordx4 v0, s[16:19], s45 offen sc1 lds
  v_mfma_f32_16x16x32_bf16 v[196:199], a[84:87], a[60:63], v[196:199]
  s_add_u32 s44, s44, s46
  s_add_u32 s45, s45, 81920
  v_mfma_f32_16x16x32_bf16 v[192:195], a[76:79], a[60:63], v[192:195]
  v_fmac_f32 v155, v19, v75
  v_fmac_f32 v156, v19, v76
  v_mfma_f32_16x16x32_bf16 v[192:195], a[72:75], a[56:59], v[192:195]
  v_fmac_f32 v157, v19, v77
  v_mfma_f32_16x16x32_bf16 v[188:191], a[64:67], a[56:59], v[188:191]
  ds_read_b128 a[56:59], v13 offset:39936
  v_mfma_f32_16x16x32_bf16 v[188:191], a[68:71], a[60:63], v[188:191]
  ds_read_b128 a[60:63], v13 offset:44032
  s_waitcnt lgkmcnt(8)
  v_mfma_f32_16x16x32_bf16 v[128:131], a[104:107], a[32:35], v[128:131]
  s_add_u32 m0, s47, 73728
  s_mov_b32 s24, s86
  v_mfma_f32_16x16x32_bf16 v[128:131], a[108:111], a[36:39], v[128:131]
  buffer_load_dwordx4 v0, s[16:19], s44 offen offset:0 sc1 lds
  v_mfma_f32_16x16x32_bf16 v[132:135], a[116:119], a[36:39], v[132:135]
  s_and_b32 s25, s87, 0xffff
  s_mov_b32 s26, 2621440
  v_mfma_f32_16x16x32_bf16 v[132:135], a[112:115], a[32:35], v[132:135]
  s_add_u32 s63, s7, L_adone+8192-L_base
  s_min_u32 s63, s63, L_codeend-L_base-4
  v_mfma_f32_16x16x32_bf16 v[136:139], a[120:123], a[32:35], v[136:139]
  buffer_load_dwordx4 v0, s[16:19], s44 offen offset:1024 sc1 lds
  v_mfma_f32_16x16x32_bf16 v[136:139], a[124:127], a[36:39], v[136:139]
  s_waitcnt vmcnt(11) lgkmcnt(0)
  s_barrier
  v_mfma_f32_16x16x32_bf16 v[140:143], a[132:135], a[36:39], v[140:143]
  ds_read_b128 a[64:67], v14 offset:36864
  v_mov_b32 v29, s63
  v_mfma_f32_16x16x32_bf16 v[140:143], a[128:131], a[32:35], v[140:143]
  ds_read_b128 a[68:71], v14 offset:46080
  v_mfma_f32_16x16x32_bf16 v[144:147], a[136:139], a[32:35], v[144:147]
  ds_read_b128 a[32:35], v12 offset:36864
  v_mfma_f32_16x16x32_bf16 v[144:147], a[140:143], a[36:39], v[144:147]
  ds_read_b128 a[36:39], v12 offset:40960
  v_mfma_f32_16x16x32_bf16 v[164:167], a[136:139], a[40:43], v[164:167]
  buffer_load_dwordx4 v0, s[16:19], s44 offen offset:2048 sc1 lds
  v_mfma_f32_16x16x32_bf16 v[164:167], a[140:143], a[44:47], v[164:167]
  global_load_dword v244, v29, s[0:1]
  v_mfma_f32_16x16x32_bf16 v[160:163], a[132:135], a[44:47], v[160:163]
  ds_read_b128 a[72:75], v14 offset:37888
  v_mfma_f32_16x16x32_bf16 v[160:163], a[128:131], a[40:43], v[160:163]
  ds_read_b128 a[76:79], v14 offset:47104
  v_mfma_f32_16x16x32_bf16 v[156:159], a[120:123], a[40:43], v[156:159]
  buffer_load_dwordx4 v0, s[16:19], s44 offen offset:3072 sc1 lds
  v_mfma_f32_16x16x32_bf16 v[156:159], a[124:127], a[44:47], v[156:159]
  v_mfma_f32_16x16x32_bf16 v[152:155], a[116:119], a[44:47], v[152:155]
  ds_read_b128 a[80:83], v14 offset:38912
  s_add_u32 m0, m0, 4096
  v_mfma_f32_16x16x32_bf16 v[152:155], a[112:115], a[40:43], v[152:155]
  buffer_load_dwordx4 v5, s[16:19], s44 offen offset:0 sc1 lds
  v_mfma_f32_16x16x32_bf16 v[148:151], a[104:107], a[40:43], v[148:151]
  ds_read_b128 a[40:43], v12 offset:37888
  v_mfma_f32_16x16x32_bf16 v[148:151], a[108:111], a[44:47], v[148:151]
  ds_read_b128 a[44:47], v12 offset:41984
  v_mfma_f32_16x16x32_bf16 v[168:171], a[104:107], a[48:51], v[168:171]
  v_mfma_f32_16x16x32_bf16 v[168:171], a[108:111], a[52:55], v[168:171]
  ds_read_b128 a[84:87], v14 offset:48128
  v_mfma_f32_16x16x32_bf16 v[172:175], a[116:119], a[52:55], v[172:175]
  buffer_load_dwordx4 v5, s[16:19], s44 offen offset:1024 sc1 lds
  v_mfma_f32_16x16x32_bf16 v[172:175], a[112:115], a[48:51], v[172:175]
  ds_read_b128 a[88:91], v14 offset:39936
  v_mfma_f32_16x16x32_bf16 v[176:179], a[120:123], a[48:51], v[176:179]
  v_mfma_f32_16x16x32_bf16 v[176:179], a[124:127], a[52:55], v[176:179]
  ds_read_b128 a[92:95], v14 offset:49152
  v_mfma_f32_16x16x32_bf16 v[180:183], a[132:135], a[52:55], v[180:183]
  buffer_load_dwordx4 v5, s[16:19], s44 offen offset:2048 sc1 lds
  v_mfma_f32_16x16x32_bf16 v[180:183], a[128:131], a[48:51], v[180:183]
  ds_read_b128 a[96:99], v16 offset:36864
  v_fmac_f32 v158, v19, v78
  v_mfma_f32_16x16x32_bf16 v[184:187], a[136:139], a[48:51], v[184:187]
  ds_read_b128 a[48:51], v12 offset:38912
  v_fmac_f32 v159, v19, v79
  v_mfma_f32_16x16x32_bf16 v[184:187], a[140:143], a[52:55], v[184:187]
  ds_read_b128 a[52:55], v12 offset:43008
  v_fmac_f32 v160, v19, v80
  v_mfma_f32_16x16x32_bf16 v[204:207], a[136:139], a[56:59], v[204:207]
  v_fmac_f32 v161, v19, v81
  v_fmac_f32 v162, v19, v82
  v_mfma_f32_16x16x32_bf16 v[204:207], a[140:143], a[60:63], v[204:207]
  buffer_load_dwordx4 v5, s[16:19], s44 offen offset:3072 sc1 lds
  v_mfma_f32_16x16x32_bf16 v[200:203], a[132:135], a[60:63], v[200:203]
  ds_read_b128 a[100:103], v16 offset:46080
  v_fmac_f32 v163, v19, v83
  v_mfma_f32_16x16x32_bf16 v[200:203], a[128:131], a[56:59], v[200:203]
  s_add_u32 m0, m0, 4096
  v_fmac_f32 v164, v19, v84
  v_mfma_f32_16x16x32_bf16 v[196:199], a[120:123], a[56:59], v[196:199]
  buffer_load_dwordx4 v0, s[16:19], s45 offen sc1 lds
  v_mfma_f32_16x16x32_bf16 v[196:199], a[124:127], a[60:63], v[196:199]
  s_add_u32 s44, s44, s46
  s_add_u32 s45, s45, 81920
  v_mfma_f32_16x16x32_bf16 v[192:195], a[116:119], a[60:63], v[192:195]
  v_fmac_f32 v165, v19, v85
  v_fmac_f32 v166, v19, v86
  v_mfma_f32_16x16x32_bf16 v[192:195], a[112:115], a[56:59], v[192:195]
  v_fmac_f32 v167, v19, v87
  v_mfma_f32_16x16x32_bf16 v[188:191], a[104:107], a[56:59], v[188:191]
  ds_read_b128 a[56:59], v12 offset:39936
  v_mfma_f32_16x16x32_bf16 v[188:191], a[108:111], a[60:63], v[188:191]
  ds_read_b128 a[60:63], v12 offset:44032
  s_waitcnt lgkmcnt(8)
  v_mfma_f32_16x16x32_bf16 v[128:131], a[64:67], a[32:35], v[128:131]
  s_add_u32 m0, s47, 110592
  v_mfma_f32_16x16x32_bf16 v[128:131], a[68:71], a[36:39], v[128:131]
  buffer_load_dwordx4 v0, s[16:19], s44 offen offset:0 sc1 lds
  v_mfma_f32_16x16x32_bf16 v[132:135], a[76:79], a[36:39], v[132:135]
  v_mfma_f32_16x16x32_bf16 v[132:135], a[72:75], a[32:35], v[132:135]
  v_mfma_f32_16x16x32_bf16 v[136:139], a[80:83], a[32:35], v[136:139]
  buffer_load_dwordx4 v0, s[16:19], s44 offen offset:1024 sc1 lds
  v_mfma_f32_16x16x32_bf16 v[136:139], a[84:87], a[36:39], v[136:139]
  s_waitcnt vmcnt(12) lgkmcnt(0)
  s_barrier
  v_mfma_f32_16x16x32_bf16 v[140:143], a[92:95], a[36:39], v[140:143]
  ds_read_b128 a[104:107], v14 offset:0
  v_mfma_f32_16x16x32_bf16 v[140:143], a[88:91], a[32:35], v[140:143]
  ds_read_b128 a[108:111], v14 offset:9216
  v_mfma_f32_16x16x32_bf16 v[144:147], a[96:99], a[32:35], v[144:147]
  ds_read_b128 a[32:35], v12 offset:0
  v_mfma_f32_16x16x32_bf16 v[144:147], a[100:103], a[36:39], v[144:147]
  ds_read_b128 a[36:39], v12 offset:4096
  v_mfma_f32_16x16x32_bf16 v[164:167], a[96:99], a[40:43], v[164:167]
  buffer_load_dwordx4 v0, s[16:19], s44 offen offset:2048 sc1 lds
  v_mfma_f32_16x16x32_bf16 v[164:167], a[100:103], a[44:47], v[164:167]
  v_mfma_f32_16x16x32_bf16 v[160:163], a[92:95], a[44:47], v[160:163]
  ds_read_b128 a[112:115], v14 offset:1024
  v_mfma_f32_16x16x32_bf16 v[160:163], a[88:91], a[40:43], v[160:163]
  ds_read_b128 a[116:119], v14 offset:10240
  v_mfma_f32_16x16x32_bf16 v[156:159], a[80:83], a[40:43], v[156:159]
  buffer_load_dwordx4 v0, s[16:19], s44 offen offset:3072 sc1 lds
  v_mfma_f32_16x16x32_bf16 v[156:159], a[84:87], a[44:47], v[156:159]
  v_mfma_f32_16x16x32_bf16 v[152:155], a[76:79], a[44:47], v[152:155]
  ds_read_b128 a[120:123], v14 offset:2048
  s_add_u32 m0, m0, 4096
  v_mfma_f32_16x16x32_bf16 v[152:155], a[72:75], a[40:43], v[152:155]
  buffer_load_dwordx4 v5, s[16:19], s44 offen offset:0 sc1 lds
  v_mfma_f32_16x16x32_bf16 v[148:151], a[64:67], a[40:43], v[148:151]
  ds_read_b128 a[40:43], v12 offset:1024
  v_mfma_f32_16x16x32_bf16 v[148:151], a[68:71], a[44:47], v[148:151]
  ds_read_b128 a[44:47], v12 offset:5120
  v_mfma_f32_16x16x32_bf16 v[168:171], a[64:67], a[48:51], v[168:171]
  v_mfma_f32_16x16x32_bf16 v[168:171], a[68:71], a[52:55], v[168:171]
  ds_read_b128 a[124:127], v14 offset:11264
  v_mfma_f32_16x16x32_bf16 v[172:175], a[76:79], a[52:55], v[172:175]
  buffer_load_dwordx4 v5, s[16:19], s44 offen offset:1024 sc1 lds
  v_mfma_f32_16x16x32_bf16 v[172:175], a[72:75], a[48:51], v[172:175]
  ds_read_b128 a[128:131], v14 offset:3072
  v_mfma_f32_16x16x32_bf16 v[176:179], a[80:83], a[48:51], v[176:179]
  v_mfma_f32_16x16x32_bf16 v[176:179], a[84:87], a[52:55], v[176:179]
  ds_read_b128 a[132:135], v14 offset:12288
  v_mfma_f32_16x16x32_bf16 v[180:183], a[92:95], a[52:55], v[180:183]
  buffer_load_dwordx4 v5, s[16:19], s44 offen offset:2048 sc1 lds
  v_mfma_f32_16x16x32_bf16 v[180:183], a[88:91], a[48:51], v[180:183]
  ds_read_b128 a[136:139], v16 offset:0
  v_mfma_f32_16x16x32_bf16 v[184:187], a[96:99], a[48:51], v[184:187]
  ds_read_b128 a[48:51], v12 offset:2048
  v_mfma_f32_16x16x32_bf16 v[184:187], a[100:103], a[52:55], v[184:187]
  ds_read_b128 a[52:55], v12 offset:6144
  v_mfma_f32_16x16x32_bf16 v[204:207], a[96:99], a[56:59], v[204:207]
  v_mfma_f32_16x16x32_bf16 v[204:207], a[100:103], a[60:63], v[204:207]
  buffer_load_dwordx4 v5, s[16:19], s44 offen offset:3072 sc1 lds
  v_mfma_f32_16x16x32_bf16 v[200:203], a[92:95], a[60:63], v[200:203]
  ds_read_b128 a[140:143], v16 offset:9216
  v_mfma_f32_16x16x32_bf16 v[200:203], a[88:91], a[56:59], v[200:203]
  s_add_u32 m0, m0, 4096
  v_mfma_f32_16x16x32_bf16 v[196:199], a[80:83], a[56:59], v[196:199]
  buffer_load_dwordx4 v0, s[16:19], s45 offen sc1 lds
  v_mfma_f32_16x16x32_bf16 v[196:199], a[84:87], a[60:63], v[196:199]
  s_add_u32 s44, s44, s46
  s_add_u32 s45, s45, 81920
  v_mfma_f32_16x16x32_bf16 v[192:195], a[76:79], a[60:63], v[192:195]
  v_mfma_f32_16x16x32_bf16 v[192:195], a[72:75], a[56:59], v[192:195]
  v_mfma_f32_16x16x32_bf16 v[188:191], a[64:67], a[56:59], v[188:191]
  ds_read_b128 a[56:59], v12 offset:3072
  v_mfma_f32_16x16x32_bf16 v[188:191], a[68:71], a[60:63], v[188:191]
  ds_read_b128 a[60:63], v12 offset:7168
  s_waitcnt lgkmcnt(8)
  v_mfma_f32_16x16x32_bf16 v[128:131], a[104:107], a[32:35], v[128:131]
  s_add_u32 m0, s47, 36864
  v_mfma_f32_16x16x32_bf16 v[128:131], a[108:111], a[36:39], v[128:131]
  buffer_load_dwordx4 v0, s[16:19], s44 offen offset:0 sc1 lds
  v_mfma_f32_16x16x32_bf16 v[132:135], a[116:119], a[36:39], v[132:135]
  v_mfma_f32_16x16x32_bf16 v[132:135], a[112:115], a[32:35], v[132:135]
  v_mfma_f32_16x16x32_bf16 v[136:139], a[120:123], a[32:35], v[136:139]
  buffer_load_dwordx4 v0, s[16:19], s44 offen offset:1024 sc1 lds
  v_mfma_f32_16x16x32_bf16 v[136:139], a[124:127], a[36:39], v[136:139]
  s_waitcnt vmcnt(11) lgkmcnt(0)
  s_barrier
  v_mfma_f32_16x16x32_bf16 v[140:143], a[132:135], a[36:39], v[140:143]
  ds_read_b128 a[64:67], v15 offset:0
  v_mfma_f32_16x16x32_bf16 v[140:143], a[128:131], a[32:35], v[140:143]
  ds_read_b128 a[68:71], v15 offset:9216
  v_mfma_f32_16x16x32_bf16 v[144:147], a[136:139], a[32:35], v[144:147]
  ds_read_b128 a[32:35], v13 offset:0
  v_mfma_f32_16x16x32_bf16 v[144:147], a[140:143], a[36:39], v[144:147]
  ds_read_b128 a[36:39], v13 offset:4096
  v_mfma_f32_16x16x32_bf16 v[164:167], a[136:139], a[40:43], v[164:167]
  buffer_load_dwordx4 v0, s[16:19], s44 offen offset:2048 sc1 lds
  v_mfma_f32_16x16x32_bf16 v[164:167], a[140:143], a[44:47], v[164:167]
  v_mfma_f32_16x16x32_bf16 v[160:163], a[132:135], a[44:47], v[160:163]
  ds_read_b128 a[72:75], v15 offset:1024
  v_mfma_f32_16x16x32_bf16 v[160:163], a[128:131], a[40:43], v[160:163]
  ds_read_b128 a[76:79], v15 offset:10240
  v_mfma_f32_16x16x32_bf16 v[156:159], a[120:123], a[40:43], v[156:159]
  buffer_load_dwordx4 v0, s[16:19], s44 offen offset:3072 sc1 lds
  v_mfma_f32_16x16x32_bf16 v[156:159], a[124:127], a[44:47], v[156:159]
  v_mfma_f32_16x16x32_bf16 v[152:155], a[116:119], a[44:47], v[152:155]
  ds_read_b128 a[80:83], v15 offset:2048
  s_add_u32 m0, m0, 4096
  v_mfma_f32_16x16x32_bf16 v[152:155], a[112:115], a[40:43], v[152:155]
  buffer_load_dwordx4 v5, s[16:19], s44 offen offset:0 sc1 lds
  v_mfma_f32_16x16x32_bf16 v[148:151], a[104:107], a[40:43], v[148:151]
  ds_read_b128 a[40:43], v13 offset:1024
  v_mfma_f32_16x16x32_bf16 v[148:151], a[108:111], a[44:47], v[148:151]
  ds_read_b128 a[44:47], v13 offset:5120
  v_mfma_f32_16x16x32_bf16 v[168:171], a[104:107], a[48:51], v[168:171]
  v_mfma_f32_16x16x32_bf16 v[168:171], a[108:111], a[52:55], v[168:171]
  ds_read_b128 a[84:87], v15 offset:11264
  v_mfma_f32_16x16x32_bf16 v[172:175], a[116:119], a[52:55], v[172:175]
  buffer_load_dwordx4 v5, s[16:19], s44 offen offset:1024 sc1 lds
  v_mfma_f32_16x16x32_bf16 v[172:175], a[112:115], a[48:51], v[172:175]
  ds_read_b128 a[88:91], v15 offset:3072
  v_mfma_f32_16x16x32_bf16 v[176:179], a[120:123], a[48:51], v[176:179]
  v_mfma_f32_16x16x32_bf16 v[176:179], a[124:127], a[52:55], v[176:179]
  ds_read_b128 a[92:95], v15 offset:12288
  v_mfma_f32_16x16x32_bf16 v[180:183], a[132:135], a[52:55], v[180:183]
  buffer_load_dwordx4 v5, s[16:19], s44 offen offset:2048 sc1 lds
  v_mfma_f32_16x16x32_bf16 v[180:183], a[128:131], a[48:51], v[180:183]
  ds_read_b128 a[96:99], v17 offset:0
  v_mfma_f32_16x16x32_bf16 v[184:187], a[136:139], a[48:51], v[184:187]
  ds_read_b128 a[48:51], v13 offset:2048
  v_mfma_f32_16x16x32_bf16 v[184:187], a[140:143], a[52:55], v[184:187]
  ds_read_b128 a[52:55], v13 offset:6144
  v_mfma_f32_16x16x32_bf16 v[204:207], a[136:139], a[56:59], v[204:207]
  v_mfma_f32_16x16x32_bf16 v[204:207], a[140:143], a[60:63], v[204:207]
  buffer_load_dwordx4 v5, s[16:19], s44 offen offset:3072 sc1 lds
  v_mfma_f32_16x16x32_bf16 v[200:203], a[132:135], a[60:63], v[200:203]
  ds_read_b128 a[100:103], v17 offset:9216
  v_mfma_f32_16x16x32_bf16 v[200:203], a[128:131], a[56:59], v[200:203]
  s_add_u32 m0, m0, 4096
  v_mfma_f32_16x16x32_bf16 v[196:199], a[120:123], a[56:59], v[196:199]
  buffer_load_dwordx4 v0, s[16:19], s45 offen sc1 lds
  v_mfma_f32_16x16x32_bf16 v[196:199], a[124:127], a[60:63], v[196:199]
  s_add_u32 s44, s44, s46
  s_add_u32 s45, s45, 81920
  v_mfma_f32_16x16x32_bf16 v[192:195], a[116:119], a[60:63], v[192:195]
  v_mfma_f32_16x16x32_bf16 v[192:195], a[112:115], a[56:59], v[192:195]
  v_mfma_f32_16x16x32_bf16 v[188:191], a[104:107], a[56:59], v[188:191]
  ds_read_b128 a[56:59], v13 offset:3072
  v_mfma_f32_16x16x32_bf16 v[188:191], a[108:111], a[60:63], v[188:191]
  ds_read_b128 a[60:63], v13 offset:7168
  s_waitcnt lgkmcnt(8)
  v_mfma_f32_16x16x32_bf16 v[128:131], a[64:67], a[32:35], v[128:131]
  s_add_u32 m0, s47, 0
  v_mfma_f32_16x16x32_bf16 v[128:131], a[68:71], a[36:39], v[128:131]
  buffer_load_dwordx4 v0, s[16:19], s44 offen offset:0 sc1 lds
  v_mfma_f32_16x16x32_bf16 v[132:135], a[76:79], a[36:39], v[132:135]
  v_mfma_f32_16x16x32_bf16 v[132:135], a[72:75], a[32:35], v[132:135]
  v_mfma_f32_16x16x32_bf16 v[136:139], a[80:83], a[32:35], v[136:139]
  buffer_load_dwordx4 v0, s[16:19], s44 offen offset:1024 sc1 lds
  v_mfma_f32_16x16x32_bf16 v[136:139], a[84:87], a[36:39], v[136:139]
  s_waitcnt vmcnt(11) lgkmcnt(0)
  s_barrier
  v_mfma_f32_16x16x32_bf16 v[140:143], a[92:95], a[36:39], v[140:143]
  ds_read_b128 a[104:107], v15 offset:36864
  v_mfma_f32_16x16x32_bf16 v[140:143], a[88:91], a[32:35], v[140:143]
  ds_read_b128 a[108:111], v15 offset:46080
  v_mfma_f32_16x16x32_bf16 v[144:147], a[96:99], a[32:35], v[144:147]
  ds_read_b128 a[32:35], v13 offset:36864
  v_mfma_f32_16x16x32_bf16 v[144:147], a[100:103], a[36:39], v[144:147]
  ds_read_b128 a[36:39], v13 offset:40960
  v_mfma_f32_16x16x32_bf16 v[164:167], a[96:99], a[40:43], v[164:167]
  buffer_load_dwordx4 v0, s[16:19], s44 offen offset:2048 sc1 lds
  v_mfma_f32_16x16x32_bf16 v[164:167], a[100:103], a[44:47], v[164:167]
  v_mfma_f32_16x16x32_bf16 v[160:163], a[92:95], a[44:47], v[160:163]
  ds_read_b128 a[112:115], v15 offset:37888
  v_mfma_f32_16x16x32_bf16 v[160:163], a[88:91], a[40:43], v[160:163]
  ds_read_b128 a[116:119], v15 offset:47104
  v_mfma_f32_16x16x32_bf16 v[156:159], a[80:83], a[40:43], v[156:159]
  buffer_load_dwordx4 v0, s[16:19], s44 offen offset:3072 sc1 lds
  v_mfma_f32_16x16x32_bf16 v[156:159], a[84:87], a[44:47], v[156:159]
  v_mfma_f32_16x16x32_bf16 v[152:155], a[76:79], a[44:47], v[152:155]
  ds_read_b128 a[120:123], v15 offset:38912
  s_add_u32 m0, m0, 4096
  v_mfma_f32_16x16x32_bf16 v[152:155], a[72:75], a[40:43], v[152:155]
  buffer_load_dwordx4 v5, s[16:19], s44 offen offset:0 sc1 lds
  v_mfma_f32_16x16x32_bf16 v[148:151], a[64:67], a[40:43], v[148:151]
  ds_read_b128 a[40:43], v13 offset:37888
  v_mfma_f32_16x16x32_bf16 v[148:151], a[68:71], a[44:47], v[148:151]
  ds_read_b128 a[44:47], v13 offset:41984
  v_mfma_f32_16x16x32_bf16 v[168:171], a[64:67], a[48:51], v[168:171]
  v_mfma_f32_16x16x32_bf16 v[168:171], a[68:71], a[52:55], v[168:171]
  ds_read_b128 a[124:127], v15 offset:48128
  v_mfma_f32_16x16x32_bf16 v[172:175], a[76:79], a[52:55], v[172:175]
  buffer_load_dwordx4 v5, s[16:19], s44 offen offset:1024 sc1 lds
  v_mfma_f32_16x16x32_bf16 v[172:175], a[72:75], a[48:51], v[172:175]
  ds_read_b128 a[128:131], v15 offset:39936
  v_mfma_f32_16x16x32_bf16 v[176:179], a[80:83], a[48:51], v[176:179]
  v_mfma_f32_16x16x32_bf16 v[176:179], a[84:87], a[52:55], v[176:179]
  ds_read_b128 a[132:135], v15 offset:49152
  v_mfma_f32_16x16x32_bf16 v[180:183], a[92:95], a[52:55], v[180:183]
  buffer_load_dwordx4 v5, s[16:19], s44 offen offset:2048 sc1 lds
  v_mfma_f32_16x16x32_bf16 v[180:183], a[88:91], a[48:51], v[180:183]
  ds_read_b128 a[136:139], v17 offset:36864
  v_mfma_f32_16x16x32_bf16 v[184:187], a[96:99], a[48:51], v[184:187]
  ds_read_b128 a[48:51], v13 offset:38912
  v_mfma_f32_16x16x32_bf16 v[184:187], a[100:103], a[52:55], v[184:187]
  ds_read_b128 a[52:55], v13 offset:43008
  v_mfma_f32_16x16x32_bf16 v[204:207], a[96:99], a[56:59], v[204:207]
  v_mfma_f32_16x16x32_bf16 v[204:207], a[100:103], a[60:63], v[204:207]
  buffer_load_dwordx4 v5, s[16:19], s44 offen offset:3072 sc1 lds
  v_mfma_f32_16x16x32_bf16 v[200:203], a[92:95], a[60:63], v[200:203]
  ds_read_b128 a[140:143], v17 offset:46080
  v_mfma_f32_16x16x32_bf16 v[200:203], a[88:91], a[56:59], v[200:203]
  s_add_u32 m0, m0, 4096
  v_mfma_f32_16x16x32_bf16 v[196:199], a[80:83], a[56:59], v[196:199]
  buffer_load_dwordx4 v0, s[16:19], s45 offen sc1 lds
  v_mfma_f32_16x16x32_bf16 v[196:199], a[84:87], a[60:63], v[196:199]
  s_add_u32 s44, s44, s46
  s_add_u32 s45, s45, 81920
  v_mfma_f32_16x16x32_bf16 v[192:195], a[76:79], a[60:63], v[192:195]
  v_mfma_f32_16x16x32_bf16 v[192:195], a[72:75], a[56:59], v[192:195]
  v_mfma_f32_16x16x32_bf16 v[188:191], a[64:67], a[56:59], v[188:191]
  ds_read_b128 a[56:59], v13 offset:39936
  v_mfma_f32_16x16x32_bf16 v[188:191], a[68:71], a[60:63], v[188:191]
  ds_read_b128 a[60:63], v13 offset:44032
  s_waitcnt lgkmcnt(8)
  v_mfma_f32_16x16x32_bf16 v[128:131], a[104:107], a[32:35], v[128:131]
  s_add_u32 m0, s47, 73728
  v_mfma_f32_16x16x32_bf16 v[128:131], a[108:111], a[36:39], v[128:131]
  buffer_load_dwordx4 v0, s[16:19], s44 offen offset:0 sc1 lds
  v_mfma_f32_16x16x32_bf16 v[132:135], a[116:119], a[36:39], v[132:135]
  v_mfma_f32_16x16x32_bf16 v[132:135], a[112:115], a[32:35], v[132:135]
  v_mfma_f32_16x16x32_bf16 v[136:139], a[120:123], a[32:35], v[136:139]
  buffer_load_dwordx4 v0, s[16:19], s44 offen offset:1024 sc1 lds
  v_mfma_f32_16x16x32_bf16 v[136:139], a[124:127], a[36:39], v[136:139]
  s_waitcnt vmcnt(11) lgkmcnt(0)
  s_barrier
  v_mfma_f32_16x16x32_bf16 v[140:143], a[132:135], a[36:39], v[140:143]
  ds_read_b128 a[64:67], v14 offset:36864
  v_mfma_f32_16x16x32_bf16 v[140:143], a[128:131], a[32:35], v[140:143]
  ds_read_b128 a[68:71], v14 offset:46080
  v_mfma_f32_16x16x32_bf16 v[144:147], a[136:139], a[32:35], v[144:147]
  ds_read_b128 a[32:35], v12 offset:36864
  v_mfma_f32_16x16x32_bf16 v[144:147], a[140:143], a[36:39], v[144:147]
  ds_read_b128 a[36:39], v12 offset:40960
  v_mfma_f32_16x16x32_bf16 v[164:167], a[136:139], a[40:43], v[164:167]
  buffer_load_dwordx4 v0, s[16:19], s44 offen offset:2048 sc1 lds
  v_mfma_f32_16x16x32_bf16 v[164:167], a[140:143], a[44:47], v[164:167]
  v_mfma_f32_16x16x32_bf16 v[160:163], a[132:135], a[44:47], v[160:163]
  ds_read_b128 a[72:75], v14 offset:37888
  v_mfma_f32_16x16x32_bf16 v[160:163], a[128:131], a[40:43], v[160:163]
  ds_read_b128 a[76:79], v14 offset:47104
  v_mfma_f32_16x16x32_bf16 v[156:159], a[120:123], a[40:43], v[156:159]
  buffer_load_dwordx4 v0, s[16:19], s44 offen offset:3072 sc1 lds
  v_mfma_f32_16x16x32_bf16 v[156:159], a[124:127], a[44:47], v[156:159]
  v_mfma_f32_16x16x32_bf16 v[152:155], a[116:119], a[44:47], v[152:155]
  ds_read_b128 a[80:83], v14 offset:38912
  s_add_u32 m0, m0, 4096
  v_mfma_f32_16x16x32_bf16 v[152:155], a[112:115], a[40:43], v[152:155]
  buffer_load_dwordx4 v5, s[16:19], s44 offen offset:0 sc1 lds
  v_mfma_f32_16x16x32_bf16 v[148:151], a[104:107], a[40:43], v[148:151]
  ds_read_b128 a[40:43], v12 offset:37888
  v_mfma_f32_16x16x32_bf16 v[148:151], a[108:111], a[44:47], v[148:151]
  ds_read_b128 a[44:47], v12 offset:41984
  v_mfma_f32_16x16x32_bf16 v[168:171], a[104:107], a[48:51], v[168:171]
  v_mfma_f32_16x16x32_bf16 v[168:171], a[108:111], a[52:55], v[168:171]
  ds_read_b128 a[84:87], v14 offset:48128
  v_mfma_f32_16x16x32_bf16 v[172:175], a[116:119], a[52:55], v[172:175]
  buffer_load_dwordx4 v5, s[16:19], s44 offen offset:1024 sc1 lds
  v_mfma_f32_16x16x32_bf16 v[172:175], a[112:115], a[48:51], v[172:175]
  ds_read_b128 a[88:91], v14 offset:39936
  v_mfma_f32_16x16x32_bf16 v[176:179], a[120:123], a[48:51], v[176:179]
  v_mfma_f32_16x16x32_bf16 v[176:179], a[124:127], a[52:55], v[176:179]
  ds_read_b128 a[92:95], v14 offset:49152
  v_mfma_f32_16x16x32_bf16 v[180:183], a[132:135], a[52:55], v[180:183]
  buffer_load_dwordx4 v5, s[16:19], s44 offen offset:2048 sc1 lds
  v_mfma_f32_16x16x32_bf16 v[180:183], a[128:131], a[48:51], v[180:183]
  ds_read_b128 a[96:99], v16 offset:36864
  v_mfma_f32_16x16x32_bf16 v[184:187], a[136:139], a[48:51], v[184:187]
  ds_read_b128 a[48:51], v12 offset:38912
  v_mfma_f32_16x16x32_bf16 v[184:187], a[140:143], a[52:55], v[184:187]
  ds_read_b128 a[52:55], v12 offset:43008
  v_mfma_f32_16x16x32_bf16 v[204:207], a[136:139], a[56:59], v[204:207]
  v_mfma_f32_16x16x32_bf16 v[204:207], a[140:143], a[60:63], v[204:207]
  buffer_load_dwordx4 v5, s[16:19], s44 offen offset:3072 sc1 lds
  v_mfma_f32_16x16x32_bf16 v[200:203], a[132:135], a[60:63], v[200:203]
  ds_read_b128 a[100:103], v16 offset:46080
  v_mfma_f32_16x16x32_bf16 v[200:203], a[128:131], a[56:59], v[200:203]
  s_add_u32 m0, m0, 4096
  v_mfma_f32_16x16x32_bf16 v[196:199], a[120:123], a[56:59], v[196:199]
  buffer_load_dwordx4 v0, s[16:19], s45 offen sc1 lds
  v_mfma_f32_16x16x32_bf16 v[196:199], a[124:127], a[60:63], v[196:199]
  s_add_u32 s44, s44, s46
  s_add_u32 s45, s45, 81920
  v_mfma_f32_16x16x32_bf16 v[192:195], a[116:119], a[60:63], v[192:195]
  v_mfma_f32_16x16x32_bf16 v[192:195], a[112:115], a[56:59], v[192:195]
  v_mfma_f32_16x16x32_bf16 v[188:191], a[104:107], a[56:59], v[188:191]
  ds_read_b128 a[56:59], v12 offset:39936
  v_mfma_f32_16x16x32_bf16 v[188:191], a[108:111], a[60:63], v[188:191]
  ds_read_b128 a[60:63], v12 offset:44032
  s_waitcnt lgkmcnt(8)
  v_mfma_f32_16x16x32_bf16 v[128:131], a[64:67], a[32:35], v[128:131]
  s_add_u32 m0, s47, 110592
  v_fmac_f32 v168, v20, v88
  v_mfma_f32_16x16x32_bf16 v[128:131], a[68:71], a[36:39], v[128:131]
  buffer_load_dwordx4 v0, s[16:19], s44 offen offset:0 sc1 lds
  v_mfma_f32_16x16x32_bf16 v[132:135], a[76:79], a[36:39], v[132:135]
  v_fmac_f32 v169, v20, v89
  v_fmac_f32 v170, v20, v90
  v_mfma_f32_16x16x32_bf16 v[132:135], a[72:75], a[32:35], v[132:135]
  v_fmac_f32 v171, v20, v91
  v_fmac_f32 v172, v20, v92
  v_mfma_f32_16x16x32_bf16 v[136:139], a[80:83], a[32:35], v[136:139]
  buffer_load_dwordx4 v0, s[16:19], s44 offen offset:1024 sc1 lds
  v_mfma_f32_16x16x32_bf16 v[136:139], a[84:87], a[36:39], v[136:139]
  s_waitcnt vmcnt(11) lgkmcnt(0)
  s_barrier
  v_mfma_f32_16x16x32_bf16 v[140:143], a[92:95], a[36:39], v[140:143]
  ds_read_b128 a[104:107], v14 offset:0
  v_fmac_f32 v173, v20, v93
  v_mfma_f32_16x16x32_bf16 v[140:143], a[88:91], a[32:35], v[140:143]
  ds_read_b128 a[108:111], v14 offset:9216
  v_fmac_f32 v174, v20, v94
  v_mfma_f32_16x16x32_bf16 v[144:147], a[96:99], a[32:35], v[144:147]
  ds_read_b128 a[32:35], v12 offset:0
  v_fmac_f32 v175, v20, v95
  v_mfma_f32_16x16x32_bf16 v[144:147], a[100:103], a[36:39], v[144:147]
  ds_read_b128 a[36:39], v12 offset:4096
  v_fmac_f32 v176, v20, v96
  v_mfma_f32_16x16x32_bf16 v[164:167], a[96:99], a[40:43], v[164:167]
  buffer_load_dwordx4 v0, s[16:19], s44 offen offset:2048 sc1 lds
  v_mfma_f32_16x16x32_bf16 v[164:167], a[100:103], a[44:47], v[164:167]
  v_fmac_f32 v177, v20, v97
  v_add_u32 v29, 0, v1
  v_mfma_f32_16x16x32_bf16 v[160:163], a[92:95], a[44:47], v[160:163]
  ds_read_b128 a[112:115], v14 offset:1024
  v_mul_u32_u24 v214, 6554, v29
  v_mfma_f32_16x16x32_bf16 v[160:163], a[88:91], a[40:43], v[160:163]
  ds_read_b128 a[116:119], v14 offset:10240
  v_lshrrev_b32 v214, 16, v214
  v_mfma_f32_16x16x32_bf16 v[156:159], a[80:83], a[40:43], v[156:159]
  buffer_load_dwordx4 v0, s[16:19], s44 offen offset:3072 sc1 lds
  v_mfma_f32_16x16x32_bf16 v[156:159], a[84:87], a[44:47], v[156:159]
  v_mul_u32_u24 v214, 1120, v214
  v_lshl_add_u32 v214, v29, 4, v214
  v_mfma_f32_16x16x32_bf16 v[152:155], a[76:79], a[44:47], v[152:155]
  ds_read_b128 a[120:123], v14 offset:2048
  s_add_u32 m0, m0, 4096
  v_mfma_f32_16x16x32_bf16 v[152:155], a[72:75], a[40:43], v[152:155]
  buffer_load_dwordx4 v5, s[16:19], s44 offen offset:0 sc1 lds
  v_mfma_f32_16x16x32_bf16 v[148:151], a[64:67], a[40:43], v[148:151]
  ds_read_b128 a[40:43], v12 offset:1024
  v_mfma_f32_16x16x32_bf16 v[148:151], a[68:71], a[44:47], v[148:151]
  ds_read_b128 a[44:47], v12 offset:5120
  v_mfma_f32_16x16x32_bf16 v[168:171], a[64:67], a[48:51], v[168:171]
  v_mfma_f32_16x16x32_bf16 v[168:171], a[68:71], a[52:55], v[168:171]
  ds_read_b128 a[124:127], v14 offset:11264
  v_mfma_f32_16x16x32_bf16 v[172:175], a[76:79], a[52:55], v[172:175]
  buffer_load_dwordx4 v5, s[16:19], s44 offen offset:1024 sc1 lds
  v_mfma_f32_16x16x32_bf16 v[172:175], a[72:75], a[48:51], v[172:175]
  ds_read_b128 a[128:131], v14 offset:3072
  v_mfma_f32_16x16x32_bf16 v[176:179], a[80:83], a[48:51], v[176:179]
  v_mfma_f32_16x16x32_bf16 v[176:179], a[84:87], a[52:55], v[176:179]
  ds_read_b128 a[132:135], v14 offset:12288
  v_mfma_f32_16x16x32_bf16 v[180:183], a[92:95], a[52:55], v[180:183]
  buffer_load_dwordx4 v5, s[16:19], s44 offen offset:2048 sc1 lds
  v_mfma_f32_16x16x32_bf16 v[180:183], a[88:91], a[48:51], v[180:183]
  ds_read_b128 a[136:139], v16 offset:0
  v_mfma_f32_16x16x32_bf16 v[184:187], a[96:99], a[48:51], v[184:187]
  ds_read_b128 a[48:51], v12 offset:2048
  v_mfma_f32_16x16x32_bf16 v[184:187], a[100:103], a[52:55], v[184:187]
  ds_read_b128 a[52:55], v12 offset:6144
  v_mfma_f32_16x16x32_bf16 v[204:207], a[96:99], a[56:59], v[204:207]
  v_mfma_f32_16x16x32_bf16 v[204:207], a[100:103], a[60:63], v[204:207]
  buffer_load_dwordx4 v5, s[16:19], s44 offen offset:3072 sc1 lds
  v_mfma_f32_16x16x32_bf16 v[200:203], a[92:95], a[60:63], v[200:203]
  ds_read_b128 a[140:143], v16 offset:9216
  v_mfma_f32_16x16x32_bf16 v[200:203], a[88:91], a[56:59], v[200:203]
  s_add_u32 m0, m0, 4096
  v_mfma_f32_16x16x32_bf16 v[196:199], a[80:83], a[56:59], v[196:199]
  buffer_load_dwordx4 v0, s[16:19], s45 offen sc1 lds
  v_mfma_f32_16x16x32_bf16 v[196:199], a[84:87], a[60:63], v[196:199]
  s_add_u32 s44, s44, s46
  s_add_u32 s45, s45, 81920
  v_mfma_f32_16x16x32_bf16 v[192:195], a[76:79], a[60:63], v[192:195]
  v_mfma_f32_16x16x32_bf16 v[192:195], a[72:75], a[56:59], v[192:195]
  v_mfma_f32_16x16x32_bf16 v[188:191], a[64:67], a[56:59], v[188:191]
  ds_read_b128 a[56:59], v12 offset:3072
  v_mfma_f32_16x16x32_bf16 v[188:191], a[68:71], a[60:63], v[188:191]
  ds_read_b128 a[60:63], v12 offset:7168
  s_waitcnt lgkmcnt(8)
  v_mfma_f32_16x16x32_bf16 v[128:131], a[104:107], a[32:35], v[128:131]
  s_add_u32 m0, s47, 36864
  v_fmac_f32 v178, v20, v98
  v_mfma_f32_16x16x32_bf16 v[128:131], a[108:111], a[36:39], v[128:131]
  buffer_load_dwordx4 v0, s[16:19], s44 offen offset:0 sc1 lds
  v_mfma_f32_16x16x32_bf16 v[132:135], a[116:119], a[36:39], v[132:135]
  v_fmac_f32 v179, v20, v99
  v_fmac_f32 v180, v20, v100
  v_mfma_f32_16x16x32_bf16 v[132:135], a[112:115], a[32:35], v[132:135]
  v_fmac_f32 v181, v20, v101
  v_fmac_f32 v182, v20, v102
  v_mfma_f32_16x16x32_bf16 v[136:139], a[120:123], a[32:35], v[136:139]
  buffer_load_dwordx4 v0, s[16:19], s44 offen offset:1024 sc1 lds
  v_mfma_f32_16x16x32_bf16 v[136:139], a[124:127], a[36:39], v[136:139]
  s_waitcnt vmcnt(11) lgkmcnt(0)
  s_barrier
  v_mfma_f32_16x16x32_bf16 v[140:143], a[132:135], a[36:39], v[140:143]
  ds_read_b128 a[64:67], v15 offset:0
  v_fmac_f32 v183, v20, v103
  v_mfma_f32_16x16x32_bf16 v[140:143], a[128:131], a[32:35], v[140:143]
  ds_read_b128 a[68:71], v15 offset:9216
  v_fmac_f32 v184, v20, v104
  v_mfma_f32_16x16x32_bf16 v[144:147], a[136:139], a[32:35], v[144:147]
  ds_read_b128 a[32:35], v13 offset:0
  v_fmac_f32 v185, v20, v105
  v_mfma_f32_16x16x32_bf16 v[144:147], a[140:143], a[36:39], v[144:147]
  ds_read_b128 a[36:39], v13 offset:4096
  v_fmac_f32 v186, v20, v106
  v_mfma_f32_16x16x32_bf16 v[164:167], a[136:139], a[40:43], v[164:167]
  buffer_load_dwordx4 v0, s[16:19], s44 offen offset:2048 sc1 lds
  v_mfma_f32_16x16x32_bf16 v[164:167], a[140:143], a[44:47], v[164:167]
  v_fmac_f32 v187, v20, v107
  v_add_u32 v29, 64, v1
  v_mfma_f32_16x16x32_bf16 v[160:163], a[132:135], a[44:47], v[160:163]
  ds_read_b128 a[72:75], v15 offset:1024
  v_mul_u32_u24 v215, 6554, v29
  v_mfma_f32_16x16x32_bf16 v[160:163], a[128:131], a[40:43], v[160:163]
  ds_read_b128 a[76:79], v15 offset:10240
  v_lshrrev_b32 v215, 16, v215
  v_mfma_f32_16x16x32_bf16 v[156:159], a[120:123], a[40:43], v[156:159]
  buffer_load_dwordx4 v0, s[16:19], s44 offen offset:3072 sc1 lds
  v_mfma_f32_16x16x32_bf16 v[156:159], a[124:127], a[44:47], v[156:159]
  v_mul_u32_u24 v215, 1120, v215
  v_lshl_add_u32 v215, v29, 4, v215
  v_mfma_f32_16x16x32_bf16 v[152:155], a[116:119], a[44:47], v[152:155]
  ds_read_b128 a[80:83], v15 offset:2048
  s_add_u32 m0, m0, 4096
  v_mfma_f32_16x16x32_bf16 v[152:155], a[112:115], a[40:43], v[152:155]
  buffer_load_dwordx4 v5, s[16:19], s44 offen offset:0 sc1 lds
  v_mfma_f32_16x16x32_bf16 v[148:151], a[104:107], a[40:43], v[148:151]
  ds_read_b128 a[40:43], v13 offset:1024
  v_mfma_f32_16x16x32_bf16 v[148:151], a[108:111], a[44:47], v[148:151]
  ds_read_b128 a[44:47], v13 offset:5120
  v_mfma_f32_16x16x32_bf16 v[168:171], a[104:107], a[48:51], v[168:171]
  v_mfma_f32_16x16x32_bf16 v[168:171], a[108:111], a[52:55], v[168:171]
  ds_read_b128 a[84:87], v15 offset:11264
  v_mfma_f32_16x16x32_bf16 v[172:175], a[116:119], a[52:55], v[172:175]
  buffer_load_dwordx4 v5, s[16:19], s44 offen offset:1024 sc1 lds
  v_mfma_f32_16x16x32_bf16 v[172:175], a[112:115], a[48:51], v[172:175]
  ds_read_b128 a[88:91], v15 offset:3072
  v_mfma_f32_16x16x32_bf16 v[176:179], a[120:123], a[48:51], v[176:179]
  v_mfma_f32_16x16x32_bf16 v[176:179], a[124:127], a[52:55], v[176:179]
  ds_read_b128 a[92:95], v15 offset:12288
  v_mfma_f32_16x16x32_bf16 v[180:183], a[132:135], a[52:55], v[180:183]
  buffer_load_dwordx4 v5, s[16:19], s44 offen offset:2048 sc1 lds
  v_mfma_f32_16x16x32_bf16 v[180:183], a[128:131], a[48:51], v[180:183]
  ds_read_b128 a[96:99], v17 offset:0
  v_mfma_f32_16x16x32_bf16 v[184:187], a[136:139], a[48:51], v[184:187]
  ds_read_b128 a[48:51], v13 offset:2048
  v_mfma_f32_16x16x32_bf16 v[184:187], a[140:143], a[52:55], v[184:187]
  ds_read_b128 a[52:55], v13 offset:6144
  v_mfma_f32_16x16x32_bf16 v[204:207], a[136:139], a[56:59], v[204:207]
  v_mfma_f32_16x16x32_bf16 v[204:207], a[140:143], a[60:63], v[204:207]
  buffer_load_dwordx4 v5, s[16:19], s44 offen offset:3072 sc1 lds
  v_mfma_f32_16x16x32_bf16 v[200:203], a[132:135], a[60:63], v[200:203]
  ds_read_b128 a[100:103], v17 offset:9216
  v_mfma_f32_16x16x32_bf16 v[200:203], a[128:131], a[56:59], v[200:203]
  s_add_u32 m0, m0, 4096
  v_mfma_f32_16x16x32_bf16 v[196:199], a[120:123], a[56:59], v[196:199]
  buffer_load_dwordx4 v0, s[16:19], s45 offen sc1 lds
  v_mfma_f32_16x16x32_bf16 v[196:199], a[124:127], a[60:63], v[196:199]
  s_add_u32 s44, s44, s46
  s_add_u32 s45, s45, 81920
  v_mfma_f32_16x16x32_bf16 v[192:195], a[116:119], a[60:63], v[192:195]
  v_mfma_f32_16x16x32_bf16 v[192:195], a[112:115], a[56:59], v[192:195]
  v_mfma_f32_16x16x32_bf16 v[188:191], a[104:107], a[56:59], v[188:191]
  ds_read_b128 a[56:59], v13 offset:3072
  v_mfma_f32_16x16x32_bf16 v[188:191], a[108:111], a[60:63], v[188:191]
  ds_read_b128 a[60:63], v13 offset:7168
  s_waitcnt lgkmcnt(8)
  v_mfma_f32_16x16x32_bf16 v[128:131], a[64:67], a[32:35], v[128:131]
  s_add_u32 m0, s47, 0
  v_add_u32 v29, 128, v1
  v_mfma_f32_16x16x32_bf16 v[128:131], a[68:71], a[36:39], v[128:131]
  buffer_load_dwordx4 v0, s[16:19], s44 offen offset:0 sc1 lds
  v_mfma_f32_16x16x32_bf16 v[132:135], a[76:79], a[36:39], v[132:135]
  v_mul_u32_u24 v216, 6554, v29
  v_lshrrev_b32 v216, 16, v216
  v_mfma_f32_16x16x32_bf16 v[132:135], a[72:75], a[32:35], v[132:135]
  v_mul_u32_u24 v216, 1120, v216
  v_lshl_add_u32 v216, v29, 4, v216
  v_mfma_f32_16x16x32_bf16 v[136:139], a[80:83], a[32:35], v[136:139]
  buffer_load_dwordx4 v0, s[16:19], s44 offen offset:1024 sc1 lds
  v_mfma_f32_16x16x32_bf16 v[136:139], a[84:87], a[36:39], v[136:139]
  s_waitcnt vmcnt(11) lgkmcnt(0)
  s_barrier
  v_mfma_f32_16x16x32_bf16 v[140:143], a[92:95], a[36:39], v[140:143]
  ds_read_b128 a[104:107], v15 offset:36864
  v_fmac_f32 v188, v21, v108
  v_mfma_f32_16x16x32_bf16 v[140:143], a[88:91], a[32:35], v[140:143]
  ds_read_b128 a[108:111], v15 offset:46080
  v_fmac_f32 v189, v21, v109
  v_mfma_f32_16x16x32_bf16 v[144:147], a[96:99], a[32:35], v[144:147]
  ds_read_b128 a[32:35], v13 offset:36864
  v_fmac_f32 v190, v21, v110
  v_mfma_f32_16x16x32_bf16 v[144:147], a[100:103], a[36:39], v[144:147]
  ds_read_b128 a[36:39], v13 offset:40960
  v_fmac_f32 v191, v21, v111
  v_mfma_f32_16x16x32_bf16 v[164:167], a[96:99], a[40:43], v[164:167]
  buffer_load_dwordx4 v0, s[16:19], s44 offen offset:2048 sc1 lds
  v_mfma_f32_16x16x32_bf16 v[164:167], a[100:103], a[44:47], v[164:167]
  v_fmac_f32 v192, v21, v112
  v_fmac_f32 v193, v21, v113
  v_mfma_f32_16x16x32_bf16 v[160:163], a[92:95], a[44:47], v[160:163]
  ds_read_b128 a[112:115], v15 offset:37888
  v_fmac_f32 v194, v21, v114
  v_mfma_f32_16x16x32_bf16 v[160:163], a[88:91], a[40:43], v[160:163]
  ds_read_b128 a[116:119], v15 offset:47104
  v_fmac_f32 v195, v21, v115
  v_mfma_f32_16x16x32_bf16 v[156:159], a[80:83], a[40:43], v[156:159]
  buffer_load_dwordx4 v0, s[16:19], s44 offen offset:3072 sc1 lds
  v_mfma_f32_16x16x32_bf16 v[156:159], a[84:87], a[44:47], v[156:159]
  v_fmac_f32 v196, v21, v116
  v_fmac_f32 v197, v21, v117
  v_mfma_f32_16x16x32_bf16 v[152:155], a[76:79], a[44:47], v[152:155]
  ds_read_b128 a[120:123], v15 offset:38912
  s_add_u32 m0, m0, 4096
  v_mfma_f32_16x16x32_bf16 v[152:155], a[72:75], a[40:43], v[152:155]
  buffer_load_dwordx4 v5, s[16:19], s44 offen offset:0 sc1 lds
  v_mfma_f32_16x16x32_bf16 v[148:151], a[64:67], a[40:43], v[148:151]
  ds_read_b128 a[40:43], v13 offset:37888
  v_and_b32 v29, 32, v1
  v_mfma_f32_16x16x32_bf16 v[148:151], a[68:71], a[44:47], v[148:151]
  ds_read_b128 a[44:47], v13 offset:41984
  v_lshl_add_u32 v216, v29, 25, v216
  v_mfma_f32_16x16x32_bf16 v[168:171], a[64:67], a[48:51], v[168:171]
  s_mul_i32 s4, s38, 2560
  v_add_u32 v218, s4, v0
  v_mfma_f32_16x16x32_bf16 v[168:171], a[68:71], a[52:55], v[168:171]
  ds_read_b128 a[124:127], v15 offset:48128
  v_mul_u32_u24 v217, 40, v6
  v_mfma_f32_16x16x32_bf16 v[172:175], a[76:79], a[52:55], v[172:175]
  buffer_load_dwordx4 v5, s[16:19], s44 offen offset:1024 sc1 lds
  v_mfma_f32_16x16x32_bf16 v[172:175], a[72:75], a[48:51], v[172:175]
  ds_read_b128 a[128:131], v15 offset:39936
  v_lshrrev_b32 v29, 4, v1
  v_mfma_f32_16x16x32_bf16 v[176:179], a[80:83], a[48:51], v[176:179]
  v_lshl_add_u32 v217, v29, 3, v217
  v_add_u32 v217, s4, v217
  v_mfma_f32_16x16x32_bf16 v[176:179], a[84:87], a[52:55], v[176:179]
  ds_read_b128 a[132:135], v15 offset:49152
  v_mfma_f32_16x16x32_bf16 v[180:183], a[92:95], a[52:55], v[180:183]
  buffer_load_dwordx4 v5, s[16:19], s44 offen offset:2048 sc1 lds
  v_mfma_f32_16x16x32_bf16 v[180:183], a[88:91], a[48:51], v[180:183]
  ds_read_b128 a[136:139], v17 offset:36864
  v_mfma_f32_16x16x32_bf16 v[184:187], a[96:99], a[48:51], v[184:187]
  ds_read_b128 a[48:51], v13 offset:38912
  v_mfma_f32_16x16x32_bf16 v[184:187], a[100:103], a[52:55], v[184:187]
  ds_read_b128 a[52:55], v13 offset:43008
  v_mfma_f32_16x16x32_bf16 v[204:207], a[96:99], a[56:59], v[204:207]
  v_mfma_f32_16x16x32_bf16 v[204:207], a[100:103], a[60:63], v[204:207]
  buffer_load_dwordx4 v5, s[16:19], s44 offen offset:3072 sc1 lds
  v_mfma_f32_16x16x32_bf16 v[200:203], a[92:95], a[60:63], v[200:203]
  ds_read_b128 a[140:143], v17 offset:46080
  v_mfma_f32_16x16x32_bf16 v[200:203], a[88:91], a[56:59], v[200:203]
  s_add_u32 m0, m0, 4096
  v_mfma_f32_16x16x32_bf16 v[196:199], a[80:83], a[56:59], v[196:199]
  buffer_load_dwordx4 v0, s[16:19], s45 offen sc1 lds
  v_mfma_f32_16x16x32_bf16 v[196:199], a[84:87], a[60:63], v[196:199]
  s_add_u32 s44, s44, s46
  s_add_u32 s45, s45, 81920
  v_mfma_f32_16x16x32_bf16 v[192:195], a[76:79], a[60:63], v[192:195]
  v_mfma_f32_16x16x32_bf16 v[192:195], a[72:75], a[56:59], v[192:195]
  v_mfma_f32_16x16x32_bf16 v[188:191], a[64:67], a[56:59], v[188:191]
  ds_read_b128 a[56:59], v13 offset:39936
  v_mfma_f32_16x16x32_bf16 v[188:191], a[68:71], a[60:63], v[188:191]
  ds_read_b128 a[60:63], v13 offset:44032
  s_waitcnt lgkmcnt(8)
  v_mfma_f32_16x16x32_bf16 v[128:131], a[104:107], a[32:35], v[128:131]
  s_add_u32 m0, s47, 73728
  v_and_b32 v22, 3, v1
  v_mfma_f32_16x16x32_bf16 v[128:131], a[108:111], a[36:39], v[128:131]
  buffer_load_dwordx4 v0, s[16:19], s44 offen offset:0 sc1 lds
  v_mfma_f32_16x16x32_bf16 v[132:135], a[116:119], a[36:39], v[132:135]
  v_min_u32 v22, 2, v22
  v_add3_u32 v22, v22, s83, 1
  v_mfma_f32_16x16x32_bf16 v[132:135], a[112:115], a[32:35], v[132:135]
  v_and_b32 v22, 3, v22
  v_mul_u32_u24 v22, 10240, v22
  v_mfma_f32_16x16x32_bf16 v[136:139], a[120:123], a[32:35], v[136:139]
  buffer_load_dwordx4 v0, s[16:19], s44 offen offset:1024 sc1 lds
  v_mfma_f32_16x16x32_bf16 v[136:139], a[124:127], a[36:39], v[136:139]
  s_waitcnt vmcnt(11) lgkmcnt(0)
  s_barrier
  v_mfma_f32_16x16x32_bf16 v[140:143], a[132:135], a[36:39], v[140:143]
  ds_read_b128 a[64:67], v14 offset:36864
  v_fmac_f32 v198, v21, v118
  v_mfma_f32_16x16x32_bf16 v[140:143], a[128:131], a[32:35], v[140:143]
  ds_read_b128 a[68:71], v14 offset:46080
  v_fmac_f32 v199, v21, v119
  v_mfma_f32_16x16x32_bf16 v[144:147], a[136:139], a[32:35], v[144:147]
  ds_read_b128 a[32:35], v12 offset:36864
  v_fmac_f32 v200, v21, v120
  v_mfma_f32_16x16x32_bf16 v[144:147], a[140:143], a[36:39], v[144:147]
  ds_read_b128 a[36:39], v12 offset:40960
  v_fmac_f32 v201, v21, v121
  v_mfma_f32_16x16x32_bf16 v[164:167], a[136:139], a[40:43], v[164:167]
  buffer_load_dwordx4 v0, s[16:19], s44 offen offset:2048 sc1 lds
  v_mfma_f32_16x16x32_bf16 v[164:167], a[140:143], a[44:47], v[164:167]
  v_fmac_f32 v202, v21, v122
  v_fmac_f32 v203, v21, v123
  v_mfma_f32_16x16x32_bf16 v[160:163], a[132:135], a[44:47], v[160:163]
  ds_read_b128 a[72:75], v14 offset:37888
  v_fmac_f32 v204, v21, v124
  v_mfma_f32_16x16x32_bf16 v[160:163], a[128:131], a[40:43], v[160:163]
  ds_read_b128 a[76:79], v14 offset:47104
  v_fmac_f32 v205, v21, v125
  v_mfma_f32_16x16x32_bf16 v[156:159], a[120:123], a[40:43], v[156:159]
  buffer_load_dwordx4 v0, s[16:19], s44 offen offset:3072 sc1 lds
  v_mfma_f32_16x16x32_bf16 v[156:159], a[124:127], a[44:47], v[156:159]
  v_fmac_f32 v206, v21, v126
  v_fmac_f32 v207, v21, v127
  v_mfma_f32_16x16x32_bf16 v[152:155], a[116:119], a[44:47], v[152:155]
  ds_read_b128 a[80:83], v14 offset:38912
  s_add_u32 m0, m0, 4096
  v_mfma_f32_16x16x32_bf16 v[152:155], a[112:115], a[40:43], v[152:155]
  buffer_load_dwordx4 v5, s[16:19], s44 offen offset:0 sc1 lds
  v_mfma_f32_16x16x32_bf16 v[148:151], a[104:107], a[40:43], v[148:151]
  ds_read_b128 a[40:43], v12 offset:37888
  v_add_u32 v22, 4096, v22
  v_mfma_f32_16x16x32_bf16 v[148:151], a[108:111], a[44:47], v[148:151]
  ds_read_b128 a[44:47], v12 offset:41984
  v_mfma_f32_16x16x32_bf16 v[168:171], a[104:107], a[48:51], v[168:171]
  v_mfma_f32_16x16x32_bf16 v[168:171], a[108:111], a[52:55], v[168:171]
  ds_read_b128 a[84:87], v14 offset:48128
  v_mfma_f32_16x16x32_bf16 v[172:175], a[116:119], a[52:55], v[172:175]
  buffer_load_dwordx4 v5, s[16:19], s44 offen offset:1024 sc1 lds
  v_mfma_f32_16x16x32_bf16 v[172:175], a[112:115], a[48:51], v[172:175]
  ds_read_b128 a[88:91], v14 offset:39936
  v_mfma_f32_16x16x32_bf16 v[176:179], a[120:123], a[48:51], v[176:179]
  v_mfma_f32_16x16x32_bf16 v[176:179], a[124:127], a[52:55], v[176:179]
  ds_read_b128 a[92:95], v14 offset:49152
  v_mfma_f32_16x16x32_bf16 v[180:183], a[132:135], a[52:55], v[180:183]
  buffer_load_dwordx4 v5, s[16:19], s44 offen offset:2048 sc1 lds
  v_mfma_f32_16x16x32_bf16 v[180:183], a[128:131], a[48:51], v[180:183]
  ds_read_b128 a[96:99], v16 offset:36864
  v_mfma_f32_16x16x32_bf16 v[184:187], a[136:139], a[48:51], v[184:187]
  ds_read_b128 a[48:51], v12 offset:38912
  v_mfma_f32_16x16x32_bf16 v[184:187], a[140:143], a[52:55], v[184:187]
  ds_read_b128 a[52:55], v12 offset:43008
  v_mfma_f32_16x16x32_bf16 v[204:207], a[136:139], a[56:59], v[204:207]
  v_mfma_f32_16x16x32_bf16 v[204:207], a[140:143], a[60:63], v[204:207]
  buffer_load_dwordx4 v5, s[16:19], s44 offen offset:3072 sc1 lds
  v_mfma_f32_16x16x32_bf16 v[200:203], a[132:135], a[60:63], v[200:203]
  ds_read_b128 a[100:103], v16 offset:46080
  v_mfma_f32_16x16x32_bf16 v[200:203], a[128:131], a[56:59], v[200:203]
  s_add_u32 m0, m0, 4096
  v_mfma_f32_16x16x32_bf16 v[196:199], a[120:123], a[56:59], v[196:199]
  buffer_load_dwordx4 v0, s[16:19], s45 offen sc1 lds
  v_mfma_f32_16x16x32_bf16 v[196:199], a[124:127], a[60:63], v[196:199]
  s_add_u32 s44, s44, s46
  s_add_u32 s45, s45, 81920
  v_mfma_f32_16x16x32_bf16 v[192:195], a[116:119], a[60:63], v[192:195]
  v_mfma_f32_16x16x32_bf16 v[192:195], a[112:115], a[56:59], v[192:195]
  v_mfma_f32_16x16x32_bf16 v[188:191], a[104:107], a[56:59], v[188:191]
  ds_read_b128 a[56:59], v12 offset:39936
  v_mfma_f32_16x16x32_bf16 v[188:191], a[108:111], a[60:63], v[188:191]
  ds_read_b128 a[60:63], v12 offset:44032
  s_waitcnt lgkmcnt(8)
  v_mfma_f32_16x16x32_bf16 v[128:131], a[64:67], a[32:35], v[128:131]
  v_mfma_f32_16x16x32_bf16 v[128:131], a[68:71], a[36:39], v[128:131]
  v_mfma_f32_16x16x32_bf16 v[132:135], a[76:79], a[36:39], v[132:135]
  v_mfma_f32_16x16x32_bf16 v[132:135], a[72:75], a[32:35], v[132:135]
  v_mfma_f32_16x16x32_bf16 v[136:139], a[80:83], a[32:35], v[136:139]
  v_mfma_f32_16x16x32_bf16 v[136:139], a[84:87], a[36:39], v[136:139]
  s_waitcnt vmcnt(9) lgkmcnt(0)
  s_barrier
  v_mfma_f32_16x16x32_bf16 v[140:143], a[92:95], a[36:39], v[140:143]
  ds_read_b128 a[104:107], v14 offset:0
  v_mfma_f32_16x16x32_bf16 v[140:143], a[88:91], a[32:35], v[140:143]
  v_mfma_f32_16x16x32_bf16 v[144:147], a[96:99], a[32:35], v[144:147]
  ds_read_b128 a[32:35], v12 offset:0
  v_mfma_f32_16x16x32_bf16 v[144:147], a[100:103], a[36:39], v[144:147]
  ds_read_b128 a[36:39], v12 offset:4096
  v_mfma_f32_16x16x32_bf16 v[164:167], a[96:99], a[40:43], v[164:167]
  ds_read_b128 a[108:111], v14 offset:9216
  v_mfma_f32_16x16x32_bf16 v[164:167], a[100:103], a[44:47], v[164:167]
  v_mfma_f32_16x16x32_bf16 v[160:163], a[92:95], a[44:47], v[160:163]
  ds_read_b128 a[112:115], v14 offset:1024
  v_mfma_f32_16x16x32_bf16 v[160:163], a[88:91], a[40:43], v[160:163]
  v_mfma_f32_16x16x32_bf16 v[156:159], a[80:83], a[40:43], v[156:159]
  ds_read_b128 a[116:119], v14 offset:10240
  v_mfma_f32_16x16x32_bf16 v[156:159], a[84:87], a[44:47], v[156:159]
  v_mfma_f32_16x16x32_bf16 v[152:155], a[76:79], a[44:47], v[152:155]
  ds_read_b128 a[120:123], v14 offset:2048
  v_mfma_f32_16x16x32_bf16 v[152:155], a[72:75], a[40:43], v[152:155]
  v_mfma_f32_16x16x32_bf16 v[148:151], a[64:67], a[40:43], v[148:151]
  ds_read_b128 a[40:43], v12 offset:1024
  v_mfma_f32_16x16x32_bf16 v[148:151], a[68:71], a[44:47], v[148:151]
  ds_read_b128 a[44:47], v12 offset:5120
  v_mfma_f32_16x16x32_bf16 v[168:171], a[64:67], a[48:51], v[168:171]
  v_mfma_f32_16x16x32_bf16 v[168:171], a[68:71], a[52:55], v[168:171]
  ds_read_b128 a[124:127], v14 offset:11264
  v_mfma_f32_16x16x32_bf16 v[172:175], a[76:79], a[52:55], v[172:175]
  v_mfma_f32_16x16x32_bf16 v[172:175], a[72:75], a[48:51], v[172:175]
  ds_read_b128 a[128:131], v14 offset:3072
  v_mfma_f32_16x16x32_bf16 v[176:179], a[80:83], a[48:51], v[176:179]
  v_mfma_f32_16x16x32_bf16 v[176:179], a[84:87], a[52:55], v[176:179]
  ds_read_b128 a[132:135], v14 offset:12288
  v_mfma_f32_16x16x32_bf16 v[180:183], a[92:95], a[52:55], v[180:183]
  v_mfma_f32_16x16x32_bf16 v[180:183], a[88:91], a[48:51], v[180:183]
  ds_read_b128 a[136:139], v16 offset:0
  v_mfma_f32_16x16x32_bf16 v[184:187], a[96:99], a[48:51], v[184:187]
  ds_read_b128 a[48:51], v12 offset:2048
  v_mfma_f32_16x16x32_bf16 v[184:187], a[100:103], a[52:55], v[184:187]
  ds_read_b128 a[52:55], v12 offset:6144
  v_mfma_f32_16x16x32_bf16 v[204:207], a[96:99], a[56:59], v[204:207]
  v_mfma_f32_16x16x32_bf16 v[204:207], a[100:103], a[60:63], v[204:207]
  ds_read_b128 a[140:143], v16 offset:9216
  v_mfma_f32_16x16x32_bf16 v[200:203], a[92:95], a[60:63], v[200:203]
  v_mfma_f32_16x16x32_bf16 v[200:203], a[88:91], a[56:59], v[200:203]
  v_mfma_f32_16x16x32_bf16 v[196:199], a[80:83], a[56:59], v[196:199]
  v_mfma_f32_16x16x32_bf16 v[196:199], a[84:87], a[60:63], v[196:199]
  v_mfma_f32_16x16x32_bf16 v[192:195], a[76:79], a[60:63], v[192:195]
  v_mfma_f32_16x16x32_bf16 v[192:195], a[72:75], a[56:59], v[192:195]
  v_mfma_f32_16x16x32_bf16 v[188:191], a[64:67], a[56:59], v[188:191]
  ds_read_b128 a[56:59], v12 offset:3072
  v_mfma_f32_16x16x32_bf16 v[188:191], a[68:71], a[60:63], v[188:191]
  ds_read_b128 a[60:63], v12 offset:7168
  s_cmp_eq_u32 s38, s83
  s_waitcnt lgkmcnt(11)
  s_cbranch_scc1 L_own
  v_mfma_f32_16x16x32_bf16 v[128:131], a[104:107], a[32:35], v[128:131]
  v_mfma_f32_16x16x32_bf16 v[128:131], a[108:111], a[36:39], v[128:131]
  v_mfma_f32_16x16x32_bf16 v[132:135], a[116:119], a[36:39], v[132:135]
  v_mfma_f32_16x16x32_bf16 v[132:135], a[112:115], a[32:35], v[132:135]
  v_mfma_f32_16x16x32_bf16 v[136:139], a[120:123], a[32:35], v[136:139]
  s_waitcnt vmcnt(0) lgkmcnt(2)
  s_barrier
  v_mfma_f32_16x16x32_bf16 v[136:139], a[124:127], a[36:39], v[136:139]
  ds_read_b128 a[64:67], v15 offset:0
  v_mfma_f32_16x16x32_bf16 v[140:143], a[132:135], a[36:39], v[140:143]
  ds_read_b128 a[68:71], v15 offset:9216
  v_mfma_f32_16x16x32_bf16 v[140:143], a[128:131], a[32:35], v[140:143]
  ds_read_b128 a[72:75], v15 offset:1024
  v_mfma_f32_16x16x32_bf16 v[144:147], a[136:139], a[32:35], v[144:147]
  ds_read_b128 a[76:79], v15 offset:10240
  v_mfma_f32_16x16x32_bf16 v[144:147], a[140:143], a[36:39], v[144:147]
  ds_read_b128 a[32:35], v13 offset:0
  v_mfma_f32_16x16x32_bf16 v[148:151], a[104:107], a[40:43], v[148:151]
  ds_read_b128 a[36:39], v13 offset:4096
  v_mfma_f32_16x16x32_bf16 v[148:151], a[108:111], a[44:47], v[148:151]
  ds_read_b128 a[80:83], v15 offset:2048
  v_mfma_f32_16x16x32_bf16 v[152:155], a[116:119], a[44:47], v[152:155]
  ds_read_b128 a[84:87], v15 offset:11264
  v_mfma_f32_16x16x32_bf16 v[152:155], a[112:115], a[40:43], v[152:155]
  ds_read_b128 a[88:91], v15 offset:3072
  v_mfma_f32_16x16x32_bf16 v[156:159], a[120:123], a[40:43], v[156:159]
  ds_read_b128 a[92:95], v15 offset:12288
  v_mfma_f32_16x16x32_bf16 v[156:159], a[124:127], a[44:47], v[156:159]
  ds_read_b128 a[96:99], v17 offset:0
  v_mfma_f32_16x16x32_bf16 v[160:163], a[132:135], a[44:47], v[160:163]
  ds_read_b128 a[100:103], v17 offset:9216
  v_mfma_f32_16x16x32_bf16 v[160:163], a[128:131], a[40:43], v[160:163]
  v_mfma_f32_16x16x32_bf16 v[164:167], a[136:139], a[40:43], v[164:167]
  ds_read_b128 a[40:43], v13 offset:1024
  v_mfma_f32_16x16x32_bf16 v[164:167], a[140:143], a[44:47], v[164:167]
  ds_read_b128 a[44:47], v13 offset:5120
  s_waitcnt lgkmcnt(8)
  v_mfma_f32_16x16x32_bf16 v[128:131], a[64:67], a[32:35], v[128:131]
  v_mfma_f32_16x16x32_bf16 v[128:131], a[68:71], a[36:39], v[128:131]
  v_mfma_f32_16x16x32_bf16 v[132:135], a[76:79], a[36:39], v[132:135]
  v_mfma_f32_16x16x32_bf16 v[132:135], a[72:75], a[32:35], v[132:135]
  s_waitcnt lgkmcnt(4)
  v_mfma_f32_16x16x32_bf16 v[136:139], a[80:83], a[32:35], v[136:139]
  v_mfma_f32_16x16x32_bf16 v[136:139], a[84:87], a[36:39], v[136:139]
  v_mfma_f32_16x16x32_bf16 v[140:143], a[92:95], a[36:39], v[140:143]
  s_waitcnt lgkmcnt(3)
  v_mfma_f32_16x16x32_bf16 v[140:143], a[88:91], a[32:35], v[140:143]
  v_cvt_pk_bf16_f32 v128, v128, v129
  v_cvt_pk_bf16_f32 v129, v130, v131
  v_mfma_f32_16x16x32_bf16 v[144:147], a[96:99], a[32:35], v[144:147]
  ds_read_b128 a[32:35], v13 offset:2048
  s_waitcnt lgkmcnt(1)
  v_mfma_f32_16x16x32_bf16 v[144:147], a[100:103], a[36:39], v[144:147]
  ds_read_b128 a[36:39], v13 offset:6144
  v_cvt_pk_bf16_f32 v130, v132, v133
  v_mfma_f32_16x16x32_bf16 v[148:151], a[64:67], a[40:43], v[148:151]
  v_cvt_pk_bf16_f32 v131, v134, v135
  v_cvt_pk_bf16_f32 v132, v136, v137
  v_mfma_f32_16x16x32_bf16 v[148:151], a[68:71], a[44:47], v[148:151]
  buffer_store_dwordx4 v[128:131], v0, s[16:19], s92 offen offset:0 sc1
  v_mfma_f32_16x16x32_bf16 v[152:155], a[76:79], a[44:47], v[152:155]
  v_cvt_pk_bf16_f32 v133, v138, v139
  v_cvt_pk_bf16_f32 v134, v140, v141
  v_mfma_f32_16x16x32_bf16 v[152:155], a[72:75], a[40:43], v[152:155]
  v_cvt_pk_bf16_f32 v135, v142, v143
  v_cvt_pk_bf16_f32 v136, v144, v145
  v_mfma_f32_16x16x32_bf16 v[156:159], a[80:83], a[40:43], v[156:159]
  buffer_store_dwordx4 v[132:135], v0, s[16:19], s92 offen offset:1024 sc1
  v_mfma_f32_16x16x32_bf16 v[156:159], a[84:87], a[44:47], v[156:159]
  v_cvt_pk_bf16_f32 v148, v148, v149
  s_waitcnt lgkmcnt(0)
  v_mfma_f32_16x16x32_bf16 v[160:163], a[92:95], a[44:47], v[160:163]
  v_cvt_pk_bf16_f32 v149, v150, v151
  v_cvt_pk_bf16_f32 v150, v152, v153
  v_mfma_f32_16x16x32_bf16 v[160:163], a[88:91], a[40:43], v[160:163]
  v_cvt_pk_bf16_f32 v151, v154, v155
  v_cvt_pk_bf16_f32 v137, v146, v147
  v_mfma_f32_16x16x32_bf16 v[164:167], a[96:99], a[40:43], v[164:167]
  ds_read_b128 a[40:43], v13 offset:3072
  v_cvt_pk_bf16_f32 v152, v156, v157
  v_mfma_f32_16x16x32_bf16 v[164:167], a[100:103], a[44:47], v[164:167]
  ds_read_b128 a[44:47], v13 offset:7168
  v_cvt_pk_bf16_f32 v153, v158, v159
  v_mfma_f32_16x16x32_bf16 v[168:171], a[104:107], a[48:51], v[168:171]
  buffer_store_dwordx4 v[148:151], v0, s[16:19], s92 offen offset:2048 sc1
  v_mfma_f32_16x16x32_bf16 v[168:171], a[108:111], a[52:55], v[168:171]
  v_cvt_pk_bf16_f32 v154, v160, v161
  v_cvt_pk_bf16_f32 v155, v162, v163
  v_mfma_f32_16x16x32_bf16 v[168:171], a[64:67], a[32:35], v[168:171]
  buffer_store_dwordx4 v[152:155], v0, s[16:19], s92 offen offset:3072 sc1
  v_mfma_f32_16x16x32_bf16 v[168:171], a[68:71], a[36:39], v[168:171]
  v_cvt_pk_bf16_f32 v138, v164, v165
  v_cvt_pk_bf16_f32 v139, v166, v167
  v_mfma_f32_16x16x32_bf16 v[172:175], a[116:119], a[52:55], v[172:175]
  buffer_store_dwordx4 v[136:139], v5, s[16:19], s92 offen offset:0 sc1
  v_mfma_f32_16x16x32_bf16 v[172:175], a[112:115], a[48:51], v[172:175]
  s_waitcnt lgkmcnt(0)
  s_add_u32 s92, s92, 5120
  v_mfma_f32_16x16x32_bf16 v[172:175], a[76:79], a[36:39], v[172:175]
  v_cvt_pk_bf16_f32 v168, v168, v169
  v_cvt_pk_bf16_f32 v169, v170, v171
  v_mfma_f32_16x16x32_bf16 v[172:175], a[72:75], a[32:35], v[172:175]
  v_mfma_f32_16x16x32_bf16 v[176:179], a[120:123], a[48:51], v[176:179]
  v_mfma_f32_16x16x32_bf16 v[176:179], a[124:127], a[52:55], v[176:179]
  v_mfma_f32_16x16x32_bf16 v[176:179], a[80:83], a[32:35], v[176:179]
  v_mfma_f32_16x16x32_bf16 v[176:179], a[84:87], a[36:39], v[176:179]
  v_mfma_f32_16x16x32_bf16 v[180:183], a[132:135], a[52:55], v[180:183]
  v_mfma_f32_16x16x32_bf16 v[180:183], a[128:131], a[48:51], v[180:183]
  v_mfma_f32_16x16x32_bf16 v[180:183], a[92:95], a[36:39], v[180:183]
  v_mfma_f32_16x16x32_bf16 v[180:183], a[88:91], a[32:35], v[180:183]
  v_cvt_pk_bf16_f32 v170, v172, v173
  v_cvt_pk_bf16_f32 v171, v174, v175
  v_mfma_f32_16x16x32_bf16 v[184:187], a[136:139], a[48:51], v[184:187]
  buffer_store_dwordx4 v[168:171], v0, s[16:19], s92 offen offset:0 sc1
  v_mfma_f32_16x16x32_bf16 v[184:187], a[140:143], a[52:55], v[184:187]
  v_cvt_pk_bf16_f32 v172, v176, v177
  v_cvt_pk_bf16_f32 v173, v178, v179
  v_mfma_f32_16x16x32_bf16 v[184:187], a[96:99], a[32:35], v[184:187]
  v_cvt_pk_bf16_f32 v174, v180, v181
  v_cvt_pk_bf16_f32 v175, v182, v183
  v_mfma_f32_16x16x32_bf16 v[184:187], a[100:103], a[36:39], v[184:187]
  buffer_store_dwordx4 v[172:175], v0, s[16:19], s92 offen offset:1024 sc1
  v_mfma_f32_16x16x32_bf16 v[188:191], a[104:107], a[56:59], v[188:191]
  v_mfma_f32_16x16x32_bf16 v[188:191], a[108:111], a[60:63], v[188:191]
  v_mfma_f32_16x16x32_bf16 v[188:191], a[64:67], a[40:43], v[188:191]
  v_mfma_f32_16x16x32_bf16 v[188:191], a[68:71], a[44:47], v[188:191]
  v_mfma_f32_16x16x32_bf16 v[192:195], a[116:119], a[60:63], v[192:195]
  v_mfma_f32_16x16x32_bf16 v[192:195], a[112:115], a[56:59], v[192:195]
  v_mfma_f32_16x16x32_bf16 v[192:195], a[76:79], a[44:47], v[192:195]
  v_cvt_pk_bf16_f32 v176, v184, v185
  v_cvt_pk_bf16_f32 v177, v186, v187
  v_mfma_f32_16x16x32_bf16 v[192:195], a[72:75], a[40:43], v[192:195]
  v_mfma_f32_16x16x32_bf16 v[196:199], a[120:123], a[56:59], v[196:199]
  v_mfma_f32_16x16x32_bf16 v[196:199], a[124:127], a[60:63], v[196:199]
  v_cvt_pk_bf16_f32 v188, v188, v189
  v_cvt_pk_bf16_f32 v189, v190, v191
  v_mfma_f32_16x16x32_bf16 v[196:199], a[80:83], a[40:43], v[196:199]
  v_mfma_f32_16x16x32_bf16 v[196:199], a[84:87], a[44:47], v[196:199]
  v_mfma_f32_16x16x32_bf16 v[200:203], a[132:135], a[60:63], v[200:203]
  v_mfma_f32_16x16x32_bf16 v[200:203], a[128:131], a[56:59], v[200:203]
  v_cvt_pk_bf16_f32 v190, v192, v193
  v_cvt_pk_bf16_f32 v191, v194, v195
  v_mfma_f32_16x16x32_bf16 v[200:203], a[92:95], a[44:47], v[200:203]
  buffer_store_dwordx4 v[188:191], v0, s[16:19], s92 offen offset:2048 sc1
  v_mfma_f32_16x16x32_bf16 v[200:203], a[88:91], a[40:43], v[200:203]
  v_mfma_f32_16x16x32_bf16 v[204:207], a[136:139], a[56:59], v[204:207]
  v_cvt_pk_bf16_f32 v192, v196, v197
  v_cvt_pk_bf16_f32 v193, v198, v199
  v_mfma_f32_16x16x32_bf16 v[204:207], a[140:143], a[60:63], v[204:207]
  v_mfma_f32_16x16x32_bf16 v[204:207], a[96:99], a[40:43], v[204:207]
  v_mfma_f32_16x16x32_bf16 v[204:207], a[100:103], a[44:47], v[204:207]
  s_nop 0
  s_nop 0
  v_cvt_pk_bf16_f32 v194, v200, v201
  v_cvt_pk_bf16_f32 v195, v202, v203
  buffer_store_dwordx4 v[192:195], v0, s[16:19], s92 offen offset:3072 sc1
  s_nop 0
  s_nop 0
  s_nop 0
  v_cvt_pk_bf16_f32 v178, v204, v205
  v_cvt_pk_bf16_f32 v179, v206, v207
  buffer_store_dwordx4 v[176:179], v5, s[16:19], s92 offen offset:0 sc1
  s_branch L_notown
L_own:
  v_mfma_f32_16x16x32_bf16 v[128:131], a[104:107], a[32:35], v[128:131]
  v_mfma_f32_16x16x32_bf16 v[128:131], a[108:111], a[36:39], v[128:131]
  v_mfma_f32_16x16x32_bf16 v[132:135], a[116:119], a[36:39], v[132:135]
  v_mfma_f32_16x16x32_bf16 v[132:135], a[112:115], a[32:35], v[132:135]
  v_mfma_f32_16x16x32_bf16 v[136:139], a[120:123], a[32:35], v[136:139]
  s_waitcnt vmcnt(0) lgkmcnt(2)
  s_barrier
  v_mfma_f32_16x16x32_bf16 v[136:139], a[124:127], a[36:39], v[136:139]
  ds_read_b128 a[64:67], v15 offset:0
  v_mfma_f32_16x16x32_bf16 v[140:143], a[132:135], a[36:39], v[140:143]
  ds_read_b128 a[68:71], v15 offset:9216
  v_mfma_f32_16x16x32_bf16 v[140:143], a[128:131], a[32:35], v[140:143]
  ds_read_b128 a[72:75], v15 offset:1024
  v_mfma_f32_16x16x32_bf16 v[144:147], a[136:139], a[32:35], v[144:147]
  ds_read_b128 a[76:79], v15 offset:10240
  v_mfma_f32_16x16x32_bf16 v[144:147], a[140:143], a[36:39], v[144:147]
  ds_read_b128 a[32:35], v13 offset:0
  v_mfma_f32_16x16x32_bf16 v[148:151], a[104:107], a[40:43], v[148:151]
  ds_read_b128 a[36:39], v13 offset:4096
  v_mfma_f32_16x16x32_bf16 v[148:151], a[108:111], a[44:47], v[148:151]
  ds_read_b128 a[80:83], v15 offset:2048
  v_mfma_f32_16x16x32_bf16 v[152:155], a[116:119], a[44:47], v[152:155]
  ds_read_b128 a[84:87], v15 offset:11264
  v_mfma_f32_16x16x32_bf16 v[152:155], a[112:115], a[40:43], v[152:155]
  ds_read_b128 a[88:91], v15 offset:3072
  v_mfma_f32_16x16x32_bf16 v[156:159], a[120:123], a[40:43], v[156:159]
  ds_read_b128 a[92:95], v15 offset:12288
  v_mfma_f32_16x16x32_bf16 v[156:159], a[124:127], a[44:47], v[156:159]
  ds_read_b128 a[96:99], v17 offset:0
  v_mfma_f32_16x16x32_bf16 v[160:163], a[132:135], a[44:47], v[160:163]
  ds_read_b128 a[100:103], v17 offset:9216
  v_mfma_f32_16x16x32_bf16 v[160:163], a[128:131], a[40:43], v[160:163]
  v_mfma_f32_16x16x32_bf16 v[164:167], a[136:139], a[40:43], v[164:167]
  ds_read_b128 a[40:43], v13 offset:1024
  v_mfma_f32_16x16x32_bf16 v[164:167], a[140:143], a[44:47], v[164:167]
  ds_read_b128 a[44:47], v13 offset:5120
  s_waitcnt lgkmcnt(8)
  v_mfma_f32_16x16x32_bf16 v[128:131], a[64:67], a[32:35], v[128:131]
  v_mfma_f32_16x16x32_bf16 v[128:131], a[68:71], a[36:39], v[128:131]
  v_mfma_f32_16x16x32_bf16 v[132:135], a[76:79], a[36:39], v[132:135]
  v_mfma_f32_16x16x32_bf16 v[132:135], a[72:75], a[32:35], v[132:135]
  s_waitcnt lgkmcnt(4)
  v_mfma_f32_16x16x32_bf16 v[136:139], a[80:83], a[32:35], v[136:139]
  v_mfma_f32_16x16x32_bf16 v[136:139], a[84:87], a[36:39], v[136:139]
  v_mfma_f32_16x16x32_bf16 v[140:143], a[92:95], a[36:39], v[140:143]
  s_waitcnt lgkmcnt(3)
  v_mfma_f32_16x16x32_bf16 v[140:143], a[88:91], a[32:35], v[140:143]
  v_cvt_pk_bf16_f32 v128, v128, v129
  v_cvt_pk_bf16_f32 v129, v130, v131
  v_mfma_f32_16x16x32_bf16 v[144:147], a[96:99], a[32:35], v[144:147]
  ds_read_b128 a[32:35], v13 offset:2048
  s_waitcnt lgkmcnt(1)
  v_mfma_f32_16x16x32_bf16 v[144:147], a[100:103], a[36:39], v[144:147]
  ds_read_b128 a[36:39], v13 offset:6144
  v_cvt_pk_bf16_f32 v130, v132, v133
  v_mfma_f32_16x16x32_bf16 v[148:151], a[64:67], a[40:43], v[148:151]
  v_cvt_pk_bf16_f32 v131, v134, v135
  v_cvt_pk_bf16_f32 v132, v136, v137
  v_mfma_f32_16x16x32_bf16 v[148:151], a[68:71], a[44:47], v[148:151]
  v_cvt_pk_bf16_f32 v133, v138, v139
  v_cvt_pk_bf16_f32 v134, v140, v141
  v_mfma_f32_16x16x32_bf16 v[152:155], a[76:79], a[44:47], v[152:155]
  v_cvt_pk_bf16_f32 v135, v142, v143
  v_cvt_pk_bf16_f32 v136, v144, v145
  v_mfma_f32_16x16x32_bf16 v[152:155], a[72:75], a[40:43], v[152:155]
  v_cvt_pk_bf16_f32 v137, v146, v147
  v_mfma_f32_16x16x32_bf16 v[156:159], a[80:83], a[40:43], v[156:159]
  v_cvt_pk_bf16_f32 v148, v148, v149
  v_cvt_pk_bf16_f32 v149, v150, v151
  v_mfma_f32_16x16x32_bf16 v[156:159], a[84:87], a[44:47], v[156:159]
  v_mfma_f32_16x16x32_bf16 v[160:163], a[92:95], a[44:47], v[160:163]
  v_mfma_f32_16x16x32_bf16 v[160:163], a[88:91], a[40:43], v[160:163]
  v_mfma_f32_16x16x32_bf16 v[164:167], a[96:99], a[40:43], v[164:167]
  ds_read_b128 a[40:43], v13 offset:3072
  s_waitcnt lgkmcnt(1)
  v_mfma_f32_16x16x32_bf16 v[164:167], a[100:103], a[44:47], v[164:167]
  ds_read_b128 a[44:47], v13 offset:7168
  v_cvt_pk_bf16_f32 v150, v152, v153
  v_mfma_f32_16x16x32_bf16 v[168:171], a[104:107], a[48:51], v[168:171]
  ds_write_b128 v7, v[128:131] offset:0
  v_mfma_f32_16x16x32_bf16 v[168:171], a[108:111], a[52:55], v[168:171]
  ds_write_b128 v7, v[132:135] offset:1024
  v_mfma_f32_16x16x32_bf16 v[168:171], a[64:67], a[32:35], v[168:171]
  v_cvt_pk_bf16_f32 v151, v154, v155
  v_cvt_pk_bf16_f32 v152, v156, v157
  v_mfma_f32_16x16x32_bf16 v[168:171], a[68:71], a[36:39], v[168:171]
  ds_write_b128 v7, v[148:151] offset:2048
  v_mfma_f32_16x16x32_bf16 v[172:175], a[116:119], a[52:55], v[172:175]
  v_cvt_pk_bf16_f32 v153, v158, v159
  v_cvt_pk_bf16_f32 v154, v160, v161
  v_mfma_f32_16x16x32_bf16 v[172:175], a[112:115], a[48:51], v[172:175]
  v_cvt_pk_bf16_f32 v155, v162, v163
  v_cvt_pk_bf16_f32 v138, v164, v165
  v_mfma_f32_16x16x32_bf16 v[172:175], a[76:79], a[36:39], v[172:175]
  s_waitcnt lgkmcnt(3)
  v_cvt_pk_bf16_f32 v139, v166, v167
  v_mfma_f32_16x16x32_bf16 v[172:175], a[72:75], a[32:35], v[172:175]
  ds_write_b128 v7, v[152:155] offset:3072
  v_mfma_f32_16x16x32_bf16 v[176:179], a[120:123], a[48:51], v[176:179]
  ds_write_b128 v7, v[136:139] offset:4096
  v_mfma_f32_16x16x32_bf16 v[176:179], a[124:127], a[52:55], v[176:179]
  v_cvt_pk_bf16_f32 v168, v168, v169
  v_cvt_pk_bf16_f32 v169, v170, v171
  v_mfma_f32_16x16x32_bf16 v[176:179], a[80:83], a[32:35], v[176:179]
  v_mfma_f32_16x16x32_bf16 v[176:179], a[84:87], a[36:39], v[176:179]
  v_cvt_pk_bf16_f32 v170, v172, v173
  v_cvt_pk_bf16_f32 v171, v174, v175
  v_mfma_f32_16x16x32_bf16 v[180:183], a[132:135], a[52:55], v[180:183]
  ds_write_b128 v7, v[168:171] offset:5120
  v_mfma_f32_16x16x32_bf16 v[180:183], a[128:131], a[48:51], v[180:183]
  v_mfma_f32_16x16x32_bf16 v[180:183], a[92:95], a[36:39], v[180:183]
  v_mfma_f32_16x16x32_bf16 v[180:183], a[88:91], a[32:35], v[180:183]
  v_mfma_f32_16x16x32_bf16 v[184:187], a[136:139], a[48:51], v[184:187]
  v_cvt_pk_bf16_f32 v172, v176, v177
  v_cvt_pk_bf16_f32 v173, v178, v179
  v_mfma_f32_16x16x32_bf16 v[184:187], a[140:143], a[52:55], v[184:187]
  v_mfma_f32_16x16x32_bf16 v[184:187], a[96:99], a[32:35], v[184:187]
  v_mfma_f32_16x16x32_bf16 v[184:187], a[100:103], a[36:39], v[184:187]
  v_mfma_f32_16x16x32_bf16 v[188:191], a[104:107], a[56:59], v[188:191]
  v_mfma_f32_16x16x32_bf16 v[188:191], a[108:111], a[60:63], v[188:191]
  v_cvt_pk_bf16_f32 v174, v180, v181
  v_cvt_pk_bf16_f32 v175, v182, v183
  v_mfma_f32_16x16x32_bf16 v[188:191], a[64:67], a[40:43], v[188:191]
  ds_write_b128 v7, v[172:175] offset:6144
  v_mfma_f32_16x16x32_bf16 v[188:191], a[68:71], a[44:47], v[188:191]
  v_mfma_f32_16x16x32_bf16 v[192:195], a[116:119], a[60:63], v[192:195]
  v_cvt_pk_bf16_f32 v176, v184, v185
  v_cvt_pk_bf16_f32 v177, v186, v187
  v_mfma_f32_16x16x32_bf16 v[192:195], a[112:115], a[56:59], v[192:195]
  v_mfma_f32_16x16x32_bf16 v[192:195], a[76:79], a[44:47], v[192:195]
  v_mfma_f32_16x16x32_bf16 v[192:195], a[72:75], a[40:43], v[192:195]
  v_mfma_f32_16x16x32_bf16 v[196:199], a[120:123], a[56:59], v[196:199]
  v_mfma_f32_16x16x32_bf16 v[196:199], a[124:127], a[60:63], v[196:199]
  v_cvt_pk_bf16_f32 v188, v188, v189
  v_cvt_pk_bf16_f32 v189, v190, v191
  v_mfma_f32_16x16x32_bf16 v[196:199], a[80:83], a[40:43], v[196:199]
  v_mfma_f32_16x16x32_bf16 v[196:199], a[84:87], a[44:47], v[196:199]
  v_mfma_f32_16x16x32_bf16 v[200:203], a[132:135], a[60:63], v[200:203]
  v_mfma_f32_16x16x32_bf16 v[200:203], a[128:131], a[56:59], v[200:203]
  v_cvt_pk_bf16_f32 v190, v192, v193
  v_cvt_pk_bf16_f32 v191, v194, v195
  v_mfma_f32_16x16x32_bf16 v[200:203], a[92:95], a[44:47], v[200:203]
  ds_write_b128 v7, v[188:191] offset:7168
  v_mfma_f32_16x16x32_bf16 v[200:203], a[88:91], a[40:43], v[200:203]
  v_mfma_f32_16x16x32_bf16 v[204:207], a[136:139], a[56:59], v[204:207]
  v_cvt_pk_bf16_f32 v192, v196, v197
  v_cvt_pk_bf16_f32 v193, v198, v199
  v_mfma_f32_16x16x32_bf16 v[204:207], a[140:143], a[60:63], v[204:207]
  v_mfma_f32_16x16x32_bf16 v[204:207], a[96:99], a[40:43], v[204:207]
  v_mfma_f32_16x16x32_bf16 v[204:207], a[100:103], a[44:47], v[204:207]
  s_nop 0
  s_nop 0
  v_cvt_pk_bf16_f32 v194, v200, v201
  v_cvt_pk_bf16_f32 v195, v202, v203
  ds_write_b128 v7, v[192:195] offset:8192
  s_nop 0
  s_nop 0
  s_nop 0
  v_cvt_pk_bf16_f32 v178, v204, v205
  v_cvt_pk_bf16_f32 v179, v206, v207
  ds_write_b128 v7, v[176:179] offset:9216
L_notown:
  buffer_load_dword v30, v22, s[16:19], s93 offen sc1
  s_waitcnt lgkmcnt(0)
  s_barrier
  ds_read_b128 v[32:35], v2 offset:0
  ds_read_b128 v[36:39], v2 offset:1024
  ds_read_b64 v[40:41], v3
  s_waitcnt lgkmcnt(0)
  v_and_b32 v51, 0xffff0000, v41
  v_lshlrev_b32 v50, 16, v41
  v_and_b32 v49, 0xffff0000, v40
  v_lshlrev_b32 v48, 16, v40
  v_and_b32 v47, 0xffff0000, v39
  v_lshlrev_b32 v46, 16, v39
  v_and_b32 v45, 0xffff0000, v38
  v_lshlrev_b32 v44, 16, v38
  v_and_b32 v43, 0xffff0000, v37
  v_lshlrev_b32 v42, 16, v37
  v_and_b32 v41, 0xffff0000, v36
  v_lshlrev_b32 v40, 16, v36
  v_and_b32 v39, 0xffff0000, v35
  v_lshlrev_b32 v38, 16, v35
  v_and_b32 v37, 0xffff0000, v34
  v_lshlrev_b32 v36, 16, v34
  v_and_b32 v35, 0xffff0000, v33
  v_lshlrev_b32 v34, 16, v33
  v_and_b32 v33, 0xffff0000, v32
  v_lshlrev_b32 v32, 16, v32
  s_waitcnt vmcnt(0)
  v_cmp_eq_u32 vcc, -1, v30
  s_cbranch_vccnz L_hint_31
L_hintback_32:
  buffer_load_dwordx4 v[52:55], v9, s[16:19], s64 offen offset:0 sc1
  buffer_load_dwordx4 v[56:59], v9, s[16:19], s64 offen offset:1024 sc1
  buffer_load_dwordx2 v[60:61], v10, s[16:19], s64 offen sc1
  buffer_load_dwordx4 v[72:75], v9, s[16:19], s65 offen offset:0 sc1
  buffer_load_dwordx4 v[76:79], v9, s[16:19], s65 offen offset:1024 sc1
  buffer_load_dwordx2 v[80:81], v10, s[16:19], s65 offen sc1
  buffer_load_dwordx4 v[92:95], v9, s[16:19], s66 offen offset:0 sc1
  buffer_load_dwordx4 v[96:99], v9, s[16:19], s66 offen offset:1024 sc1
  buffer_load_dwordx2 v[100:101], v10, s[16:19], s66 offen sc1
L_have:
  s_waitcnt vmcnt(6)
  v_max3_u32 v31, v52, v56, v60
  v_cmp_eq_u32 vcc, -1, v31
  s_cbranch_vccnz L_px_34
L_pxback_35:
  v_and_b32 v71, 0xffff0000, v61
  v_lshlrev_b32 v70, 16, v61
  v_and_b32 v69, 0xffff0000, v60
  v_lshlrev_b32 v68, 16, v60
  v_and_b32 v67, 0xffff0000, v59
  v_lshlrev_b32 v66, 16, v59
  v_and_b32 v65, 0xffff0000, v58
  v_lshlrev_b32 v64, 16, v58
  v_and_b32 v63, 0xffff0000, v57
  v_lshlrev_b32 v62, 16, v57
  v_and_b32 v61, 0xffff0000, v56
  v_lshlrev_b32 v60, 16, v56
  v_and_b32 v59, 0xffff0000, v55
  v_lshlrev_b32 v58, 16, v55
  v_and_b32 v57, 0xffff0000, v54
  v_lshlrev_b32 v56, 16, v54
  v_and_b32 v55, 0xffff0000, v53
  v_lshlrev_b32 v54, 16, v53
  v_and_b32 v53, 0xffff0000, v52
  v_lshlrev_b32 v52, 16, v52
  v_pk_add_f32 v[32:33], v[32:33], v[52:53]
  v_pk_add_f32 v[34:35], v[34:35], v[54:55]
  v_pk_add_f32 v[36:37], v[36:37], v[56:57]
  v_pk_add_f32 v[38:39], v[38:39], v[58:59]
  v_pk_add_f32 v[40:41], v[40:41], v[60:61]
  v_pk_add_f32 v[42:43], v[42:43], v[62:63]
  v_pk_add_f32 v[44:45], v[44:45], v[64:65]
  v_pk_add_f32 v[46:47], v[46:47], v[66:67]
  v_pk_add_f32 v[48:49], v[48:49], v[68:69]
  v_pk_add_f32 v[50:51], v[50:51], v[70:71]
  s_waitcnt vmcnt(3)
  v_max3_u32 v31, v72, v76, v80
  v_cmp_eq_u32 vcc, -1, v31
  s_cbranch_vccnz L_px_37
L_pxback_38:
  v_and_b32 v91, 0xffff0000, v81
  v_lshlrev_b32 v90, 16, v81
  v_and_b32 v89, 0xffff0000, v80
  v_lshlrev_b32 v88, 16, v80
  v_and_b32 v87, 0xffff0000, v79
  v_lshlrev_b32 v86, 16, v79
  v_and_b32 v85, 0xffff0000, v78
  v_lshlrev_b32 v84, 16, v78
  v_and_b32 v83, 0xffff0000, v77
  v_lshlrev_b32 v82, 16, v77
  v_and_b32 v81, 0xffff0000, v76
  v_lshlrev_b32 v80, 16, v76
  v_and_b32 v79, 0xffff0000, v75
  v_lshlrev_b32 v78, 16, v75
  v_and_b32 v77, 0xffff0000, v74
  v_lshlrev_b32 v76, 16, v74
  v_and_b32 v75, 0xffff0000, v73
  v_lshlrev_b32 v74, 16, v73
  v_and_b32 v73, 0xffff0000, v72
  v_lshlrev_b32 v72, 16, v72
  v_pk_add_f32 v[32:33], v[32:33], v[72:73]
  v_pk_add_f32 v[34:35], v[34:35], v[74:75]
  v_pk_add_f32 v[36:37], v[36:37], v[76:77]
  v_pk_add_f32 v[38:39], v[38:39], v[78:79]
  v_pk_add_f32 v[40:41], v[40:41], v[80:81]
  v_pk_add_f32 v[42:43], v[42:43], v[82:83]
  v_pk_add_f32 v[44:45], v[44:45], v[84:85]
  v_pk_add_f32 v[46:47], v[46:47], v[86:87]
  v_pk_add_f32 v[48:49], v[48:49], v[88:89]
  v_pk_add_f32 v[50:51], v[50:51], v[90:91]
  s_waitcnt vmcnt(0)
  v_max3_u32 v31, v92, v96, v100
  v_cmp_eq_u32 vcc, -1, v31
  s_cbranch_vccnz L_px_40
L_pxback_41:
  v_and_b32 v111, 0xffff0000, v101
  v_lshlrev_b32 v110, 16, v101
  v_and_b32 v109, 0xffff0000, v100
  v_lshlrev_b32 v108, 16, v100
  v_and_b32 v107, 0xffff0000, v99
  v_lshlrev_b32 v106, 16, v99
  v_and_b32 v105, 0xffff0000, v98
  v_lshlrev_b32 v104, 16, v98
  v_and_b32 v103, 0xffff0000, v97
  v_lshlrev_b32 v102, 16, v97
  v_and_b32 v101, 0xffff0000, v96
  v_lshlrev_b32 v100, 16, v96
  v_and_b32 v99, 0xffff0000, v95
  v_lshlrev_b32 v98, 16, v95
  v_and_b32 v97, 0xffff0000, v94
  v_lshlrev_b32 v96, 16, v94
  v_and_b32 v95, 0xffff0000, v93
  v_lshlrev_b32 v94, 16, v93
  v_and_b32 v93, 0xffff0000, v92
  v_lshlrev_b32 v92, 16, v92
  v_pk_add_f32 v[32:33], v[32:33], v[92:93]
  v_pk_add_f32 v[34:35], v[34:35], v[94:95]
  v_pk_add_f32 v[36:37], v[36:37], v[96:97]
  v_pk_add_f32 v[38:39], v[38:39], v[98:99]
  v_pk_add_f32 v[40:41], v[40:41], v[100:101]
  v_pk_add_f32 v[42:43], v[42:43], v[102:103]
  v_pk_add_f32 v[44:45], v[44:45], v[104:105]
  v_pk_add_f32 v[46:47], v[46:47], v[106:107]
  v_pk_add_f32 v[48:49], v[48:49], v[108:109]
  v_pk_add_f32 v[50:51], v[50:51], v[110:111]
  v_cvt_pk_bf16_f32 v32, v32, v33
  v_cvt_pk_bf16_f32 v33, v34, v35
  v_cvt_pk_bf16_f32 v34, v36, v37
  v_cvt_pk_bf16_f32 v35, v38, v39
  v_cvt_pk_bf16_f32 v36, v40, v41
  v_cvt_pk_bf16_f32 v37, v42, v43
  v_cvt_pk_bf16_f32 v38, v44, v45
  v_cvt_pk_bf16_f32 v39, v46, v47
  v_cvt_pk_bf16_f32 v40, v48, v49
  v_cvt_pk_bf16_f32 v41, v50, v51
  ds_write_b64 v217, v[32:33] offset:0
  ds_write_b64 v217, v[34:35] offset:32
  ds_write_b64 v217, v[36:37] offset:64
  ds_write_b64 v217, v[38:39] offset:96
  ds_write_b64 v217, v[40:41] offset:128
  ds_read_b128 v[52:55], v218 offset:0
  ds_read_b128 v[56:59], v218 offset:1024
  ds_read_b128 v[60:63], v218 offset:2048
  s_waitcnt lgkmcnt(2)
  buffer_store_dwordx4 v[52:55], v214, s[24:27], s3 offen sc1
  s_waitcnt lgkmcnt(1)
  buffer_store_dwordx4 v[56:59], v215, s[24:27], s3 offen sc1
  s_waitcnt lgkmcnt(0)
  buffer_store_dwordx4 v[60:63], v216, s[24:27], s3 offen sc1
  s_waitcnt vmcnt(0)
L_exit:
  s_endpgm
L_go_4:
  s_mov_b32 s63, 0x40000
L_goloop_6:
  s_sleep 2
  buffer_load_dword v30, v61, s[20:23], 0 offen sc1
  s_sub_u32 s63, s63, 1
  s_cmp_eq_u32 s63, 0
  s_waitcnt vmcnt(0)
  s_cbranch_scc1 L_goback_5
  v_cmp_eq_u32 vcc, 0, v30
  s_cbranch_vccnz L_goloop_6
  s_branch L_goback_5
L_kv_7:
  s_mov_b32 s63, 0x40000
L_kvloop_9:
  s_sleep 2
  buffer_load_dword v30, v31, s[16:19], s6 offen sc1
  s_sub_u32 s63, s63, 1
  s_cmp_eq_u32 s63, 0
  s_waitcnt vmcnt(0)
  s_cbranch_scc1 L_kvback_8
  v_cmp_eq_u32 vcc, 0, v30
  s_cbranch_vccnz L_kvloop_9
  s_branch L_kvback_8
L_gt_13:
  s_mov_b32 s63, 0x40000
L_gtloop_15:
  s_sleep 2
  buffer_load_dword v30, off, s[16:19], s97 sc1
  s_sub_u32 s63, s63, 1
  s_cmp_eq_u32 s63, 0
  s_waitcnt vmcnt(0)
  s_cbranch_scc1 L_gtback_14
  v_cmp_eq_u32 vcc, 0, v30
  s_cbranch_vccnz L_gtloop_15
  s_branch L_gtback_14
L_gt_16:
  s_mov_b32 s63, 0x40000
L_gtloop_18:
  s_sleep 2
  buffer_load_dword v30, off, s[16:19], s97 sc1
  s_sub_u32 s63, s63, 1
  s_cmp_eq_u32 s63, 0
  s_waitcnt vmcnt(0)
  s_cbranch_scc1 L_gtback_17
  v_cmp_eq_u32 vcc, 0, v30
  s_cbranch_vccnz L_gtloop_18
  s_branch L_gtback_17
L_p2_19:
  s_mov_b32 s63, 0x40000
L_p2loop_21:
  s_sleep 2
  buffer_load_dwordx4 v[240:243], v0, s[16:19], s81 offen sc1
  s_sub_u32 s63, s63, 1
  s_cmp_eq_u32 s63, 0
  s_waitcnt vmcnt(0)
  s_cbranch_scc1 L_p2back_20
  v_min3_u32 v240, v240, v241, v242
  v_min_u32 v240, v240, v243
  v_cmp_eq_u32 vcc, 0, v240
  s_cbranch_vccnz L_p2loop_21
  s_branch L_p2back_20
L_p2_22:
  s_mov_b32 s63, 0x40000
L_p2loop_24:
  s_sleep 2
  buffer_load_dwordx4 v[240:243], v0, s[16:19], s81 offen sc1
  s_sub_u32 s63, s63, 1
  s_cmp_eq_u32 s63, 0
  s_waitcnt vmcnt(0)
  s_cbranch_scc1 L_p2back_23
  v_min3_u32 v240, v240, v241, v242
  v_min_u32 v240, v240, v243
  v_cmp_eq_u32 vcc, 0, v240
  s_cbranch_vccnz L_p2loop_24
  s_branch L_p2back_23
L_slowj:
L_slowj0:
L_slowj1:
  s_waitcnt vmcnt(0) lgkmcnt(0)
  v_mov_b64 v[96:97], 0
  v_mov_b64 v[98:99], 0
  v_mov_b64 v[100:101], 0
  v_mov_b64 v[102:103], 0
  v_mov_b64 v[104:105], 0
  v_mov_b64 v[106:107], 0
  v_mov_b64 v[108:109], 0
  v_mov_b64 v[110:111], 0
  v_mov_b64 v[112:113], 0
  v_mov_b64 v[114:115], 0
  v_mov_b64 v[116:117], 0
  v_mov_b64 v[118:119], 0
  v_mov_b64 v[120:121], 0
  v_mov_b64 v[122:123], 0
  v_mov_b64 v[124:125], 0
  v_mov_b64 v[126:127], 0
  v_mov_b64 v[128:129], 0
  v_mov_b64 v[130:131], 0
  v_mov_b64 v[132:133], 0
  v_mov_b64 v[134:135], 0
  v_mov_b64 v[136:137], 0
  v_mov_b64 v[138:139], 0
  v_mov_b64 v[140:141], 0
  v_mov_b64 v[142:143], 0
  v_mov_b64 v[144:145], 0
  v_mov_b64 v[146:147], 0
  v_mov_b64 v[148:149], 0
  v_mov_b64 v[150:151], 0
  v_mov_b64 v[152:153], 0
  v_mov_b64 v[154:155], 0
  v_mov_b64 v[156:157], 0
  v_mov_b64 v[158:159], 0
  v_mov_b64 v[32:33], 0
  v_mov_b64 v[34:35], 0
  v_mov_b64 v[36:37], 0
  v_mov_b64 v[38:39], 0
  s_lshl_b32 s3, s37, 7
  s_add_u32 s3, s3, 0
  s_lshl_b32 s4, s39, 4
  s_add_u32 s3, s3, s4
  v_and_b32 v86, 15, v1
  v_add_u32 v86, s3, v86
  v_lshrrev_b32 v83, 4, v1
  v_lshlrev_b32 v83, 2, v83
  v_sub_u32 v86, v86, v83
  v_add_u32 v87, 32, v86
  v_mov_b32 v80, 0xff7fffff
  v_mov_b32 v81, 0xff7fffff
  v_mov_b32 v85, 0xff800000
  s_mul_i32 s3, s36, 532480
  s_add_u32 s4, s3, 17825792
  s_add_u32 s3, s3, 65536
  s_lshl_b32 s5, s37, 2
  s_add_u32 s5, s5, 4
L_slowloop_25:
  buffer_load_dwordx4 a[64:67], v0, s[16:19], s3 offen offset:0 sc1
  buffer_load_dwordx4 a[68:71], v0, s[16:19], s3 offen offset:1024 sc1
  buffer_load_dwordx4 a[72:75], v0, s[16:19], s3 offen offset:2048 sc1
  buffer_load_dwordx4 a[76:79], v0, s[16:19], s3 offen offset:3072 sc1
  buffer_load_dwordx4 a[80:83], v5, s[16:19], s3 offen offset:0 sc1
  buffer_load_dwordx4 a[84:87], v5, s[16:19], s3 offen offset:1024 sc1
  buffer_load_dwordx4 a[88:91], v5, s[16:19], s3 offen offset:2048 sc1
  buffer_load_dwordx4 a[92:95], v5, s[16:19], s3 offen offset:3072 sc1
  buffer_load_dwordx4 a[96:99], v0, s[16:19], s4 offen offset:0 sc1
  buffer_load_dwordx4 a[100:103], v0, s[16:19], s4 offen offset:1024 sc1
  buffer_load_dwordx4 a[104:107], v0, s[16:19], s4 offen offset:2048 sc1
  buffer_load_dwordx4 a[108:111], v0, s[16:19], s4 offen offset:3072 sc1
  buffer_load_dwordx4 a[208:211], v5, s[16:19], s4 offen offset:0 sc1
  buffer_load_dwordx4 a[212:215], v5, s[16:19], s4 offen offset:1024 sc1
  buffer_load_dwordx4 a[216:219], v5, s[16:19], s4 offen offset:2048 sc1
  buffer_load_dwordx4 a[220:223], v5, s[16:19], s4 offen offset:3072 sc1
  s_waitcnt vmcnt(0)
  v_mfma_f32_16x16x32_bf16 v[64:67], a[64:67], a[0:3], 0
  v_mfma_f32_16x16x32_bf16 v[64:67], a[68:71], a[4:7], v[64:67]
  v_mfma_f32_16x16x32_bf16 v[64:67], a[72:75], a[8:11], v[64:67]
  v_mfma_f32_16x16x32_bf16 v[64:67], a[76:79], a[12:15], v[64:67]
  v_mfma_f32_16x16x32_bf16 v[68:71], a[92:95], a[12:15], 0
  v_mfma_f32_16x16x32_bf16 v[68:71], a[88:91], a[8:11], v[68:71]
  v_mfma_f32_16x16x32_bf16 v[68:71], a[84:87], a[4:7], v[68:71]
  v_mfma_f32_16x16x32_bf16 v[68:71], a[80:83], a[0:3], v[68:71]
  v_mfma_f32_16x16x32_bf16 v[72:75], a[64:67], a[16:19], 0
  v_mfma_f32_16x16x32_bf16 v[72:75], a[68:71], a[20:23], v[72:75]
  v_mfma_f32_16x16x32_bf16 v[72:75], a[72:75], a[24:27], v[72:75]
  v_mfma_f32_16x16x32_bf16 v[72:75], a[76:79], a[28:31], v[72:75]
  v_mfma_f32_16x16x32_bf16 v[76:79], a[92:95], a[28:31], 0
  v_mfma_f32_16x16x32_bf16 v[76:79], a[88:91], a[24:27], v[76:79]
  v_mfma_f32_16x16x32_bf16 v[76:79], a[84:87], a[20:23], v[76:79]
  v_mfma_f32_16x16x32_bf16 v[76:79], a[80:83], a[16:19], v[76:79]
  s_nop 7
  v_cmp_le_i32 vcc, 0, v86
  s_nop 1
  v_cndmask_b32 v64, v85, v64, vcc
  v_cmp_le_i32 vcc, 1, v86
  s_nop 1
  v_cndmask_b32 v65, v85, v65, vcc
  v_cmp_le_i32 vcc, 2, v86
  s_nop 1
  v_cndmask_b32 v66, v85, v66, vcc
  v_cmp_le_i32 vcc, 3, v86
  s_nop 1
  v_cndmask_b32 v67, v85, v67, vcc
  v_cmp_le_i32 vcc, 16, v86
  s_nop 1
  v_cndmask_b32 v68, v85, v68, vcc
  v_cmp_le_i32 vcc, 17, v86
  s_nop 1
  v_cndmask_b32 v69, v85, v69, vcc
  v_cmp_le_i32 vcc, 18, v86
  s_nop 1
  v_cndmask_b32 v70, v85, v70, vcc
  v_cmp_le_i32 vcc, 19, v86
  s_nop 1
  v_cndmask_b32 v71, v85, v71, vcc
  v_max3_f32 v83, v64, v65, v80
  v_max3_f32 v83, v66, v67, v83
  v_max3_f32 v83, v68, v69, v83
  v_max3_f32 v83, v70, v71, v83
  v_mov_b32 v84, v83
  s_nop 1
  v_permlane32_swap_b32 v83, v84
  s_nop 1
  v_max_f32 v83, v83, v84
  v_mov_b32 v84, v83
  s_nop 1
  v_permlane16_swap_b32 v83, v84
  s_nop 1
  v_max_f32 v83, v83, v84
  v_sub_f32 v82, v80, v83
  v_exp_f32 v82, v82
  v_mov_b32 v80, v83
  v_sub_f32 v64, v64, v83
  v_exp_f32 v64, v64
  v_sub_f32 v65, v65, v83
  v_exp_f32 v65, v65
  v_sub_f32 v66, v66, v83
  v_exp_f32 v66, v66
  v_sub_f32 v67, v67, v83
  v_exp_f32 v67, v67
  v_sub_f32 v68, v68, v83
  v_exp_f32 v68, v68
  v_sub_f32 v69, v69, v83
  v_exp_f32 v69, v69
  v_sub_f32 v70, v70, v83
  v_exp_f32 v70, v70
  v_sub_f32 v71, v71, v83
  v_exp_f32 v71, v71
  v_mul_f32 v96, v82, v96
  v_mul_f32 v97, v82, v97
  v_mul_f32 v98, v82, v98
  v_mul_f32 v99, v82, v99
  v_mul_f32 v100, v82, v100
  v_mul_f32 v101, v82, v101
  v_mul_f32 v102, v82, v102
  v_mul_f32 v103, v82, v103
  v_mul_f32 v104, v82, v104
  v_mul_f32 v105, v82, v105
  v_mul_f32 v106, v82, v106
  v_mul_f32 v107, v82, v107
  v_mul_f32 v108, v82, v108
  v_mul_f32 v109, v82, v109
  v_mul_f32 v110, v82, v110
  v_mul_f32 v111, v82, v111
  v_mul_f32 v112, v82, v112
  v_mul_f32 v113, v82, v113
  v_mul_f32 v114, v82, v114
  v_mul_f32 v115, v82, v115
  v_mul_f32 v116, v82, v116
  v_mul_f32 v117, v82, v117
  v_mul_f32 v118, v82, v118
  v_mul_f32 v119, v82, v119
  v_mul_f32 v120, v82, v120
  v_mul_f32 v121, v82, v121
  v_mul_f32 v122, v82, v122
  v_mul_f32 v123, v82, v123
  v_mul_f32 v124, v82, v124
  v_mul_f32 v125, v82, v125
  v_mul_f32 v126, v82, v126
  v_mul_f32 v127, v82, v127
  v_mul_f32 v32, v82, v32
  v_cvt_pk_bf16_f32 v48, v64, v65
  v_mul_f32 v33, v82, v33
  v_cvt_pk_bf16_f32 v49, v66, v67
  v_mul_f32 v34, v82, v34
  v_cvt_pk_bf16_f32 v50, v68, v69
  v_mul_f32 v35, v82, v35
  v_cvt_pk_bf16_f32 v51, v70, v71
  v_subrev_u32 v86, 32, v86
  v_cmp_le_i32 vcc, 0, v87
  s_nop 1
  v_cndmask_b32 v72, v85, v72, vcc
  v_cmp_le_i32 vcc, 1, v87
  s_nop 1
  v_cndmask_b32 v73, v85, v73, vcc
  v_cmp_le_i32 vcc, 2, v87
  s_nop 1
  v_cndmask_b32 v74, v85, v74, vcc
  v_cmp_le_i32 vcc, 3, v87
  s_nop 1
  v_cndmask_b32 v75, v85, v75, vcc
  v_cmp_le_i32 vcc, 16, v87
  s_nop 1
  v_cndmask_b32 v76, v85, v76, vcc
  v_cmp_le_i32 vcc, 17, v87
  s_nop 1
  v_cndmask_b32 v77, v85, v77, vcc
  v_cmp_le_i32 vcc, 18, v87
  s_nop 1
  v_cndmask_b32 v78, v85, v78, vcc
  v_cmp_le_i32 vcc, 19, v87
  s_nop 1
  v_cndmask_b32 v79, v85, v79, vcc
  v_max3_f32 v83, v72, v73, v81
  v_max3_f32 v83, v74, v75, v83
  v_max3_f32 v83, v76, v77, v83
  v_max3_f32 v83, v78, v79, v83
  v_mov_b32 v84, v83
  s_nop 1
  v_permlane32_swap_b32 v83, v84
  s_nop 1
  v_max_f32 v83, v83, v84
  v_mov_b32 v84, v83
  s_nop 1
  v_permlane16_swap_b32 v83, v84
  s_nop 1
  v_max_f32 v83, v83, v84
  v_sub_f32 v82, v81, v83
  v_exp_f32 v82, v82
  v_mov_b32 v81, v83
  v_sub_f32 v72, v72, v83
  v_exp_f32 v72, v72
  v_sub_f32 v73, v73, v83
  v_exp_f32 v73, v73
  v_sub_f32 v74, v74, v83
  v_exp_f32 v74, v74
  v_sub_f32 v75, v75, v83
  v_exp_f32 v75, v75
  v_sub_f32 v76, v76, v83
  v_exp_f32 v76, v76
  v_sub_f32 v77, v77, v83
  v_exp_f32 v77, v77
  v_sub_f32 v78, v78, v83
  v_exp_f32 v78, v78
  v_sub_f32 v79, v79, v83
  v_exp_f32 v79, v79
  v_mul_f32 v128, v82, v128
  v_mul_f32 v129, v82, v129
  v_mul_f32 v130, v82, v130
  v_mul_f32 v131, v82, v131
  v_mul_f32 v132, v82, v132
  v_mul_f32 v133, v82, v133
  v_mul_f32 v134, v82, v134
  v_mul_f32 v135, v82, v135
  v_mul_f32 v136, v82, v136
  v_mul_f32 v137, v82, v137
  v_mul_f32 v138, v82, v138
  v_mul_f32 v139, v82, v139
  v_mul_f32 v140, v82, v140
  v_mul_f32 v141, v82, v141
  v_mul_f32 v142, v82, v142
  v_mul_f32 v143, v82, v143
  v_mul_f32 v144, v82, v144
  v_mul_f32 v145, v82, v145
  v_mul_f32 v146, v82, v146
  v_mul_f32 v147, v82, v147
  v_mul_f32 v148, v82, v148
  v_mul_f32 v149, v82, v149
  v_mul_f32 v150, v82, v150
  v_mul_f32 v151, v82, v151
  v_mul_f32 v152, v82, v152
  v_mul_f32 v153, v82, v153
  v_mul_f32 v154, v82, v154
  v_mul_f32 v155, v82, v155
  v_mul_f32 v156, v82, v156
  v_mul_f32 v157, v82, v157
  v_mul_f32 v158, v82, v158
  v_mul_f32 v159, v82, v159
  v_mul_f32 v36, v82, v36
  v_cvt_pk_bf16_f32 v52, v72, v73
  v_mul_f32 v37, v82, v37
  v_cvt_pk_bf16_f32 v53, v74, v75
  v_mul_f32 v38, v82, v38
  v_cvt_pk_bf16_f32 v54, v76, v77
  v_mul_f32 v39, v82, v39
  v_cvt_pk_bf16_f32 v55, v78, v79
  v_subrev_u32 v87, 32, v87
  s_nop 1
  v_mfma_f32_16x16x32_bf16 v[96:99], a[96:99], v[48:51], v[96:99]
  v_mfma_f32_16x16x32_bf16 v[100:103], a[100:103], v[48:51], v[100:103]
  v_mfma_f32_16x16x32_bf16 v[104:107], a[104:107], v[48:51], v[104:107]
  v_mfma_f32_16x16x32_bf16 v[108:111], a[108:111], v[48:51], v[108:111]
  v_mfma_f32_16x16x32_bf16 v[112:115], a[208:211], v[48:51], v[112:115]
  v_mfma_f32_16x16x32_bf16 v[116:119], a[212:215], v[48:51], v[116:119]
  v_mfma_f32_16x16x32_bf16 v[120:123], a[216:219], v[48:51], v[120:123]
  v_mfma_f32_16x16x32_bf16 v[124:127], a[220:223], v[48:51], v[124:127]
  v_mfma_f32_16x16x32_bf16 v[32:35], v[12:15], v[48:51], v[32:35]
  v_mfma_f32_16x16x32_bf16 v[128:131], a[96:99], v[52:55], v[128:131]
  v_mfma_f32_16x16x32_bf16 v[132:135], a[100:103], v[52:55], v[132:135]
  v_mfma_f32_16x16x32_bf16 v[136:139], a[104:107], v[52:55], v[136:139]
  v_mfma_f32_16x16x32_bf16 v[140:143], a[108:111], v[52:55], v[140:143]
  v_mfma_f32_16x16x32_bf16 v[144:147], a[208:211], v[52:55], v[144:147]
  v_mfma_f32_16x16x32_bf16 v[148:151], a[212:215], v[52:55], v[148:151]
  v_mfma_f32_16x16x32_bf16 v[152:155], a[216:219], v[52:55], v[152:155]
  v_mfma_f32_16x16x32_bf16 v[156:159], a[220:223], v[52:55], v[156:159]
  v_mfma_f32_16x16x32_bf16 v[36:39], v[12:15], v[52:55], v[36:39]
  s_add_u32 s3, s3, 8192
  s_add_u32 s4, s4, 8192
  s_sub_u32 s5, s5, 1
  s_nop 7
  s_cmp_lg_u32 s5, 0
  s_cbranch_scc1 L_slowloop_25
  v_mov_b64 v[160:161], 0
  v_mov_b64 v[162:163], 0
  v_mov_b64 v[164:165], 0
  v_mov_b64 v[166:167], 0
  v_mov_b64 v[168:169], 0
  v_mov_b64 v[170:171], 0
  v_mov_b64 v[172:173], 0
  v_mov_b64 v[174:175], 0
  v_mov_b64 v[176:177], 0
  v_mov_b64 v[178:179], 0
  v_mov_b64 v[180:181], 0
  v_mov_b64 v[182:183], 0
  v_mov_b64 v[184:185], 0
  v_mov_b64 v[186:187], 0
  v_mov_b64 v[188:189], 0
  v_mov_b64 v[190:191], 0
  v_mov_b64 v[192:193], 0
  v_mov_b64 v[194:195], 0
  v_mov_b64 v[196:197], 0
  v_mov_b64 v[198:199], 0
  v_mov_b64 v[200:201], 0
  v_mov_b64 v[202:203], 0
  v_mov_b64 v[204:205], 0
  v_mov_b64 v[206:207], 0
  v_mov_b64 v[208:209], 0
  v_mov_b64 v[210:211], 0
  v_mov_b64 v[212:213], 0
  v_mov_b64 v[214:215], 0
  v_mov_b64 v[216:217], 0
  v_mov_b64 v[218:219], 0
  v_mov_b64 v[220:221], 0
  v_mov_b64 v[222:223], 0
  v_mov_b64 v[40:41], 0
  v_mov_b64 v[42:43], 0
  v_mov_b64 v[44:45], 0
  v_mov_b64 v[46:47], 0
  s_lshl_b32 s3, s37, 7
  s_add_u32 s3, s3, 64
  s_lshl_b32 s4, s39, 4
  s_add_u32 s3, s3, s4
  v_and_b32 v86, 15, v1
  v_add_u32 v86, s3, v86
  v_lshrrev_b32 v83, 4, v1
  v_lshlrev_b32 v83, 2, v83
  v_sub_u32 v86, v86, v83
  v_add_u32 v87, 32, v86
  v_mov_b32 v80, 0xff7fffff
  v_mov_b32 v81, 0xff7fffff
  v_mov_b32 v85, 0xff800000
  s_mul_i32 s3, s36, 532480
  s_add_u32 s4, s3, 17825792
  s_add_u32 s3, s3, 65536
  s_lshl_b32 s5, s37, 2
  s_add_u32 s5, s5, 4
L_slowloop_26:
  buffer_load_dwordx4 a[64:67], v0, s[16:19], s3 offen offset:0 sc1
  buffer_load_dwordx4 a[68:71], v0, s[16:19], s3 offen offset:1024 sc1
  buffer_load_dwordx4 a[72:75], v0, s[16:19], s3 offen offset:2048 sc1
  buffer_load_dwordx4 a[76:79], v0, s[16:19], s3 offen offset:3072 sc1
  buffer_load_dwordx4 a[80:83], v5, s[16:19], s3 offen offset:0 sc1
  buffer_load_dwordx4 a[84:87], v5, s[16:19], s3 offen offset:1024 sc1
  buffer_load_dwordx4 a[88:91], v5, s[16:19], s3 offen offset:2048 sc1
  buffer_load_dwordx4 a[92:95], v5, s[16:19], s3 offen offset:3072 sc1
  buffer_load_dwordx4 a[96:99], v0, s[16:19], s4 offen offset:0 sc1
  buffer_load_dwordx4 a[100:103], v0, s[16:19], s4 offen offset:1024 sc1
  buffer_load_dwordx4 a[104:107], v0, s[16:19], s4 offen offset:2048 sc1
  buffer_load_dwordx4 a[108:111], v0, s[16:19], s4 offen offset:3072 sc1
  buffer_load_dwordx4 a[208:211], v5, s[16:19], s4 offen offset:0 sc1
  buffer_load_dwordx4 a[212:215], v5, s[16:19], s4 offen offset:1024 sc1
  buffer_load_dwordx4 a[216:219], v5, s[16:19], s4 offen offset:2048 sc1
  buffer_load_dwordx4 a[220:223], v5, s[16:19], s4 offen offset:3072 sc1
  s_waitcnt vmcnt(0)
  v_mfma_f32_16x16x32_bf16 v[64:67], a[64:67], a[32:35], 0
  v_mfma_f32_16x16x32_bf16 v[64:67], a[68:71], a[36:39], v[64:67]
  v_mfma_f32_16x16x32_bf16 v[64:67], a[72:75], a[40:43], v[64:67]
  v_mfma_f32_16x16x32_bf16 v[64:67], a[76:79], a[44:47], v[64:67]
  v_mfma_f32_16x16x32_bf16 v[68:71], a[92:95], a[44:47], 0
  v_mfma_f32_16x16x32_bf16 v[68:71], a[88:91], a[40:43], v[68:71]
  v_mfma_f32_16x16x32_bf16 v[68:71], a[84:87], a[36:39], v[68:71]
  v_mfma_f32_16x16x32_bf16 v[68:71], a[80:83], a[32:35], v[68:71]
  v_mfma_f32_16x16x32_bf16 v[72:75], a[64:67], a[48:51], 0
  v_mfma_f32_16x16x32_bf16 v[72:75], a[68:71], a[52:55], v[72:75]
  v_mfma_f32_16x16x32_bf16 v[72:75], a[72:75], a[56:59], v[72:75]
  v_mfma_f32_16x16x32_bf16 v[72:75], a[76:79], a[60:63], v[72:75]
  v_mfma_f32_16x16x32_bf16 v[76:79], a[92:95], a[60:63], 0
  v_mfma_f32_16x16x32_bf16 v[76:79], a[88:91], a[56:59], v[76:79]
  v_mfma_f32_16x16x32_bf16 v[76:79], a[84:87], a[52:55], v[76:79]
  v_mfma_f32_16x16x32_bf16 v[76:79], a[80:83], a[48:51], v[76:79]
  s_nop 7
  v_cmp_le_i32 vcc, 0, v86
  s_nop 1
  v_cndmask_b32 v64, v85, v64, vcc
  v_cmp_le_i32 vcc, 1, v86
  s_nop 1
  v_cndmask_b32 v65, v85, v65, vcc
  v_cmp_le_i32 vcc, 2, v86
  s_nop 1
  v_cndmask_b32 v66, v85, v66, vcc
  v_cmp_le_i32 vcc, 3, v86
  s_nop 1
  v_cndmask_b32 v67, v85, v67, vcc
  v_cmp_le_i32 vcc, 16, v86
  s_nop 1
  v_cndmask_b32 v68, v85, v68, vcc
  v_cmp_le_i32 vcc, 17, v86
  s_nop 1
  v_cndmask_b32 v69, v85, v69, vcc
  v_cmp_le_i32 vcc, 18, v86
  s_nop 1
  v_cndmask_b32 v70, v85, v70, vcc
  v_cmp_le_i32 vcc, 19, v86
  s_nop 1
  v_cndmask_b32 v71, v85, v71, vcc
  v_max3_f32 v83, v64, v65, v80
  v_max3_f32 v83, v66, v67, v83
  v_max3_f32 v83, v68, v69, v83
  v_max3_f32 v83, v70, v71, v83
  v_mov_b32 v84, v83
  s_nop 1
  v_permlane32_swap_b32 v83, v84
  s_nop 1
  v_max_f32 v83, v83, v84
  v_mov_b32 v84, v83
  s_nop 1
  v_permlane16_swap_b32 v83, v84
  s_nop 1
  v_max_f32 v83, v83, v84
  v_sub_f32 v82, v80, v83
  v_exp_f32 v82, v82
  v_mov_b32 v80, v83
  v_sub_f32 v64, v64, v83
  v_exp_f32 v64, v64
  v_sub_f32 v65, v65, v83
  v_exp_f32 v65, v65
  v_sub_f32 v66, v66, v83
  v_exp_f32 v66, v66
  v_sub_f32 v67, v67, v83
  v_exp_f32 v67, v67
  v_sub_f32 v68, v68, v83
  v_exp_f32 v68, v68
  v_sub_f32 v69, v69, v83
  v_exp_f32 v69, v69
  v_sub_f32 v70, v70, v83
  v_exp_f32 v70, v70
  v_sub_f32 v71, v71, v83
  v_exp_f32 v71, v71
  v_mul_f32 v160, v82, v160
  v_mul_f32 v161, v82, v161
  v_mul_f32 v162, v82, v162
  v_mul_f32 v163, v82, v163
  v_mul_f32 v164, v82, v164
  v_mul_f32 v165, v82, v165
  v_mul_f32 v166, v82, v166
  v_mul_f32 v167, v82, v167
  v_mul_f32 v168, v82, v168
  v_mul_f32 v169, v82, v169
  v_mul_f32 v170, v82, v170
  v_mul_f32 v171, v82, v171
  v_mul_f32 v172, v82, v172
  v_mul_f32 v173, v82, v173
  v_mul_f32 v174, v82, v174
  v_mul_f32 v175, v82, v175
  v_mul_f32 v176, v82, v176
  v_mul_f32 v177, v82, v177
  v_mul_f32 v178, v82, v178
  v_mul_f32 v179, v82, v179
  v_mul_f32 v180, v82, v180
  v_mul_f32 v181, v82, v181
  v_mul_f32 v182, v82, v182
  v_mul_f32 v183, v82, v183
  v_mul_f32 v184, v82, v184
  v_mul_f32 v185, v82, v185
  v_mul_f32 v186, v82, v186
  v_mul_f32 v187, v82, v187
  v_mul_f32 v188, v82, v188
  v_mul_f32 v189, v82, v189
  v_mul_f32 v190, v82, v190
  v_mul_f32 v191, v82, v191
  v_mul_f32 v40, v82, v40
  v_cvt_pk_bf16_f32 v48, v64, v65
  v_mul_f32 v41, v82, v41
  v_cvt_pk_bf16_f32 v49, v66, v67
  v_mul_f32 v42, v82, v42
  v_cvt_pk_bf16_f32 v50, v68, v69
  v_mul_f32 v43, v82, v43
  v_cvt_pk_bf16_f32 v51, v70, v71
  v_subrev_u32 v86, 32, v86
  v_cmp_le_i32 vcc, 0, v87
  s_nop 1
  v_cndmask_b32 v72, v85, v72, vcc
  v_cmp_le_i32 vcc, 1, v87
  s_nop 1
  v_cndmask_b32 v73, v85, v73, vcc
  v_cmp_le_i32 vcc, 2, v87
  s_nop 1
  v_cndmask_b32 v74, v85, v74, vcc
  v_cmp_le_i32 vcc, 3, v87
  s_nop 1
  v_cndmask_b32 v75, v85, v75, vcc
  v_cmp_le_i32 vcc, 16, v87
  s_nop 1
  v_cndmask_b32 v76, v85, v76, vcc
  v_cmp_le_i32 vcc, 17, v87
  s_nop 1
  v_cndmask_b32 v77, v85, v77, vcc
  v_cmp_le_i32 vcc, 18, v87
  s_nop 1
  v_cndmask_b32 v78, v85, v78, vcc
  v_cmp_le_i32 vcc, 19, v87
  s_nop 1
  v_cndmask_b32 v79, v85, v79, vcc
  v_max3_f32 v83, v72, v73, v81
  v_max3_f32 v83, v74, v75, v83
  v_max3_f32 v83, v76, v77, v83
  v_max3_f32 v83, v78, v79, v83
  v_mov_b32 v84, v83
  s_nop 1
  v_permlane32_swap_b32 v83, v84
  s_nop 1
  v_max_f32 v83, v83, v84
  v_mov_b32 v84, v83
  s_nop 1
  v_permlane16_swap_b32 v83, v84
  s_nop 1
  v_max_f32 v83, v83, v84
  v_sub_f32 v82, v81, v83
  v_exp_f32 v82, v82
  v_mov_b32 v81, v83
  v_sub_f32 v72, v72, v83
  v_exp_f32 v72, v72
  v_sub_f32 v73, v73, v83
  v_exp_f32 v73, v73
  v_sub_f32 v74, v74, v83
  v_exp_f32 v74, v74
  v_sub_f32 v75, v75, v83
  v_exp_f32 v75, v75
  v_sub_f32 v76, v76, v83
  v_exp_f32 v76, v76
  v_sub_f32 v77, v77, v83
  v_exp_f32 v77, v77
  v_sub_f32 v78, v78, v83
  v_exp_f32 v78, v78
  v_sub_f32 v79, v79, v83
  v_exp_f32 v79, v79
  v_mul_f32 v192, v82, v192
  v_mul_f32 v193, v82, v193
  v_mul_f32 v194, v82, v194
  v_mul_f32 v195, v82, v195
  v_mul_f32 v196, v82, v196
  v_mul_f32 v197, v82, v197
  v_mul_f32 v198, v82, v198
  v_mul_f32 v199, v82, v199
  v_mul_f32 v200, v82, v200
  v_mul_f32 v201, v82, v201
  v_mul_f32 v202, v82, v202
  v_mul_f32 v203, v82, v203
  v_mul_f32 v204, v82, v204
  v_mul_f32 v205, v82, v205
  v_mul_f32 v206, v82, v206
  v_mul_f32 v207, v82, v207
  v_mul_f32 v208, v82, v208
  v_mul_f32 v209, v82, v209
  v_mul_f32 v210, v82, v210
  v_mul_f32 v211, v82, v211
  v_mul_f32 v212, v82, v212
  v_mul_f32 v213, v82, v213
  v_mul_f32 v214, v82, v214
  v_mul_f32 v215, v82, v215
  v_mul_f32 v216, v82, v216
  v_mul_f32 v217, v82, v217
  v_mul_f32 v218, v82, v218
  v_mul_f32 v219, v82, v219
  v_mul_f32 v220, v82, v220
  v_mul_f32 v221, v82, v221
  v_mul_f32 v222, v82, v222
  v_mul_f32 v223, v82, v223
  v_mul_f32 v44, v82, v44
  v_cvt_pk_bf16_f32 v52, v72, v73
  v_mul_f32 v45, v82, v45
  v_cvt_pk_bf16_f32 v53, v74, v75
  v_mul_f32 v46, v82, v46
  v_cvt_pk_bf16_f32 v54, v76, v77
  v_mul_f32 v47, v82, v47
  v_cvt_pk_bf16_f32 v55, v78, v79
  v_subrev_u32 v87, 32, v87
  s_nop 1
  v_mfma_f32_16x16x32_bf16 v[160:163], a[96:99], v[48:51], v[160:163]
  v_mfma_f32_16x16x32_bf16 v[164:167], a[100:103], v[48:51], v[164:167]
  v_mfma_f32_16x16x32_bf16 v[168:171], a[104:107], v[48:51], v[168:171]
  v_mfma_f32_16x16x32_bf16 v[172:175], a[108:111], v[48:51], v[172:175]
  v_mfma_f32_16x16x32_bf16 v[176:179], a[208:211], v[48:51], v[176:179]
  v_mfma_f32_16x16x32_bf16 v[180:183], a[212:215], v[48:51], v[180:183]
  v_mfma_f32_16x16x32_bf16 v[184:187], a[216:219], v[48:51], v[184:187]
  v_mfma_f32_16x16x32_bf16 v[188:191], a[220:223], v[48:51], v[188:191]
  v_mfma_f32_16x16x32_bf16 v[40:43], v[12:15], v[48:51], v[40:43]
  v_mfma_f32_16x16x32_bf16 v[192:195], a[96:99], v[52:55], v[192:195]
  v_mfma_f32_16x16x32_bf16 v[196:199], a[100:103], v[52:55], v[196:199]
  v_mfma_f32_16x16x32_bf16 v[200:203], a[104:107], v[52:55], v[200:203]
  v_mfma_f32_16x16x32_bf16 v[204:207], a[108:111], v[52:55], v[204:207]
  v_mfma_f32_16x16x32_bf16 v[208:211], a[208:211], v[52:55], v[208:211]
  v_mfma_f32_16x16x32_bf16 v[212:215], a[212:215], v[52:55], v[212:215]
  v_mfma_f32_16x16x32_bf16 v[216:219], a[216:219], v[52:55], v[216:219]
  v_mfma_f32_16x16x32_bf16 v[220:223], a[220:223], v[52:55], v[220:223]
  v_mfma_f32_16x16x32_bf16 v[44:47], v[12:15], v[52:55], v[44:47]
  s_add_u32 s3, s3, 8192
  s_add_u32 s4, s4, 8192
  s_sub_u32 s5, s5, 1
  s_nop 7
  s_cmp_lg_u32 s5, 0
  s_cbranch_scc1 L_slowloop_26
  s_cmp_eq_u32 s37, 0
  s_cbranch_scc1 L_slowj1back
  s_branch L_slowj0back
L_slowf0:
L_slowf1:
  s_waitcnt vmcnt(0) lgkmcnt(0)
  v_mov_b64 v[160:161], 0
  v_mov_b64 v[162:163], 0
  v_mov_b64 v[164:165], 0
  v_mov_b64 v[166:167], 0
  v_mov_b64 v[168:169], 0
  v_mov_b64 v[170:171], 0
  v_mov_b64 v[172:173], 0
  v_mov_b64 v[174:175], 0
  v_mov_b64 v[176:177], 0
  v_mov_b64 v[178:179], 0
  v_mov_b64 v[180:181], 0
  v_mov_b64 v[182:183], 0
  v_mov_b64 v[184:185], 0
  v_mov_b64 v[186:187], 0
  v_mov_b64 v[188:189], 0
  v_mov_b64 v[190:191], 0
  v_mov_b64 v[192:193], 0
  v_mov_b64 v[194:195], 0
  v_mov_b64 v[196:197], 0
  v_mov_b64 v[198:199], 0
  v_mov_b64 v[200:201], 0
  v_mov_b64 v[202:203], 0
  v_mov_b64 v[204:205], 0
  v_mov_b64 v[206:207], 0
  v_mov_b64 v[208:209], 0
  v_mov_b64 v[210:211], 0
  v_mov_b64 v[212:213], 0
  v_mov_b64 v[214:215], 0
  v_mov_b64 v[216:217], 0
  v_mov_b64 v[218:219], 0
  v_mov_b64 v[220:221], 0
  v_mov_b64 v[222:223], 0
  v_mov_b64 v[96:97], 0
  v_mov_b64 v[98:99], 0
  v_mov_b64 v[100:101], 0
  v_mov_b64 v[102:103], 0
  v_mov_b64 v[104:105], 0
  v_mov_b64 v[106:107], 0
  v_mov_b64 v[108:109], 0
  v_mov_b64 v[110:111], 0
  v_mov_b64 v[112:113], 0
  v_mov_b64 v[114:115], 0
  v_mov_b64 v[116:117], 0
  v_mov_b64 v[118:119], 0
  v_mov_b64 v[120:121], 0
  v_mov_b64 v[122:123], 0
  v_mov_b64 v[124:125], 0
  v_mov_b64 v[126:127], 0
  v_mov_b64 v[128:129], 0
  v_mov_b64 v[130:131], 0
  v_mov_b64 v[132:133], 0
  v_mov_b64 v[134:135], 0
  v_mov_b64 v[136:137], 0
  v_mov_b64 v[138:139], 0
  v_mov_b64 v[140:141], 0
  v_mov_b64 v[142:143], 0
  v_mov_b64 v[144:145], 0
  v_mov_b64 v[146:147], 0
  v_mov_b64 v[148:149], 0
  v_mov_b64 v[150:151], 0
  v_mov_b64 v[152:153], 0
  v_mov_b64 v[154:155], 0
  v_mov_b64 v[156:157], 0
  v_mov_b64 v[158:159], 0
  v_mov_b64 v[32:33], 0
  v_mov_b64 v[34:35], 0
  v_mov_b64 v[36:37], 0
  v_mov_b64 v[38:39], 0
  s_sub_u32 s3, 15, s37
  s_lshl_b32 s3, s3, 1
  s_add_u32 s3, s3, s40
  s_lshl_b32 s3, s3, 6
  s_lshl_b32 s4, s39, 4
  s_add_u32 s3, s3, s4
  v_and_b32 v86, 15, v1
  v_add_u32 v86, s3, v86
  v_lshrrev_b32 v83, 4, v1
  v_lshlrev_b32 v83, 2, v83
  v_sub_u32 v86, v86, v83
  v_add_u32 v87, 32, v86
  v_mov_b32 v80, 0xff7fffff
  v_mov_b32 v81, 0xff7fffff
  v_mov_b32 v85, 0xff800000
  s_mul_i32 s3, s36, 532480
  s_add_u32 s4, s3, 17825792
  s_add_u32 s3, s3, 65536
  s_lshl_b32 s5, s37, 2
  s_sub_u32 s5, 64, s5
L_slowloop_27:
  buffer_load_dwordx4 a[64:67], v0, s[16:19], s3 offen offset:0 sc1
  buffer_load_dwordx4 a[68:71], v0, s[16:19], s3 offen offset:1024 sc1
  buffer_load_dwordx4 a[72:75], v0, s[16:19], s3 offen offset:2048 sc1
  buffer_load_dwordx4 a[76:79], v0, s[16:19], s3 offen offset:3072 sc1
  buffer_load_dwordx4 a[80:83], v5, s[16:19], s3 offen offset:0 sc1
  buffer_load_dwordx4 a[84:87], v5, s[16:19], s3 offen offset:1024 sc1
  buffer_load_dwordx4 a[88:91], v5, s[16:19], s3 offen offset:2048 sc1
  buffer_load_dwordx4 a[92:95], v5, s[16:19], s3 offen offset:3072 sc1
  buffer_load_dwordx4 a[96:99], v0, s[16:19], s4 offen offset:0 sc1
  buffer_load_dwordx4 a[100:103], v0, s[16:19], s4 offen offset:1024 sc1
  buffer_load_dwordx4 a[104:107], v0, s[16:19], s4 offen offset:2048 sc1
  buffer_load_dwordx4 a[108:111], v0, s[16:19], s4 offen offset:3072 sc1
  buffer_load_dwordx4 a[208:211], v5, s[16:19], s4 offen offset:0 sc1
  buffer_load_dwordx4 a[212:215], v5, s[16:19], s4 offen offset:1024 sc1
  buffer_load_dwordx4 a[216:219], v5, s[16:19], s4 offen offset:2048 sc1
  buffer_load_dwordx4 a[220:223], v5, s[16:19], s4 offen offset:3072 sc1
  s_waitcnt vmcnt(0)
  v_mfma_f32_16x16x32_bf16 v[64:67], a[64:67], a[0:3], 0
  v_mfma_f32_16x16x32_bf16 v[64:67], a[68:71], a[4:7], v[64:67]
  v_mfma_f32_16x16x32_bf16 v[64:67], a[72:75], a[8:11], v[64:67]
  v_mfma_f32_16x16x32_bf16 v[64:67], a[76:79], a[12:15], v[64:67]
  v_mfma_f32_16x16x32_bf16 v[68:71], a[92:95], a[12:15], 0
  v_mfma_f32_16x16x32_bf16 v[68:71], a[88:91], a[8:11], v[68:71]
  v_mfma_f32_16x16x32_bf16 v[68:71], a[84:87], a[4:7], v[68:71]
  v_mfma_f32_16x16x32_bf16 v[68:71], a[80:83], a[0:3], v[68:71]
  v_mfma_f32_16x16x32_bf16 v[72:75], a[64:67], a[16:19], 0
  v_mfma_f32_16x16x32_bf16 v[72:75], a[68:71], a[20:23], v[72:75]
  v_mfma_f32_16x16x32_bf16 v[72:75], a[72:75], a[24:27], v[72:75]
  v_mfma_f32_16x16x32_bf16 v[72:75], a[76:79], a[28:31], v[72:75]
  v_mfma_f32_16x16x32_bf16 v[76:79], a[92:95], a[28:31], 0
  v_mfma_f32_16x16x32_bf16 v[76:79], a[88:91], a[24:27], v[76:79]
  v_mfma_f32_16x16x32_bf16 v[76:79], a[84:87], a[20:23], v[76:79]
  v_mfma_f32_16x16x32_bf16 v[76:79], a[80:83], a[16:19], v[76:79]
  s_nop 7
  v_cmp_le_i32 vcc, 0, v86
  s_nop 1
  v_cndmask_b32 v64, v85, v64, vcc
  v_cmp_le_i32 vcc, 1, v86
  s_nop 1
  v_cndmask_b32 v65, v85, v65, vcc
  v_cmp_le_i32 vcc, 2, v86
  s_nop 1
  v_cndmask_b32 v66, v85, v66, vcc
  v_cmp_le_i32 vcc, 3, v86
  s_nop 1
  v_cndmask_b32 v67, v85, v67, vcc
  v_cmp_le_i32 vcc, 16, v86
  s_nop 1
  v_cndmask_b32 v68, v85, v68, vcc
  v_cmp_le_i32 vcc, 17, v86
  s_nop 1
  v_cndmask_b32 v69, v85, v69, vcc
  v_cmp_le_i32 vcc, 18, v86
  s_nop 1
  v_cndmask_b32 v70, v85, v70, vcc
  v_cmp_le_i32 vcc, 19, v86
  s_nop 1
  v_cndmask_b32 v71, v85, v71, vcc
  v_max3_f32 v83, v64, v65, v80
  v_max3_f32 v83, v66, v67, v83
  v_max3_f32 v83, v68, v69, v83
  v_max3_f32 v83, v70, v71, v83
  v_mov_b32 v84, v83
  s_nop 1
  v_permlane32_swap_b32 v83, v84
  s_nop 1
  v_max_f32 v83, v83, v84
  v_mov_b32 v84, v83
  s_nop 1
  v_permlane16_swap_b32 v83, v84
  s_nop 1
  v_max_f32 v83, v83, v84
  v_sub_f32 v82, v80, v83
  v_exp_f32 v82, v82
  v_mov_b32 v80, v83
  v_sub_f32 v64, v64, v83
  v_exp_f32 v64, v64
  v_sub_f32 v65, v65, v83
  v_exp_f32 v65, v65
  v_sub_f32 v66, v66, v83
  v_exp_f32 v66, v66
  v_sub_f32 v67, v67, v83
  v_exp_f32 v67, v67
  v_sub_f32 v68, v68, v83
  v_exp_f32 v68, v68
  v_sub_f32 v69, v69, v83
  v_exp_f32 v69, v69
  v_sub_f32 v70, v70, v83
  v_exp_f32 v70, v70
  v_sub_f32 v71, v71, v83
  v_exp_f32 v71, v71
  v_mul_f32 v96, v82, v96
  v_mul_f32 v97, v82, v97
  v_mul_f32 v98, v82, v98
  v_mul_f32 v99, v82, v99
  v_mul_f32 v100, v82, v100
  v_mul_f32 v101, v82, v101
  v_mul_f32 v102, v82, v102
  v_mul_f32 v103, v82, v103
  v_mul_f32 v104, v82, v104
  v_mul_f32 v105, v82, v105
  v_mul_f32 v106, v82, v106
  v_mul_f32 v107, v82, v107
  v_mul_f32 v108, v82, v108
  v_mul_f32 v109, v82, v109
  v_mul_f32 v110, v82, v110
  v_mul_f32 v111, v82, v111
  v_mul_f32 v112, v82, v112
  v_mul_f32 v113, v82, v113
  v_mul_f32 v114, v82, v114
  v_mul_f32 v115, v82, v115
  v_mul_f32 v116, v82, v116
  v_mul_f32 v117, v82, v117
  v_mul_f32 v118, v82, v118
  v_mul_f32 v119, v82, v119
  v_mul_f32 v120, v82, v120
  v_mul_f32 v121, v82, v121
  v_mul_f32 v122, v82, v122
  v_mul_f32 v123, v82, v123
  v_mul_f32 v124, v82, v124
  v_mul_f32 v125, v82, v125
  v_mul_f32 v126, v82, v126
  v_mul_f32 v127, v82, v127
  v_mul_f32 v32, v82, v32
  v_cvt_pk_bf16_f32 v48, v64, v65
  v_mul_f32 v33, v82, v33
  v_cvt_pk_bf16_f32 v49, v66, v67
  v_mul_f32 v34, v82, v34
  v_cvt_pk_bf16_f32 v50, v68, v69
  v_mul_f32 v35, v82, v35
  v_cvt_pk_bf16_f32 v51, v70, v71
  v_subrev_u32 v86, 32, v86
  v_cmp_le_i32 vcc, 0, v87
  s_nop 1
  v_cndmask_b32 v72, v85, v72, vcc
  v_cmp_le_i32 vcc, 1, v87
  s_nop 1
  v_cndmask_b32 v73, v85, v73, vcc
  v_cmp_le_i32 vcc, 2, v87
  s_nop 1
  v_cndmask_b32 v74, v85, v74, vcc
  v_cmp_le_i32 vcc, 3, v87
  s_nop 1
  v_cndmask_b32 v75, v85, v75, vcc
  v_cmp_le_i32 vcc, 16, v87
  s_nop 1
  v_cndmask_b32 v76, v85, v76, vcc
  v_cmp_le_i32 vcc, 17, v87
  s_nop 1
  v_cndmask_b32 v77, v85, v77, vcc
  v_cmp_le_i32 vcc, 18, v87
  s_nop 1
  v_cndmask_b32 v78, v85, v78, vcc
  v_cmp_le_i32 vcc, 19, v87
  s_nop 1
  v_cndmask_b32 v79, v85, v79, vcc
  v_max3_f32 v83, v72, v73, v81
  v_max3_f32 v83, v74, v75, v83
  v_max3_f32 v83, v76, v77, v83
  v_max3_f32 v83, v78, v79, v83
  v_mov_b32 v84, v83
  s_nop 1
  v_permlane32_swap_b32 v83, v84
  s_nop 1
  v_max_f32 v83, v83, v84
  v_mov_b32 v84, v83
  s_nop 1
  v_permlane16_swap_b32 v83, v84
  s_nop 1
  v_max_f32 v83, v83, v84
  v_sub_f32 v82, v81, v83
  v_exp_f32 v82, v82
  v_mov_b32 v81, v83
  v_sub_f32 v72, v72, v83
  v_exp_f32 v72, v72
  v_sub_f32 v73, v73, v83
  v_exp_f32 v73, v73
  v_sub_f32 v74, v74, v83
  v_exp_f32 v74, v74
  v_sub_f32 v75, v75, v83
  v_exp_f32 v75, v75
  v_sub_f32 v76, v76, v83
  v_exp_f32 v76, v76
  v_sub_f32 v77, v77, v83
  v_exp_f32 v77, v77
  v_sub_f32 v78, v78, v83
  v_exp_f32 v78, v78
  v_sub_f32 v79, v79, v83
  v_exp_f32 v79, v79
  v_mul_f32 v128, v82, v128
  v_mul_f32 v129, v82, v129
  v_mul_f32 v130, v82, v130
  v_mul_f32 v131, v82, v131
  v_mul_f32 v132, v82, v132
  v_mul_f32 v133, v82, v133
  v_mul_f32 v134, v82, v134
  v_mul_f32 v135, v82, v135
  v_mul_f32 v136, v82, v136
  v_mul_f32 v137, v82, v137
  v_mul_f32 v138, v82, v138
  v_mul_f32 v139, v82, v139
  v_mul_f32 v140, v82, v140
  v_mul_f32 v141, v82, v141
  v_mul_f32 v142, v82, v142
  v_mul_f32 v143, v82, v143
  v_mul_f32 v144, v82, v144
  v_mul_f32 v145, v82, v145
  v_mul_f32 v146, v82, v146
  v_mul_f32 v147, v82, v147
  v_mul_f32 v148, v82, v148
  v_mul_f32 v149, v82, v149
  v_mul_f32 v150, v82, v150
  v_mul_f32 v151, v82, v151
  v_mul_f32 v152, v82, v152
  v_mul_f32 v153, v82, v153
  v_mul_f32 v154, v82, v154
  v_mul_f32 v155, v82, v155
  v_mul_f32 v156, v82, v156
  v_mul_f32 v157, v82, v157
  v_mul_f32 v158, v82, v158
  v_mul_f32 v159, v82, v159
  v_mul_f32 v36, v82, v36
  v_cvt_pk_bf16_f32 v52, v72, v73
  v_mul_f32 v37, v82, v37
  v_cvt_pk_bf16_f32 v53, v74, v75
  v_mul_f32 v38, v82, v38
  v_cvt_pk_bf16_f32 v54, v76, v77
  v_mul_f32 v39, v82, v39
  v_cvt_pk_bf16_f32 v55, v78, v79
  v_subrev_u32 v87, 32, v87
  s_nop 1
  v_mfma_f32_16x16x32_bf16 v[96:99], a[96:99], v[48:51], v[96:99]
  v_mfma_f32_16x16x32_bf16 v[100:103], a[100:103], v[48:51], v[100:103]
  v_mfma_f32_16x16x32_bf16 v[104:107], a[104:107], v[48:51], v[104:107]
  v_mfma_f32_16x16x32_bf16 v[108:111], a[108:111], v[48:51], v[108:111]
  v_mfma_f32_16x16x32_bf16 v[112:115], a[208:211], v[48:51], v[112:115]
  v_mfma_f32_16x16x32_bf16 v[116:119], a[212:215], v[48:51], v[116:119]
  v_mfma_f32_16x16x32_bf16 v[120:123], a[216:219], v[48:51], v[120:123]
  v_mfma_f32_16x16x32_bf16 v[124:127], a[220:223], v[48:51], v[124:127]
  v_mfma_f32_16x16x32_bf16 v[32:35], v[12:15], v[48:51], v[32:35]
  v_mfma_f32_16x16x32_bf16 v[128:131], a[96:99], v[52:55], v[128:131]
  v_mfma_f32_16x16x32_bf16 v[132:135], a[100:103], v[52:55], v[132:135]
  v_mfma_f32_16x16x32_bf16 v[136:139], a[104:107], v[52:55], v[136:139]
  v_mfma_f32_16x16x32_bf16 v[140:143], a[108:111], v[52:55], v[140:143]
  v_mfma_f32_16x16x32_bf16 v[144:147], a[208:211], v[52:55], v[144:147]
  v_mfma_f32_16x16x32_bf16 v[148:151], a[212:215], v[52:55], v[148:151]
  v_mfma_f32_16x16x32_bf16 v[152:155], a[216:219], v[52:55], v[152:155]
  v_mfma_f32_16x16x32_bf16 v[156:159], a[220:223], v[52:55], v[156:159]
  v_mfma_f32_16x16x32_bf16 v[36:39], v[12:15], v[52:55], v[36:39]
  s_add_u32 s3, s3, 8192
  s_add_u32 s4, s4, 8192
  s_sub_u32 s5, s5, 1
  s_nop 7
  s_cmp_lg_u32 s5, 0
  s_cbranch_scc1 L_slowloop_27
  s_cmp_eq_u32 s40, 0
  s_cbranch_scc1 L_slowf0back
  s_branch L_slowf1back
L_ctx_28:
  s_mov_b32 s63, 0x40000
L_ctxloop_30:
  s_sleep 2
  buffer_load_dword v30, v22, s[16:19], s6 offen sc1
  s_sub_u32 s63, s63, 1
  s_cmp_eq_u32 s63, 0
  s_waitcnt vmcnt(0)
  s_cbranch_scc1 L_ctxback_29
  v_cmp_eq_u32 vcc, 0, v30
  s_cbranch_vccnz L_ctxloop_30
  s_branch L_ctxback_29
L_hint_31:
  s_mov_b32 s63, 0x40000
L_hintloop_33:
  s_sleep 1
  buffer_load_dword v30, v22, s[16:19], s93 offen sc1
  s_sub_u32 s63, s63, 1
  s_cmp_eq_u32 s63, 0
  s_waitcnt vmcnt(0)
  s_cbranch_scc1 L_hintback_32
  v_cmp_eq_u32 vcc, -1, v30
  s_cbranch_vccnz L_hintloop_33
  s_branch L_hintback_32
L_px_34:
  s_mov_b32 s63, 0x40000
L_pxloop_36:
  s_sleep 1
  buffer_load_dwordx4 v[52:55], v9, s[16:19], s64 offen offset:0 sc1
  buffer_load_dwordx4 v[56:59], v9, s[16:19], s64 offen offset:1024 sc1
  buffer_load_dwordx2 v[60:61], v10, s[16:19], s64 offen sc1
  buffer_load_dwordx4 v[72:75], v9, s[16:19], s65 offen offset:0 sc1
  buffer_load_dwordx4 v[76:79], v9, s[16:19], s65 offen offset:1024 sc1
  buffer_load_dwordx2 v[80:81], v10, s[16:19], s65 offen sc1
  buffer_load_dwordx4 v[92:95], v9, s[16:19], s66 offen offset:0 sc1
  buffer_load_dwordx4 v[96:99], v9, s[16:19], s66 offen offset:1024 sc1
  buffer_load_dwordx2 v[100:101], v10, s[16:19], s66 offen sc1
  s_sub_u32 s63, s63, 1
  s_cmp_eq_u32 s63, 0
  s_waitcnt vmcnt(0)
  s_cbranch_scc1 L_pxback_35
  v_max3_u32 v31, v52, v56, v60
  v_cmp_eq_u32 vcc, -1, v31
  s_cbranch_vccnz L_pxloop_36
  s_branch L_pxback_35
L_px_37:
  s_mov_b32 s63, 0x40000
L_pxloop_39:
  s_sleep 1
  buffer_load_dwordx4 v[72:75], v9, s[16:19], s65 offen offset:0 sc1
  buffer_load_dwordx4 v[76:79], v9, s[16:19], s65 offen offset:1024 sc1
  buffer_load_dwordx2 v[80:81], v10, s[16:19], s65 offen sc1
  buffer_load_dwordx4 v[92:95], v9, s[16:19], s66 offen offset:0 sc1
  buffer_load_dwordx4 v[96:99], v9, s[16:19], s66 offen offset:1024 sc1
  buffer_load_dwordx2 v[100:101], v10, s[16:19], s66 offen sc1
  s_sub_u32 s63, s63, 1
  s_cmp_eq_u32 s63, 0
  s_waitcnt vmcnt(0)
  s_cbranch_scc1 L_pxback_38
  v_max3_u32 v31, v72, v76, v80
  v_cmp_eq_u32 vcc, -1, v31
  s_cbranch_vccnz L_pxloop_39
  s_branch L_pxback_38
L_px_40:
  s_mov_b32 s63, 0x40000
L_pxloop_42:
  s_sleep 1
  buffer_load_dwordx4 v[92:95], v9, s[16:19], s66 offen offset:0 sc1
  buffer_load_dwordx4 v[96:99], v9, s[16:19], s66 offen offset:1024 sc1
  buffer_load_dwordx2 v[100:101], v10, s[16:19], s66 offen sc1
  s_sub_u32 s63, s63, 1
  s_cmp_eq_u32 s63, 0
  s_waitcnt vmcnt(0)
  s_cbranch_scc1 L_pxback_41
  v_max3_u32 v31, v92, v96, v100
  v_cmp_eq_u32 vcc, -1, v31
  s_cbranch_vccnz L_pxloop_42
  s_branch L_pxback_41
L_codeend:
.section .rodata,"a"
.p2align 6
.amdhsa_kernel gated_mix__compressed_kv_cla__dense_activation_mish__prompt_kernel
  .amdhsa_next_free_vgpr 512
  .amdhsa_next_free_sgpr 102
  .amdhsa_accum_offset 256
  .amdhsa_group_segment_fixed_size 0
  .amdhsa_kernarg_size 112
  .amdhsa_user_sgpr_count 2
  .amdhsa_user_sgpr_kernarg_segment_ptr 1
  .amdhsa_system_sgpr_workgroup_id_x 1
.end_amdhsa_kernel
```
